```python
import torch

def _softmax(x, axis=-1):
    return torch.softmax(x, dim=axis)
def _gelu(x):
    return torch.nn.functional.gelu(x, approximate="tanh")
def _silu(x):
    return torch.nn.functional.silu(x)
def _sigmoid(x):
    return torch.sigmoid(x)
def _layernorm(x, axis=-1, eps=1e-5):
    m = x.mean(dim=axis, keepdim=True)
    v = x.var(dim=axis, keepdim=True, unbiased=False)
    return (x - m) / torch.sqrt(v + eps)
def _scatter_add(tgt, idx, src, axis=0):
    return tgt.clone().index_add_(axis, idx, src)
def _segment_sum(src, seg, n):
    out = torch.zeros((n,) + src.shape[1:], dtype=src.dtype)
    return out.index_add_(0, seg, src)
def _pad(x, pw):
    flat = tuple(v for pair in reversed(pw) for v in pair)
    return torch.nn.functional.pad(x, flat)

kernel_name = 'gated_mix__linear_kernel_hedgehog__grouped_kv_mqa__prompt'

def setup_inputs():

    _w = (lambda a: (lambda t: t.to(torch.bfloat16) if t.is_floating_point() else t)(torch.as_tensor(a)))
    def _A_setup():
        B, S, D, H = 1, 2048, 640, 32
        Dh = D // H
        return {
            "x": _w((lambda *s: torch.randn(*s, dtype=torch.bfloat16) * 0.05)(B, S, D)),
            "wqkv": _w((lambda *s: torch.randn(*s, dtype=torch.bfloat16) * 1.6)(D, 3 * D)),
            "w_phi": _w((lambda *s: torch.randn(*s, dtype=torch.bfloat16) * 1.6)(H, Dh, Dh) * (Dh ** -0.5)),
            "wo": _w((lambda *s: torch.randn(*s, dtype=torch.bfloat16) * 0.05)(D, D)),
        }
    _A_in = _A_setup()

    def _B_setup():
        B, S, D, H = 1, 2048, 640, 32
        Dh = D // H
        return {
            "x": _w((lambda *s: torch.randn(*s, dtype=torch.bfloat16) * 0.05)(B, S, D)),
            "wq": _w((lambda *s: torch.randn(*s, dtype=torch.bfloat16) * 1.6)(D, H * Dh)),
            "wk": _w((lambda *s: torch.randn(*s, dtype=torch.bfloat16) * 1.6)(D, Dh)),
            "wv": _w((lambda *s: torch.randn(*s, dtype=torch.bfloat16) * 0.05)(D, Dh)),
            "wo": _w((lambda *s: torch.randn(*s, dtype=torch.bfloat16) * 0.05)(H * Dh, D)),
        }
    _B_in = _B_setup()

    return {
        "A_x": _A_in["x"],
        "A_wqkv": _A_in["wqkv"],
        "A_w_phi": _A_in["w_phi"],
        "A_wo": _A_in["wo"],
        "B_x": _B_in["x"],
        "B_wq": _B_in["wq"],
        "B_wk": _B_in["wk"],
        "B_wv": _B_in["wv"],
        "B_wo": _B_in["wo"],
        "gate_w": _w((lambda *s: torch.randn(*s, dtype=torch.bfloat16) * 0.05)(640) * 16.0),
    }

def reference(A_x, A_wqkv, A_w_phi, A_wo, B_x, B_wq, B_wk, B_wv, B_wo, gate_w):
    def _A_ref(x, wqkv, w_phi, wo):
        B, S, D = x.shape
        H = 32; Dh = D // H
        qkv = (lambda x, *d: x.permute(*d))((x @ wqkv).reshape(B, S, 3, H, Dh), 2, 0, 3, 1, 4)
        q, k, v = qkv[0], qkv[1], qkv[2]
        pq = torch.einsum("bhsd,hdf->bhsf", q, w_phi)
        pk = torch.einsum("bhsd,hdf->bhsf", k, w_phi)
        phi_q = torch.concatenate([_softmax(pq, axis=-1), _softmax(-pq, axis=-1)], axis=-1)
        phi_k = torch.concatenate([_softmax(pk, axis=-1), _softmax(-pk, axis=-1)], axis=-1)
        kv = torch.einsum("bhsf,bhsd->bhfd", phi_k, v)
        z  = torch.einsum("bhsf->bhf", phi_k)
        num = torch.einsum("bhqf,bhfd->bhqd", phi_q, kv)
        den = torch.einsum("bhqf,bhf->bhq", phi_q, z)[..., None] + 1e-6
        o = num / den
        return (lambda x, *d: x.permute(*d))(o, 0, 2, 1, 3).reshape(B, S, D) @ wo

    def _B_ref(x, wq, wk, wv, wo):
        B, S, D = x.shape
        H = 32
        Dh = D // H
        q = (lambda x, *d: x.permute(*d))((x @ wq).reshape(B, S, H, Dh), 0, 2, 1, 3)
        k = x @ wk
        v = x @ wv
        scores = torch.einsum("bhqd,bkd->bhqk", q, k) * (Dh ** -0.5)
        p = _softmax(scores, axis=-1)
        o = torch.einsum("bhqk,bkd->bhqd", p, v)
        return (lambda x, *d: x.permute(*d))(o, 0, 2, 1, 3).reshape(B, S, H * Dh) @ wo

    x = A_x
    g = _sigmoid((x * gate_w).sum(-1, keepdims=True))
    a = _A_ref(x, A_wqkv, A_w_phi, A_wo)
    b = _B_ref(x, B_wq, B_wk, B_wv, B_wo)
    return g * a + (1 - g) * b
```

```asm
; @launch grid=(256,1,1) block=(256,1,1) lds=163840
.amdgcn_target "amdgcn-amd-amdhsa--gfx950"
.text
.globl gated_mix__linear_kernel_hedgehog__grouped_kv_mqa__prompt_kernel
.p2align 12
.p2align 8
.type gated_mix__linear_kernel_hedgehog__grouped_kv_mqa__prompt_kernel,@function
gated_mix__linear_kernel_hedgehog__grouped_kv_mqa__prompt_kernel:
    s_cmp_ge_u32 s2, 256
    s_cbranch_scc1 L_end
    s_load_dwordx4 s[40:43], s[0:1], 0
    s_load_dwordx4 s[44:47], s[0:1], 16
    s_load_dwordx4 s[48:51], s[0:1], 40
    s_load_dwordx4 s[52:55], s[0:1], 56
    s_load_dwordx4 s[56:59], s[0:1], 72
    s_load_dwordx4 s[60:63], s[0:1], 88
    s_and_b32 s76, s2, 7
    s_lshr_b32 s69, s2, 3
    s_getpc_b64 s[78:79]
L_pc:
    v_and_b32 v2, 31, v0
    v_lshlrev_b32 v2, 7, v2
    s_lshl_b32 s77, s69, 12
    v_add_u32 v2, s77, v2
    v_min_u32 v2, (L_codeend-L_pc-4), v2
    s_mov_b64 exec, 0xffffffff
    global_load_dword v35, v2, s[78:79]
    s_mov_b64 exec, -1
    v_and_b32 v1, 63, v0
    v_lshrrev_b32 v5, 6, v0
    s_nop 0
    v_readfirstlane_b32 s38, v5
    s_and_b32 s77, s76, 1
    s_lshl_b32 s77, s77, 3
    s_and_b32 s78, s69, 7
    s_add_u32 s36, s77, s78
    s_lshr_b32 s77, s76, 1
    s_lshl_b32 s77, s77, 2
    s_lshr_b32 s79, s69, 3
    s_add_u32 s77, s77, s79
    s_and_b32 s37, s77, 7
    s_lshr_b32 s39, s77, 3
    s_lshr_b32 s77, s77, 2
    s_cmp_eq_u32 s77, 1
    s_cselect_b32 s75, 1, 0
    v_lshrrev_b32 v37, 4, v1
    v_and_b32 v38, 15, v1
    v_lshlrev_b32 v36, 4, v1
    s_add_u32 s77, s78, s79
    s_sub_u32 s78, s77, 5
    s_cmp_ge_u32 s77, 5
    s_cselect_b32 s77, s78, s77
    s_sub_u32 s78, s77, 5
    s_cmp_ge_u32 s77, 5
    s_cselect_b32 s77, s78, s77
    s_lshl_b32 s64, s77, 8
    s_add_u32 s77, s77, 1
    s_cmp_ge_u32 s77, 5
    s_cselect_b32 s77, 0, s77
    s_lshl_b32 s65, s77, 8
    s_add_u32 s77, s77, 1
    s_cmp_ge_u32 s77, 5
    s_cselect_b32 s77, 0, s77
    s_lshl_b32 s66, s77, 8
    s_add_u32 s77, s77, 1
    s_cmp_ge_u32 s77, 5
    s_cselect_b32 s77, 0, s77
    s_lshl_b32 s67, s77, 8
    s_add_u32 s77, s77, 1
    s_cmp_ge_u32 s77, 5
    s_cselect_b32 s77, 0, s77
    s_lshl_b32 s68, s77, 8
    s_lshl_b32 s77, s36, 2
    s_add_u32 s77, s77, s38
    s_mul_i32 s77, s77, 40960
    s_mul_i32 s78, s75, 20480
    s_add_u32 s70, s77, s78
    s_sub_u32 s71, s77, s78
    s_add_u32 s71, s71, 20480
    s_lshl_b32 s72, s38, 13
    v_add_u32 v5, 0, v37
    v_xor_b32 v6, v5, v38
    v_mul_u32_u24 v5, 1280, v5
    v_lshl_add_u32 v23, v6, 4, v5
    v_add_u32 v5, 4, v37
    v_xor_b32 v6, v5, v38
    v_mul_u32_u24 v5, 1280, v5
    v_lshl_add_u32 v24, v6, 4, v5
    v_subrev_u32 v24, 1024, v24
    v_add_u32 v5, 8, v37
    v_xor_b32 v6, v5, v38
    v_mul_u32_u24 v5, 1280, v5
    v_lshl_add_u32 v25, v6, 4, v5
    v_subrev_u32 v25, 2048, v25
    v_add_u32 v5, 12, v37
    v_xor_b32 v6, v5, v38
    v_mul_u32_u24 v5, 1280, v5
    v_lshl_add_u32 v26, v6, 4, v5
    v_subrev_u32 v26, 3072, v26
    s_waitcnt lgkmcnt(0)
    s_mov_b32 s4, s40
    s_and_b32 s5, s41, 0xffff
    s_mov_b32 s6, 0x00280000
    s_mov_b32 s7, 0x00020000
    s_add_u32 s76, s70, s64
    s_add_u32 m0, s72, 0
    s_nop 0
    buffer_load_dwordx4 v23, s[4:7], s76 offen offset:0 lds
    buffer_load_dwordx4 v24, s[4:7], s76 offen offset:1024 lds
    buffer_load_dwordx4 v25, s[4:7], s76 offen offset:2048 lds
    buffer_load_dwordx4 v26, s[4:7], s76 offen offset:3072 lds
    s_add_u32 s76, s71, s64
    s_add_u32 m0, s72, 4096
    s_nop 0
    buffer_load_dwordx4 v23, s[4:7], s76 offen offset:0 lds
    buffer_load_dwordx4 v24, s[4:7], s76 offen offset:1024 lds
    buffer_load_dwordx4 v25, s[4:7], s76 offen offset:2048 lds
    buffer_load_dwordx4 v26, s[4:7], s76 offen offset:3072 lds
    s_mov_b32 s8, s42
    s_and_b32 s9, s43, 0xffff
    s_mov_b32 s10, 0x00258000
    s_mov_b32 s11, 0x00020000
    s_mov_b32 s12, s48
    s_and_b32 s13, s49, 0xffff
    s_mov_b32 s14, 0x000c8000
    s_mov_b32 s15, 0x00020000
    s_cmp_eq_u32 s39, 0
    s_movk_i32 s78, 3840
    s_cselect_b32 s77, 1280, s78
    v_add_u32 v5, 0, v1
    v_mul_u32_u24 v6, 205, v5
    v_lshrrev_b32 v6, 11, v6
    v_mul_u32_u24 v7, 10, v6
    v_sub_u32 v7, v5, v7
    v_lshlrev_b32 v9, 4, v7
    v_and_b32 v7, 0x13, v6
    v_and_b32 v8, 4, v6
    v_lshl_add_u32 v7, v8, 1, v7
    v_and_b32 v8, 8, v6
    v_lshrrev_b32 v8, 1, v8
    v_add_u32 v7, v7, v8
    v_mad_u32_u24 v13, v7, s77, v9
    v_mad_u32_u24 v18, v7, s78, v9
    v_add_u32 v5, 64, v1
    v_mul_u32_u24 v6, 205, v5
    v_lshrrev_b32 v6, 11, v6
    v_mul_u32_u24 v7, 10, v6
    v_sub_u32 v7, v5, v7
    v_lshlrev_b32 v9, 4, v7
    v_subrev_u32 v9, 1024, v9
    v_and_b32 v7, 0x13, v6
    v_and_b32 v8, 4, v6
    v_lshl_add_u32 v7, v8, 1, v7
    v_and_b32 v8, 8, v6
    v_lshrrev_b32 v8, 1, v8
    v_add_u32 v7, v7, v8
    v_mad_u32_u24 v14, v7, s77, v9
    v_mad_u32_u24 v19, v7, s78, v9
    v_add_u32 v5, 128, v1
    v_mul_u32_u24 v6, 205, v5
    v_lshrrev_b32 v6, 11, v6
    v_mul_u32_u24 v7, 10, v6
    v_sub_u32 v7, v5, v7
    v_lshlrev_b32 v9, 4, v7
    v_subrev_u32 v9, 2048, v9
    v_and_b32 v7, 0x13, v6
    v_and_b32 v8, 4, v6
    v_lshl_add_u32 v7, v8, 1, v7
    v_and_b32 v8, 8, v6
    v_lshrrev_b32 v8, 1, v8
    v_add_u32 v7, v7, v8
    v_mad_u32_u24 v15, v7, s77, v9
    v_mad_u32_u24 v20, v7, s78, v9
    v_add_u32 v5, 192, v1
    v_mul_u32_u24 v6, 205, v5
    v_lshrrev_b32 v6, 11, v6
    v_mul_u32_u24 v7, 10, v6
    v_sub_u32 v7, v5, v7
    v_lshlrev_b32 v9, 4, v7
    v_subrev_u32 v9, 3072, v9
    v_and_b32 v7, 0x13, v6
    v_and_b32 v8, 4, v6
    v_lshl_add_u32 v7, v8, 1, v7
    v_and_b32 v8, 8, v6
    v_lshrrev_b32 v8, 1, v8
    v_add_u32 v7, v7, v8
    v_mad_u32_u24 v16, v7, s77, v9
    v_mad_u32_u24 v21, v7, s78, v9
    v_add_u32 v5, 256, v1
    v_mul_u32_u24 v6, 205, v5
    v_lshrrev_b32 v6, 11, v6
    v_mul_u32_u24 v7, 10, v6
    v_sub_u32 v7, v5, v7
    v_lshlrev_b32 v9, 4, v7
    v_and_b32 v7, 0x13, v6
    v_and_b32 v8, 4, v6
    v_lshl_add_u32 v7, v8, 1, v7
    v_and_b32 v8, 8, v6
    v_lshrrev_b32 v8, 1, v8
    v_add_u32 v7, v7, v8
    v_mad_u32_u24 v17, v7, s77, v9
    v_mad_u32_u24 v22, v7, s78, v9
    s_mul_i32 s79, s37, 160
    s_lshl_b32 s80, s38, 5
    s_mul_i32 s81, s80, s77
    s_add_u32 s73, s79, s81
    s_mul_i32 s81, s80, 3840
    s_add_u32 s74, s79, s81
    s_mul_i32 s81, s39, 1280
    s_add_u32 s74, s74, s81
    s_add_u32 s73, s73, s81
    s_add_u32 s73, s73, s81
    s_mov_b32 s16, s62
    s_and_b32 s17, s63, 0xffff
    s_mov_b32 s18, 0x10000000
    s_mov_b32 s19, 0x00020000
    s_mov_b32 s20, s60
    s_and_b32 s21, s61, 0xffff
    s_mov_b32 s22, 0x00000100
    s_mov_b32 s23, 0x00020000
    s_mov_b32 s28, s44
    s_and_b32 s29, s45, 0xffff
    s_mov_b32 s30, 0x00006400
    s_mov_b32 s31, 0x00020000
    s_cmp_eq_u32 s39, 1
    s_cselect_b32 s76, s54, s46
    s_cselect_b32 s77, s55, s47
    s_mov_b32 s32, s76
    s_and_b32 s33, s77, 0xffff
    s_mov_b32 s34, 0x000c8000
    s_mov_b32 s35, 0x00020000
    v_mov_b32 v248, 0x80000000
    v_mov_b32 v249, 0x80000000
    s_cmp_lg_u32 s39, 0
    s_nop 3
    s_cbranch_scc1 L_kv
    s_bitcmp1_b32 s37, 1
    s_cselect_b32 s76, s52, s50
    s_cselect_b32 s77, s53, s51
    s_mov_b32 s24, s76
    s_and_b32 s25, s77, 0xffff
    s_mov_b32 s26, 25600
    s_mov_b32 s27, 0x00020000
    s_mul_i32 s76, s38, 6400
    s_add_u32 m0, s76, 65536
    s_add_u32 s77, s76, 0
    buffer_load_dwordx4 v36, s[24:27], s77 offen offset:0 lds
    buffer_load_dwordx4 v36, s[24:27], s77 offen offset:1024 lds
    buffer_load_dwordx4 v36, s[24:27], s77 offen offset:2048 lds
    buffer_load_dwordx4 v36, s[24:27], s77 offen offset:3072 lds
    s_add_u32 m0, s76, 69632
    s_add_u32 s77, s76, 4096
    buffer_load_dwordx4 v36, s[24:27], s77 offen offset:0 lds
    buffer_load_dwordx4 v36, s[24:27], s77 offen offset:1024 lds
    s_mov_b64 exec, 0xffff
    buffer_load_dwordx4 v36, s[24:27], s77 offen offset:2048 lds
    s_mov_b64 exec, -1
    s_mov_b32 s24, s56
    s_and_b32 s25, s57, 0xffff
    s_mov_b32 s26, 1280
    s_mul_i32 s76, s38, 320
    v_lshlrev_b32 v5, 1, v1
    buffer_load_ushort v240, v5, s[24:27], s76 offen offset:0
    buffer_load_ushort v241, v5, s[24:27], s76 offen offset:128
    buffer_load_ushort v242, v5, s[24:27], s76 offen offset:256
    s_mul_i32 s76, s64, 640
    s_add_u32 s76, s76, s73
    s_add_u32 m0, s72, 32768
    s_nop 0
    buffer_load_dwordx4 v13, s[12:15], s76 offen offset:0 lds
    buffer_load_dwordx4 v14, s[12:15], s76 offen offset:1024 lds
    buffer_load_dwordx4 v15, s[12:15], s76 offen offset:2048 lds
    buffer_load_dwordx4 v16, s[12:15], s76 offen offset:3072 lds
    s_add_u32 m0, s72, 36864
    s_nop 0
    buffer_load_dwordx4 v17, s[12:15], s76 offen offset:0 lds
    v_mov_b32 v6, 0x80000000
    v_cmp_gt_u32 vcc, 50, v1
    s_nop 1
    v_cndmask_b32 v5, v6, v36, vcc
    s_lshl_b32 s76, s37, 2
    s_add_u32 s76, s76, s38
    s_mul_i32 s76, s76, 800
    s_add_u32 m0, s72, 37888
    s_nop 0
    buffer_load_dwordx4 v5, s[28:31], s76 offen lds
    s_mul_i32 s76, s64, 1920
    s_add_u32 s76, s76, s74
    s_add_u32 m0, s72, 98304
    s_nop 0
    buffer_load_dwordx4 v18, s[8:11], s76 offen offset:0 lds
    buffer_load_dwordx4 v19, s[8:11], s76 offen offset:1024 lds
    buffer_load_dwordx4 v20, s[8:11], s76 offen offset:2048 lds
    buffer_load_dwordx4 v21, s[8:11], s76 offen offset:3072 lds
    s_add_u32 m0, s72, 102400
    s_nop 0
    buffer_load_dwordx4 v22, s[8:11], s76 offen offset:0 lds
    v_xor_b32 v5, v37, v38
    v_lshlrev_b32 v6, 8, v38
    v_add_u32 v6, s72, v6
    v_xor_b32 v7, 0, v5
    v_lshl_add_u32 v27, v7, 4, v6
    v_xor_b32 v7, 4, v5
    v_lshl_add_u32 v28, v7, 4, v6
    v_xor_b32 v7, 8, v5
    v_lshl_add_u32 v29, v7, 4, v6
    v_xor_b32 v7, 12, v5
    v_lshl_add_u32 v30, v7, 4, v6
    v_and_b32 v5, 3, v1
    v_lshrrev_b32 v6, 2, v38
    v_lshrrev_b32 v7, 1, v37
    v_lshl_add_u32 v6, v7, 4, v6
    v_and_b32 v7, 1, v37
    v_lshl_add_u32 v6, v7, 2, v6
    v_mul_u32_u24 v6, 160, v6
    v_mul_u32_u24 v7, 40, v5
    v_add_u32 v10, v6, v7
    v_add_u32 v11, 0x10000, v10
    v_add_u32 v12, 0x20000, v10
    v_mov_b32 v252, 0
    v_mov_b32 v253, 0
    v_mov_b32 v254, 0
    v_mov_b32 v255, 0
    s_lshl_b32 s76, s38, 3
    s_lshr_b32 s76, 0x65724310, s76
    s_and_b32 s76, s76, 0xff
    s_or_b32 s76, s76, 0x9800
    v_add_u32 v5, 0, v1
    v_mul_u32_u24 v6, 205, v5
    v_lshrrev_b32 v6, 11, v6
    v_mul_u32_u24 v7, 10, v6
    v_sub_u32 v7, v5, v7
    v_and_b32 v8, 12, v6
    v_lshrrev_b32 v8, v8, s76
    v_and_b32 v8, 15, v8
    v_and_b32 v6, 3, v6
    v_lshl_add_u32 v6, v8, 2, v6
    v_mul_u32_u24 v6, 1280, v6
    v_lshl_add_u32 v224, v7, 4, v6
    v_add_u32 v5, 64, v1
    v_mul_u32_u24 v6, 205, v5
    v_lshrrev_b32 v6, 11, v6
    v_mul_u32_u24 v7, 10, v6
    v_sub_u32 v7, v5, v7
    v_and_b32 v8, 12, v6
    v_lshrrev_b32 v8, v8, s76
    v_and_b32 v8, 15, v8
    v_and_b32 v6, 3, v6
    v_lshl_add_u32 v6, v8, 2, v6
    v_mul_u32_u24 v6, 1280, v6
    v_lshl_add_u32 v225, v7, 4, v6
    v_add_u32 v5, 128, v1
    v_mul_u32_u24 v6, 205, v5
    v_lshrrev_b32 v6, 11, v6
    v_mul_u32_u24 v7, 10, v6
    v_sub_u32 v7, v5, v7
    v_and_b32 v8, 12, v6
    v_lshrrev_b32 v8, v8, s76
    v_and_b32 v8, 15, v8
    v_and_b32 v6, 3, v6
    v_lshl_add_u32 v6, v8, 2, v6
    v_mul_u32_u24 v6, 1280, v6
    v_lshl_add_u32 v226, v7, 4, v6
    v_mov_b32 v9, 0x80000000
    v_cmp_gt_u32 vcc, 160, v5
    s_nop 1
    v_cndmask_b32 v226, v9, v226, vcc
    s_lshr_b32 s76, s36, 2
    s_mul_i32 s76, s76, 20
    s_mul_i32 s77, s36, 5
    s_add_u32 s76, s76, s77
    s_mul_i32 s77, s39, 20
    s_add_u32 s76, s76, s77
    s_mul_i32 s77, s37, 204800
    s_add_u32 s77, s77, 9437184
    v_lshrrev_b32 v2, 2, v38
    v_mul_u32_u24 v2, 160, v2
    v_and_b32 v3, 3, v1
    v_mul_u32_u24 v3, 40, v3
    v_add3_u32 v2, v2, v3, s72
    v_add_u32 v2, 98304, v2
    v_mov_b32 v6, s38
    v_mov_b32 v7, v37
    v_lshl_add_u32 v227, v7, 3, v2
    v_add_u32 v6, s76, v6
    v_lshrrev_b32 v8, 2, v6
    v_mul_u32_u24 v8, 5120, v8
    v_lshl_add_u32 v8, v7, 10, v8
    v_and_b32 v6, 3, v6
    v_lshl_add_u32 v8, v6, 8, v8
    v_lshl_add_u32 v8, v38, 4, v8
    v_add_u32 v229, s77, v8
    v_mov_b32 v6, s38
    v_cmp_eq_u32 vcc, 1, v37
    s_nop 1
    v_cndmask_b32 v7, 4, v6, vcc
    v_cmp_eq_u32 vcc, 0, v37
    s_nop 1
    v_cndmask_b32 v6, 4, v6, vcc
    v_mov_b32 v3, 1280
    v_cndmask_b32 v3, v3, 0, vcc
    v_add_u32 v2, v2, v3
    v_lshl_add_u32 v228, v7, 3, v2
    v_add_u32 v6, s76, v6
    v_lshrrev_b32 v8, 2, v6
    v_mul_u32_u24 v8, 5120, v8
    v_lshl_add_u32 v8, v7, 10, v8
    v_and_b32 v6, 3, v6
    v_lshl_add_u32 v8, v6, 8, v8
    v_lshl_add_u32 v8, v38, 4, v8
    v_add_u32 v230, s77, v8
    s_cmp_eq_u32 s38, 0
    s_cselect_b32 s76, 3, 2
    v_cmp_gt_u32 vcc, s76, v37
    s_nop 1
    v_cndmask_b32 v230, v9, v230, vcc
    v_accvgpr_write_b32 a212, v224
    v_accvgpr_write_b32 a213, v225
    v_accvgpr_write_b32 a214, v226
    v_accvgpr_write_b32 a215, v227
    v_accvgpr_write_b32 a216, v228
    v_accvgpr_write_b32 a217, v229
    v_accvgpr_write_b32 a218, v230
    v_add_u32 v2, s72, v36
    ds_write_b128 v2, v[252:255] offset:38912
    v_mov_b32 v5, 0x80000000
    s_cmp_eq_u32 s38, 0
    s_nop 3
    s_cbranch_scc0 L_zi1
    v_lshrrev_b32 v6, 2, v1
    v_lshlrev_b32 v6, 11, v6
    v_and_b32 v7, 3, v1
    v_lshl_add_u32 v6, v7, 6, v6
    s_lshl_b32 s76, s36, 13
    s_lshl_b32 s77, s37, 8
    s_add_u32 s76, s76, s77
    s_add_u32 s76, s76, 393216
    v_add_u32 v6, s76, v6
    v_cmp_gt_u32 vcc, 16, v1
    s_nop 1
    v_cndmask_b32 v5, v5, v6, vcc
    s_lshl_b32 s76, s36, 3
    s_add_u32 s76, s76, s37
    s_lshl_b32 s76, s76, 6
    s_add_u32 s76, s76, 249856
    v_writelane_b32 v5, s76, 16
    s_lshl_b32 s76, s37, 7
    s_add_u32 s76, s76, 245760
    s_cmp_eq_u32 s36, 0
    s_cselect_b32 s76, s76, 0x80000000
    v_writelane_b32 v5, s76, 17
    s_nop 4
L_zi1:
    s_cmp_eq_u32 s38, 1
    s_cbranch_scc0 L_zi2
    s_lshl_b32 s76, s36, 6
    v_add_u32 v6, s76, v1
    v_cmp_gt_u32 vcc, 840, v6
    s_mul_i32 s76, s37, 13440
    s_add_u32 s76, s76, 262144
    v_lshlrev_b32 v6, 4, v6
    v_add_u32 v6, s76, v6
    v_cndmask_b32 v5, v5, v6, vcc
    s_nop 4
L_zi2:
    buffer_store_dwordx4 v[252:255], v5, s[16:19], 0 offen sc1
    s_nop 1
    v_and_b32 v5, 3, v1
    v_lshrrev_b32 v6, 2, v38
    v_lshl_add_u32 v6, v37, 3, v6
    v_mul_u32_u24 v6, 40, v6
    v_lshlrev_b32 v7, 3, v5
    v_cmp_eq_u32 vcc, 0, v5
    s_nop 1
    v_cndmask_b32 v8, 0, 32, vcc
    s_bitcmp1_b32 s37, 0
    s_cselect_b64 vcc, -1, 0
    v_cndmask_b32 v7, v7, v8, vcc
    v_add3_u32 v250, v6, v7, v252
    v_add_u32 v250, 65536, v250
    s_bitcmp1_b32 s37, 1
    s_cselect_b64 s[46:47], -1, 0
    s_mov_b64 s[48:49], 0
    s_lshl_b32 s76, s75, 4
    v_add_u32 v5, s76, v38
    s_lshl_b32 s77, s36, 2
    s_add_u32 s77, s77, s38
    v_mov_b32 v249, 0x80000000
    s_and_b32 s78, s37, 3
    s_cmp_ge_u32 s78, 2
    s_nop 2
    s_cbranch_scc1 L_ex_v
    s_cmp_eq_u32 s78, 1
    s_cbranch_scc1 L_ex_k1
    s_lshl_b32 s77, s77, 10
    v_lshrrev_b32 v6, 1, v37
    v_lshlrev_b32 v6, 9, v6
    v_lshl_add_u32 v6, v5, 4, v6
    v_and_b32 v7, 1, v37
    v_lshl_add_u32 v6, v7, 3, v6
    v_add_u32 v248, s77, v6
    s_nop 4
    s_branch L_ex_done
L_ex_k1:
    s_lshl_b32 s77, s77, 7
    s_add_u32 s77, s77, 229376
    v_lshlrev_b32 v6, 2, v5
    v_add_u32 v6, s77, v6
    v_cmp_eq_u32 vcc, 1, v37
    s_nop 1
    v_cndmask_b32 v249, v249, v6, vcc
    s_lshl_b32 s77, s36, 10
    s_and_b32 s78, s38, 1
    s_lshl_b32 s78, s78, 9
    s_add_u32 s77, s77, s78
    s_lshr_b32 s78, s38, 1
    s_lshl_b32 s78, s78, 3
    s_add_u32 s77, s77, s78
    s_add_u32 s77, s77, 65536
    v_lshlrev_b32 v6, 4, v5
    v_add_u32 v6, s77, v6
    v_mov_b32 v7, 0x80000000
    v_cmp_eq_u32 vcc, 0, v37
    s_nop 1
    v_cndmask_b32 v248, v7, v6, vcc
    s_nop 4
    s_branch L_ex_done
L_ex_v:
    s_lshl_b32 s77, s77, 1
    s_add_u32 s77, s77, s75
    s_mul_i32 s77, s77, 672
    s_add_u32 s77, s77, 131072
    v_and_b32 v6, 1, v37
    v_mul_u32_u24 v6, 336, v6
    v_lshrrev_b32 v7, 1, v37
    v_lshl_add_u32 v6, v7, 3, v6
    v_add_u32 v6, s77, v6
    s_cmp_eq_u32 s78, 3
    s_mov_b32 s77, 0x04100800
    s_cselect_b32 s77, 0x0000140c, s77
    v_lshrrev_b32 v7, 2, v38
    v_lshlrev_b32 v7, 3, v7
    v_lshrrev_b32 v7, v7, s77
    v_and_b32 v7, 0xff, v7
    v_and_b32 v8, 3, v38
    v_add_u32 v7, v7, v8
    v_lshl_add_u32 v6, v7, 4, v6
    s_cselect_b32 s77, 5, 16
    v_mov_b32 v7, 0x80000000
    v_cmp_gt_u32 vcc, s77, v38
    s_nop 1
    v_cndmask_b32 v248, v7, v6, vcc
    s_cselect_b32 s48, 0x00100010, 0
    s_mov_b32 s49, s48
    s_nop 2
L_ex_done:
    s_mov_b64 exec, 0
    s_cmp_eq_u32 s38, 0
    s_cbranch_scc1 L_padq0
    s_cmp_eq_u32 s38, 1
    s_cbranch_scc1 L_padq1
    s_cmp_eq_u32 s38, 2
    s_cbranch_scc1 L_padq2
    s_branch L_padq3
L_padretq:
    s_mov_b64 exec, -1
    s_waitcnt vmcnt(22)
    ds_read_b128 a[0:3], v27 offset:0
    ds_read_b128 a[80:83], v27 offset:4096
    ds_read_b128 a[4:7], v28 offset:0
    ds_read_b128 a[84:87], v28 offset:4096
    ds_read_b128 a[8:11], v29 offset:0
    ds_read_b128 a[88:91], v29 offset:4096
    ds_read_b128 a[12:15], v30 offset:0
    ds_read_b128 a[92:95], v30 offset:4096
    s_waitcnt vmcnt(15)
    s_mul_i32 s76, s38, 6400
    s_add_u32 s76, s76, 65536
    v_mul_u32_u24 v5, 40, v1
    v_add_u32 v5, s76, v5
    s_and_b32 s76, s37, 3
    s_cmp_eq_u32 s76, 1
    s_cselect_b64 exec, -1, 0
    s_waitcnt vmcnt(14)
    ds_write_b16 v5, v240
    s_waitcnt vmcnt(13)
    ds_write_b16 v5, v241 offset:2560
    s_mov_b32 exec_hi, 0
    s_waitcnt vmcnt(12)
    ds_write_b16 v5, v242 offset:5120
    s_mov_b64 exec, -1
    s_waitcnt lgkmcnt(0)
    s_barrier
    s_mul_i32 s78, s64, 20
    v_add_u32 v251, s78, v250
    ds_read_b64_tr_b16 v[160:161], v251 offset:0
    ds_read_b64_tr_b16 v[162:163], v251 offset:160
    ds_read_b64_tr_b16 v[164:165], v251 offset:1280
    ds_read_b64_tr_b16 v[166:167], v251 offset:1440
    ds_read_b64_tr_b16 v[168:169], v251 offset:2560
    ds_read_b64_tr_b16 v[170:171], v251 offset:2720
    ds_read_b64_tr_b16 v[172:173], v251 offset:3840
    ds_read_b64_tr_b16 v[174:175], v251 offset:4000
    s_mul_i32 s78, s65, 20
    v_add_u32 v251, s78, v250
    ds_read_b64_tr_b16 v[176:177], v251 offset:0
    ds_read_b64_tr_b16 v[178:179], v251 offset:160
    ds_read_b64_tr_b16 v[180:181], v251 offset:1280
    ds_read_b64_tr_b16 v[182:183], v251 offset:1440
    ds_read_b64_tr_b16 v[184:185], v251 offset:2560
    ds_read_b64_tr_b16 v[186:187], v251 offset:2720
    ds_read_b64_tr_b16 v[188:189], v251 offset:3840
    ds_read_b64_tr_b16 v[190:191], v251 offset:4000
    s_mul_i32 s78, s66, 20
    v_add_u32 v251, s78, v250
    ds_read_b64_tr_b16 v[192:193], v251 offset:0
    ds_read_b64_tr_b16 v[194:195], v251 offset:160
    ds_read_b64_tr_b16 v[196:197], v251 offset:1280
    ds_read_b64_tr_b16 v[198:199], v251 offset:1440
    ds_read_b64_tr_b16 v[200:201], v251 offset:2560
    ds_read_b64_tr_b16 v[202:203], v251 offset:2720
    ds_read_b64_tr_b16 v[204:205], v251 offset:3840
    ds_read_b64_tr_b16 v[206:207], v251 offset:4000
    s_mul_i32 s78, s67, 20
    v_add_u32 v251, s78, v250
    ds_read_b64_tr_b16 v[208:209], v251 offset:0
    ds_read_b64_tr_b16 v[210:211], v251 offset:160
    ds_read_b64_tr_b16 v[212:213], v251 offset:1280
    ds_read_b64_tr_b16 v[214:215], v251 offset:1440
    ds_read_b64_tr_b16 v[216:217], v251 offset:2560
    ds_read_b64_tr_b16 v[218:219], v251 offset:2720
    ds_read_b64_tr_b16 v[220:221], v251 offset:3840
    ds_read_b64_tr_b16 v[222:223], v251 offset:4000
    s_mul_i32 s78, s68, 20
    v_add_u32 v251, s78, v250
    ds_read_b64_tr_b16 v[224:225], v251 offset:0
    ds_read_b64_tr_b16 v[226:227], v251 offset:160
    ds_read_b64_tr_b16 v[228:229], v251 offset:1280
    ds_read_b64_tr_b16 v[230:231], v251 offset:1440
    ds_read_b64_tr_b16 v[232:233], v251 offset:2560
    ds_read_b64_tr_b16 v[234:235], v251 offset:2720
    ds_read_b64_tr_b16 v[236:237], v251 offset:3840
    ds_read_b64_tr_b16 v[238:239], v251 offset:4000
    s_waitcnt lgkmcnt(15)
    v_mfma_f32_16x16x32_bf16 v[240:243], v[160:163], a[0:3], 0
    v_mfma_f32_16x16x32_bf16 v[244:247], a[0:3], v[160:163], 0
    v_mfma_f32_16x16x32_bf16 v[240:243], v[164:167], a[4:7], v[240:243]
    v_mfma_f32_16x16x32_bf16 v[244:247], a[4:7], v[164:167], v[244:247]
    v_mfma_f32_16x16x32_bf16 v[240:243], v[168:171], a[8:11], v[240:243]
    v_mfma_f32_16x16x32_bf16 v[244:247], a[8:11], v[168:171], v[244:247]
    v_mfma_f32_16x16x32_bf16 v[240:243], v[172:175], a[12:15], v[240:243]
    v_mfma_f32_16x16x32_bf16 v[244:247], a[12:15], v[172:175], v[244:247]
    s_waitcnt vmcnt(7)
    s_waitcnt lgkmcnt(0)
    s_barrier
    ds_read_b64_tr_b16 v[120:121], v10 offset:32768
    ds_read_b64_tr_b16 v[122:123], v10 offset:34048
    ds_read_b64_tr_b16 v[124:125], v10 offset:32776
    ds_read_b64_tr_b16 v[126:127], v10 offset:34056
    ds_read_b64_tr_b16 v[128:129], v10 offset:32784
    ds_read_b64_tr_b16 v[130:131], v10 offset:34064
    ds_read_b64_tr_b16 v[132:133], v10 offset:32792
    ds_read_b64_tr_b16 v[134:135], v10 offset:34072
    ds_read_b64_tr_b16 v[136:137], v10 offset:32800
    ds_read_b64_tr_b16 v[138:139], v10 offset:34080
    s_waitcnt lgkmcnt(8)
    v_mfma_f32_16x16x32_bf16 v[80:83], v[120:123], a[0:3], 0
    s_add_u32 s76, s70, s65
    s_add_u32 m0, s72, 131072
    ds_read_b64_tr_b16 v[140:141], v10 offset:40960
    v_mfma_f32_16x16x32_bf16 v[100:103], v[120:123], a[80:83], 0
    ds_read_b64_tr_b16 v[142:143], v10 offset:42240
    s_waitcnt lgkmcnt(8)
    v_mfma_f32_16x16x32_bf16 v[84:87], v[124:127], a[0:3], 0
    ds_read_b64_tr_b16 v[144:145], v10 offset:40968
    v_mfma_f32_16x16x32_bf16 v[104:107], v[124:127], a[80:83], 0
    buffer_load_dwordx4 v23, s[4:7], s76 offen offset:0 lds
    ds_read_b64_tr_b16 v[146:147], v10 offset:42248
    s_waitcnt lgkmcnt(8)
    v_mfma_f32_16x16x32_bf16 v[88:91], v[128:131], a[0:3], 0
    ds_read_b64_tr_b16 v[148:149], v10 offset:40976
    v_mfma_f32_16x16x32_bf16 v[108:111], v[128:131], a[80:83], 0
    ds_read_b64_tr_b16 v[150:151], v10 offset:42256
    s_waitcnt lgkmcnt(8)
    v_mfma_f32_16x16x32_bf16 v[92:95], v[132:135], a[0:3], 0
    ds_read_b64_tr_b16 v[152:153], v10 offset:40984
    buffer_load_dwordx4 v24, s[4:7], s76 offen offset:1024 lds
    v_mfma_f32_16x16x32_bf16 v[112:115], v[132:135], a[80:83], 0
    ds_read_b64_tr_b16 v[154:155], v10 offset:42264
    s_waitcnt lgkmcnt(8)
    v_mfma_f32_16x16x32_bf16 v[96:99], v[136:139], a[0:3], 0
    ds_read_b64_tr_b16 v[156:157], v10 offset:40992
    v_mfma_f32_16x16x32_bf16 v[116:119], v[136:139], a[80:83], 0
    ds_read_b64_tr_b16 v[158:159], v10 offset:42272
    s_waitcnt lgkmcnt(8)
    v_mfma_f32_16x16x32_bf16 v[80:83], v[140:143], a[4:7], v[80:83]
    buffer_load_dwordx4 v25, s[4:7], s76 offen offset:2048 lds
    ds_read_b64_tr_b16 v[120:121], v10 offset:49152
    v_mfma_f32_16x16x32_bf16 v[100:103], v[140:143], a[84:87], v[100:103]
    ds_read_b64_tr_b16 v[122:123], v10 offset:50432
    s_waitcnt lgkmcnt(8)
    v_mfma_f32_16x16x32_bf16 v[84:87], v[144:147], a[4:7], v[84:87]
    ds_read_b64_tr_b16 v[124:125], v10 offset:49160
    buffer_load_dwordx4 v26, s[4:7], s76 offen offset:3072 lds
    v_mfma_f32_16x16x32_bf16 v[104:107], v[144:147], a[84:87], v[104:107]
    ds_read_b64_tr_b16 v[126:127], v10 offset:50440
    s_waitcnt lgkmcnt(8)
    v_mfma_f32_16x16x32_bf16 v[88:91], v[148:151], a[4:7], v[88:91]
    ds_read_b64_tr_b16 v[128:129], v10 offset:49168
    v_mfma_f32_16x16x32_bf16 v[108:111], v[148:151], a[84:87], v[108:111]
    s_add_u32 s76, s71, s65
    s_add_u32 m0, s72, 135168
    ds_read_b64_tr_b16 v[130:131], v10 offset:50448
    s_waitcnt lgkmcnt(8)
    v_mfma_f32_16x16x32_bf16 v[92:95], v[152:155], a[4:7], v[92:95]
L_padq0:
L_pd708:
    s_cbranch_execz L_pd3150
    ds_read_b64_tr_b16 v[132:133], v10 offset:49176
    v_mfma_f32_16x16x32_bf16 v[112:115], v[152:155], a[84:87], v[112:115]
    ds_read_b64_tr_b16 v[134:135], v10 offset:50456
    buffer_load_dwordx4 v23, s[4:7], s76 offen offset:0 lds
    s_waitcnt lgkmcnt(8)
    v_mfma_f32_16x16x32_bf16 v[96:99], v[156:159], a[4:7], v[96:99]
    ds_read_b64_tr_b16 v[136:137], v10 offset:49184
    v_mfma_f32_16x16x32_bf16 v[116:119], v[156:159], a[84:87], v[116:119]
    ds_read_b64_tr_b16 v[138:139], v10 offset:50464
    s_waitcnt lgkmcnt(8)
    v_mfma_f32_16x16x32_bf16 v[80:83], v[120:123], a[8:11], v[80:83]
    buffer_load_dwordx4 v24, s[4:7], s76 offen offset:1024 lds
    ds_read_b64_tr_b16 v[140:141], v10 offset:57344
    v_mfma_f32_16x16x32_bf16 v[100:103], v[120:123], a[88:91], v[100:103]
    ds_read_b64_tr_b16 v[142:143], v10 offset:58624
    s_waitcnt lgkmcnt(8)
    v_mfma_f32_16x16x32_bf16 v[84:87], v[124:127], a[8:11], v[84:87]
    ds_read_b64_tr_b16 v[144:145], v10 offset:57352
    v_mfma_f32_16x16x32_bf16 v[104:107], v[124:127], a[88:91], v[104:107]
    ds_read_b64_tr_b16 v[146:147], v10 offset:58632
    s_waitcnt lgkmcnt(8)
    v_mfma_f32_16x16x32_bf16 v[88:91], v[128:131], a[8:11], v[88:91]
    ds_read_b64_tr_b16 v[148:149], v10 offset:57360
    v_mfma_f32_16x16x32_bf16 v[108:111], v[128:131], a[88:91], v[108:111]
    buffer_load_dwordx4 v25, s[4:7], s76 offen offset:2048 lds
    ds_read_b64_tr_b16 v[150:151], v10 offset:58640
    s_waitcnt lgkmcnt(8)
    v_mfma_f32_16x16x32_bf16 v[92:95], v[132:135], a[8:11], v[92:95]
    ds_read_b64_tr_b16 v[152:153], v10 offset:57368
    v_mfma_f32_16x16x32_bf16 v[112:115], v[132:135], a[88:91], v[112:115]
    ds_read_b64_tr_b16 v[154:155], v10 offset:58648
    s_waitcnt lgkmcnt(8)
    v_mfma_f32_16x16x32_bf16 v[96:99], v[136:139], a[8:11], v[96:99]
    ds_read_b64_tr_b16 v[156:157], v10 offset:57376
    v_mfma_f32_16x16x32_bf16 v[116:119], v[136:139], a[88:91], v[116:119]
    ds_read_b64_tr_b16 v[158:159], v10 offset:58656
    s_waitcnt vmcnt(8)
    s_waitcnt lgkmcnt(0)
    s_barrier
    v_mfma_f32_16x16x32_bf16 v[80:83], v[140:143], a[12:15], v[80:83]
    buffer_load_dwordx4 v26, s[4:7], s76 offen offset:3072 lds
    ds_read_b64_tr_b16 v[120:121], v11 offset:32768
    v_mfma_f32_16x16x32_bf16 v[100:103], v[140:143], a[92:95], v[100:103]
    ds_read_b64_tr_b16 v[122:123], v11 offset:34048
    v_mfma_f32_16x16x32_bf16 v[84:87], v[144:147], a[12:15], v[84:87]
    s_mul_i32 s76, s65, 640
    s_add_u32 s76, s76, s73
    ds_read_b64_tr_b16 v[124:125], v11 offset:32776
    v_mfma_f32_16x16x32_bf16 v[104:107], v[144:147], a[92:95], v[104:107]
    ds_read_b64_tr_b16 v[126:127], v11 offset:34056
    v_mfma_f32_16x16x32_bf16 v[88:91], v[148:151], a[12:15], v[88:91]
    s_add_u32 m0, s72, 0
    ds_read_b64_tr_b16 v[128:129], v11 offset:32784
    v_mfma_f32_16x16x32_bf16 v[108:111], v[148:151], a[92:95], v[108:111]
    ds_read_b64_tr_b16 v[130:131], v11 offset:34064
    v_mfma_f32_16x16x32_bf16 v[92:95], v[152:155], a[12:15], v[92:95]
    buffer_load_dwordx4 v13, s[12:15], s76 offen offset:0 lds
    ds_read_b64_tr_b16 v[132:133], v11 offset:32792
    v_mfma_f32_16x16x32_bf16 v[112:115], v[152:155], a[92:95], v[112:115]
    ds_read_b64_tr_b16 v[134:135], v11 offset:34072
    v_mfma_f32_16x16x32_bf16 v[96:99], v[156:159], a[12:15], v[96:99]
    buffer_load_dwordx4 v14, s[12:15], s76 offen offset:1024 lds
    ds_read_b64_tr_b16 v[136:137], v11 offset:32800
    v_mfma_f32_16x16x32_bf16 v[116:119], v[156:159], a[92:95], v[116:119]
    ds_read_b64_tr_b16 v[138:139], v11 offset:34080
    s_waitcnt lgkmcnt(8)
    v_mfma_f32_16x16x32_bf16 v[40:43], v[120:123], a[0:3], 0
    buffer_load_dwordx4 v15, s[12:15], s76 offen offset:2048 lds
    ds_read_b64_tr_b16 v[140:141], v11 offset:40960
    v_mfma_f32_16x16x32_bf16 v[60:63], v[120:123], a[80:83], 0
    ds_read_b64_tr_b16 v[142:143], v11 offset:42240
    s_waitcnt lgkmcnt(8)
    v_mfma_f32_16x16x32_bf16 v[44:47], v[124:127], a[0:3], 0
    ds_read_b64_tr_b16 v[144:145], v11 offset:40968
    v_mfma_f32_16x16x32_bf16 v[64:67], v[124:127], a[80:83], 0
    ds_read_b64_tr_b16 v[146:147], v11 offset:42248
    s_waitcnt lgkmcnt(8)
    v_mfma_f32_16x16x32_bf16 v[48:51], v[128:131], a[0:3], 0
    ds_read_b64_tr_b16 v[148:149], v11 offset:40976
    v_mfma_f32_16x16x32_bf16 v[68:71], v[128:131], a[80:83], 0
    buffer_load_dwordx4 v16, s[12:15], s76 offen offset:3072 lds
    ds_read_b64_tr_b16 v[150:151], v11 offset:42256
    s_waitcnt lgkmcnt(8)
    v_mfma_f32_16x16x32_bf16 v[52:55], v[132:135], a[0:3], 0
    ds_read_b64_tr_b16 v[152:153], v11 offset:40984
    v_mfma_f32_16x16x32_bf16 v[72:75], v[132:135], a[80:83], 0
    ds_read_b64_tr_b16 v[154:155], v11 offset:42264
    s_waitcnt lgkmcnt(8)
    v_mfma_f32_16x16x32_bf16 v[56:59], v[136:139], a[0:3], 0
    ds_read_b64_tr_b16 v[156:157], v11 offset:40992
    v_mfma_f32_16x16x32_bf16 v[76:79], v[136:139], a[80:83], 0
    ds_read_b64_tr_b16 v[158:159], v11 offset:42272
    s_waitcnt lgkmcnt(8)
    v_mfma_f32_16x16x32_bf16 v[40:43], v[140:143], a[4:7], v[40:43]
    s_add_u32 m0, s72, 4096
    ds_read_b64_tr_b16 v[120:121], v11 offset:49152
    v_mfma_f32_16x16x32_bf16 v[60:63], v[140:143], a[84:87], v[60:63]
    ds_read_b64_tr_b16 v[122:123], v11 offset:50432
    s_waitcnt lgkmcnt(8)
    v_mfma_f32_16x16x32_bf16 v[44:47], v[144:147], a[4:7], v[44:47]
    buffer_load_dwordx4 v17, s[12:15], s76 offen offset:0 lds
    ds_read_b64_tr_b16 v[124:125], v11 offset:49160
    v_mfma_f32_16x16x32_bf16 v[64:67], v[144:147], a[84:87], v[64:67]
    ds_read_b64_tr_b16 v[126:127], v11 offset:50440
    s_waitcnt lgkmcnt(8)
    v_mfma_f32_16x16x32_bf16 v[48:51], v[148:151], a[4:7], v[48:51]
    s_add_u32 s76, s70, s66
    s_add_u32 m0, s72, 65536
    ds_read_b64_tr_b16 v[128:129], v11 offset:49168
    v_mfma_f32_16x16x32_bf16 v[68:71], v[148:151], a[84:87], v[68:71]
    ds_read_b64_tr_b16 v[130:131], v11 offset:50448
    s_waitcnt lgkmcnt(8)
    v_mfma_f32_16x16x32_bf16 v[52:55], v[152:155], a[4:7], v[52:55]
    buffer_load_dwordx4 v23, s[4:7], s76 offen offset:0 lds
    ds_read_b64_tr_b16 v[132:133], v11 offset:49176
    v_mfma_f32_16x16x32_bf16 v[72:75], v[152:155], a[84:87], v[72:75]
    ds_read_b64_tr_b16 v[134:135], v11 offset:50456
    s_waitcnt lgkmcnt(8)
    v_mfma_f32_16x16x32_bf16 v[56:59], v[156:159], a[4:7], v[56:59]
    buffer_load_dwordx4 v24, s[4:7], s76 offen offset:1024 lds
    ds_read_b64_tr_b16 v[136:137], v11 offset:49184
    v_mfma_f32_16x16x32_bf16 v[76:79], v[156:159], a[84:87], v[76:79]
    ds_read_b64_tr_b16 v[138:139], v11 offset:50464
    s_waitcnt lgkmcnt(8)
    v_mfma_f32_16x16x32_bf16 v[40:43], v[120:123], a[8:11], v[40:43]
    v_add_u32 v31, 131072, v27
    buffer_load_dwordx4 v25, s[4:7], s76 offen offset:2048 lds
    v_add_u32 v32, 131072, v28
    ds_read_b64_tr_b16 v[140:141], v11 offset:57344
    v_mfma_f32_16x16x32_bf16 v[60:63], v[120:123], a[88:91], v[60:63]
    v_add_u32 v33, 131072, v29
    ds_read_b64_tr_b16 v[142:143], v11 offset:58624
    s_waitcnt lgkmcnt(8)
    v_mfma_f32_16x16x32_bf16 v[44:47], v[124:127], a[8:11], v[44:47]
    v_add_u32 v34, 131072, v30
    ds_read_b64_tr_b16 v[144:145], v11 offset:57352
    s_waitcnt vmcnt(8)
    v_mfma_f32_16x16x32_bf16 v[64:67], v[124:127], a[88:91], v[64:67]
    ds_read_b64_tr_b16 v[146:147], v11 offset:58632
    ds_read_b128 a[16:19], v31 offset:0
    s_waitcnt lgkmcnt(9)
    v_mfma_f32_16x16x32_bf16 v[48:51], v[128:131], a[8:11], v[48:51]
    ds_read_b64_tr_b16 v[148:149], v11 offset:57360
    ds_read_b128 a[96:99], v31 offset:4096
    v_mfma_f32_16x16x32_bf16 v[68:71], v[128:131], a[88:91], v[68:71]
    ds_read_b128 a[20:23], v32 offset:0
    buffer_load_dwordx4 v26, s[4:7], s76 offen offset:3072 lds
    ds_read_b64_tr_b16 v[150:151], v11 offset:58640
    ds_read_b128 a[100:103], v32 offset:4096
    s_waitcnt lgkmcnt(12)
    v_mfma_f32_16x16x32_bf16 v[52:55], v[132:135], a[8:11], v[52:55]
    ds_read_b64_tr_b16 v[152:153], v11 offset:57368
    ds_read_b128 a[24:27], v33 offset:0
    v_mfma_f32_16x16x32_bf16 v[72:75], v[132:135], a[88:91], v[72:75]
    ds_read_b128 a[104:107], v33 offset:4096
    ds_read_b64_tr_b16 v[154:155], v11 offset:58648
    s_waitcnt lgkmcnt(14)
    v_mfma_f32_16x16x32_bf16 v[56:59], v[136:139], a[8:11], v[56:59]
    ds_read_b128 a[28:31], v34 offset:0
    ds_read_b64_tr_b16 v[156:157], v11 offset:57376
    v_mfma_f32_16x16x32_bf16 v[76:79], v[136:139], a[88:91], v[76:79]
    ds_read_b128 a[108:111], v34 offset:4096
    ds_read_b64_tr_b16 v[158:159], v11 offset:58656
    s_waitcnt vmcnt(4)
    s_waitcnt lgkmcnt(0)
    s_barrier
    v_mfma_f32_16x16x32_bf16 v[40:43], v[140:143], a[12:15], v[40:43]
    v_mfma_f32_16x16x32_bf16 v[240:243], v[176:179], a[16:19], v[240:243]
    s_add_u32 s76, s71, s66
    s_add_u32 m0, s72, 69632
    ds_read_b64_tr_b16 v[120:121], v10 offset:0
    v_mfma_f32_16x16x32_bf16 v[60:63], v[140:143], a[92:95], v[60:63]
    ds_read_b64_tr_b16 v[122:123], v10 offset:1280
    v_mfma_f32_16x16x32_bf16 v[44:47], v[144:147], a[12:15], v[44:47]
    ds_read_b64_tr_b16 v[124:125], v10 offset:8
    buffer_load_dwordx4 v23, s[4:7], s76 offen offset:0 lds
    v_mfma_f32_16x16x32_bf16 v[64:67], v[144:147], a[92:95], v[64:67]
    ds_read_b64_tr_b16 v[126:127], v10 offset:1288
    v_mfma_f32_16x16x32_bf16 v[48:51], v[148:151], a[12:15], v[48:51]
    ds_read_b64_tr_b16 v[128:129], v10 offset:16
    v_mfma_f32_16x16x32_bf16 v[68:71], v[148:151], a[92:95], v[68:71]
    v_mfma_f32_16x16x32_bf16 v[244:247], a[16:19], v[176:179], v[244:247]
    buffer_load_dwordx4 v24, s[4:7], s76 offen offset:1024 lds
    ds_read_b64_tr_b16 v[130:131], v10 offset:1296
    v_mfma_f32_16x16x32_bf16 v[52:55], v[152:155], a[12:15], v[52:55]
    ds_read_b64_tr_b16 v[132:133], v10 offset:24
    v_mfma_f32_16x16x32_bf16 v[72:75], v[152:155], a[92:95], v[72:75]
    ds_read_b64_tr_b16 v[134:135], v10 offset:1304
    buffer_load_dwordx4 v25, s[4:7], s76 offen offset:2048 lds
    v_mfma_f32_16x16x32_bf16 v[56:59], v[156:159], a[12:15], v[56:59]
    ds_read_b64_tr_b16 v[136:137], v10 offset:32
    v_mfma_f32_16x16x32_bf16 v[76:79], v[156:159], a[92:95], v[76:79]
    ds_read_b64_tr_b16 v[138:139], v10 offset:1312
    s_waitcnt lgkmcnt(8)
    v_mfma_f32_16x16x32_bf16 v[80:83], v[120:123], a[16:19], v[80:83]
    v_mfma_f32_16x16x32_bf16 v[240:243], v[180:183], a[20:23], v[240:243]
    buffer_load_dwordx4 v26, s[4:7], s76 offen offset:3072 lds
    ds_read_b64_tr_b16 v[140:141], v10 offset:8192
    v_mfma_f32_16x16x32_bf16 v[100:103], v[120:123], a[96:99], v[100:103]
    ds_read_b64_tr_b16 v[142:143], v10 offset:9472
    s_waitcnt lgkmcnt(8)
    v_mfma_f32_16x16x32_bf16 v[84:87], v[124:127], a[16:19], v[84:87]
    ds_read_b64_tr_b16 v[144:145], v10 offset:8200
    s_mul_i32 s76, s65, 1920
    s_add_u32 s76, s76, s74
    v_mfma_f32_16x16x32_bf16 v[104:107], v[124:127], a[96:99], v[104:107]
    ds_read_b64_tr_b16 v[146:147], v10 offset:9480
    s_waitcnt lgkmcnt(8)
    v_mfma_f32_16x16x32_bf16 v[88:91], v[128:131], a[16:19], v[88:91]
    ds_read_b64_tr_b16 v[148:149], v10 offset:8208
    v_mfma_f32_16x16x32_bf16 v[108:111], v[128:131], a[96:99], v[108:111]
    v_mfma_f32_16x16x32_bf16 v[244:247], a[20:23], v[180:183], v[244:247]
    s_add_u32 m0, s72, 32768
    ds_read_b64_tr_b16 v[150:151], v10 offset:9488
    s_waitcnt lgkmcnt(8)
    v_mfma_f32_16x16x32_bf16 v[92:95], v[132:135], a[16:19], v[92:95]
    ds_read_b64_tr_b16 v[152:153], v10 offset:8216
    v_mfma_f32_16x16x32_bf16 v[112:115], v[132:135], a[96:99], v[112:115]
    ds_read_b64_tr_b16 v[154:155], v10 offset:9496
    buffer_load_dwordx4 v18, s[8:11], s76 offen offset:0 lds
    s_waitcnt lgkmcnt(8)
    v_mfma_f32_16x16x32_bf16 v[96:99], v[136:139], a[16:19], v[96:99]
    ds_read_b64_tr_b16 v[156:157], v10 offset:8224
    v_mfma_f32_16x16x32_bf16 v[116:119], v[136:139], a[96:99], v[116:119]
    ds_read_b64_tr_b16 v[158:159], v10 offset:9504
    s_waitcnt lgkmcnt(8)
    v_mfma_f32_16x16x32_bf16 v[80:83], v[140:143], a[20:23], v[80:83]
    v_mfma_f32_16x16x32_bf16 v[240:243], v[184:187], a[24:27], v[240:243]
    buffer_load_dwordx4 v19, s[8:11], s76 offen offset:1024 lds
    ds_read_b64_tr_b16 v[120:121], v10 offset:16384
    v_mfma_f32_16x16x32_bf16 v[100:103], v[140:143], a[100:103], v[100:103]
    ds_read_b64_tr_b16 v[122:123], v10 offset:17664
    s_waitcnt lgkmcnt(8)
    v_mfma_f32_16x16x32_bf16 v[84:87], v[144:147], a[20:23], v[84:87]
    ds_read_b64_tr_b16 v[124:125], v10 offset:16392
    v_mfma_f32_16x16x32_bf16 v[104:107], v[144:147], a[100:103], v[104:107]
    buffer_load_dwordx4 v20, s[8:11], s76 offen offset:2048 lds
    ds_read_b64_tr_b16 v[126:127], v10 offset:17672
    s_waitcnt lgkmcnt(8)
    v_mfma_f32_16x16x32_bf16 v[88:91], v[148:151], a[20:23], v[88:91]
    ds_read_b64_tr_b16 v[128:129], v10 offset:16400
    v_mfma_f32_16x16x32_bf16 v[244:247], a[24:27], v[184:187], v[244:247]
    v_mfma_f32_16x16x32_bf16 v[108:111], v[148:151], a[100:103], v[108:111]
    ds_read_b64_tr_b16 v[130:131], v10 offset:17680
    s_waitcnt lgkmcnt(8)
    v_mfma_f32_16x16x32_bf16 v[92:95], v[152:155], a[20:23], v[92:95]
    ds_read_b64_tr_b16 v[132:133], v10 offset:16408
    buffer_load_dwordx4 v21, s[8:11], s76 offen offset:3072 lds
    v_mfma_f32_16x16x32_bf16 v[112:115], v[152:155], a[100:103], v[112:115]
    ds_read_b64_tr_b16 v[134:135], v10 offset:17688
    s_waitcnt lgkmcnt(8)
    v_mfma_f32_16x16x32_bf16 v[96:99], v[156:159], a[20:23], v[96:99]
    ds_read_b64_tr_b16 v[136:137], v10 offset:16416
    v_mfma_f32_16x16x32_bf16 v[116:119], v[156:159], a[100:103], v[116:119]
    ds_read_b64_tr_b16 v[138:139], v10 offset:17696
    s_waitcnt lgkmcnt(8)
    v_mfma_f32_16x16x32_bf16 v[80:83], v[120:123], a[24:27], v[80:83]
    v_add_u32 v31, 65536, v27
    s_add_u32 m0, s72, 36864
    v_add_u32 v32, 65536, v28
    ds_read_b64_tr_b16 v[140:141], v10 offset:24576
    v_mfma_f32_16x16x32_bf16 v[100:103], v[120:123], a[104:107], v[100:103]
    v_add_u32 v33, 65536, v29
    ds_read_b64_tr_b16 v[142:143], v10 offset:25856
    s_waitcnt lgkmcnt(8)
    v_mfma_f32_16x16x32_bf16 v[84:87], v[124:127], a[24:27], v[84:87]
    v_add_u32 v34, 65536, v30
    buffer_load_dwordx4 v22, s[8:11], s76 offen offset:0 lds
    s_waitcnt vmcnt(5)
    ds_read_b64_tr_b16 v[144:145], v10 offset:24584
    v_mfma_f32_16x16x32_bf16 v[104:107], v[124:127], a[104:107], v[104:107]
    ds_read_b128 a[32:35], v31 offset:0
    ds_read_b64_tr_b16 v[146:147], v10 offset:25864
    s_waitcnt lgkmcnt(9)
    v_mfma_f32_16x16x32_bf16 v[88:91], v[128:131], a[24:27], v[88:91]
    ds_read_b128 a[112:115], v31 offset:4096
    s_mul_i32 s76, s66, 640
    s_add_u32 s76, s76, s73
    ds_read_b128 a[36:39], v32 offset:0
    ds_read_b64_tr_b16 v[148:149], v10 offset:24592
    v_mfma_f32_16x16x32_bf16 v[108:111], v[128:131], a[104:107], v[108:111]
    ds_read_b128 a[116:119], v32 offset:4096
    ds_read_b64_tr_b16 v[150:151], v10 offset:25872
    s_waitcnt lgkmcnt(12)
    v_mfma_f32_16x16x32_bf16 v[92:95], v[132:135], a[24:27], v[92:95]
    ds_read_b128 a[40:43], v33 offset:0
    s_add_u32 m0, s72, 131072
    ds_read_b128 a[120:123], v33 offset:4096
    ds_read_b64_tr_b16 v[152:153], v10 offset:24600
    v_mfma_f32_16x16x32_bf16 v[112:115], v[132:135], a[104:107], v[112:115]
    ds_read_b128 a[44:47], v34 offset:0
    ds_read_b64_tr_b16 v[154:155], v10 offset:25880
    s_waitcnt lgkmcnt(15)
    v_mfma_f32_16x16x32_bf16 v[96:99], v[136:139], a[24:27], v[96:99]
    ds_read_b128 a[124:127], v34 offset:4096
    buffer_load_dwordx4 v13, s[12:15], s76 offen offset:0 lds
    v_mfma_f32_16x16x32_bf16 v[240:243], v[188:191], a[28:31], v[240:243]
    ds_read_b64_tr_b16 v[156:157], v10 offset:24608
    v_mfma_f32_16x16x32_bf16 v[116:119], v[136:139], a[104:107], v[116:119]
    v_mfma_f32_16x16x32_bf16 v[244:247], a[28:31], v[188:191], v[244:247]
    ds_read_b64_tr_b16 v[158:159], v10 offset:25888
    s_waitcnt vmcnt(1)
    s_waitcnt lgkmcnt(0)
    s_barrier
    v_mfma_f32_16x16x32_bf16 v[80:83], v[140:143], a[28:31], v[80:83]
    v_mfma_f32_16x16x32_bf16 v[240:243], v[192:195], a[32:35], v[240:243]
    buffer_load_dwordx4 v14, s[12:15], s76 offen offset:1024 lds
    ds_read_b64_tr_b16 v[120:121], v10 offset:32768
    v_mfma_f32_16x16x32_bf16 v[100:103], v[140:143], a[108:111], v[100:103]
    ds_read_b64_tr_b16 v[122:123], v10 offset:34048
    v_mfma_f32_16x16x32_bf16 v[84:87], v[144:147], a[28:31], v[84:87]
    ds_read_b64_tr_b16 v[124:125], v10 offset:32776
    v_mfma_f32_16x16x32_bf16 v[104:107], v[144:147], a[108:111], v[104:107]
    buffer_load_dwordx4 v15, s[12:15], s76 offen offset:2048 lds
    ds_read_b64_tr_b16 v[126:127], v10 offset:34056
    v_mfma_f32_16x16x32_bf16 v[88:91], v[148:151], a[28:31], v[88:91]
    ds_read_b64_tr_b16 v[128:129], v10 offset:32784
    v_mfma_f32_16x16x32_bf16 v[244:247], a[32:35], v[192:195], v[244:247]
    v_mfma_f32_16x16x32_bf16 v[108:111], v[148:151], a[108:111], v[108:111]
    ds_read_b64_tr_b16 v[130:131], v10 offset:34064
    v_mfma_f32_16x16x32_bf16 v[92:95], v[152:155], a[28:31], v[92:95]
    ds_read_b64_tr_b16 v[132:133], v10 offset:32792
    buffer_load_dwordx4 v16, s[12:15], s76 offen offset:3072 lds
    v_mfma_f32_16x16x32_bf16 v[112:115], v[152:155], a[108:111], v[112:115]
    ds_read_b64_tr_b16 v[134:135], v10 offset:34072
    v_mfma_f32_16x16x32_bf16 v[96:99], v[156:159], a[28:31], v[96:99]
    ds_read_b64_tr_b16 v[136:137], v10 offset:32800
    v_mfma_f32_16x16x32_bf16 v[116:119], v[156:159], a[108:111], v[116:119]
    ds_read_b64_tr_b16 v[138:139], v10 offset:34080
    s_waitcnt lgkmcnt(8)
    v_mfma_f32_16x16x32_bf16 v[40:43], v[120:123], a[16:19], v[40:43]
    v_mfma_f32_16x16x32_bf16 v[240:243], v[196:199], a[36:39], v[240:243]
    s_add_u32 m0, s72, 135168
    ds_read_b64_tr_b16 v[140:141], v10 offset:40960
    v_mfma_f32_16x16x32_bf16 v[60:63], v[120:123], a[96:99], v[60:63]
    ds_read_b64_tr_b16 v[142:143], v10 offset:42240
    s_waitcnt lgkmcnt(8)
    v_mfma_f32_16x16x32_bf16 v[44:47], v[124:127], a[16:19], v[44:47]
    ds_read_b64_tr_b16 v[144:145], v10 offset:40968
    buffer_load_dwordx4 v17, s[12:15], s76 offen offset:0 lds
    v_mfma_f32_16x16x32_bf16 v[64:67], v[124:127], a[96:99], v[64:67]
    ds_read_b64_tr_b16 v[146:147], v10 offset:42248
    s_waitcnt lgkmcnt(8)
    v_mfma_f32_16x16x32_bf16 v[48:51], v[128:131], a[16:19], v[48:51]
    ds_read_b64_tr_b16 v[148:149], v10 offset:40976
    v_mfma_f32_16x16x32_bf16 v[68:71], v[128:131], a[96:99], v[68:71]
    v_mfma_f32_16x16x32_bf16 v[244:247], a[36:39], v[196:199], v[244:247]
    s_add_u32 s76, s70, s67
    s_add_u32 m0, s72, 98304
    ds_read_b64_tr_b16 v[150:151], v10 offset:42256
    s_waitcnt lgkmcnt(8)
    v_mfma_f32_16x16x32_bf16 v[52:55], v[132:135], a[16:19], v[52:55]
    ds_read_b64_tr_b16 v[152:153], v10 offset:40984
    v_mfma_f32_16x16x32_bf16 v[72:75], v[132:135], a[96:99], v[72:75]
    ds_read_b64_tr_b16 v[154:155], v10 offset:42264
    buffer_load_dwordx4 v23, s[4:7], s76 offen offset:0 lds
    s_waitcnt lgkmcnt(8)
    v_mfma_f32_16x16x32_bf16 v[56:59], v[136:139], a[16:19], v[56:59]
    ds_read_b64_tr_b16 v[156:157], v10 offset:40992
    v_mfma_f32_16x16x32_bf16 v[76:79], v[136:139], a[96:99], v[76:79]
    ds_read_b64_tr_b16 v[158:159], v10 offset:42272
    s_waitcnt lgkmcnt(8)
    v_mfma_f32_16x16x32_bf16 v[40:43], v[140:143], a[20:23], v[40:43]
    v_mfma_f32_16x16x32_bf16 v[240:243], v[200:203], a[40:43], v[240:243]
    buffer_load_dwordx4 v24, s[4:7], s76 offen offset:1024 lds
    ds_read_b64_tr_b16 v[120:121], v10 offset:49152
    v_mfma_f32_16x16x32_bf16 v[60:63], v[140:143], a[100:103], v[60:63]
    ds_read_b64_tr_b16 v[122:123], v10 offset:50432
    s_waitcnt lgkmcnt(8)
    v_mfma_f32_16x16x32_bf16 v[44:47], v[144:147], a[20:23], v[44:47]
    ds_read_b64_tr_b16 v[124:125], v10 offset:49160
    v_mfma_f32_16x16x32_bf16 v[64:67], v[144:147], a[100:103], v[64:67]
    buffer_load_dwordx4 v25, s[4:7], s76 offen offset:2048 lds
    ds_read_b64_tr_b16 v[126:127], v10 offset:50440
    s_waitcnt lgkmcnt(8)
    v_mfma_f32_16x16x32_bf16 v[48:51], v[148:151], a[20:23], v[48:51]
    ds_read_b64_tr_b16 v[128:129], v10 offset:49168
    v_mfma_f32_16x16x32_bf16 v[244:247], a[40:43], v[200:203], v[244:247]
    v_mfma_f32_16x16x32_bf16 v[68:71], v[148:151], a[100:103], v[68:71]
    ds_read_b64_tr_b16 v[130:131], v10 offset:50448
    s_waitcnt lgkmcnt(8)
    v_mfma_f32_16x16x32_bf16 v[52:55], v[152:155], a[20:23], v[52:55]
    ds_read_b64_tr_b16 v[132:133], v10 offset:49176
    buffer_load_dwordx4 v26, s[4:7], s76 offen offset:3072 lds
    v_mfma_f32_16x16x32_bf16 v[72:75], v[152:155], a[100:103], v[72:75]
    ds_read_b64_tr_b16 v[134:135], v10 offset:50456
    s_waitcnt lgkmcnt(8)
    v_mfma_f32_16x16x32_bf16 v[56:59], v[156:159], a[20:23], v[56:59]
    ds_read_b64_tr_b16 v[136:137], v10 offset:49184
    v_mfma_f32_16x16x32_bf16 v[76:79], v[156:159], a[100:103], v[76:79]
    ds_read_b64_tr_b16 v[138:139], v10 offset:50464
    s_waitcnt lgkmcnt(8)
    v_mfma_f32_16x16x32_bf16 v[40:43], v[120:123], a[24:27], v[40:43]
    v_mfma_f32_16x16x32_bf16 v[240:243], v[204:207], a[44:47], v[240:243]
    s_add_u32 s76, s71, s67
    s_add_u32 m0, s72, 102400
    ds_read_b64_tr_b16 v[140:141], v10 offset:57344
    v_mfma_f32_16x16x32_bf16 v[60:63], v[120:123], a[104:107], v[60:63]
    ds_read_b64_tr_b16 v[142:143], v10 offset:58624
    s_waitcnt lgkmcnt(8)
    v_mfma_f32_16x16x32_bf16 v[44:47], v[124:127], a[24:27], v[44:47]
    ds_read_b64_tr_b16 v[144:145], v10 offset:57352
    v_mfma_f32_16x16x32_bf16 v[64:67], v[124:127], a[104:107], v[64:67]
    buffer_load_dwordx4 v23, s[4:7], s76 offen offset:0 lds
    ds_read_b64_tr_b16 v[146:147], v10 offset:58632
    s_waitcnt lgkmcnt(8)
    v_mfma_f32_16x16x32_bf16 v[48:51], v[128:131], a[24:27], v[48:51]
    ds_read_b64_tr_b16 v[148:149], v10 offset:57360
    v_mfma_f32_16x16x32_bf16 v[244:247], a[44:47], v[204:207], v[244:247]
    v_mfma_f32_16x16x32_bf16 v[68:71], v[128:131], a[104:107], v[68:71]
    ds_read_b64_tr_b16 v[150:151], v10 offset:58640
    s_waitcnt lgkmcnt(8)
    v_mfma_f32_16x16x32_bf16 v[52:55], v[132:135], a[24:27], v[52:55]
    ds_read_b64_tr_b16 v[152:153], v10 offset:57368
    buffer_load_dwordx4 v24, s[4:7], s76 offen offset:1024 lds
    v_mfma_f32_16x16x32_bf16 v[72:75], v[132:135], a[104:107], v[72:75]
    ds_read_b64_tr_b16 v[154:155], v10 offset:58648
    s_waitcnt lgkmcnt(8)
    v_mfma_f32_16x16x32_bf16 v[56:59], v[136:139], a[24:27], v[56:59]
    ds_read_b64_tr_b16 v[156:157], v10 offset:57376
    v_mfma_f32_16x16x32_bf16 v[76:79], v[136:139], a[104:107], v[76:79]
    ds_read_b64_tr_b16 v[158:159], v10 offset:58656
    s_waitcnt vmcnt(6)
    s_waitcnt lgkmcnt(0)
    s_barrier
    v_mfma_f32_16x16x32_bf16 v[40:43], v[140:143], a[28:31], v[40:43]
    buffer_load_dwordx4 v25, s[4:7], s76 offen offset:2048 lds
    ds_read_b64_tr_b16 v[120:121], v12 offset:0
    v_mfma_f32_16x16x32_bf16 v[60:63], v[140:143], a[108:111], v[60:63]
    ds_read_b64_tr_b16 v[122:123], v12 offset:1280
    v_mfma_f32_16x16x32_bf16 v[44:47], v[144:147], a[28:31], v[44:47]
    buffer_load_dwordx4 v26, s[4:7], s76 offen offset:3072 lds
    ds_read_b64_tr_b16 v[124:125], v12 offset:8
    v_mfma_f32_16x16x32_bf16 v[64:67], v[144:147], a[108:111], v[64:67]
    ds_read_b64_tr_b16 v[126:127], v12 offset:1288
    v_mfma_f32_16x16x32_bf16 v[48:51], v[148:151], a[28:31], v[48:51]
    s_mul_i32 s76, s67, 640
    s_add_u32 s76, s76, s73
    ds_read_b64_tr_b16 v[128:129], v12 offset:16
    v_mfma_f32_16x16x32_bf16 v[68:71], v[148:151], a[108:111], v[68:71]
    ds_read_b64_tr_b16 v[130:131], v12 offset:1296
    v_mfma_f32_16x16x32_bf16 v[52:55], v[152:155], a[28:31], v[52:55]
    s_add_u32 m0, s72, 65536
    ds_read_b64_tr_b16 v[132:133], v12 offset:24
    v_mfma_f32_16x16x32_bf16 v[72:75], v[152:155], a[108:111], v[72:75]
    ds_read_b64_tr_b16 v[134:135], v12 offset:1304
    v_mfma_f32_16x16x32_bf16 v[56:59], v[156:159], a[28:31], v[56:59]
    buffer_load_dwordx4 v13, s[12:15], s76 offen offset:0 lds
    ds_read_b64_tr_b16 v[136:137], v12 offset:32
    v_mfma_f32_16x16x32_bf16 v[76:79], v[156:159], a[108:111], v[76:79]
    ds_read_b64_tr_b16 v[138:139], v12 offset:1312
    s_waitcnt lgkmcnt(8)
    v_mfma_f32_16x16x32_bf16 v[80:83], v[120:123], a[32:35], v[80:83]
    buffer_load_dwordx4 v14, s[12:15], s76 offen offset:1024 lds
    ds_read_b64_tr_b16 v[140:141], v12 offset:8192
    v_mfma_f32_16x16x32_bf16 v[100:103], v[120:123], a[112:115], v[100:103]
    ds_read_b64_tr_b16 v[142:143], v12 offset:9472
    s_waitcnt lgkmcnt(8)
    v_mfma_f32_16x16x32_bf16 v[84:87], v[124:127], a[32:35], v[84:87]
    ds_read_b64_tr_b16 v[144:145], v12 offset:8200
    v_mfma_f32_16x16x32_bf16 v[104:107], v[124:127], a[112:115], v[104:107]
    ds_read_b64_tr_b16 v[146:147], v12 offset:9480
    s_waitcnt lgkmcnt(8)
    v_mfma_f32_16x16x32_bf16 v[88:91], v[128:131], a[32:35], v[88:91]
    ds_read_b64_tr_b16 v[148:149], v12 offset:8208
    v_mfma_f32_16x16x32_bf16 v[108:111], v[128:131], a[112:115], v[108:111]
    buffer_load_dwordx4 v15, s[12:15], s76 offen offset:2048 lds
    ds_read_b64_tr_b16 v[150:151], v12 offset:9488
    s_waitcnt lgkmcnt(8)
    v_mfma_f32_16x16x32_bf16 v[92:95], v[132:135], a[32:35], v[92:95]
    ds_read_b64_tr_b16 v[152:153], v12 offset:8216
    v_mfma_f32_16x16x32_bf16 v[112:115], v[132:135], a[112:115], v[112:115]
    ds_read_b64_tr_b16 v[154:155], v12 offset:9496
    s_waitcnt lgkmcnt(8)
    v_mfma_f32_16x16x32_bf16 v[96:99], v[136:139], a[32:35], v[96:99]
    ds_read_b64_tr_b16 v[156:157], v12 offset:8224
    v_mfma_f32_16x16x32_bf16 v[116:119], v[136:139], a[112:115], v[116:119]
    ds_read_b64_tr_b16 v[158:159], v12 offset:9504
    s_waitcnt lgkmcnt(8)
    v_mfma_f32_16x16x32_bf16 v[80:83], v[140:143], a[36:39], v[80:83]
    buffer_load_dwordx4 v16, s[12:15], s76 offen offset:3072 lds
    ds_read_b64_tr_b16 v[120:121], v12 offset:16384
    v_mfma_f32_16x16x32_bf16 v[100:103], v[140:143], a[116:119], v[100:103]
    ds_read_b64_tr_b16 v[122:123], v12 offset:17664
    s_waitcnt lgkmcnt(8)
    v_mfma_f32_16x16x32_bf16 v[84:87], v[144:147], a[36:39], v[84:87]
    s_add_u32 m0, s72, 69632
    ds_read_b64_tr_b16 v[124:125], v12 offset:16392
    v_mfma_f32_16x16x32_bf16 v[104:107], v[144:147], a[116:119], v[104:107]
    ds_read_b64_tr_b16 v[126:127], v12 offset:17672
    s_waitcnt lgkmcnt(8)
    v_mfma_f32_16x16x32_bf16 v[88:91], v[148:151], a[36:39], v[88:91]
    buffer_load_dwordx4 v17, s[12:15], s76 offen offset:0 lds
    ds_read_b64_tr_b16 v[128:129], v12 offset:16400
    v_mfma_f32_16x16x32_bf16 v[108:111], v[148:151], a[116:119], v[108:111]
    ds_read_b64_tr_b16 v[130:131], v12 offset:17680
    s_waitcnt lgkmcnt(8)
    v_mfma_f32_16x16x32_bf16 v[92:95], v[152:155], a[36:39], v[92:95]
    s_add_u32 s76, s70, s68
    s_add_u32 m0, s72, 0
    ds_read_b64_tr_b16 v[132:133], v12 offset:16408
    v_mfma_f32_16x16x32_bf16 v[112:115], v[152:155], a[116:119], v[112:115]
    ds_read_b64_tr_b16 v[134:135], v12 offset:17688
    s_waitcnt lgkmcnt(8)
    v_mfma_f32_16x16x32_bf16 v[96:99], v[156:159], a[36:39], v[96:99]
    buffer_load_dwordx4 v23, s[4:7], s76 offen offset:0 lds
    ds_read_b64_tr_b16 v[136:137], v12 offset:16416
    v_mfma_f32_16x16x32_bf16 v[116:119], v[156:159], a[116:119], v[116:119]
    ds_read_b64_tr_b16 v[138:139], v12 offset:17696
    s_waitcnt lgkmcnt(8)
    v_mfma_f32_16x16x32_bf16 v[80:83], v[120:123], a[40:43], v[80:83]
    v_add_u32 v31, 65536, v27
    buffer_load_dwordx4 v24, s[4:7], s76 offen offset:1024 lds
    v_add_u32 v32, 65536, v28
    ds_read_b64_tr_b16 v[140:141], v12 offset:24576
    v_mfma_f32_16x16x32_bf16 v[100:103], v[120:123], a[120:123], v[100:103]
    v_add_u32 v33, 65536, v29
    ds_read_b64_tr_b16 v[142:143], v12 offset:25856
    s_waitcnt lgkmcnt(8)
    v_mfma_f32_16x16x32_bf16 v[84:87], v[124:127], a[40:43], v[84:87]
    v_add_u32 v34, 65536, v30
    ds_read_b64_tr_b16 v[144:145], v12 offset:24584
    s_waitcnt vmcnt(7)
    v_mfma_f32_16x16x32_bf16 v[104:107], v[124:127], a[120:123], v[104:107]
    ds_read_b64_tr_b16 v[146:147], v12 offset:25864
    ds_read_b128 a[48:51], v31 offset:32768
    s_waitcnt lgkmcnt(9)
    v_mfma_f32_16x16x32_bf16 v[88:91], v[128:131], a[40:43], v[88:91]
    ds_read_b64_tr_b16 v[148:149], v12 offset:24592
    ds_read_b128 a[128:131], v31 offset:36864
    v_mfma_f32_16x16x32_bf16 v[108:111], v[128:131], a[120:123], v[108:111]
    ds_read_b128 a[52:55], v32 offset:32768
    buffer_load_dwordx4 v25, s[4:7], s76 offen offset:2048 lds
    ds_read_b64_tr_b16 v[150:151], v12 offset:25872
    ds_read_b128 a[132:135], v32 offset:36864
    s_waitcnt lgkmcnt(12)
    v_mfma_f32_16x16x32_bf16 v[92:95], v[132:135], a[40:43], v[92:95]
    ds_read_b64_tr_b16 v[152:153], v12 offset:24600
    ds_read_b128 a[56:59], v33 offset:32768
    v_mfma_f32_16x16x32_bf16 v[112:115], v[132:135], a[120:123], v[112:115]
    ds_read_b128 a[136:139], v33 offset:36864
    ds_read_b64_tr_b16 v[154:155], v12 offset:25880
    s_waitcnt lgkmcnt(14)
    v_mfma_f32_16x16x32_bf16 v[96:99], v[136:139], a[40:43], v[96:99]
    ds_read_b128 a[60:63], v34 offset:32768
    ds_read_b64_tr_b16 v[156:157], v12 offset:24608
    v_mfma_f32_16x16x32_bf16 v[116:119], v[136:139], a[120:123], v[116:119]
    ds_read_b128 a[140:143], v34 offset:36864
    ds_read_b64_tr_b16 v[158:159], v12 offset:25888
    s_waitcnt vmcnt(3)
    s_waitcnt lgkmcnt(0)
    s_barrier
    v_mfma_f32_16x16x32_bf16 v[80:83], v[140:143], a[44:47], v[80:83]
    v_mfma_f32_16x16x32_bf16 v[240:243], v[208:211], a[48:51], v[240:243]
    buffer_load_dwordx4 v26, s[4:7], s76 offen offset:3072 lds
    ds_read_b64_tr_b16 v[120:121], v11 offset:0
    v_mfma_f32_16x16x32_bf16 v[100:103], v[140:143], a[124:127], v[100:103]
    ds_read_b64_tr_b16 v[122:123], v11 offset:1280
    v_mfma_f32_16x16x32_bf16 v[84:87], v[144:147], a[44:47], v[84:87]
L_padq1:
L_pd1268:
    s_cbranch_execz L_pd3857
    ds_read_b64_tr_b16 v[124:125], v11 offset:8
    s_add_u32 s76, s71, s68
    s_add_u32 m0, s72, 4096
    v_mfma_f32_16x16x32_bf16 v[104:107], v[144:147], a[124:127], v[104:107]
    ds_read_b64_tr_b16 v[126:127], v11 offset:1288
    v_mfma_f32_16x16x32_bf16 v[88:91], v[148:151], a[44:47], v[88:91]
    ds_read_b64_tr_b16 v[128:129], v11 offset:16
    v_mfma_f32_16x16x32_bf16 v[108:111], v[148:151], a[124:127], v[108:111]
    v_mfma_f32_16x16x32_bf16 v[244:247], a[48:51], v[208:211], v[244:247]
    buffer_load_dwordx4 v23, s[4:7], s76 offen offset:0 lds
    ds_read_b64_tr_b16 v[130:131], v11 offset:1296
    v_mfma_f32_16x16x32_bf16 v[92:95], v[152:155], a[44:47], v[92:95]
    ds_read_b64_tr_b16 v[132:133], v11 offset:24
    v_mfma_f32_16x16x32_bf16 v[112:115], v[152:155], a[124:127], v[112:115]
    ds_read_b64_tr_b16 v[134:135], v11 offset:1304
    buffer_load_dwordx4 v24, s[4:7], s76 offen offset:1024 lds
    v_mfma_f32_16x16x32_bf16 v[96:99], v[156:159], a[44:47], v[96:99]
    ds_read_b64_tr_b16 v[136:137], v11 offset:32
    v_mfma_f32_16x16x32_bf16 v[116:119], v[156:159], a[124:127], v[116:119]
    ds_read_b64_tr_b16 v[138:139], v11 offset:1312
    s_waitcnt lgkmcnt(8)
    v_mfma_f32_16x16x32_bf16 v[80:83], v[120:123], a[48:51], v[80:83]
    v_mfma_f32_16x16x32_bf16 v[240:243], v[212:215], a[52:55], v[240:243]
    buffer_load_dwordx4 v25, s[4:7], s76 offen offset:2048 lds
    ds_read_b64_tr_b16 v[140:141], v11 offset:8192
    v_mfma_f32_16x16x32_bf16 v[100:103], v[120:123], a[128:131], v[100:103]
    ds_read_b64_tr_b16 v[142:143], v11 offset:9472
    s_waitcnt lgkmcnt(8)
    v_mfma_f32_16x16x32_bf16 v[84:87], v[124:127], a[48:51], v[84:87]
    ds_read_b64_tr_b16 v[144:145], v11 offset:8200
    v_mfma_f32_16x16x32_bf16 v[104:107], v[124:127], a[128:131], v[104:107]
    ds_read_b64_tr_b16 v[146:147], v11 offset:9480
    s_waitcnt lgkmcnt(8)
    v_mfma_f32_16x16x32_bf16 v[88:91], v[128:131], a[48:51], v[88:91]
    ds_read_b64_tr_b16 v[148:149], v11 offset:8208
    v_mfma_f32_16x16x32_bf16 v[108:111], v[128:131], a[128:131], v[108:111]
    v_mfma_f32_16x16x32_bf16 v[244:247], a[52:55], v[212:215], v[244:247]
    buffer_load_dwordx4 v26, s[4:7], s76 offen offset:3072 lds
    ds_read_b64_tr_b16 v[150:151], v11 offset:9488
    s_waitcnt lgkmcnt(8)
    v_mfma_f32_16x16x32_bf16 v[92:95], v[132:135], a[48:51], v[92:95]
    ds_read_b64_tr_b16 v[152:153], v11 offset:8216
    v_mfma_f32_16x16x32_bf16 v[112:115], v[132:135], a[128:131], v[112:115]
    ds_read_b64_tr_b16 v[154:155], v11 offset:9496
    s_waitcnt lgkmcnt(8)
    v_mfma_f32_16x16x32_bf16 v[96:99], v[136:139], a[48:51], v[96:99]
    ds_read_b64_tr_b16 v[156:157], v11 offset:8224
    v_mfma_f32_16x16x32_bf16 v[116:119], v[136:139], a[128:131], v[116:119]
    ds_read_b64_tr_b16 v[158:159], v11 offset:9504
    s_waitcnt lgkmcnt(8)
    v_mfma_f32_16x16x32_bf16 v[80:83], v[140:143], a[52:55], v[80:83]
    v_mfma_f32_16x16x32_bf16 v[240:243], v[216:219], a[56:59], v[240:243]
    s_mul_i32 s76, s68, 640
    s_add_u32 s76, s76, s73
    ds_read_b64_tr_b16 v[120:121], v11 offset:16384
    v_mfma_f32_16x16x32_bf16 v[100:103], v[140:143], a[132:135], v[100:103]
    ds_read_b64_tr_b16 v[122:123], v11 offset:17664
    s_waitcnt lgkmcnt(8)
    v_mfma_f32_16x16x32_bf16 v[84:87], v[144:147], a[52:55], v[84:87]
    s_add_u32 m0, s72, 32768
    ds_read_b64_tr_b16 v[124:125], v11 offset:16392
    v_mfma_f32_16x16x32_bf16 v[104:107], v[144:147], a[132:135], v[104:107]
    ds_read_b64_tr_b16 v[126:127], v11 offset:17672
    s_waitcnt lgkmcnt(8)
    v_mfma_f32_16x16x32_bf16 v[88:91], v[148:151], a[52:55], v[88:91]
    buffer_load_dwordx4 v13, s[12:15], s76 offen offset:0 lds
    ds_read_b64_tr_b16 v[128:129], v11 offset:16400
    v_mfma_f32_16x16x32_bf16 v[244:247], a[56:59], v[216:219], v[244:247]
    v_mfma_f32_16x16x32_bf16 v[108:111], v[148:151], a[132:135], v[108:111]
    ds_read_b64_tr_b16 v[130:131], v11 offset:17680
    s_waitcnt lgkmcnt(8)
    v_mfma_f32_16x16x32_bf16 v[92:95], v[152:155], a[52:55], v[92:95]
    buffer_load_dwordx4 v14, s[12:15], s76 offen offset:1024 lds
    ds_read_b64_tr_b16 v[132:133], v11 offset:16408
    v_mfma_f32_16x16x32_bf16 v[112:115], v[152:155], a[132:135], v[112:115]
    ds_read_b64_tr_b16 v[134:135], v11 offset:17688
    s_waitcnt lgkmcnt(8)
    v_mfma_f32_16x16x32_bf16 v[96:99], v[156:159], a[52:55], v[96:99]
    buffer_load_dwordx4 v15, s[12:15], s76 offen offset:2048 lds
    ds_read_b64_tr_b16 v[136:137], v11 offset:16416
    v_mfma_f32_16x16x32_bf16 v[116:119], v[156:159], a[132:135], v[116:119]
    ds_read_b64_tr_b16 v[138:139], v11 offset:17696
    s_waitcnt lgkmcnt(8)
    v_mfma_f32_16x16x32_bf16 v[80:83], v[120:123], a[56:59], v[80:83]
    s_waitcnt vmcnt(3)
    buffer_load_dwordx4 v16, s[12:15], s76 offen offset:3072 lds
    ds_read_b64_tr_b16 v[140:141], v11 offset:24576
    ds_read_b128 a[64:67], v27 offset:0
    v_mfma_f32_16x16x32_bf16 v[100:103], v[120:123], a[136:139], v[100:103]
    ds_read_b64_tr_b16 v[142:143], v11 offset:25856
    ds_read_b128 a[144:147], v27 offset:4096
    s_waitcnt lgkmcnt(10)
    v_mfma_f32_16x16x32_bf16 v[84:87], v[124:127], a[56:59], v[84:87]
    ds_read_b64_tr_b16 v[144:145], v11 offset:24584
    ds_read_b128 a[68:71], v28 offset:0
    v_mfma_f32_16x16x32_bf16 v[104:107], v[124:127], a[136:139], v[104:107]
    s_add_u32 m0, s72, 36864
    ds_read_b128 a[148:151], v28 offset:4096
    ds_read_b64_tr_b16 v[146:147], v11 offset:25864
    s_waitcnt lgkmcnt(12)
    v_mfma_f32_16x16x32_bf16 v[88:91], v[128:131], a[56:59], v[88:91]
    ds_read_b128 a[72:75], v29 offset:0
    ds_read_b64_tr_b16 v[148:149], v11 offset:24592
    v_mfma_f32_16x16x32_bf16 v[108:111], v[128:131], a[136:139], v[108:111]
    ds_read_b128 a[152:155], v29 offset:4096
    ds_read_b64_tr_b16 v[150:151], v11 offset:25872
    s_waitcnt lgkmcnt(14)
    v_mfma_f32_16x16x32_bf16 v[92:95], v[132:135], a[56:59], v[92:95]
    ds_read_b128 a[76:79], v30 offset:0
    ds_read_b64_tr_b16 v[152:153], v11 offset:24600
    buffer_load_dwordx4 v17, s[12:15], s76 offen offset:0 lds
    ds_read_b128 a[156:159], v30 offset:4096
    v_mfma_f32_16x16x32_bf16 v[112:115], v[132:135], a[136:139], v[112:115]
    ds_read_b64_tr_b16 v[154:155], v11 offset:25880
    v_mfma_f32_16x16x32_bf16 v[240:243], v[220:223], a[60:63], v[240:243]
    s_waitcnt lgkmcnt(15)
    v_mfma_f32_16x16x32_bf16 v[96:99], v[136:139], a[56:59], v[96:99]
    ds_read_b64_tr_b16 v[156:157], v11 offset:24608
    v_mfma_f32_16x16x32_bf16 v[244:247], a[60:63], v[220:223], v[244:247]
    v_mfma_f32_16x16x32_bf16 v[116:119], v[136:139], a[136:139], v[116:119]
    ds_read_b64_tr_b16 v[158:159], v11 offset:25888
    s_waitcnt vmcnt(0)
    s_waitcnt lgkmcnt(0)
    s_barrier
    v_mfma_f32_16x16x32_bf16 v[80:83], v[140:143], a[60:63], v[80:83]
    v_mfma_f32_16x16x32_bf16 v[240:243], v[224:227], a[64:67], v[240:243]
    s_mul_i32 s76, s66, 1920
    s_add_u32 s76, s76, s74
    v_mfma_f32_16x16x32_bf16 v[244:247], a[64:67], v[224:227], v[244:247]
    ds_read_b64_tr_b16 v[120:121], v10 offset:32768
    v_mfma_f32_16x16x32_bf16 v[100:103], v[140:143], a[140:143], v[100:103]
    v_mfma_f32_16x16x32_bf16 v[240:243], v[228:231], a[68:71], v[240:243]
    ds_read_b64_tr_b16 v[122:123], v10 offset:34048
    v_mfma_f32_16x16x32_bf16 v[84:87], v[144:147], a[60:63], v[84:87]
    v_mfma_f32_16x16x32_bf16 v[244:247], a[68:71], v[228:231], v[244:247]
    s_add_u32 m0, s72, 98304
    v_mfma_f32_16x16x32_bf16 v[240:243], v[232:235], a[72:75], v[240:243]
    ds_read_b64_tr_b16 v[124:125], v10 offset:32776
    v_mfma_f32_16x16x32_bf16 v[104:107], v[144:147], a[140:143], v[104:107]
    v_mfma_f32_16x16x32_bf16 v[244:247], a[72:75], v[232:235], v[244:247]
    ds_read_b64_tr_b16 v[126:127], v10 offset:34056
    v_mfma_f32_16x16x32_bf16 v[88:91], v[148:151], a[60:63], v[88:91]
    v_mfma_f32_16x16x32_bf16 v[240:243], v[236:239], a[76:79], v[240:243]
    buffer_load_dwordx4 v18, s[8:11], s76 offen offset:0 lds
    v_mfma_f32_16x16x32_bf16 v[244:247], a[76:79], v[236:239], v[244:247]
    ds_read_b64_tr_b16 v[128:129], v10 offset:32784
    v_mfma_f32_16x16x32_bf16 v[108:111], v[148:151], a[140:143], v[108:111]
    s_nop 3
    v_mul_f32 v251, 0xbfb8aa3b, v240
    ds_read_b64_tr_b16 v[130:131], v10 offset:34064
    v_mfma_f32_16x16x32_bf16 v[92:95], v[152:155], a[60:63], v[92:95]
    v_exp_f32 v251, v251
    buffer_load_dwordx4 v19, s[8:11], s76 offen offset:1024 lds
    v_mul_f32 v240, 0x3ea52b5c, v240
    ds_read_b64_tr_b16 v[132:133], v10 offset:32792
    v_mfma_f32_16x16x32_bf16 v[112:115], v[152:155], a[140:143], v[112:115]
    v_mul_f32 v241, 0x3ea52b5c, v241
    ds_read_b64_tr_b16 v[134:135], v10 offset:34072
    v_mfma_f32_16x16x32_bf16 v[96:99], v[156:159], a[60:63], v[96:99]
    v_mul_f32 v242, 0x3ea52b5c, v242
    buffer_load_dwordx4 v20, s[8:11], s76 offen offset:2048 lds
    v_mul_f32 v243, 0x3ea52b5c, v243
    ds_read_b64_tr_b16 v[136:137], v10 offset:32800
    v_mfma_f32_16x16x32_bf16 v[116:119], v[156:159], a[140:143], v[116:119]
    v_cndmask_b32 v240, v240, v244, s[46:47]
    ds_read_b64_tr_b16 v[138:139], v10 offset:34080
    s_waitcnt lgkmcnt(8)
    v_mfma_f32_16x16x32_bf16 v[80:83], v[120:123], a[64:67], v[80:83]
    s_lshl_b32 s78, s38, 9
    s_lshl_b32 s79, s75, 8
    s_add_u32 s78, s78, s79
    v_lshlrev_b32 v23, 4, v38
    v_add_u32 v23, s78, v23
    v_xor_b32 v24, 0x100, v23
    v_mul_u32_u24 v26, 6144, v37
    v_add_u32 v25, v23, v26
    v_add_u32 v26, v24, v26
    buffer_load_dwordx4 v21, s[8:11], s76 offen offset:3072 lds
    v_cndmask_b32 v241, v241, v245, s[46:47]
    ds_read_b64_tr_b16 v[140:141], v10 offset:40960
    v_mfma_f32_16x16x32_bf16 v[100:103], v[120:123], a[144:147], v[100:103]
    v_cndmask_b32 v242, v242, v246, s[46:47]
    ds_read_b64_tr_b16 v[142:143], v10 offset:42240
    v_cndmask_b32 v243, v243, v247, s[46:47]
    s_waitcnt lgkmcnt(8)
    v_mfma_f32_16x16x32_bf16 v[84:87], v[124:127], a[64:67], v[84:87]
    ds_read_b64_tr_b16 v[144:145], v10 offset:40968
    v_add_f32 v251, 1.0, v251
    v_mfma_f32_16x16x32_bf16 v[104:107], v[124:127], a[144:147], v[104:107]
    s_add_u32 m0, s72, 102400
    v_rcp_f32 v251, v251
    ds_read_b64_tr_b16 v[146:147], v10 offset:42248
    v_cndmask_b32 v240, v240, 1.0, s[48:49]
    s_waitcnt lgkmcnt(8)
    v_mfma_f32_16x16x32_bf16 v[88:91], v[128:131], a[64:67], v[88:91]
    ds_read_b64_tr_b16 v[148:149], v10 offset:40976
    v_cndmask_b32 v241, v241, 1.0, s[48:49]
    v_mfma_f32_16x16x32_bf16 v[108:111], v[128:131], a[144:147], v[108:111]
    ds_read_b64_tr_b16 v[150:151], v10 offset:42256
    v_cndmask_b32 v242, v242, 1.0, s[48:49]
    s_waitcnt lgkmcnt(8)
    v_mfma_f32_16x16x32_bf16 v[92:95], v[132:135], a[64:67], v[92:95]
    v_cndmask_b32 v243, v243, 1.0, s[48:49]
    ds_read_b64_tr_b16 v[152:153], v10 offset:40984
    buffer_load_dwordx4 v22, s[8:11], s76 offen offset:0 lds
    v_cvt_pk_bf16_f32 v244, v240, v241
    v_mfma_f32_16x16x32_bf16 v[112:115], v[132:135], a[144:147], v[112:115]
    ds_read_b64_tr_b16 v[154:155], v10 offset:42264
    v_cvt_pk_bf16_f32 v245, v242, v243
    s_waitcnt lgkmcnt(8)
    v_mfma_f32_16x16x32_bf16 v[96:99], v[136:139], a[64:67], v[96:99]
    buffer_store_dwordx2 v[244:245], v248, s[16:19], 0 offen sc1
    ds_read_b64_tr_b16 v[156:157], v10 offset:40992
    v_mfma_f32_16x16x32_bf16 v[116:119], v[136:139], a[144:147], v[116:119]
    buffer_store_dword v251, v249, s[16:19], 0 offen sc1
    ds_read_b64_tr_b16 v[158:159], v10 offset:42272
    s_waitcnt lgkmcnt(8)
    v_mfma_f32_16x16x32_bf16 v[80:83], v[140:143], a[68:71], v[80:83]
    s_mul_i32 s76, s67, 1920
    s_add_u32 s76, s76, s74
    ds_read_b64_tr_b16 v[120:121], v10 offset:49152
    v_mfma_f32_16x16x32_bf16 v[100:103], v[140:143], a[148:151], v[100:103]
    ds_read_b64_tr_b16 v[122:123], v10 offset:50432
    s_waitcnt lgkmcnt(8)
    v_mfma_f32_16x16x32_bf16 v[84:87], v[144:147], a[68:71], v[84:87]
    s_add_u32 m0, s72, 131072
    ds_read_b64_tr_b16 v[124:125], v10 offset:49160
    v_mfma_f32_16x16x32_bf16 v[104:107], v[144:147], a[148:151], v[104:107]
    ds_read_b64_tr_b16 v[126:127], v10 offset:50440
    s_waitcnt lgkmcnt(8)
    v_mfma_f32_16x16x32_bf16 v[88:91], v[148:151], a[68:71], v[88:91]
    buffer_load_dwordx4 v18, s[8:11], s76 offen offset:0 lds
    ds_read_b64_tr_b16 v[128:129], v10 offset:49168
    v_mfma_f32_16x16x32_bf16 v[108:111], v[148:151], a[148:151], v[108:111]
    ds_read_b64_tr_b16 v[130:131], v10 offset:50448
    s_waitcnt lgkmcnt(8)
    v_mfma_f32_16x16x32_bf16 v[92:95], v[152:155], a[68:71], v[92:95]
    buffer_load_dwordx4 v19, s[8:11], s76 offen offset:1024 lds
    ds_read_b64_tr_b16 v[132:133], v10 offset:49176
    v_mfma_f32_16x16x32_bf16 v[112:115], v[152:155], a[148:151], v[112:115]
    ds_read_b64_tr_b16 v[134:135], v10 offset:50456
    s_waitcnt lgkmcnt(8)
    v_mfma_f32_16x16x32_bf16 v[96:99], v[156:159], a[68:71], v[96:99]
    buffer_load_dwordx4 v20, s[8:11], s76 offen offset:2048 lds
    ds_read_b64_tr_b16 v[136:137], v10 offset:49184
    v_mfma_f32_16x16x32_bf16 v[116:119], v[156:159], a[148:151], v[116:119]
    ds_read_b64_tr_b16 v[138:139], v10 offset:50464
    s_waitcnt lgkmcnt(8)
    v_mfma_f32_16x16x32_bf16 v[80:83], v[120:123], a[72:75], v[80:83]
    buffer_load_dwordx4 v21, s[8:11], s76 offen offset:3072 lds
    ds_read_b64_tr_b16 v[140:141], v10 offset:57344
    v_mfma_f32_16x16x32_bf16 v[100:103], v[120:123], a[152:155], v[100:103]
    ds_read_b64_tr_b16 v[142:143], v10 offset:58624
    s_waitcnt lgkmcnt(8)
    v_mfma_f32_16x16x32_bf16 v[84:87], v[124:127], a[72:75], v[84:87]
    ds_read_b64_tr_b16 v[144:145], v10 offset:57352
    v_mfma_f32_16x16x32_bf16 v[104:107], v[124:127], a[152:155], v[104:107]
    s_add_u32 m0, s72, 135168
    ds_read_b64_tr_b16 v[146:147], v10 offset:58632
    s_waitcnt lgkmcnt(8)
    v_mfma_f32_16x16x32_bf16 v[88:91], v[128:131], a[72:75], v[88:91]
    ds_read_b64_tr_b16 v[148:149], v10 offset:57360
    v_mfma_f32_16x16x32_bf16 v[108:111], v[128:131], a[152:155], v[108:111]
    ds_read_b64_tr_b16 v[150:151], v10 offset:58640
    s_waitcnt lgkmcnt(8)
    v_mfma_f32_16x16x32_bf16 v[92:95], v[132:135], a[72:75], v[92:95]
    ds_read_b64_tr_b16 v[152:153], v10 offset:57368
    buffer_load_dwordx4 v22, s[8:11], s76 offen offset:0 lds
    v_mfma_f32_16x16x32_bf16 v[112:115], v[132:135], a[152:155], v[112:115]
    ds_read_b64_tr_b16 v[154:155], v10 offset:58648
    s_waitcnt lgkmcnt(8)
    v_mfma_f32_16x16x32_bf16 v[96:99], v[136:139], a[72:75], v[96:99]
    ds_read_b64_tr_b16 v[156:157], v10 offset:57376
    v_mfma_f32_16x16x32_bf16 v[116:119], v[136:139], a[152:155], v[116:119]
    ds_read_b64_tr_b16 v[158:159], v10 offset:58656
    s_waitcnt vmcnt(7)
    s_waitcnt vmcnt(5)
    s_waitcnt lgkmcnt(0)
    s_barrier
    v_mfma_f32_16x16x32_bf16 v[80:83], v[140:143], a[76:79], v[80:83]
    s_lshl_b32 s78, s36, 4
    s_lshr_b32 s79, s37, 1
    s_lshl_b32 s79, s79, 2
    s_add_u32 s78, s78, s79
    s_cmp_eq_u32 s38, 0
    s_cselect_b32 s78, s78, 0x1000
    v_mov_b32 v6, 1
    v_mov_b32 v7, s78
    s_mov_b64 exec, 1
    buffer_atomic_add v6, v7, s[20:23], 0 offen sc1
    s_mov_b64 exec, -1
    ds_read_b64_tr_b16 v[120:121], v11 offset:32768
    v_mfma_f32_16x16x32_bf16 v[100:103], v[140:143], a[156:159], v[100:103]
    ds_read_b64_tr_b16 v[122:123], v11 offset:34048
    s_mul_i32 s76, s68, 1920
    s_add_u32 s76, s76, s74
    v_mfma_f32_16x16x32_bf16 v[84:87], v[144:147], a[76:79], v[84:87]
    ds_read_b64_tr_b16 v[124:125], v11 offset:32776
    v_mfma_f32_16x16x32_bf16 v[104:107], v[144:147], a[156:159], v[104:107]
    s_add_u32 m0, s72, 0
    ds_read_b64_tr_b16 v[126:127], v11 offset:34056
    v_mfma_f32_16x16x32_bf16 v[88:91], v[148:151], a[76:79], v[88:91]
    ds_read_b64_tr_b16 v[128:129], v11 offset:32784
    v_mfma_f32_16x16x32_bf16 v[108:111], v[148:151], a[156:159], v[108:111]
    buffer_load_dwordx4 v18, s[8:11], s76 offen offset:0 lds
    ds_read_b64_tr_b16 v[130:131], v11 offset:34064
    v_mfma_f32_16x16x32_bf16 v[92:95], v[152:155], a[76:79], v[92:95]
    ds_read_b64_tr_b16 v[132:133], v11 offset:32792
    buffer_load_dwordx4 v19, s[8:11], s76 offen offset:1024 lds
    v_mfma_f32_16x16x32_bf16 v[112:115], v[152:155], a[156:159], v[112:115]
    ds_read_b64_tr_b16 v[134:135], v11 offset:34072
    v_mfma_f32_16x16x32_bf16 v[96:99], v[156:159], a[76:79], v[96:99]
    buffer_load_dwordx4 v20, s[8:11], s76 offen offset:2048 lds
    ds_read_b64_tr_b16 v[136:137], v11 offset:32800
    v_mfma_f32_16x16x32_bf16 v[116:119], v[156:159], a[156:159], v[116:119]
    ds_read_b64_tr_b16 v[138:139], v11 offset:34080
    s_waitcnt lgkmcnt(8)
    v_mfma_f32_16x16x32_bf16 v[40:43], v[120:123], a[32:35], v[40:43]
    v_cvt_pk_bf16_f32 v160, v80, v81
    buffer_load_dwordx4 v21, s[8:11], s76 offen offset:3072 lds
    v_cvt_pk_bf16_f32 v161, v82, v83
    ds_read_b64_tr_b16 v[140:141], v11 offset:40960
    v_mfma_f32_16x16x32_bf16 v[60:63], v[120:123], a[112:115], v[60:63]
    v_cvt_pk_bf16_f32 v162, v84, v85
    ds_read_b64_tr_b16 v[142:143], v11 offset:42240
    v_cvt_pk_bf16_f32 v163, v86, v87
    s_waitcnt lgkmcnt(8)
    v_mfma_f32_16x16x32_bf16 v[44:47], v[124:127], a[32:35], v[44:47]
    ds_read_b64_tr_b16 v[144:145], v11 offset:40968
    v_cvt_pk_bf16_f32 v164, v88, v89
    v_mfma_f32_16x16x32_bf16 v[64:67], v[124:127], a[112:115], v[64:67]
    s_add_u32 m0, s72, 4096
    v_cvt_pk_bf16_f32 v165, v90, v91
    ds_read_b64_tr_b16 v[146:147], v11 offset:42248
    v_cvt_pk_bf16_f32 v166, v92, v93
    s_waitcnt lgkmcnt(8)
    v_mfma_f32_16x16x32_bf16 v[48:51], v[128:131], a[32:35], v[48:51]
    ds_read_b64_tr_b16 v[148:149], v11 offset:40976
    v_cvt_pk_bf16_f32 v167, v94, v95
    v_mfma_f32_16x16x32_bf16 v[68:71], v[128:131], a[112:115], v[68:71]
    ds_read_b64_tr_b16 v[150:151], v11 offset:42256
    v_cvt_pk_bf16_f32 v168, v96, v97
    s_waitcnt lgkmcnt(8)
    v_mfma_f32_16x16x32_bf16 v[52:55], v[132:135], a[32:35], v[52:55]
    v_cvt_pk_bf16_f32 v169, v98, v99
    ds_read_b64_tr_b16 v[152:153], v11 offset:40984
    buffer_load_dwordx4 v22, s[8:11], s76 offen offset:0 lds
    v_mov_b32 v170, 0
    v_mfma_f32_16x16x32_bf16 v[72:75], v[132:135], a[112:115], v[72:75]
    ds_read_b64_tr_b16 v[154:155], v11 offset:42264
    v_mov_b32 v171, 0
    s_waitcnt lgkmcnt(8)
    v_mfma_f32_16x16x32_bf16 v[56:59], v[136:139], a[32:35], v[56:59]
    v_cvt_pk_bf16_f32 v172, v100, v101
    ds_read_b64_tr_b16 v[156:157], v11 offset:40992
    v_mfma_f32_16x16x32_bf16 v[76:79], v[136:139], a[112:115], v[76:79]
    v_cvt_pk_bf16_f32 v173, v102, v103
    ds_read_b64_tr_b16 v[158:159], v11 offset:42272
    s_waitcnt lgkmcnt(8)
    v_mfma_f32_16x16x32_bf16 v[40:43], v[140:143], a[36:39], v[40:43]
    v_cvt_pk_bf16_f32 v174, v104, v105
    ds_read_b64_tr_b16 v[120:121], v11 offset:49152
    v_cvt_pk_bf16_f32 v175, v106, v107
    v_mfma_f32_16x16x32_bf16 v[60:63], v[140:143], a[116:119], v[60:63]
    ds_read_b64_tr_b16 v[122:123], v11 offset:50432
    v_cvt_pk_bf16_f32 v176, v108, v109
    s_waitcnt lgkmcnt(8)
    v_mfma_f32_16x16x32_bf16 v[44:47], v[144:147], a[36:39], v[44:47]
    v_cvt_pk_bf16_f32 v177, v110, v111
    ds_read_b64_tr_b16 v[124:125], v11 offset:49160
    v_mfma_f32_16x16x32_bf16 v[64:67], v[144:147], a[116:119], v[64:67]
    v_cvt_pk_bf16_f32 v178, v112, v113
    ds_read_b64_tr_b16 v[126:127], v11 offset:50440
    v_cvt_pk_bf16_f32 v179, v114, v115
    s_waitcnt lgkmcnt(8)
    v_mfma_f32_16x16x32_bf16 v[48:51], v[148:151], a[36:39], v[48:51]
    ds_read_b64_tr_b16 v[128:129], v11 offset:49168
    v_cvt_pk_bf16_f32 v180, v116, v117
    v_mfma_f32_16x16x32_bf16 v[68:71], v[148:151], a[116:119], v[68:71]
    v_cvt_pk_bf16_f32 v181, v118, v119
    ds_read_b64_tr_b16 v[130:131], v11 offset:50448
    s_waitcnt lgkmcnt(8)
    v_mfma_f32_16x16x32_bf16 v[52:55], v[152:155], a[36:39], v[52:55]
    v_mov_b32 v182, 0
    ds_read_b64_tr_b16 v[132:133], v11 offset:49176
    v_mov_b32 v183, 0
    v_mfma_f32_16x16x32_bf16 v[72:75], v[152:155], a[116:119], v[72:75]
    ds_read_b64_tr_b16 v[134:135], v11 offset:50456
    s_lshl_b32 s52, s36, 3
    s_add_u32 s52, s52, s37
    s_mul_i32 s52, s52, 12288
    s_add_u32 s52, s52, 11534336
    s_add_u32 s53, s52, 4096
    s_waitcnt lgkmcnt(8)
    v_mfma_f32_16x16x32_bf16 v[56:59], v[156:159], a[36:39], v[56:59]
    v_subrev_u32 v29, 12288, v25
    ds_read_b64_tr_b16 v[136:137], v11 offset:49184
    v_mfma_f32_16x16x32_bf16 v[76:79], v[156:159], a[116:119], v[76:79]
    v_subrev_u32 v30, 12288, v26
    ds_read_b64_tr_b16 v[138:139], v11 offset:50464
    s_waitcnt lgkmcnt(8)
    v_mfma_f32_16x16x32_bf16 v[40:43], v[120:123], a[40:43], v[40:43]
    buffer_store_dwordx4 v[160:163], v29, s[16:19], s52 offen offset:0 sc1
    ds_read_b64_tr_b16 v[140:141], v11 offset:57344
    v_mfma_f32_16x16x32_bf16 v[60:63], v[120:123], a[120:123], v[60:63]
    ds_read_b64_tr_b16 v[142:143], v11 offset:58624
    buffer_store_dwordx4 v[164:167], v29, s[16:19], s52 offen offset:2048 sc1
    s_waitcnt lgkmcnt(8)
    v_mfma_f32_16x16x32_bf16 v[44:47], v[124:127], a[40:43], v[44:47]
    ds_read_b64_tr_b16 v[144:145], v11 offset:57352
    v_mfma_f32_16x16x32_bf16 v[64:67], v[124:127], a[120:123], v[64:67]
    buffer_store_dwordx4 v[168:171], v29, s[16:19], s53 offen offset:0 sc1
    ds_read_b64_tr_b16 v[146:147], v11 offset:58632
    s_waitcnt lgkmcnt(8)
    v_mfma_f32_16x16x32_bf16 v[48:51], v[128:131], a[40:43], v[48:51]
    ds_read_b64_tr_b16 v[148:149], v11 offset:57360
    v_mfma_f32_16x16x32_bf16 v[68:71], v[128:131], a[120:123], v[68:71]
    buffer_store_dwordx4 v[172:175], v30, s[16:19], s52 offen offset:0 sc1
    ds_read_b64_tr_b16 v[150:151], v11 offset:58640
    s_waitcnt lgkmcnt(8)
    v_mfma_f32_16x16x32_bf16 v[52:55], v[132:135], a[40:43], v[52:55]
    ds_read_b64_tr_b16 v[152:153], v11 offset:57368
    buffer_store_dwordx4 v[176:179], v30, s[16:19], s52 offen offset:2048 sc1
    v_mfma_f32_16x16x32_bf16 v[72:75], v[132:135], a[120:123], v[72:75]
    ds_read_b64_tr_b16 v[154:155], v11 offset:58648
    s_waitcnt lgkmcnt(8)
    v_mfma_f32_16x16x32_bf16 v[56:59], v[136:139], a[40:43], v[56:59]
    buffer_store_dwordx4 v[180:183], v30, s[16:19], s53 offen offset:0 sc1
    ds_read_b64_tr_b16 v[156:157], v11 offset:57376
    v_mfma_f32_16x16x32_bf16 v[76:79], v[136:139], a[120:123], v[76:79]
    ds_read_b64_tr_b16 v[158:159], v11 offset:58656
    s_waitcnt vmcnt(12)
    s_waitcnt lgkmcnt(0)
    s_barrier
    v_mfma_f32_16x16x32_bf16 v[40:43], v[140:143], a[44:47], v[40:43]
    ds_read_b64_tr_b16 v[120:121], v12 offset:0
    v_mfma_f32_16x16x32_bf16 v[60:63], v[140:143], a[124:127], v[60:63]
    ds_read_b64_tr_b16 v[122:123], v12 offset:1280
    v_mfma_f32_16x16x32_bf16 v[44:47], v[144:147], a[44:47], v[44:47]
    ds_read_b64_tr_b16 v[124:125], v12 offset:8
    v_mfma_f32_16x16x32_bf16 v[64:67], v[144:147], a[124:127], v[64:67]
    ds_read_b64_tr_b16 v[126:127], v12 offset:1288
    v_mfma_f32_16x16x32_bf16 v[48:51], v[148:151], a[44:47], v[48:51]
    ds_read_b64_tr_b16 v[128:129], v12 offset:16
    v_mfma_f32_16x16x32_bf16 v[68:71], v[148:151], a[124:127], v[68:71]
    ds_read_b64_tr_b16 v[130:131], v12 offset:1296
    v_mfma_f32_16x16x32_bf16 v[52:55], v[152:155], a[44:47], v[52:55]
    ds_read_b64_tr_b16 v[132:133], v12 offset:24
    v_mfma_f32_16x16x32_bf16 v[72:75], v[152:155], a[124:127], v[72:75]
    ds_read_b64_tr_b16 v[134:135], v12 offset:1304
    v_mfma_f32_16x16x32_bf16 v[56:59], v[156:159], a[44:47], v[56:59]
    ds_read_b64_tr_b16 v[136:137], v12 offset:32
    v_mfma_f32_16x16x32_bf16 v[76:79], v[156:159], a[124:127], v[76:79]
    ds_read_b64_tr_b16 v[138:139], v12 offset:1312
    s_waitcnt lgkmcnt(8)
    v_mfma_f32_16x16x32_bf16 v[40:43], v[120:123], a[48:51], v[40:43]
    ds_read_b64_tr_b16 v[140:141], v12 offset:8192
    v_mfma_f32_16x16x32_bf16 v[60:63], v[120:123], a[128:131], v[60:63]
    ds_read_b64_tr_b16 v[142:143], v12 offset:9472
    s_waitcnt lgkmcnt(8)
    v_mfma_f32_16x16x32_bf16 v[44:47], v[124:127], a[48:51], v[44:47]
    ds_read_b64_tr_b16 v[144:145], v12 offset:8200
    v_mfma_f32_16x16x32_bf16 v[64:67], v[124:127], a[128:131], v[64:67]
    ds_read_b64_tr_b16 v[146:147], v12 offset:9480
    s_waitcnt lgkmcnt(8)
    v_mfma_f32_16x16x32_bf16 v[48:51], v[128:131], a[48:51], v[48:51]
    ds_read_b64_tr_b16 v[148:149], v12 offset:8208
    v_mfma_f32_16x16x32_bf16 v[68:71], v[128:131], a[128:131], v[68:71]
    ds_read_b64_tr_b16 v[150:151], v12 offset:9488
    s_waitcnt lgkmcnt(8)
    v_mfma_f32_16x16x32_bf16 v[52:55], v[132:135], a[48:51], v[52:55]
    ds_read_b64_tr_b16 v[152:153], v12 offset:8216
    v_mfma_f32_16x16x32_bf16 v[72:75], v[132:135], a[128:131], v[72:75]
    ds_read_b64_tr_b16 v[154:155], v12 offset:9496
    s_waitcnt lgkmcnt(8)
    v_mfma_f32_16x16x32_bf16 v[56:59], v[136:139], a[48:51], v[56:59]
    ds_read_b64_tr_b16 v[156:157], v12 offset:8224
    v_mfma_f32_16x16x32_bf16 v[76:79], v[136:139], a[128:131], v[76:79]
    ds_read_b64_tr_b16 v[158:159], v12 offset:9504
    s_waitcnt lgkmcnt(8)
    v_mfma_f32_16x16x32_bf16 v[40:43], v[140:143], a[52:55], v[40:43]
    ds_read_b64_tr_b16 v[120:121], v12 offset:16384
    v_mfma_f32_16x16x32_bf16 v[60:63], v[140:143], a[132:135], v[60:63]
    ds_read_b64_tr_b16 v[122:123], v12 offset:17664
    s_waitcnt lgkmcnt(8)
    v_mfma_f32_16x16x32_bf16 v[44:47], v[144:147], a[52:55], v[44:47]
    ds_read_b64_tr_b16 v[124:125], v12 offset:16392
    v_mfma_f32_16x16x32_bf16 v[64:67], v[144:147], a[132:135], v[64:67]
    ds_read_b64_tr_b16 v[126:127], v12 offset:17672
    s_waitcnt lgkmcnt(8)
    v_mfma_f32_16x16x32_bf16 v[48:51], v[148:151], a[52:55], v[48:51]
    ds_read_b64_tr_b16 v[128:129], v12 offset:16400
    v_mfma_f32_16x16x32_bf16 v[68:71], v[148:151], a[132:135], v[68:71]
    ds_read_b64_tr_b16 v[130:131], v12 offset:17680
    s_waitcnt lgkmcnt(8)
    v_mfma_f32_16x16x32_bf16 v[52:55], v[152:155], a[52:55], v[52:55]
    ds_read_b64_tr_b16 v[132:133], v12 offset:16408
    v_mfma_f32_16x16x32_bf16 v[72:75], v[152:155], a[132:135], v[72:75]
    ds_read_b64_tr_b16 v[134:135], v12 offset:17688
    s_waitcnt lgkmcnt(8)
    v_mfma_f32_16x16x32_bf16 v[56:59], v[156:159], a[52:55], v[56:59]
    ds_read_b64_tr_b16 v[136:137], v12 offset:16416
    v_mfma_f32_16x16x32_bf16 v[76:79], v[156:159], a[132:135], v[76:79]
    ds_read_b64_tr_b16 v[138:139], v12 offset:17696
    s_waitcnt lgkmcnt(8)
    v_mfma_f32_16x16x32_bf16 v[40:43], v[120:123], a[56:59], v[40:43]
    ds_read_b64_tr_b16 v[140:141], v12 offset:24576
    v_mfma_f32_16x16x32_bf16 v[60:63], v[120:123], a[136:139], v[60:63]
    ds_read_b64_tr_b16 v[142:143], v12 offset:25856
    s_waitcnt lgkmcnt(8)
    v_mfma_f32_16x16x32_bf16 v[44:47], v[124:127], a[56:59], v[44:47]
    ds_read_b64_tr_b16 v[144:145], v12 offset:24584
    v_mfma_f32_16x16x32_bf16 v[64:67], v[124:127], a[136:139], v[64:67]
    ds_read_b64_tr_b16 v[146:147], v12 offset:25864
    s_waitcnt lgkmcnt(8)
    v_mfma_f32_16x16x32_bf16 v[48:51], v[128:131], a[56:59], v[48:51]
    ds_read_b64_tr_b16 v[148:149], v12 offset:24592
    v_mfma_f32_16x16x32_bf16 v[68:71], v[128:131], a[136:139], v[68:71]
    ds_read_b64_tr_b16 v[150:151], v12 offset:25872
    s_waitcnt lgkmcnt(8)
    v_mfma_f32_16x16x32_bf16 v[52:55], v[132:135], a[56:59], v[52:55]
    ds_read_b64_tr_b16 v[152:153], v12 offset:24600
    v_mfma_f32_16x16x32_bf16 v[72:75], v[132:135], a[136:139], v[72:75]
    ds_read_b64_tr_b16 v[154:155], v12 offset:25880
    s_waitcnt lgkmcnt(8)
    v_mfma_f32_16x16x32_bf16 v[56:59], v[136:139], a[56:59], v[56:59]
    ds_read_b64_tr_b16 v[156:157], v12 offset:24608
    v_mfma_f32_16x16x32_bf16 v[76:79], v[136:139], a[136:139], v[76:79]
    ds_read_b64_tr_b16 v[158:159], v12 offset:25888
    s_waitcnt vmcnt(6)
    s_waitcnt vmcnt(0)
    s_waitcnt lgkmcnt(0)
    s_barrier
    v_mfma_f32_16x16x32_bf16 v[40:43], v[140:143], a[60:63], v[40:43]
    s_lshl_b32 s78, s36, 3
    s_add_u32 s78, s78, s37
    s_lshl_b32 s78, s78, 6
    s_add_u32 s78, s78, 249856
    s_cmp_eq_u32 s38, 0
    s_cselect_b32 s78, s78, 0x80000000
    v_mov_b32 v6, 1
    v_mov_b32 v7, s78
    s_mov_b64 exec, 1
    buffer_store_dword v6, v7, s[16:19], 0 offen sc1
    s_mov_b64 exec, -1
    ds_read_b64_tr_b16 v[120:121], v10 offset:0
    v_mfma_f32_16x16x32_bf16 v[60:63], v[140:143], a[140:143], v[60:63]
    ds_read_b64_tr_b16 v[122:123], v10 offset:1280
    v_mfma_f32_16x16x32_bf16 v[44:47], v[144:147], a[60:63], v[44:47]
    ds_read_b64_tr_b16 v[124:125], v10 offset:8
    v_mfma_f32_16x16x32_bf16 v[64:67], v[144:147], a[140:143], v[64:67]
    ds_read_b64_tr_b16 v[126:127], v10 offset:1288
    v_mfma_f32_16x16x32_bf16 v[48:51], v[148:151], a[60:63], v[48:51]
    ds_read_b64_tr_b16 v[128:129], v10 offset:16
    v_mfma_f32_16x16x32_bf16 v[68:71], v[148:151], a[140:143], v[68:71]
    ds_read_b64_tr_b16 v[130:131], v10 offset:1296
    v_mfma_f32_16x16x32_bf16 v[52:55], v[152:155], a[60:63], v[52:55]
    ds_read_b64_tr_b16 v[132:133], v10 offset:24
    v_mfma_f32_16x16x32_bf16 v[72:75], v[152:155], a[140:143], v[72:75]
    ds_read_b64_tr_b16 v[134:135], v10 offset:1304
    v_mfma_f32_16x16x32_bf16 v[56:59], v[156:159], a[60:63], v[56:59]
    ds_read_b64_tr_b16 v[136:137], v10 offset:32
    v_mfma_f32_16x16x32_bf16 v[76:79], v[156:159], a[140:143], v[76:79]
    ds_read_b64_tr_b16 v[138:139], v10 offset:1312
    s_waitcnt lgkmcnt(8)
    v_mfma_f32_16x16x32_bf16 v[40:43], v[120:123], a[64:67], v[40:43]
    v_lshrrev_b32 v254, 2, v38
    ds_read_b64_tr_b16 v[140:141], v10 offset:8192
    v_mfma_f32_16x16x32_bf16 v[60:63], v[120:123], a[144:147], v[60:63]
    v_mul_u32_u24 v254, 40, v254
L_padq2:
L_pd1839:
    s_cbranch_execz L_pd7535
    ds_read_b64_tr_b16 v[142:143], v10 offset:9472
    s_waitcnt lgkmcnt(8)
    v_mfma_f32_16x16x32_bf16 v[44:47], v[124:127], a[64:67], v[44:47]
    v_lshl_add_u32 v254, v37, 13, v254
    ds_read_b64_tr_b16 v[144:145], v10 offset:8200
    v_mfma_f32_16x16x32_bf16 v[64:67], v[124:127], a[144:147], v[64:67]
    s_add_u32 s54, s72, 1024
    ds_read_b64_tr_b16 v[146:147], v10 offset:9480
    s_waitcnt lgkmcnt(8)
    v_mfma_f32_16x16x32_bf16 v[48:51], v[128:131], a[64:67], v[48:51]
    v_and_b32 v255, 3, v1
    ds_read_b64_tr_b16 v[148:149], v10 offset:8208
    v_mfma_f32_16x16x32_bf16 v[68:71], v[128:131], a[144:147], v[68:71]
    ds_read_b64_tr_b16 v[150:151], v10 offset:9488
    v_cmp_eq_u32 s[56:57], v255, v37
    s_waitcnt lgkmcnt(8)
    v_mfma_f32_16x16x32_bf16 v[52:55], v[132:135], a[64:67], v[52:55]
    ds_read_b64_tr_b16 v[152:153], v10 offset:8216
    v_mov_b32 v255, s54
    v_mfma_f32_16x16x32_bf16 v[72:75], v[132:135], a[144:147], v[72:75]
    ds_read_b64_tr_b16 v[154:155], v10 offset:9496
    v_cndmask_b32 v254, v255, v254, s[56:57]
    s_waitcnt lgkmcnt(8)
    v_mfma_f32_16x16x32_bf16 v[56:59], v[136:139], a[64:67], v[56:59]
    ds_read_b64_tr_b16 v[156:157], v10 offset:8224
    ds_read_b64_tr_b16 v[204:205], v254 offset:37888
    v_mfma_f32_16x16x32_bf16 v[76:79], v[136:139], a[144:147], v[76:79]
    ds_read_b64_tr_b16 v[158:159], v10 offset:9504
    s_waitcnt lgkmcnt(9)
    v_mfma_f32_16x16x32_bf16 v[40:43], v[140:143], a[68:71], v[40:43]
    ds_read_b64_tr_b16 v[206:207], v254 offset:38048
    ds_read_b64_tr_b16 v[120:121], v10 offset:16384
    v_mfma_f32_16x16x32_bf16 v[60:63], v[140:143], a[148:151], v[60:63]
    ds_read_b64_tr_b16 v[208:209], v254 offset:38208
    ds_read_b64_tr_b16 v[122:123], v10 offset:17664
    s_waitcnt lgkmcnt(11)
    v_mfma_f32_16x16x32_bf16 v[44:47], v[144:147], a[68:71], v[44:47]
    ds_read_b64_tr_b16 v[124:125], v10 offset:16392
    ds_read_b64_tr_b16 v[210:211], v254 offset:38368
    v_mfma_f32_16x16x32_bf16 v[64:67], v[144:147], a[148:151], v[64:67]
    ds_read_b64_tr_b16 v[126:127], v10 offset:17672
    ds_read_b64_tr_b16 v[212:213], v254 offset:38528
    s_waitcnt lgkmcnt(13)
    v_mfma_f32_16x16x32_bf16 v[48:51], v[148:151], a[68:71], v[48:51]
    ds_read_b64_tr_b16 v[128:129], v10 offset:16400
    v_mfma_f32_16x16x32_bf16 v[68:71], v[148:151], a[148:151], v[68:71]
    ds_read_b64_tr_b16 v[214:215], v254 offset:37896
    ds_read_b64_tr_b16 v[130:131], v10 offset:17680
    s_waitcnt lgkmcnt(14)
    v_mfma_f32_16x16x32_bf16 v[52:55], v[152:155], a[68:71], v[52:55]
    ds_read_b64_tr_b16 v[216:217], v254 offset:38056
    ds_read_b64_tr_b16 v[132:133], v10 offset:16408
    v_mfma_f32_16x16x32_bf16 v[72:75], v[152:155], a[148:151], v[72:75]
    ds_read_b64_tr_b16 v[134:135], v10 offset:17688
    ds_read_b64_tr_b16 v[218:219], v254 offset:38216
    s_waitcnt lgkmcnt(15)
    v_mfma_f32_16x16x32_bf16 v[56:59], v[156:159], a[68:71], v[56:59]
    ds_read_b64_tr_b16 v[136:137], v10 offset:16416
    ds_read_b64_tr_b16 v[220:221], v254 offset:38376
    v_mfma_f32_16x16x32_bf16 v[76:79], v[156:159], a[148:151], v[76:79]
    ds_read_b64_tr_b16 v[138:139], v10 offset:17696
    s_waitcnt lgkmcnt(14)
    v_mfma_f32_16x16x32_bf16 v[40:43], v[120:123], a[72:75], v[40:43]
    ds_read_b64_tr_b16 v[222:223], v254 offset:38536
    ds_read_b64_tr_b16 v[140:141], v10 offset:24576
    v_mfma_f32_16x16x32_bf16 v[60:63], v[120:123], a[152:155], v[60:63]
    ds_read_b64_tr_b16 v[224:225], v254 offset:37904
    ds_read_b64_tr_b16 v[142:143], v10 offset:25856
    s_waitcnt lgkmcnt(15)
    v_mfma_f32_16x16x32_bf16 v[44:47], v[124:127], a[72:75], v[44:47]
    ds_read_b64_tr_b16 v[144:145], v10 offset:24584
    ds_read_b64_tr_b16 v[226:227], v254 offset:38064
    v_mfma_f32_16x16x32_bf16 v[64:67], v[124:127], a[152:155], v[64:67]
    ds_read_b64_tr_b16 v[146:147], v10 offset:25864
    ds_read_b64_tr_b16 v[228:229], v254 offset:38224
    s_waitcnt lgkmcnt(15)
    v_mfma_f32_16x16x32_bf16 v[48:51], v[128:131], a[72:75], v[48:51]
    ds_read_b64_tr_b16 v[148:149], v10 offset:24592
    v_mfma_f32_16x16x32_bf16 v[68:71], v[128:131], a[152:155], v[68:71]
    ds_read_b64_tr_b16 v[230:231], v254 offset:38384
    ds_read_b64_tr_b16 v[150:151], v10 offset:25872
    s_waitcnt lgkmcnt(15)
    v_mfma_f32_16x16x32_bf16 v[52:55], v[132:135], a[72:75], v[52:55]
    ds_read_b64_tr_b16 v[232:233], v254 offset:38544
    ds_read_b64_tr_b16 v[152:153], v10 offset:24600
    v_mfma_f32_16x16x32_bf16 v[72:75], v[132:135], a[152:155], v[72:75]
    ds_read_b64_tr_b16 v[154:155], v10 offset:25880
    ds_read_b64_tr_b16 v[234:235], v254 offset:37912
    s_waitcnt lgkmcnt(15)
    v_mfma_f32_16x16x32_bf16 v[56:59], v[136:139], a[72:75], v[56:59]
    ds_read_b64_tr_b16 v[156:157], v10 offset:24608
    ds_read_b64_tr_b16 v[236:237], v254 offset:38072
    v_mfma_f32_16x16x32_bf16 v[76:79], v[136:139], a[152:155], v[76:79]
    ds_read_b64_tr_b16 v[158:159], v10 offset:25888
    s_waitcnt lgkmcnt(14)
    v_mfma_f32_16x16x32_bf16 v[40:43], v[140:143], a[76:79], v[40:43]
    ds_read_b64_tr_b16 v[238:239], v254 offset:38232
    v_mfma_f32_16x16x32_bf16 v[60:63], v[140:143], a[156:159], v[60:63]
    ds_read_b64_tr_b16 v[240:241], v254 offset:38392
    s_waitcnt lgkmcnt(13)
    v_mfma_f32_16x16x32_bf16 v[44:47], v[144:147], a[76:79], v[44:47]
    ds_read_b64_tr_b16 v[242:243], v254 offset:38552
    v_mfma_f32_16x16x32_bf16 v[64:67], v[144:147], a[156:159], v[64:67]
    ds_read_b64_tr_b16 v[244:245], v254 offset:37920
    s_waitcnt lgkmcnt(11)
    v_mfma_f32_16x16x32_bf16 v[48:51], v[148:151], a[76:79], v[48:51]
    v_mfma_f32_16x16x32_bf16 v[68:71], v[148:151], a[156:159], v[68:71]
    ds_read_b64_tr_b16 v[246:247], v254 offset:38080
    s_waitcnt lgkmcnt(9)
    v_mfma_f32_16x16x32_bf16 v[52:55], v[152:155], a[76:79], v[52:55]
    ds_read_b64_tr_b16 v[248:249], v254 offset:38240
    v_mfma_f32_16x16x32_bf16 v[72:75], v[152:155], a[156:159], v[72:75]
    ds_read_b64_tr_b16 v[250:251], v254 offset:38400
    s_waitcnt lgkmcnt(7)
    v_mfma_f32_16x16x32_bf16 v[56:59], v[156:159], a[76:79], v[56:59]
    ds_read_b64_tr_b16 v[252:253], v254 offset:38560
    v_mfma_f32_16x16x32_bf16 v[76:79], v[156:159], a[156:159], v[76:79]
    s_waitcnt lgkmcnt(0)
    s_barrier
    v_cvt_pk_bf16_f32 v184, v40, v41
    v_cvt_pk_bf16_f32 v185, v42, v43
    v_cvt_pk_bf16_f32 v186, v44, v45
    v_cvt_pk_bf16_f32 v187, v46, v47
    v_cvt_pk_bf16_f32 v188, v48, v49
    v_cvt_pk_bf16_f32 v189, v50, v51
    v_cvt_pk_bf16_f32 v190, v52, v53
    v_cvt_pk_bf16_f32 v191, v54, v55
    v_cvt_pk_bf16_f32 v192, v56, v57
    v_cvt_pk_bf16_f32 v193, v58, v59
    v_mfma_f32_16x16x32_bf16 v[40:43], v[204:207], v[184:187], 0
    v_cvt_pk_bf16_f32 v194, v60, v61
    v_cvt_pk_bf16_f32 v195, v62, v63
    v_mfma_f32_16x16x32_bf16 v[44:47], v[214:217], v[184:187], 0
    v_cvt_pk_bf16_f32 v196, v64, v65
    v_cvt_pk_bf16_f32 v197, v66, v67
    v_mfma_f32_16x16x32_bf16 v[48:51], v[224:227], v[184:187], 0
    v_cvt_pk_bf16_f32 v198, v68, v69
    v_mfma_f32_16x16x32_bf16 v[52:55], v[234:237], v[184:187], 0
    v_cvt_pk_bf16_f32 v199, v70, v71
    v_cvt_pk_bf16_f32 v200, v72, v73
    v_mfma_f32_16x16x32_bf16 v[56:59], v[244:247], v[184:187], 0
    v_cvt_pk_bf16_f32 v201, v74, v75
    v_mfma_f32_16x16x32_bf16 v[40:43], v[208:211], v[188:191], v[40:43]
    v_cvt_pk_bf16_f32 v202, v76, v77
    v_cvt_pk_bf16_f32 v203, v78, v79
    v_mfma_f32_16x16x32_bf16 v[44:47], v[218:221], v[188:191], v[44:47]
    s_mov_b32 s54, 0x3fb8aa3b
    v_mfma_f32_16x16x32_bf16 v[48:51], v[228:231], v[188:191], v[48:51]
    s_lshl_b32 s57, s36, 3
    s_add_u32 s57, s57, s37
    v_mfma_f32_16x16x32_bf16 v[52:55], v[238:241], v[188:191], v[52:55]
    s_mul_i32 s57, s57, 40960
    v_mfma_f32_16x16x32_bf16 v[56:59], v[248:251], v[188:191], v[56:59]
    s_add_u32 s57, s57, 20971520
    s_add_u32 s62, s57, 4096
    v_mfma_f32_16x16x16_bf16 v[40:43], v[212:213], v[192:193], v[40:43]
    s_add_u32 s63, s57, 8192
    v_mfma_f32_16x16x16_bf16 v[44:47], v[222:223], v[192:193], v[44:47]
    v_mul_u32_u24 v104, 10240, v37
    v_add_u32 v104, v104, v23
    v_mfma_f32_16x16x16_bf16 v[48:51], v[232:233], v[192:193], v[48:51]
    v_xor_b32 v105, 0x100, v104
    v_mfma_f32_16x16x16_bf16 v[52:55], v[242:243], v[192:193], v[52:55]
    ds_write_b128 v25, v[160:163] offset:32768
    ds_write_b128 v25, v[164:167] offset:34816
    v_mfma_f32_16x16x16_bf16 v[56:59], v[252:253], v[192:193], v[56:59]
    ds_write_b128 v25, v[168:171] offset:36864
    v_mfma_f32_16x16x32_bf16 v[60:63], v[204:207], v[194:197], 0
    v_mfma_f32_16x16x32_bf16 v[64:67], v[214:217], v[194:197], 0
    v_mfma_f32_16x16x32_bf16 v[68:71], v[224:227], v[194:197], 0
    v_mfma_f32_16x16x32_bf16 v[72:75], v[234:237], v[194:197], 0
    ds_write_b128 v26, v[172:175] offset:32768
    ds_write_b128 v26, v[176:179] offset:34816
    ds_write_b128 v26, v[180:183] offset:36864
    v_mfma_f32_16x16x32_bf16 v[76:79], v[244:247], v[194:197], 0
    v_max3_f32 v2, v40, v41, v42
    v_min3_f32 v4, v40, v41, v42
    v_mfma_f32_16x16x32_bf16 v[60:63], v[208:211], v[198:201], v[60:63]
    v_max3_f32 v2, v2, v43, v44
    v_min3_f32 v4, v4, v43, v44
    v_mfma_f32_16x16x32_bf16 v[64:67], v[218:221], v[198:201], v[64:67]
    v_max3_f32 v2, v2, v45, v46
    v_min3_f32 v4, v4, v45, v46
    v_mfma_f32_16x16x32_bf16 v[68:71], v[228:231], v[198:201], v[68:71]
    v_max3_f32 v2, v2, v47, v48
    v_min3_f32 v4, v4, v47, v48
    v_mfma_f32_16x16x32_bf16 v[72:75], v[238:241], v[198:201], v[72:75]
    v_max3_f32 v2, v2, v49, v50
    v_min3_f32 v4, v4, v49, v50
    v_mfma_f32_16x16x32_bf16 v[76:79], v[248:251], v[198:201], v[76:79]
    v_max3_f32 v2, v2, v51, v52
    v_min3_f32 v4, v4, v51, v52
    v_mfma_f32_16x16x16_bf16 v[60:63], v[212:213], v[202:203], v[60:63]
    v_max3_f32 v2, v2, v53, v54
    v_min3_f32 v4, v4, v53, v54
    v_mfma_f32_16x16x16_bf16 v[64:67], v[222:223], v[202:203], v[64:67]
    v_max3_f32 v2, v2, v55, v56
    v_min3_f32 v4, v4, v55, v56
    v_mfma_f32_16x16x16_bf16 v[68:71], v[232:233], v[202:203], v[68:71]
    v_max3_f32 v2, v2, v57, v58
    v_min3_f32 v4, v4, v57, v58
    v_mfma_f32_16x16x16_bf16 v[72:75], v[242:243], v[202:203], v[72:75]
    v_max_f32 v2, v2, v59
    v_min_f32 v4, v4, v59
    v_mfma_f32_16x16x16_bf16 v[76:79], v[252:253], v[202:203], v[76:79]
    v_mul_f32 v2, 0xbfb8aa3b, v2
    v_mul_f32 v4, s54, v4
    v_pk_fma_f32 v[204:205], v[40:41], s[54:55], v[2:3] op_sel_hi:[1,0,0]
    v_pk_fma_f32 v[224:225], v[40:41], s[54:55], v[4:5] op_sel_hi:[1,0,0] neg_lo:[1,0,0] neg_hi:[1,0,0]
    v_pk_fma_f32 v[206:207], v[42:43], s[54:55], v[2:3] op_sel_hi:[1,0,0]
    v_pk_fma_f32 v[226:227], v[42:43], s[54:55], v[4:5] op_sel_hi:[1,0,0] neg_lo:[1,0,0] neg_hi:[1,0,0]
    v_pk_fma_f32 v[208:209], v[44:45], s[54:55], v[2:3] op_sel_hi:[1,0,0]
    v_pk_fma_f32 v[228:229], v[44:45], s[54:55], v[4:5] op_sel_hi:[1,0,0] neg_lo:[1,0,0] neg_hi:[1,0,0]
    v_pk_fma_f32 v[210:211], v[46:47], s[54:55], v[2:3] op_sel_hi:[1,0,0]
    v_pk_fma_f32 v[230:231], v[46:47], s[54:55], v[4:5] op_sel_hi:[1,0,0] neg_lo:[1,0,0] neg_hi:[1,0,0]
    v_pk_fma_f32 v[212:213], v[48:49], s[54:55], v[2:3] op_sel_hi:[1,0,0]
    v_pk_fma_f32 v[232:233], v[48:49], s[54:55], v[4:5] op_sel_hi:[1,0,0] neg_lo:[1,0,0] neg_hi:[1,0,0]
    v_pk_fma_f32 v[214:215], v[50:51], s[54:55], v[2:3] op_sel_hi:[1,0,0]
    v_pk_fma_f32 v[234:235], v[50:51], s[54:55], v[4:5] op_sel_hi:[1,0,0] neg_lo:[1,0,0] neg_hi:[1,0,0]
    v_pk_fma_f32 v[216:217], v[52:53], s[54:55], v[2:3] op_sel_hi:[1,0,0]
    v_pk_fma_f32 v[236:237], v[52:53], s[54:55], v[4:5] op_sel_hi:[1,0,0] neg_lo:[1,0,0] neg_hi:[1,0,0]
    v_pk_fma_f32 v[218:219], v[54:55], s[54:55], v[2:3] op_sel_hi:[1,0,0]
    v_pk_fma_f32 v[238:239], v[54:55], s[54:55], v[4:5] op_sel_hi:[1,0,0] neg_lo:[1,0,0] neg_hi:[1,0,0]
    v_pk_fma_f32 v[220:221], v[56:57], s[54:55], v[2:3] op_sel_hi:[1,0,0]
    v_pk_fma_f32 v[240:241], v[56:57], s[54:55], v[4:5] op_sel_hi:[1,0,0] neg_lo:[1,0,0] neg_hi:[1,0,0]
    v_pk_fma_f32 v[222:223], v[58:59], s[54:55], v[2:3] op_sel_hi:[1,0,0]
    v_pk_fma_f32 v[242:243], v[58:59], s[54:55], v[4:5] op_sel_hi:[1,0,0] neg_lo:[1,0,0] neg_hi:[1,0,0]
    v_exp_f32 v204, v204
    v_exp_f32 v205, v205
    v_exp_f32 v206, v206
    v_exp_f32 v207, v207
    v_exp_f32 v208, v208
    v_exp_f32 v209, v209
    v_exp_f32 v210, v210
    v_exp_f32 v211, v211
    v_exp_f32 v212, v212
    v_exp_f32 v213, v213
    v_exp_f32 v214, v214
    v_exp_f32 v215, v215
    v_exp_f32 v216, v216
    v_exp_f32 v217, v217
    v_exp_f32 v218, v218
    v_exp_f32 v219, v219
    v_exp_f32 v220, v220
    v_exp_f32 v221, v221
    v_exp_f32 v222, v222
    v_exp_f32 v223, v223
    v_exp_f32 v224, v224
    v_exp_f32 v225, v225
    v_exp_f32 v226, v226
    v_exp_f32 v227, v227
    v_exp_f32 v228, v228
    v_exp_f32 v229, v229
    v_exp_f32 v230, v230
    v_exp_f32 v231, v231
    v_exp_f32 v232, v232
    v_exp_f32 v233, v233
    v_exp_f32 v234, v234
    v_exp_f32 v235, v235
    v_exp_f32 v236, v236
    v_exp_f32 v237, v237
    v_exp_f32 v238, v238
    v_exp_f32 v239, v239
    v_exp_f32 v240, v240
    v_exp_f32 v241, v241
    v_exp_f32 v242, v242
    v_exp_f32 v243, v243
    v_pk_add_f32 v[248:249], v[204:205], v[206:207]
    v_pk_add_f32 v[250:251], v[224:225], v[226:227]
    v_pk_add_f32 v[248:249], v[248:249], v[208:209]
    v_pk_add_f32 v[250:251], v[250:251], v[228:229]
    v_pk_add_f32 v[248:249], v[248:249], v[210:211]
    v_pk_add_f32 v[250:251], v[250:251], v[230:231]
    v_pk_add_f32 v[248:249], v[248:249], v[212:213]
    v_pk_add_f32 v[250:251], v[250:251], v[232:233]
    v_pk_add_f32 v[248:249], v[248:249], v[214:215]
    v_pk_add_f32 v[250:251], v[250:251], v[234:235]
    v_pk_add_f32 v[248:249], v[248:249], v[216:217]
    s_lshl_b32 s78, s38, 6
    v_lshlrev_b32 v31, 2, v1
    v_add_u32 v31, s78, v31
    s_lshl_b32 s78, s36, 4
    s_lshr_b32 s79, s37, 1
    s_lshl_b32 s79, s79, 2
    s_add_u32 s78, s78, s79
    v_writelane_b32 v31, s78, 16
    s_mov_b64 exec, 0x1ffff
    buffer_load_dword v39, v31, s[20:23], 0 offen sc1
    s_mov_b64 exec, -1
    v_pk_add_f32 v[250:251], v[250:251], v[236:237]
    v_pk_add_f32 v[248:249], v[248:249], v[218:219]
    v_pk_add_f32 v[250:251], v[250:251], v[238:239]
    v_pk_add_f32 v[248:249], v[248:249], v[220:221]
    v_pk_add_f32 v[250:251], v[250:251], v[240:241]
    v_pk_add_f32 v[248:249], v[248:249], v[222:223]
    v_pk_add_f32 v[250:251], v[250:251], v[242:243]
    v_add_f32 v248, v248, v249
    v_add_f32 v250, v250, v251
    v_rcp_f32 v248, v248
    v_rcp_f32 v250, v250
    v_pk_mul_f32 v[204:205], v[204:205], v[248:249] op_sel_hi:[1,0]
    v_pk_mul_f32 v[224:225], v[224:225], v[250:251] op_sel_hi:[1,0]
    v_pk_mul_f32 v[206:207], v[206:207], v[248:249] op_sel_hi:[1,0]
    v_pk_mul_f32 v[226:227], v[226:227], v[250:251] op_sel_hi:[1,0]
    v_pk_mul_f32 v[208:209], v[208:209], v[248:249] op_sel_hi:[1,0]
    v_pk_mul_f32 v[228:229], v[228:229], v[250:251] op_sel_hi:[1,0]
    v_pk_mul_f32 v[210:211], v[210:211], v[248:249] op_sel_hi:[1,0]
    v_pk_mul_f32 v[230:231], v[230:231], v[250:251] op_sel_hi:[1,0]
    v_pk_mul_f32 v[212:213], v[212:213], v[248:249] op_sel_hi:[1,0]
    v_pk_mul_f32 v[232:233], v[232:233], v[250:251] op_sel_hi:[1,0]
    v_pk_mul_f32 v[214:215], v[214:215], v[248:249] op_sel_hi:[1,0]
    v_pk_mul_f32 v[234:235], v[234:235], v[250:251] op_sel_hi:[1,0]
    v_pk_mul_f32 v[216:217], v[216:217], v[248:249] op_sel_hi:[1,0]
    v_pk_mul_f32 v[236:237], v[236:237], v[250:251] op_sel_hi:[1,0]
    v_pk_mul_f32 v[218:219], v[218:219], v[248:249] op_sel_hi:[1,0]
    v_pk_mul_f32 v[238:239], v[238:239], v[250:251] op_sel_hi:[1,0]
    v_pk_mul_f32 v[220:221], v[220:221], v[248:249] op_sel_hi:[1,0]
    v_pk_mul_f32 v[240:241], v[240:241], v[250:251] op_sel_hi:[1,0]
    v_pk_mul_f32 v[222:223], v[222:223], v[248:249] op_sel_hi:[1,0]
    v_pk_mul_f32 v[242:243], v[242:243], v[250:251] op_sel_hi:[1,0]
    v_cvt_pk_bf16_f32 v152, v204, v205
    v_cvt_pk_bf16_f32 v153, v206, v207
    v_cvt_pk_bf16_f32 v154, v208, v209
    v_cvt_pk_bf16_f32 v155, v210, v211
    v_cvt_pk_bf16_f32 v156, v212, v213
    v_cvt_pk_bf16_f32 v157, v214, v215
    v_cvt_pk_bf16_f32 v158, v216, v217
    v_cvt_pk_bf16_f32 v159, v218, v219
    v_cvt_pk_bf16_f32 v160, v220, v221
    v_cvt_pk_bf16_f32 v161, v222, v223
    v_cvt_pk_bf16_f32 v162, v224, v225
    v_cvt_pk_bf16_f32 v163, v226, v227
    v_cvt_pk_bf16_f32 v164, v228, v229
    v_cvt_pk_bf16_f32 v165, v230, v231
    v_cvt_pk_bf16_f32 v166, v232, v233
    v_cvt_pk_bf16_f32 v167, v234, v235
    v_cvt_pk_bf16_f32 v168, v236, v237
    v_cvt_pk_bf16_f32 v169, v238, v239
    v_cvt_pk_bf16_f32 v170, v240, v241
    v_cvt_pk_bf16_f32 v171, v242, v243
    v_max3_f32 v2, v60, v61, v62
    v_min3_f32 v4, v60, v61, v62
    v_max3_f32 v2, v2, v63, v64
    v_min3_f32 v4, v4, v63, v64
    v_max3_f32 v2, v2, v65, v66
    v_min3_f32 v4, v4, v65, v66
    v_max3_f32 v2, v2, v67, v68
    v_min3_f32 v4, v4, v67, v68
    v_max3_f32 v2, v2, v69, v70
    v_min3_f32 v4, v4, v69, v70
    v_max3_f32 v2, v2, v71, v72
    v_min3_f32 v4, v4, v71, v72
    v_max3_f32 v2, v2, v73, v74
    v_min3_f32 v4, v4, v73, v74
    v_max3_f32 v2, v2, v75, v76
    v_min3_f32 v4, v4, v75, v76
    v_max3_f32 v2, v2, v77, v78
    v_min3_f32 v4, v4, v77, v78
    v_max_f32 v2, v2, v79
    v_min_f32 v4, v4, v79
    v_mul_f32 v2, 0xbfb8aa3b, v2
    v_mul_f32 v4, s54, v4
    v_pk_fma_f32 v[204:205], v[60:61], s[54:55], v[2:3] op_sel_hi:[1,0,0]
    v_pk_fma_f32 v[224:225], v[60:61], s[54:55], v[4:5] op_sel_hi:[1,0,0] neg_lo:[1,0,0] neg_hi:[1,0,0]
    v_pk_fma_f32 v[206:207], v[62:63], s[54:55], v[2:3] op_sel_hi:[1,0,0]
    v_pk_fma_f32 v[226:227], v[62:63], s[54:55], v[4:5] op_sel_hi:[1,0,0] neg_lo:[1,0,0] neg_hi:[1,0,0]
    v_pk_fma_f32 v[208:209], v[64:65], s[54:55], v[2:3] op_sel_hi:[1,0,0]
    s_waitcnt vmcnt(0)
    s_mov_b64 exec, 0x1ffff
    v_cmp_gt_u32 vcc, 2, v39
    s_mov_b64 exec, -1
    s_nop 3
    s_cbranch_vccnz L_qpoll1
L_qpoll1_ok:
    v_and_b32 v5, 31, v1
    v_cmp_lt_u32 vcc, 20, v5
    v_lshrrev_b32 v6, 5, v1
    v_mul_u32_u24 v6, 336, v6
    v_lshl_add_u32 v5, v5, 4, v6
    v_add_u32 v5, 131072, v5
    v_mov_b32 v6, 0x80000000
    v_cndmask_b32 v9, v5, v6, vcc
    v_pk_fma_f32 v[228:229], v[64:65], s[54:55], v[4:5] op_sel_hi:[1,0,0] neg_lo:[1,0,0] neg_hi:[1,0,0]
    s_add_u32 s80, s69, 0
    s_and_b32 s80, s80, 3
    s_lshl_b32 s81, s38, 2
    s_add_u32 s80, s80, s81
    s_lshl_b32 s81, s80, 10
    s_add_u32 s81, s81, 65536
    s_mul_i32 s82, s80, 5376
    s_add_u32 s83, s82, 2688
    s_lshl_b32 s80, s80, 12
    v_pk_fma_f32 v[210:211], v[66:67], s[54:55], v[2:3] op_sel_hi:[1,0,0]
    v_pk_fma_f32 v[230:231], v[66:67], s[54:55], v[4:5] op_sel_hi:[1,0,0] neg_lo:[1,0,0] neg_hi:[1,0,0]
    v_pk_fma_f32 v[212:213], v[68:69], s[54:55], v[2:3] op_sel_hi:[1,0,0]
    v_pk_fma_f32 v[232:233], v[68:69], s[54:55], v[4:5] op_sel_hi:[1,0,0] neg_lo:[1,0,0] neg_hi:[1,0,0]
    v_pk_fma_f32 v[214:215], v[70:71], s[54:55], v[2:3] op_sel_hi:[1,0,0]
    buffer_load_dwordx4 a[160:163], v36, s[16:19], s80 offen offset:0 sc1
    v_pk_fma_f32 v[234:235], v[70:71], s[54:55], v[4:5] op_sel_hi:[1,0,0] neg_lo:[1,0,0] neg_hi:[1,0,0]
    v_pk_fma_f32 v[216:217], v[72:73], s[54:55], v[2:3] op_sel_hi:[1,0,0]
    v_pk_fma_f32 v[236:237], v[72:73], s[54:55], v[4:5] op_sel_hi:[1,0,0] neg_lo:[1,0,0] neg_hi:[1,0,0]
    v_pk_fma_f32 v[218:219], v[74:75], s[54:55], v[2:3] op_sel_hi:[1,0,0]
    v_pk_fma_f32 v[238:239], v[74:75], s[54:55], v[4:5] op_sel_hi:[1,0,0] neg_lo:[1,0,0] neg_hi:[1,0,0]
    v_pk_fma_f32 v[220:221], v[76:77], s[54:55], v[2:3] op_sel_hi:[1,0,0]
    buffer_load_dwordx4 a[176:179], v36, s[16:19], s81 offen sc1
    v_pk_fma_f32 v[240:241], v[76:77], s[54:55], v[4:5] op_sel_hi:[1,0,0] neg_lo:[1,0,0] neg_hi:[1,0,0]
    v_pk_fma_f32 v[222:223], v[78:79], s[54:55], v[2:3] op_sel_hi:[1,0,0]
    v_pk_fma_f32 v[242:243], v[78:79], s[54:55], v[4:5] op_sel_hi:[1,0,0] neg_lo:[1,0,0] neg_hi:[1,0,0]
    v_exp_f32 v204, v204
    v_exp_f32 v205, v205
    buffer_load_dwordx4 a[180:183], v9, s[16:19], s82 offen offset:0 sc1
    v_exp_f32 v206, v206
    v_exp_f32 v207, v207
    v_exp_f32 v208, v208
    v_exp_f32 v209, v209
    v_exp_f32 v210, v210
    v_exp_f32 v211, v211
    buffer_load_dwordx4 a[184:187], v9, s[16:19], s82 offen offset:672 sc1
    v_exp_f32 v212, v212
    v_exp_f32 v213, v213
    v_exp_f32 v214, v214
    v_exp_f32 v215, v215
    v_exp_f32 v216, v216
    buffer_load_dwordx4 a[164:167], v36, s[16:19], s80 offen offset:1024 sc1
    v_exp_f32 v217, v217
    v_exp_f32 v218, v218
    v_exp_f32 v219, v219
    v_exp_f32 v220, v220
    v_exp_f32 v221, v221
    v_exp_f32 v222, v222
    buffer_load_dwordx4 a[188:191], v9, s[16:19], s82 offen offset:1344 sc1
    v_exp_f32 v223, v223
    v_exp_f32 v224, v224
    v_exp_f32 v225, v225
    v_exp_f32 v226, v226
    v_exp_f32 v227, v227
    v_exp_f32 v228, v228
    buffer_load_dwordx4 a[192:195], v9, s[16:19], s82 offen offset:2016 sc1
    v_exp_f32 v229, v229
    v_exp_f32 v230, v230
    v_exp_f32 v231, v231
    v_exp_f32 v232, v232
    v_exp_f32 v233, v233
    buffer_load_dwordx4 a[168:171], v36, s[16:19], s80 offen offset:2048 sc1
    v_exp_f32 v234, v234
    v_exp_f32 v235, v235
    v_exp_f32 v236, v236
    v_exp_f32 v237, v237
    v_exp_f32 v238, v238
    v_exp_f32 v239, v239
    buffer_load_dwordx4 a[196:199], v9, s[16:19], s83 offen offset:0 sc1
    v_exp_f32 v240, v240
    v_exp_f32 v241, v241
    v_exp_f32 v242, v242
    v_exp_f32 v243, v243
    v_pk_add_f32 v[248:249], v[204:205], v[206:207]
    buffer_load_dwordx4 a[200:203], v9, s[16:19], s83 offen offset:672 sc1
    v_pk_add_f32 v[250:251], v[224:225], v[226:227]
    v_pk_add_f32 v[248:249], v[248:249], v[208:209]
    v_pk_add_f32 v[250:251], v[250:251], v[228:229]
    v_pk_add_f32 v[248:249], v[248:249], v[210:211]
    v_pk_add_f32 v[250:251], v[250:251], v[230:231]
    v_pk_add_f32 v[248:249], v[248:249], v[212:213]
    buffer_load_dwordx4 a[172:175], v36, s[16:19], s80 offen offset:3072 sc1
    v_pk_add_f32 v[250:251], v[250:251], v[232:233]
    v_pk_add_f32 v[248:249], v[248:249], v[214:215]
    v_pk_add_f32 v[250:251], v[250:251], v[234:235]
    v_pk_add_f32 v[248:249], v[248:249], v[216:217]
    v_pk_add_f32 v[250:251], v[250:251], v[236:237]
    buffer_load_dwordx4 a[204:207], v9, s[16:19], s83 offen offset:1344 sc1
    v_pk_add_f32 v[248:249], v[248:249], v[218:219]
    v_pk_add_f32 v[250:251], v[250:251], v[238:239]
    v_pk_add_f32 v[248:249], v[248:249], v[220:221]
    v_pk_add_f32 v[250:251], v[250:251], v[240:241]
    v_pk_add_f32 v[248:249], v[248:249], v[222:223]
    v_pk_add_f32 v[250:251], v[250:251], v[242:243]
    buffer_load_dwordx4 a[208:211], v9, s[16:19], s83 offen offset:2016 sc1
    v_add_f32 v248, v248, v249
    v_add_f32 v250, v250, v251
    v_rcp_f32 v248, v248
    v_rcp_f32 v250, v250
    v_pk_mul_f32 v[204:205], v[204:205], v[248:249] op_sel_hi:[1,0]
    v_lshrrev_b32 v10, 5, v1
    v_and_b32 v11, 31, v1
    v_lshlrev_b32 v5, 4, v11
    v_add_u32 v5, 32768, v5
    v_lshl_add_u32 v16, v10, 11, v5
    v_lshl_add_u32 v17, v10, 3, v5
    v_xor_b32 v18, 8, v17
    s_waitcnt lgkmcnt(0)
    s_barrier
    v_pk_mul_f32 v[224:225], v[224:225], v[250:251] op_sel_hi:[1,0]
    ds_read_b128 v[120:123], v16 offset:0
    v_pk_mul_f32 v[206:207], v[206:207], v[248:249] op_sel_hi:[1,0]
    v_pk_mul_f32 v[226:227], v[226:227], v[250:251] op_sel_hi:[1,0]
    v_pk_mul_f32 v[208:209], v[208:209], v[248:249] op_sel_hi:[1,0]
    ds_read_b64 v[124:125], v17 offset:4096
    v_pk_mul_f32 v[228:229], v[228:229], v[250:251] op_sel_hi:[1,0]
    v_pk_mul_f32 v[210:211], v[210:211], v[248:249] op_sel_hi:[1,0]
    v_pk_mul_f32 v[230:231], v[230:231], v[250:251] op_sel_hi:[1,0]
    ds_read_b64 v[126:127], v18 offset:4096
    v_pk_mul_f32 v[212:213], v[212:213], v[248:249] op_sel_hi:[1,0]
    v_pk_mul_f32 v[232:233], v[232:233], v[250:251] op_sel_hi:[1,0]
    v_pk_mul_f32 v[214:215], v[214:215], v[248:249] op_sel_hi:[1,0]
    ds_read_b128 v[128:131], v16 offset:512
    v_pk_mul_f32 v[234:235], v[234:235], v[250:251] op_sel_hi:[1,0]
    v_pk_mul_f32 v[216:217], v[216:217], v[248:249] op_sel_hi:[1,0]
    v_pk_mul_f32 v[236:237], v[236:237], v[250:251] op_sel_hi:[1,0]
    v_pk_mul_f32 v[218:219], v[218:219], v[248:249] op_sel_hi:[1,0]
    ds_read_b64 v[132:133], v17 offset:4608
    v_pk_mul_f32 v[238:239], v[238:239], v[250:251] op_sel_hi:[1,0]
    v_pk_mul_f32 v[220:221], v[220:221], v[248:249] op_sel_hi:[1,0]
    v_pk_mul_f32 v[240:241], v[240:241], v[250:251] op_sel_hi:[1,0]
    ds_read_b64 v[134:135], v18 offset:4608
    v_pk_mul_f32 v[222:223], v[222:223], v[248:249] op_sel_hi:[1,0]
    v_pk_mul_f32 v[242:243], v[242:243], v[250:251] op_sel_hi:[1,0]
    v_cvt_pk_bf16_f32 v172, v204, v205
    ds_read_b128 v[136:139], v16 offset:6144
    v_cvt_pk_bf16_f32 v173, v206, v207
    v_cvt_pk_bf16_f32 v174, v208, v209
    v_cvt_pk_bf16_f32 v175, v210, v211
    ds_read_b64 v[140:141], v17 offset:10240
    v_cvt_pk_bf16_f32 v176, v212, v213
    v_cvt_pk_bf16_f32 v177, v214, v215
    v_cvt_pk_bf16_f32 v178, v216, v217
    v_cvt_pk_bf16_f32 v179, v218, v219
    ds_read_b64 v[142:143], v18 offset:10240
    v_cvt_pk_bf16_f32 v180, v220, v221
    v_cvt_pk_bf16_f32 v181, v222, v223
    v_cvt_pk_bf16_f32 v182, v224, v225
    ds_read_b128 v[144:147], v16 offset:6656
    v_cvt_pk_bf16_f32 v183, v226, v227
    v_cvt_pk_bf16_f32 v184, v228, v229
    v_cvt_pk_bf16_f32 v185, v230, v231
    ds_read_b64 v[148:149], v17 offset:10752
    v_cvt_pk_bf16_f32 v186, v232, v233
    v_cvt_pk_bf16_f32 v187, v234, v235
    v_cvt_pk_bf16_f32 v188, v236, v237
    ds_read_b64 v[150:151], v18 offset:10752
    v_cvt_pk_bf16_f32 v189, v238, v239
    v_cvt_pk_bf16_f32 v190, v240, v241
    v_cvt_pk_bf16_f32 v191, v242, v243
    s_waitcnt vmcnt(12) lgkmcnt(11)
    v_mfma_f32_32x32x16_bf16 v[40:55], a[160:163], v[120:123], 0
    s_waitcnt vmcnt(11) lgkmcnt(10)
    s_nop 8
    v_mfma_f32_32x32x8_bf16 v[40:55], a[176:177], v[124:125], v[40:55]
    s_waitcnt lgkmcnt(8)
    v_mfma_f32_32x32x16_bf16 v[56:71], a[160:163], v[128:131], 0
    s_add_u32 s80, s69, 1
    s_and_b32 s80, s80, 3
    s_nop 7
    v_exp_f32 v40, v40
    v_exp_f32 v41, v41
    v_exp_f32 v42, v42
    v_exp_f32 v43, v43
    v_cvt_pk_bf16_f32 v72, v40, v41
    v_exp_f32 v44, v44
    v_exp_f32 v45, v45
    v_exp_f32 v46, v46
    v_exp_f32 v47, v47
    v_cvt_pk_bf16_f32 v73, v42, v43
    v_cvt_pk_bf16_f32 v74, v44, v45
    s_waitcnt lgkmcnt(7)
    v_mfma_f32_32x32x8_bf16 v[56:71], a[176:177], v[132:133], v[56:71]
    s_lshl_b32 s81, s38, 2
    v_exp_f32 v48, v48
    v_exp_f32 v49, v49
    v_exp_f32 v50, v50
    v_exp_f32 v51, v51
    v_cvt_pk_bf16_f32 v75, v46, v47
    v_cvt_pk_bf16_f32 v76, v48, v49
    v_exp_f32 v52, v52
    v_exp_f32 v53, v53
    v_exp_f32 v54, v54
    v_exp_f32 v55, v55
    v_cvt_pk_bf16_f32 v77, v50, v51
    v_cvt_pk_bf16_f32 v78, v52, v53
    v_cvt_pk_bf16_f32 v79, v54, v55
    s_waitcnt lgkmcnt(5)
    v_mfma_f32_32x32x16_bf16 v[40:55], a[160:163], v[136:139], 0
    s_add_u32 s80, s80, s81
    s_lshl_b32 s81, s80, 10
    v_exp_f32 v56, v56
    v_add_u32 v12, 0x1000, v36
    v_exp_f32 v57, v57
    v_add_u32 v13, 0x2000, v36
    v_exp_f32 v58, v58
    v_mov_b32 v34, 1
    v_exp_f32 v59, v59
    v_cvt_pk_bf16_f32 v80, v56, v57
    s_waitcnt vmcnt(10)
    v_mfma_f32_32x32x16_bf16 v[192:207], a[180:183], v[72:75], 0
    s_add_u32 s81, s81, 65536
    v_exp_f32 v60, v60
    v_exp_f32 v61, v61
    v_exp_f32 v62, v62
    v_exp_f32 v63, v63
    v_cvt_pk_bf16_f32 v81, v58, v59
    v_cvt_pk_bf16_f32 v82, v60, v61
    s_waitcnt lgkmcnt(4)
    v_mfma_f32_32x32x8_bf16 v[40:55], a[176:177], v[140:141], v[40:55]
    v_exp_f32 v64, v64
    v_exp_f32 v65, v65
    v_exp_f32 v66, v66
    v_exp_f32 v67, v67
    v_cvt_pk_bf16_f32 v83, v62, v63
    v_cvt_pk_bf16_f32 v84, v64, v65
    s_waitcnt vmcnt(9)
L_padq3:
L_pd2449:
    s_cbranch_execz L_pd7689
    v_mfma_f32_32x32x16_bf16 v[192:207], a[184:187], v[76:79], v[192:207]
    buffer_store_dwordx4 v[152:155], v104, s[16:19], s57 offen offset:0 sc1
    v_exp_f32 v68, v68
    v_exp_f32 v69, v69
    v_exp_f32 v70, v70
    v_exp_f32 v71, v71
    v_cvt_pk_bf16_f32 v85, v66, v67
    v_cvt_pk_bf16_f32 v86, v68, v69
    v_cvt_pk_bf16_f32 v87, v70, v71
    s_waitcnt lgkmcnt(2)
    v_mfma_f32_32x32x16_bf16 v[56:71], a[160:163], v[144:147], 0
    s_mul_i32 s82, s80, 5376
    s_add_u32 s83, s82, 2688
    v_exp_f32 v40, v40
    v_mov_b32 v8, 0
    v_exp_f32 v41, v41
    v_exp_f32 v42, v42
    v_exp_f32 v43, v43
    v_cvt_pk_bf16_f32 v72, v40, v41
    v_mfma_f32_32x32x16_bf16 v[208:223], a[180:183], v[80:83], 0
    s_lshl_b32 s80, s80, 12
    s_mul_i32 s76, s38, 3072
    v_exp_f32 v44, v44
    v_add_u32 v14, s76, v36
    v_exp_f32 v45, v45
    v_exp_f32 v46, v46
    v_exp_f32 v47, v47
    v_cvt_pk_bf16_f32 v73, v42, v43
    v_cvt_pk_bf16_f32 v74, v44, v45
    s_waitcnt lgkmcnt(1)
    v_mfma_f32_32x32x8_bf16 v[56:71], a[176:177], v[148:149], v[56:71]
    v_exp_f32 v48, v48
    v_exp_f32 v49, v49
    v_exp_f32 v50, v50
    v_exp_f32 v51, v51
    v_cvt_pk_bf16_f32 v75, v46, v47
    v_cvt_pk_bf16_f32 v76, v48, v49
    v_mfma_f32_32x32x16_bf16 v[208:223], a[184:187], v[84:87], v[208:223]
    buffer_store_dwordx4 v[156:159], v104, s[16:19], s57 offen offset:2048 sc1
    v_exp_f32 v52, v52
    v_exp_f32 v53, v53
    v_exp_f32 v54, v54
    v_exp_f32 v55, v55
    v_cvt_pk_bf16_f32 v77, v50, v51
    v_cvt_pk_bf16_f32 v78, v52, v53
    v_cvt_pk_bf16_f32 v79, v54, v55
    s_waitcnt vmcnt(10)
    v_mfma_f32_32x32x16_bf16 v[40:55], a[164:167], v[120:123], 0
    buffer_load_dwordx4 a[0:3], v36, s[16:19], s80 offen offset:0 sc1
    v_exp_f32 v56, v56
    v_add_u32 v15, 69632, v14
    v_exp_f32 v57, v57
    v_exp_f32 v58, v58
    v_exp_f32 v59, v59
    v_cvt_pk_bf16_f32 v80, v56, v57
    v_mfma_f32_32x32x16_bf16 v[224:239], a[180:183], v[72:75], 0
    buffer_load_dwordx4 a[16:19], v36, s[16:19], s81 offen sc1
    v_exp_f32 v60, v60
    v_exp_f32 v61, v61
    v_exp_f32 v62, v62
    v_exp_f32 v63, v63
    v_cvt_pk_bf16_f32 v81, v58, v59
    v_cvt_pk_bf16_f32 v82, v60, v61
    v_mfma_f32_32x32x8_bf16 v[40:55], a[176:177], v[126:127], v[40:55]
    s_lshl_b32 s41, s37, 1
    v_exp_f32 v64, v64
    v_exp_f32 v65, v65
    v_exp_f32 v66, v66
    v_exp_f32 v67, v67
    v_cvt_pk_bf16_f32 v83, v62, v63
    v_cvt_pk_bf16_f32 v84, v64, v65
    v_mfma_f32_32x32x16_bf16 v[224:239], a[184:187], v[76:79], v[224:239]
    buffer_load_dwordx4 a[20:23], v9, s[16:19], s82 offen offset:0 sc1
    v_exp_f32 v68, v68
    v_exp_f32 v69, v69
    v_exp_f32 v70, v70
    v_exp_f32 v71, v71
    v_cvt_pk_bf16_f32 v85, v66, v67
    v_cvt_pk_bf16_f32 v86, v68, v69
    v_cvt_pk_bf16_f32 v87, v70, v71
    buffer_store_dwordx4 v[160:163], v104, s[16:19], s62 offen offset:0 sc1
    v_mfma_f32_32x32x16_bf16 v[56:71], a[164:167], v[128:131], 0
    buffer_load_dwordx4 a[24:27], v9, s[16:19], s82 offen offset:672 sc1
    v_exp_f32 v40, v40
    v_exp_f32 v41, v41
    v_exp_f32 v42, v42
    v_exp_f32 v43, v43
    v_cvt_pk_bf16_f32 v72, v40, v41
    v_mfma_f32_32x32x16_bf16 v[240:255], a[180:183], v[80:83], 0
    buffer_load_dwordx4 a[4:7], v36, s[16:19], s80 offen offset:1024 sc1
    v_exp_f32 v44, v44
    v_exp_f32 v45, v45
    v_exp_f32 v46, v46
    v_exp_f32 v47, v47
    v_cvt_pk_bf16_f32 v73, v42, v43
    v_cvt_pk_bf16_f32 v74, v44, v45
    v_mfma_f32_32x32x8_bf16 v[56:71], a[176:177], v[134:135], v[56:71]
    s_add_u32 s41, s41, s39
    v_exp_f32 v48, v48
    v_exp_f32 v49, v49
    v_exp_f32 v50, v50
    v_exp_f32 v51, v51
    v_cvt_pk_bf16_f32 v75, v46, v47
    v_cvt_pk_bf16_f32 v76, v48, v49
    v_mfma_f32_32x32x16_bf16 v[240:255], a[184:187], v[84:87], v[240:255]
    buffer_store_dwordx4 v[164:167], v104, s[16:19], s62 offen offset:2048 sc1
    v_exp_f32 v52, v52
    v_exp_f32 v53, v53
    v_exp_f32 v54, v54
    v_exp_f32 v55, v55
    v_cvt_pk_bf16_f32 v77, v50, v51
    v_cvt_pk_bf16_f32 v78, v52, v53
    v_cvt_pk_bf16_f32 v79, v54, v55
    v_mfma_f32_32x32x16_bf16 v[40:55], a[164:167], v[136:139], 0
    buffer_load_dwordx4 a[28:31], v9, s[16:19], s82 offen offset:1344 sc1
    v_exp_f32 v56, v56
    v_exp_f32 v57, v57
    v_exp_f32 v58, v58
    v_exp_f32 v59, v59
    v_cvt_pk_bf16_f32 v80, v56, v57
    s_waitcnt vmcnt(17)
    v_mfma_f32_32x32x16_bf16 v[192:207], a[188:191], v[72:75], v[192:207]
    buffer_load_dwordx4 a[32:35], v9, s[16:19], s82 offen offset:2016 sc1
    v_exp_f32 v60, v60
    v_exp_f32 v61, v61
    v_exp_f32 v62, v62
    v_exp_f32 v63, v63
    v_cvt_pk_bf16_f32 v81, v58, v59
    v_cvt_pk_bf16_f32 v82, v60, v61
    v_mfma_f32_32x32x8_bf16 v[40:55], a[176:177], v[142:143], v[40:55]
    s_lshr_b32 s42, s38, 1
    v_exp_f32 v64, v64
    v_exp_f32 v65, v65
    v_exp_f32 v66, v66
    v_exp_f32 v67, v67
    v_cvt_pk_bf16_f32 v83, v62, v63
    v_cvt_pk_bf16_f32 v84, v64, v65
    s_waitcnt vmcnt(17)
    v_mfma_f32_32x32x16_bf16 v[192:207], a[192:195], v[76:79], v[192:207]
    buffer_store_dwordx4 v[168:171], v104, s[16:19], s63 offen offset:0 sc1
    v_exp_f32 v68, v68
    v_exp_f32 v69, v69
    v_exp_f32 v70, v70
    v_exp_f32 v71, v71
    v_cvt_pk_bf16_f32 v85, v66, v67
    v_cvt_pk_bf16_f32 v86, v68, v69
    v_cvt_pk_bf16_f32 v87, v70, v71
    v_mfma_f32_32x32x16_bf16 v[56:71], a[164:167], v[144:147], 0
    buffer_load_dwordx4 a[8:11], v36, s[16:19], s80 offen offset:2048 sc1
    v_exp_f32 v40, v40
    v_exp_f32 v41, v41
    v_exp_f32 v42, v42
    v_exp_f32 v43, v43
    v_cvt_pk_bf16_f32 v72, v40, v41
    v_mfma_f32_32x32x16_bf16 v[208:223], a[188:191], v[80:83], v[208:223]
    buffer_load_dwordx4 a[36:39], v9, s[16:19], s83 offen offset:0 sc1
    v_exp_f32 v44, v44
    v_exp_f32 v45, v45
    v_exp_f32 v46, v46
    v_exp_f32 v47, v47
    v_cvt_pk_bf16_f32 v73, v42, v43
    v_cvt_pk_bf16_f32 v74, v44, v45
    s_waitcnt lgkmcnt(0)
    v_mfma_f32_32x32x8_bf16 v[56:71], a[176:177], v[150:151], v[56:71]
    s_and_b32 s43, s38, 1
    v_exp_f32 v48, v48
    v_min_u32 v5, 20, v11
    v_exp_f32 v49, v49
    v_mul_u32_u24 v5, 80, v5
    v_exp_f32 v50, v50
    v_exp_f32 v51, v51
    v_cvt_pk_bf16_f32 v75, v46, v47
    v_cvt_pk_bf16_f32 v76, v48, v49
    v_mfma_f32_32x32x16_bf16 v[208:223], a[192:195], v[84:87], v[208:223]
    buffer_store_dwordx4 v[172:175], v105, s[16:19], s57 offen offset:0 sc1
    v_exp_f32 v52, v52
    v_exp_f32 v53, v53
    v_exp_f32 v54, v54
    v_exp_f32 v55, v55
    v_cvt_pk_bf16_f32 v77, v50, v51
    v_cvt_pk_bf16_f32 v78, v52, v53
    v_cvt_pk_bf16_f32 v79, v54, v55
    s_waitcnt vmcnt(20)
    v_mfma_f32_32x32x16_bf16 v[40:55], a[168:171], v[120:123], 0
    buffer_load_dwordx4 a[40:43], v9, s[16:19], s83 offen offset:672 sc1
    v_exp_f32 v56, v56
    v_exp_f32 v57, v57
    v_exp_f32 v58, v58
    v_exp_f32 v59, v59
    v_cvt_pk_bf16_f32 v80, v56, v57
    v_mfma_f32_32x32x16_bf16 v[224:239], a[188:191], v[72:75], v[224:239]
    buffer_load_dwordx4 a[12:15], v36, s[16:19], s80 offen offset:3072 sc1
    v_exp_f32 v60, v60
    v_exp_f32 v61, v61
    v_exp_f32 v62, v62
    v_exp_f32 v63, v63
    v_cvt_pk_bf16_f32 v81, v58, v59
    v_cvt_pk_bf16_f32 v82, v60, v61
    v_mfma_f32_32x32x8_bf16 v[40:55], a[178:179], v[124:125], v[40:55]
    s_mul_i32 s76, s42, 1680
    v_exp_f32 v64, v64
    v_exp_f32 v65, v65
    v_exp_f32 v66, v66
    v_exp_f32 v67, v67
    v_cvt_pk_bf16_f32 v83, v62, v63
    v_cvt_pk_bf16_f32 v84, v64, v65
    v_mfma_f32_32x32x16_bf16 v[224:239], a[192:195], v[76:79], v[224:239]
    buffer_store_dwordx4 v[176:179], v105, s[16:19], s57 offen offset:2048 sc1
    v_exp_f32 v68, v68
    v_exp_f32 v69, v69
    v_exp_f32 v70, v70
    v_exp_f32 v71, v71
    v_cvt_pk_bf16_f32 v85, v66, v67
    v_cvt_pk_bf16_f32 v86, v68, v69
    v_cvt_pk_bf16_f32 v87, v70, v71
    v_mfma_f32_32x32x16_bf16 v[56:71], a[168:171], v[128:131], 0
    buffer_load_dwordx4 a[44:47], v9, s[16:19], s83 offen offset:1344 sc1
    v_exp_f32 v40, v40
    v_exp_f32 v41, v41
    v_exp_f32 v42, v42
    v_exp_f32 v43, v43
    v_cvt_pk_bf16_f32 v72, v40, v41
    v_mfma_f32_32x32x16_bf16 v[240:255], a[188:191], v[80:83], v[240:255]
    buffer_load_dwordx4 a[48:51], v9, s[16:19], s83 offen offset:2016 sc1
    v_exp_f32 v44, v44
    v_exp_f32 v45, v45
    v_exp_f32 v46, v46
    v_exp_f32 v47, v47
    v_cvt_pk_bf16_f32 v73, v42, v43
    v_cvt_pk_bf16_f32 v74, v44, v45
    v_mfma_f32_32x32x8_bf16 v[56:71], a[178:179], v[132:133], v[56:71]
    s_add_u32 s76, s76, 143360
    v_exp_f32 v48, v48
    v_add_u32 v5, s76, v5
    v_exp_f32 v49, v49
    v_lshl_add_u32 v21, v10, 4, v5
    v_exp_f32 v50, v50
    v_exp_f32 v51, v51
    v_cvt_pk_bf16_f32 v75, v46, v47
    v_cvt_pk_bf16_f32 v76, v48, v49
    v_mfma_f32_32x32x16_bf16 v[240:255], a[192:195], v[84:87], v[240:255]
    buffer_store_dwordx4 v[180:183], v105, s[16:19], s62 offen offset:0 sc1
    v_exp_f32 v52, v52
    v_exp_f32 v53, v53
    v_exp_f32 v54, v54
    v_exp_f32 v55, v55
    v_cvt_pk_bf16_f32 v77, v50, v51
    v_cvt_pk_bf16_f32 v78, v52, v53
    v_cvt_pk_bf16_f32 v79, v54, v55
    v_mfma_f32_32x32x16_bf16 v[40:55], a[168:171], v[136:139], 0
    s_add_u32 s80, s69, 2
    s_and_b32 s80, s80, 3
    v_exp_f32 v56, v56
    v_lshl_add_u32 v22, v10, 3, v5
    v_exp_f32 v57, v57
    v_exp_f32 v58, v58
    v_exp_f32 v59, v59
    v_cvt_pk_bf16_f32 v80, v56, v57
    s_waitcnt vmcnt(25)
    v_mfma_f32_32x32x16_bf16 v[192:207], a[196:199], v[72:75], v[192:207]
    buffer_store_dwordx4 v[184:187], v105, s[16:19], s62 offen offset:2048 sc1
    v_exp_f32 v60, v60
    v_exp_f32 v61, v61
    v_exp_f32 v62, v62
    v_exp_f32 v63, v63
    v_cvt_pk_bf16_f32 v81, v58, v59
    v_cvt_pk_bf16_f32 v82, v60, v61
    v_mfma_f32_32x32x8_bf16 v[40:55], a[178:179], v[140:141], v[40:55]
    s_mul_i32 s76, s42, 10240
    v_exp_f32 v64, v64
    v_exp_f32 v65, v65
    v_exp_f32 v66, v66
    v_exp_f32 v67, v67
    v_cvt_pk_bf16_f32 v83, v62, v63
    v_cvt_pk_bf16_f32 v84, v64, v65
    s_waitcnt vmcnt(25)
    v_mfma_f32_32x32x16_bf16 v[192:207], a[200:203], v[76:79], v[192:207]
    s_lshl_b32 s77, s43, 9
    v_exp_f32 v68, v68
    v_exp_f32 v69, v69
    v_exp_f32 v70, v70
    v_exp_f32 v71, v71
    v_cvt_pk_bf16_f32 v85, v66, v67
    v_cvt_pk_bf16_f32 v86, v68, v69
    v_cvt_pk_bf16_f32 v87, v70, v71
    v_mfma_f32_32x32x16_bf16 v[56:71], a[168:171], v[144:147], 0
    s_lshl_b32 s81, s38, 2
    s_add_u32 s80, s80, s81
    v_exp_f32 v40, v40
    v_exp_f32 v41, v41
    v_exp_f32 v42, v42
    v_exp_f32 v43, v43
    v_cvt_pk_bf16_f32 v72, v40, v41
    v_mfma_f32_32x32x16_bf16 v[208:223], a[196:199], v[80:83], v[208:223]
    buffer_store_dwordx4 v[188:191], v105, s[16:19], s63 offen offset:0 sc1
    v_exp_f32 v44, v44
    v_exp_f32 v45, v45
    v_exp_f32 v46, v46
    v_exp_f32 v47, v47
    v_cvt_pk_bf16_f32 v73, v42, v43
    v_cvt_pk_bf16_f32 v74, v44, v45
    v_mfma_f32_32x32x8_bf16 v[56:71], a[178:179], v[148:149], v[56:71]
    s_add_u32 s76, s76, s77
    v_exp_f32 v48, v48
    v_lshlrev_b32 v5, 4, v11
    v_exp_f32 v49, v49
    v_add_u32 v5, s76, v5
    v_exp_f32 v50, v50
    v_exp_f32 v51, v51
    v_cvt_pk_bf16_f32 v75, v46, v47
    v_cvt_pk_bf16_f32 v76, v48, v49
    v_mfma_f32_32x32x16_bf16 v[208:223], a[200:203], v[84:87], v[208:223]
    v_exp_f32 v52, v52
    v_exp_f32 v53, v53
    v_exp_f32 v54, v54
    v_exp_f32 v55, v55
    v_cvt_pk_bf16_f32 v77, v50, v51
    v_cvt_pk_bf16_f32 v78, v52, v53
    v_cvt_pk_bf16_f32 v79, v54, v55
    s_waitcnt vmcnt(25)
    v_mfma_f32_32x32x16_bf16 v[40:55], a[172:175], v[120:123], 0
    s_lshl_b32 s81, s80, 10
    s_add_u32 s81, s81, 65536
    v_exp_f32 v56, v56
    v_lshl_add_u32 v23, v10, 11, v5
    v_exp_f32 v57, v57
    v_lshl_add_u32 v24, v10, 3, v5
    v_exp_f32 v58, v58
    v_exp_f32 v59, v59
    v_cvt_pk_bf16_f32 v80, v56, v57
    v_mfma_f32_32x32x16_bf16 v[224:239], a[196:199], v[72:75], v[224:239]
    s_mul_i32 s76, s38, 12288
    v_exp_f32 v60, v60
    v_exp_f32 v61, v61
    v_exp_f32 v62, v62
    v_exp_f32 v63, v63
    v_cvt_pk_bf16_f32 v81, v58, v59
    v_cvt_pk_bf16_f32 v82, v60, v61
    v_mfma_f32_32x32x8_bf16 v[40:55], a[178:179], v[126:127], v[40:55]
    v_exp_f32 v64, v64
    v_exp_f32 v65, v65
    v_exp_f32 v66, v66
    v_exp_f32 v67, v67
    v_cvt_pk_bf16_f32 v83, v62, v63
    v_cvt_pk_bf16_f32 v84, v64, v65
    v_mfma_f32_32x32x16_bf16 v[224:239], a[200:203], v[76:79], v[224:239]
    v_exp_f32 v68, v68
    v_exp_f32 v69, v69
    v_exp_f32 v70, v70
    v_exp_f32 v71, v71
    v_cvt_pk_bf16_f32 v85, v66, v67
    v_cvt_pk_bf16_f32 v86, v68, v69
    v_cvt_pk_bf16_f32 v87, v70, v71
    v_mfma_f32_32x32x16_bf16 v[56:71], a[172:175], v[128:131], 0
    s_mul_i32 s82, s80, 5376
    s_add_u32 s83, s82, 2688
    v_exp_f32 v40, v40
    v_exp_f32 v41, v41
    v_exp_f32 v42, v42
    v_exp_f32 v43, v43
    v_cvt_pk_bf16_f32 v72, v40, v41
    v_mfma_f32_32x32x16_bf16 v[240:255], a[196:199], v[80:83], v[240:255]
    s_add_u32 s76, s76, 32768
    s_cmp_eq_u32 s38, 0
    s_cselect_b32 s76, 20480, s76
    v_exp_f32 v44, v44
    v_add_u32 v25, s76, v36
    v_exp_f32 v45, v45
    v_exp_f32 v46, v46
    v_exp_f32 v47, v47
    v_cvt_pk_bf16_f32 v73, v42, v43
    v_cvt_pk_bf16_f32 v74, v44, v45
    v_mfma_f32_32x32x8_bf16 v[56:71], a[178:179], v[134:135], v[56:71]
    v_exp_f32 v48, v48
    v_exp_f32 v49, v49
    v_exp_f32 v50, v50
    v_exp_f32 v51, v51
    v_cvt_pk_bf16_f32 v75, v46, v47
    v_cvt_pk_bf16_f32 v76, v48, v49
    v_mfma_f32_32x32x16_bf16 v[240:255], a[200:203], v[84:87], v[240:255]
    v_exp_f32 v52, v52
    v_exp_f32 v53, v53
    v_exp_f32 v54, v54
    v_exp_f32 v55, v55
    v_cvt_pk_bf16_f32 v77, v50, v51
    v_cvt_pk_bf16_f32 v78, v52, v53
    v_cvt_pk_bf16_f32 v79, v54, v55
    v_mfma_f32_32x32x16_bf16 v[40:55], a[172:175], v[136:139], 0
    s_lshl_b32 s80, s80, 12
    v_exp_f32 v56, v56
    v_lshrrev_b32 v5, 4, v11
    v_exp_f32 v57, v57
    v_mul_u32_u24 v5, 40960, v5
    v_exp_f32 v58, v58
    v_lshl_add_u32 v5, v38, 4, v5
    v_exp_f32 v59, v59
    v_cvt_pk_bf16_f32 v80, v56, v57
    s_waitcnt vmcnt(24)
    v_mfma_f32_32x32x16_bf16 v[192:207], a[204:207], v[72:75], v[192:207]
    buffer_load_dwordx4 a[52:55], v36, s[16:19], s80 offen offset:0 sc1
    v_exp_f32 v60, v60
    v_exp_f32 v61, v61
    v_exp_f32 v62, v62
    v_exp_f32 v63, v63
    v_cvt_pk_bf16_f32 v81, v58, v59
    v_cvt_pk_bf16_f32 v82, v60, v61
    v_mfma_f32_32x32x8_bf16 v[40:55], a[178:179], v[142:143], v[40:55]
    v_exp_f32 v64, v64
    v_exp_f32 v65, v65
    v_exp_f32 v66, v66
    v_exp_f32 v67, v67
    v_cvt_pk_bf16_f32 v83, v62, v63
    v_cvt_pk_bf16_f32 v84, v64, v65
    s_waitcnt vmcnt(24)
    v_mfma_f32_32x32x16_bf16 v[192:207], a[208:211], v[76:79], v[192:207]
    v_exp_f32 v68, v68
    v_exp_f32 v69, v69
    v_exp_f32 v70, v70
    v_exp_f32 v71, v71
    v_cvt_pk_bf16_f32 v85, v66, v67
    v_cvt_pk_bf16_f32 v86, v68, v69
    v_cvt_pk_bf16_f32 v87, v70, v71
    v_mfma_f32_32x32x16_bf16 v[56:71], a[172:175], v[144:147], 0
    buffer_load_dwordx4 a[68:71], v36, s[16:19], s81 offen sc1
    v_exp_f32 v40, v40
    v_lshl_add_u32 v6, v10, 8, v5
    v_exp_f32 v41, v41
    v_exp_f32 v42, v42
    v_exp_f32 v43, v43
    v_cvt_pk_bf16_f32 v72, v40, v41
    v_mfma_f32_32x32x16_bf16 v[208:223], a[204:207], v[80:83], v[208:223]
    buffer_load_dwordx4 a[72:75], v9, s[16:19], s82 offen offset:0 sc1
    v_exp_f32 v44, v44
    v_exp_f32 v45, v45
    v_exp_f32 v46, v46
    v_exp_f32 v47, v47
    v_cvt_pk_bf16_f32 v73, v42, v43
    v_cvt_pk_bf16_f32 v74, v44, v45
    v_mfma_f32_32x32x8_bf16 v[56:71], a[178:179], v[150:151], v[56:71]
    s_waitcnt vmcnt(6)
    v_exp_f32 v48, v48
    v_exp_f32 v49, v49
    v_exp_f32 v50, v50
    v_exp_f32 v51, v51
    v_cvt_pk_bf16_f32 v75, v46, v47
    v_cvt_pk_bf16_f32 v76, v48, v49
    v_mfma_f32_32x32x16_bf16 v[208:223], a[208:211], v[84:87], v[208:223]
    s_mul_i32 s76, s42, 768
    v_exp_f32 v52, v52
    v_add_u32 v26, s76, v6
    v_exp_f32 v53, v53
    v_exp_f32 v54, v54
    v_exp_f32 v55, v55
    v_cvt_pk_bf16_f32 v77, v50, v51
    v_cvt_pk_bf16_f32 v78, v52, v53
    v_cvt_pk_bf16_f32 v79, v54, v55
    v_mfma_f32_32x32x16_bf16 v[40:55], a[0:3], v[120:123], 0
    buffer_load_dwordx4 a[76:79], v9, s[16:19], s82 offen offset:672 sc1
    v_exp_f32 v56, v56
    v_accvgpr_read_b32 v88, a212
    v_exp_f32 v57, v57
    v_accvgpr_read_b32 v89, a213
    v_exp_f32 v58, v58
    v_accvgpr_read_b32 v90, a214
    v_exp_f32 v59, v59
    v_accvgpr_read_b32 v91, a215
    v_cvt_pk_bf16_f32 v80, v56, v57
    v_mfma_f32_32x32x16_bf16 v[224:239], a[204:207], v[72:75], v[224:239]
    buffer_load_dwordx4 a[56:59], v36, s[16:19], s80 offen offset:1024 sc1
    v_exp_f32 v60, v60
    v_exp_f32 v61, v61
    v_exp_f32 v62, v62
    v_exp_f32 v63, v63
    v_cvt_pk_bf16_f32 v81, v58, v59
    v_cvt_pk_bf16_f32 v82, v60, v61
    v_mfma_f32_32x32x8_bf16 v[40:55], a[16:17], v[124:125], v[40:55]
    s_lshl_b32 s76, s42, 3
    v_exp_f32 v64, v64
    v_add_u32 v5, s76, v5
    v_exp_f32 v65, v65
    v_lshl_or_b32 v27, v10, 31, v5
    v_exp_f32 v66, v66
    v_exp_f32 v67, v67
    v_cvt_pk_bf16_f32 v83, v62, v63
    v_cvt_pk_bf16_f32 v84, v64, v65
    v_mfma_f32_32x32x16_bf16 v[224:239], a[208:211], v[76:79], v[224:239]
    v_exp_f32 v68, v68
    v_exp_f32 v69, v69
    v_exp_f32 v70, v70
    v_exp_f32 v71, v71
    v_cvt_pk_bf16_f32 v85, v66, v67
    v_cvt_pk_bf16_f32 v86, v68, v69
    v_cvt_pk_bf16_f32 v87, v70, v71
    v_mfma_f32_32x32x16_bf16 v[56:71], a[0:3], v[128:131], 0
    buffer_load_dwordx4 a[80:83], v9, s[16:19], s82 offen offset:1344 sc1
    v_exp_f32 v40, v40
    v_accvgpr_read_b32 v92, a216
    v_exp_f32 v41, v41
    v_accvgpr_read_b32 v93, a217
    v_exp_f32 v42, v42
    v_accvgpr_read_b32 v94, a218
    v_exp_f32 v43, v43
    v_cvt_pk_bf16_f32 v72, v40, v41
    v_mfma_f32_32x32x16_bf16 v[240:255], a[204:207], v[80:83], v[240:255]
    buffer_load_dwordx4 a[84:87], v9, s[16:19], s82 offen offset:2016 sc1
    v_exp_f32 v44, v44
    v_exp_f32 v45, v45
    v_exp_f32 v46, v46
    v_exp_f32 v47, v47
    v_cvt_pk_bf16_f32 v73, v42, v43
    v_cvt_pk_bf16_f32 v74, v44, v45
    v_mfma_f32_32x32x8_bf16 v[56:71], a[16:17], v[132:133], v[56:71]
    s_lshl_b32 s76, s36, 3
    v_exp_f32 v48, v48
    v_exp_f32 v49, v49
    v_exp_f32 v50, v50
    v_exp_f32 v51, v51
    v_cvt_pk_bf16_f32 v75, v46, v47
    v_cvt_pk_bf16_f32 v76, v48, v49
    v_mfma_f32_32x32x16_bf16 v[240:255], a[208:211], v[84:87], v[240:255]
    s_lshl_b32 s77, s43, 1
    s_add_u32 s76, s76, s77
    v_exp_f32 v52, v52
    v_exp_f32 v53, v53
    v_exp_f32 v54, v54
    v_exp_f32 v55, v55
    v_cvt_pk_bf16_f32 v77, v50, v51
    v_cvt_pk_bf16_f32 v78, v52, v53
    v_cvt_pk_bf16_f32 v79, v54, v55
    s_mul_i32 s78, s36, 51200
    v_mfma_f32_32x32x16_bf16 v[40:55], a[0:3], v[136:139], 0
    buffer_load_dwordx4 a[60:63], v36, s[16:19], s80 offen offset:2048 sc1
    v_exp_f32 v56, v56
    v_exp_f32 v57, v57
    v_exp_f32 v58, v58
    v_exp_f32 v59, v59
    v_cvt_pk_bf16_f32 v80, v56, v57
    v_mfma_f32_32x32x16_bf16 v[192:207], a[20:23], v[72:75], v[192:207]
    buffer_load_dwordx4 a[88:91], v9, s[16:19], s83 offen offset:0 sc1
    v_exp_f32 v60, v60
    v_exp_f32 v61, v61
    v_exp_f32 v62, v62
    v_exp_f32 v63, v63
    v_cvt_pk_bf16_f32 v81, v58, v59
    v_cvt_pk_bf16_f32 v82, v60, v61
    v_mfma_f32_32x32x8_bf16 v[40:55], a[16:17], v[140:141], v[40:55]
    s_mul_i32 s76, s76, 40960
    v_exp_f32 v64, v64
    v_exp_f32 v65, v65
    v_exp_f32 v66, v66
    v_exp_f32 v67, v67
    v_cvt_pk_bf16_f32 v83, v62, v63
    v_cvt_pk_bf16_f32 v84, v64, v65
    v_mfma_f32_32x32x16_bf16 v[192:207], a[24:27], v[76:79], v[192:207]
    s_lshr_b32 s77, s41, 2
    s_mul_i32 s77, s77, 5120
    v_exp_f32 v68, v68
    v_exp_f32 v69, v69
    v_exp_f32 v70, v70
    v_exp_f32 v71, v71
    v_cvt_pk_bf16_f32 v85, v66, v67
    v_cvt_pk_bf16_f32 v86, v68, v69
    v_cvt_pk_bf16_f32 v87, v70, v71
    s_mul_i32 s79, s37, 160
    s_add_u32 s78, s78, s79
    s_lshl_b32 s79, s38, 13
    v_mfma_f32_32x32x16_bf16 v[56:71], a[0:3], v[144:147], 0
    buffer_load_dwordx4 a[92:95], v9, s[16:19], s83 offen offset:672 sc1
    v_exp_f32 v40, v40
    v_exp_f32 v41, v41
    v_exp_f32 v42, v42
    v_exp_f32 v43, v43
    v_cvt_pk_bf16_f32 v72, v40, v41
    v_mfma_f32_32x32x16_bf16 v[208:223], a[20:23], v[80:83], v[208:223]
    buffer_load_dwordx4 a[64:67], v36, s[16:19], s80 offen offset:3072 sc1
    v_exp_f32 v44, v44
    v_exp_f32 v45, v45
    v_exp_f32 v46, v46
    v_exp_f32 v47, v47
    v_cvt_pk_bf16_f32 v73, v42, v43
    v_cvt_pk_bf16_f32 v74, v44, v45
    v_mfma_f32_32x32x8_bf16 v[56:71], a[16:17], v[148:149], v[56:71]
    s_add_u32 s76, s76, s77
    v_exp_f32 v48, v48
    v_exp_f32 v49, v49
    v_exp_f32 v50, v50
    v_exp_f32 v51, v51
    v_cvt_pk_bf16_f32 v75, v46, v47
    v_cvt_pk_bf16_f32 v76, v48, v49
    v_mfma_f32_32x32x16_bf16 v[208:223], a[24:27], v[84:87], v[208:223]
    s_mul_i32 s77, s41, 1280
    s_add_u32 s76, s76, s77
    v_exp_f32 v52, v52
    v_exp_f32 v53, v53
    v_exp_f32 v54, v54
    v_exp_f32 v55, v55
    v_cvt_pk_bf16_f32 v77, v50, v51
    v_cvt_pk_bf16_f32 v78, v52, v53
    v_cvt_pk_bf16_f32 v79, v54, v55
    s_add_u32 m0, s79, 98304
    s_nop 0
    buffer_load_dwordx4 v88, s[32:35], s78 offen lds
    s_add_u32 m0, s79, 99328
    v_mfma_f32_32x32x16_bf16 v[40:55], a[4:7], v[120:123], 0
    buffer_load_dwordx4 a[96:99], v9, s[16:19], s83 offen offset:1344 sc1
    v_exp_f32 v56, v56
    v_exp_f32 v57, v57
    v_exp_f32 v58, v58
    v_exp_f32 v59, v59
    v_cvt_pk_bf16_f32 v80, v56, v57
    v_mfma_f32_32x32x16_bf16 v[224:239], a[20:23], v[72:75], v[224:239]
    buffer_load_dwordx4 a[100:103], v9, s[16:19], s83 offen offset:2016 sc1
    v_exp_f32 v60, v60
    v_exp_f32 v61, v61
    v_exp_f32 v62, v62
    v_exp_f32 v63, v63
    v_cvt_pk_bf16_f32 v81, v58, v59
    v_cvt_pk_bf16_f32 v82, v60, v61
    v_mfma_f32_32x32x8_bf16 v[40:55], a[16:17], v[126:127], v[40:55]
    s_add_u32 s44, s76, 2097152
    v_exp_f32 v64, v64
    v_exp_f32 v65, v65
    v_exp_f32 v66, v66
    v_exp_f32 v67, v67
    v_cvt_pk_bf16_f32 v83, v62, v63
    v_cvt_pk_bf16_f32 v84, v64, v65
    v_mfma_f32_32x32x16_bf16 v[224:239], a[24:27], v[76:79], v[224:239]
    s_add_u32 s45, s44, 163840
    s_add_u32 s72, s44, 5120
    v_exp_f32 v68, v68
    v_exp_f32 v69, v69
    v_exp_f32 v70, v70
    v_exp_f32 v71, v71
    v_cvt_pk_bf16_f32 v85, v66, v67
    v_cvt_pk_bf16_f32 v86, v68, v69
    v_cvt_pk_bf16_f32 v87, v70, v71
    buffer_load_dwordx4 v89, s[32:35], s78 offen lds
    s_add_u32 m0, s79, 100352
    s_nop 0
    buffer_load_dwordx4 v90, s[32:35], s78 offen lds
    v_mfma_f32_32x32x16_bf16 v[56:71], a[4:7], v[128:131], 0
    s_add_u32 s80, s69, 3
    s_and_b32 s80, s80, 3
    v_exp_f32 v40, v40
    v_exp_f32 v41, v41
    v_exp_f32 v42, v42
    v_exp_f32 v43, v43
    v_cvt_pk_bf16_f32 v72, v40, v41
    v_mfma_f32_32x32x16_bf16 v[240:255], a[20:23], v[80:83], v[240:255]
    s_add_u32 s73, s45, 5120
    s_lshl_b32 s76, s36, 9
    v_exp_f32 v44, v44
    v_exp_f32 v45, v45
    v_exp_f32 v46, v46
    v_exp_f32 v47, v47
    v_cvt_pk_bf16_f32 v73, v42, v43
    v_cvt_pk_bf16_f32 v74, v44, v45
    v_mfma_f32_32x32x8_bf16 v[56:71], a[16:17], v[134:135], v[56:71]
    s_lshl_b32 s77, s43, 7
    v_exp_f32 v48, v48
    v_exp_f32 v49, v49
    v_exp_f32 v50, v50
    v_exp_f32 v51, v51
    v_cvt_pk_bf16_f32 v75, v46, v47
    v_cvt_pk_bf16_f32 v76, v48, v49
    v_mfma_f32_32x32x16_bf16 v[240:255], a[24:27], v[84:87], v[240:255]
    v_exp_f32 v52, v52
    v_exp_f32 v53, v53
    v_exp_f32 v54, v54
    v_exp_f32 v55, v55
    v_cvt_pk_bf16_f32 v77, v50, v51
    v_cvt_pk_bf16_f32 v78, v52, v53
    v_cvt_pk_bf16_f32 v79, v54, v55
    v_mfma_f32_32x32x16_bf16 v[40:55], a[4:7], v[136:139], 0
    s_lshl_b32 s81, s38, 2
    s_add_u32 s80, s80, s81
    v_exp_f32 v56, v56
    v_exp_f32 v57, v57
    v_exp_f32 v58, v58
    v_exp_f32 v59, v59
    v_cvt_pk_bf16_f32 v80, v56, v57
    v_mfma_f32_32x32x16_bf16 v[192:207], a[28:31], v[72:75], v[192:207]
    s_add_u32 s76, s76, s77
    s_add_u32 s76, s76, 229376
    v_exp_f32 v60, v60
    v_lshlrev_b32 v5, 2, v11
    v_exp_f32 v61, v61
    v_exp_f32 v62, v62
    v_exp_f32 v63, v63
    v_cvt_pk_bf16_f32 v81, v58, v59
    v_cvt_pk_bf16_f32 v82, v60, v61
    v_mfma_f32_32x32x8_bf16 v[40:55], a[16:17], v[142:143], v[40:55]
    v_exp_f32 v64, v64
    v_exp_f32 v65, v65
    v_exp_f32 v66, v66
    v_exp_f32 v67, v67
    v_cvt_pk_bf16_f32 v83, v62, v63
    v_cvt_pk_bf16_f32 v84, v64, v65
    v_mfma_f32_32x32x16_bf16 v[192:207], a[32:35], v[76:79], v[192:207]
    v_exp_f32 v68, v68
L_pd3150:
    s_cbranch_execz L_pd8396
    v_exp_f32 v69, v69
    v_exp_f32 v70, v70
    v_exp_f32 v71, v71
    v_cvt_pk_bf16_f32 v85, v66, v67
    v_cvt_pk_bf16_f32 v86, v68, v69
    v_cvt_pk_bf16_f32 v87, v70, v71
    v_mfma_f32_32x32x16_bf16 v[56:71], a[4:7], v[144:147], 0
    s_lshl_b32 s81, s80, 10
    s_add_u32 s81, s81, 65536
    v_exp_f32 v40, v40
    v_lshl_add_u32 v5, v10, 8, v5
    v_exp_f32 v41, v41
    v_exp_f32 v42, v42
    v_exp_f32 v43, v43
    v_cvt_pk_bf16_f32 v72, v40, v41
    v_mfma_f32_32x32x16_bf16 v[208:223], a[28:31], v[80:83], v[208:223]
    buffer_load_dword v19, v5, s[16:19], s76 offen sc1
    v_exp_f32 v44, v44
    v_exp_f32 v45, v45
    v_exp_f32 v46, v46
    v_exp_f32 v47, v47
    v_cvt_pk_bf16_f32 v73, v42, v43
    v_cvt_pk_bf16_f32 v74, v44, v45
    v_mfma_f32_32x32x8_bf16 v[56:71], a[16:17], v[150:151], v[56:71]
    v_exp_f32 v48, v48
    v_exp_f32 v49, v49
    v_exp_f32 v50, v50
    v_exp_f32 v51, v51
    v_cvt_pk_bf16_f32 v75, v46, v47
    v_cvt_pk_bf16_f32 v76, v48, v49
    v_mfma_f32_32x32x16_bf16 v[208:223], a[32:35], v[84:87], v[208:223]
    v_exp_f32 v52, v52
    v_exp_f32 v53, v53
    v_exp_f32 v54, v54
    v_exp_f32 v55, v55
    v_cvt_pk_bf16_f32 v77, v50, v51
    v_cvt_pk_bf16_f32 v78, v52, v53
    v_cvt_pk_bf16_f32 v79, v54, v55
    v_mfma_f32_32x32x16_bf16 v[40:55], a[8:11], v[120:123], 0
    s_mul_i32 s82, s80, 5376
    s_add_u32 s83, s82, 2688
    v_exp_f32 v56, v56
    v_exp_f32 v57, v57
    v_exp_f32 v58, v58
    v_exp_f32 v59, v59
    v_cvt_pk_bf16_f32 v80, v56, v57
    v_mfma_f32_32x32x16_bf16 v[224:239], a[28:31], v[72:75], v[224:239]
    s_lshl_b32 s76, s36, 13
    s_lshl_b32 s77, s43, 11
    v_exp_f32 v60, v60
    v_exp_f32 v61, v61
    v_exp_f32 v62, v62
    v_exp_f32 v63, v63
    v_cvt_pk_bf16_f32 v81, v58, v59
    v_cvt_pk_bf16_f32 v82, v60, v61
    v_mfma_f32_32x32x8_bf16 v[40:55], a[18:19], v[124:125], v[40:55]
    v_exp_f32 v64, v64
    v_exp_f32 v65, v65
    v_exp_f32 v66, v66
    v_exp_f32 v67, v67
    v_cvt_pk_bf16_f32 v83, v62, v63
    v_cvt_pk_bf16_f32 v84, v64, v65
    v_mfma_f32_32x32x16_bf16 v[224:239], a[32:35], v[76:79], v[224:239]
    v_exp_f32 v68, v68
    v_exp_f32 v69, v69
    v_exp_f32 v70, v70
    v_exp_f32 v71, v71
    v_cvt_pk_bf16_f32 v85, v66, v67
    v_cvt_pk_bf16_f32 v86, v68, v69
    v_cvt_pk_bf16_f32 v87, v70, v71
    v_mfma_f32_32x32x16_bf16 v[56:71], a[8:11], v[128:131], 0
    s_lshl_b32 s80, s80, 12
    s_add_u32 s46, s76, s77
    v_exp_f32 v40, v40
    v_exp_f32 v41, v41
    v_exp_f32 v42, v42
    v_exp_f32 v43, v43
    v_cvt_pk_bf16_f32 v72, v40, v41
    v_mfma_f32_32x32x16_bf16 v[240:255], a[28:31], v[80:83], v[240:255]
    buffer_load_dwordx4 a[104:107], v36, s[16:19], s80 offen offset:0 sc1
    v_exp_f32 v44, v44
    v_exp_f32 v45, v45
    v_exp_f32 v46, v46
    v_exp_f32 v47, v47
    v_cvt_pk_bf16_f32 v73, v42, v43
    v_cvt_pk_bf16_f32 v74, v44, v45
    v_mfma_f32_32x32x8_bf16 v[56:71], a[18:19], v[132:133], v[56:71]
    s_lshl_b32 s77, s41, 7
    v_exp_f32 v48, v48
    v_exp_f32 v49, v49
    v_exp_f32 v50, v50
    v_exp_f32 v51, v51
    v_cvt_pk_bf16_f32 v75, v46, v47
    v_cvt_pk_bf16_f32 v76, v48, v49
    v_mfma_f32_32x32x16_bf16 v[240:255], a[32:35], v[84:87], v[240:255]
    v_exp_f32 v52, v52
    v_exp_f32 v53, v53
    v_exp_f32 v54, v54
    v_exp_f32 v55, v55
    v_cvt_pk_bf16_f32 v77, v50, v51
    v_cvt_pk_bf16_f32 v78, v52, v53
    v_cvt_pk_bf16_f32 v79, v54, v55
    v_mfma_f32_32x32x16_bf16 v[40:55], a[8:11], v[136:139], 0
    buffer_load_dwordx4 a[120:123], v36, s[16:19], s81 offen sc1
    v_exp_f32 v56, v56
    v_exp_f32 v57, v57
    v_exp_f32 v58, v58
    v_exp_f32 v59, v59
    v_cvt_pk_bf16_f32 v80, v56, v57
    v_mfma_f32_32x32x16_bf16 v[192:207], a[36:39], v[72:75], v[192:207]
    buffer_load_dwordx4 a[124:127], v9, s[16:19], s82 offen offset:0 sc1
    v_exp_f32 v60, v60
    v_exp_f32 v61, v61
    v_exp_f32 v62, v62
    v_exp_f32 v63, v63
    v_cvt_pk_bf16_f32 v81, v58, v59
    v_cvt_pk_bf16_f32 v82, v60, v61
    v_mfma_f32_32x32x8_bf16 v[40:55], a[18:19], v[140:141], v[40:55]
    s_add_u32 s46, s46, s77
    v_exp_f32 v64, v64
    v_exp_f32 v65, v65
    v_exp_f32 v66, v66
    v_exp_f32 v67, v67
    v_cvt_pk_bf16_f32 v83, v62, v63
    v_cvt_pk_bf16_f32 v84, v64, v65
    v_mfma_f32_32x32x16_bf16 v[192:207], a[40:43], v[76:79], v[192:207]
    s_lshl_b32 s77, s42, 6
    v_exp_f32 v68, v68
    v_exp_f32 v69, v69
    v_exp_f32 v70, v70
    v_exp_f32 v71, v71
    v_cvt_pk_bf16_f32 v85, v66, v67
    v_cvt_pk_bf16_f32 v86, v68, v69
    v_cvt_pk_bf16_f32 v87, v70, v71
    v_mfma_f32_32x32x16_bf16 v[56:71], a[8:11], v[144:147], 0
    buffer_load_dwordx4 a[128:131], v9, s[16:19], s82 offen offset:672 sc1
    v_exp_f32 v40, v40
    v_exp_f32 v41, v41
    v_exp_f32 v42, v42
    v_exp_f32 v43, v43
    v_cvt_pk_bf16_f32 v72, v40, v41
    v_mfma_f32_32x32x16_bf16 v[208:223], a[36:39], v[80:83], v[208:223]
    buffer_load_dwordx4 a[108:111], v36, s[16:19], s80 offen offset:1024 sc1
    v_exp_f32 v44, v44
    v_exp_f32 v45, v45
    v_exp_f32 v46, v46
    v_exp_f32 v47, v47
    v_cvt_pk_bf16_f32 v73, v42, v43
    v_cvt_pk_bf16_f32 v74, v44, v45
    v_mfma_f32_32x32x8_bf16 v[56:71], a[18:19], v[148:149], v[56:71]
    s_add_u32 s46, s46, s77
    v_exp_f32 v48, v48
    v_exp_f32 v49, v49
    v_exp_f32 v50, v50
    v_exp_f32 v51, v51
    v_cvt_pk_bf16_f32 v75, v46, v47
    v_cvt_pk_bf16_f32 v76, v48, v49
    v_mfma_f32_32x32x16_bf16 v[208:223], a[40:43], v[84:87], v[208:223]
    s_add_u32 s46, s46, 393216
    v_exp_f32 v52, v52
    v_exp_f32 v53, v53
    v_exp_f32 v54, v54
    v_exp_f32 v55, v55
    v_cvt_pk_bf16_f32 v77, v50, v51
    v_cvt_pk_bf16_f32 v78, v52, v53
    v_cvt_pk_bf16_f32 v79, v54, v55
    v_mfma_f32_32x32x16_bf16 v[40:55], a[12:15], v[120:123], 0
    buffer_load_dwordx4 a[132:135], v9, s[16:19], s82 offen offset:1344 sc1
    v_exp_f32 v56, v56
    v_exp_f32 v57, v57
    v_exp_f32 v58, v58
    v_exp_f32 v59, v59
    v_cvt_pk_bf16_f32 v80, v56, v57
    v_mfma_f32_32x32x16_bf16 v[224:239], a[36:39], v[72:75], v[224:239]
    buffer_load_dwordx4 a[136:139], v9, s[16:19], s82 offen offset:2016 sc1
    v_exp_f32 v60, v60
    v_exp_f32 v61, v61
    v_exp_f32 v62, v62
    v_exp_f32 v63, v63
    v_cvt_pk_bf16_f32 v81, v58, v59
    v_cvt_pk_bf16_f32 v82, v60, v61
    v_mfma_f32_32x32x8_bf16 v[40:55], a[18:19], v[126:127], v[40:55]
    s_add_u32 s47, s46, 4096
    v_exp_f32 v64, v64
    v_exp_f32 v65, v65
    v_exp_f32 v66, v66
    v_exp_f32 v67, v67
    v_cvt_pk_bf16_f32 v83, v62, v63
    v_cvt_pk_bf16_f32 v84, v64, v65
    v_mfma_f32_32x32x16_bf16 v[224:239], a[40:43], v[76:79], v[224:239]
    s_lshl_b32 s77, s39, 11
    v_exp_f32 v68, v68
    v_exp_f32 v69, v69
    v_exp_f32 v70, v70
    v_exp_f32 v71, v71
    v_cvt_pk_bf16_f32 v85, v66, v67
    v_cvt_pk_bf16_f32 v86, v68, v69
    v_cvt_pk_bf16_f32 v87, v70, v71
    v_mfma_f32_32x32x16_bf16 v[56:71], a[12:15], v[128:131], 0
    buffer_load_dwordx4 a[112:115], v36, s[16:19], s80 offen offset:2048 sc1
    v_exp_f32 v40, v40
    v_exp_f32 v41, v41
    v_exp_f32 v42, v42
    v_exp_f32 v43, v43
    v_cvt_pk_bf16_f32 v72, v40, v41
    v_mfma_f32_32x32x16_bf16 v[240:255], a[36:39], v[80:83], v[240:255]
    buffer_load_dwordx4 a[140:143], v9, s[16:19], s83 offen offset:0 sc1
    v_exp_f32 v44, v44
    v_exp_f32 v45, v45
    v_exp_f32 v46, v46
    v_exp_f32 v47, v47
    v_cvt_pk_bf16_f32 v73, v42, v43
    v_cvt_pk_bf16_f32 v74, v44, v45
    v_mfma_f32_32x32x8_bf16 v[56:71], a[18:19], v[134:135], v[56:71]
    s_add_u32 s48, s76, s77
    v_exp_f32 v48, v48
    v_exp_f32 v49, v49
    v_exp_f32 v50, v50
    v_exp_f32 v51, v51
    v_cvt_pk_bf16_f32 v75, v46, v47
    v_cvt_pk_bf16_f32 v76, v48, v49
    v_mfma_f32_32x32x16_bf16 v[240:255], a[40:43], v[84:87], v[240:255]
    s_lshl_b32 s77, s38, 9
    v_exp_f32 v52, v52
    v_exp_f32 v53, v53
    v_exp_f32 v54, v54
    v_exp_f32 v55, v55
    v_cvt_pk_bf16_f32 v77, v50, v51
    v_cvt_pk_bf16_f32 v78, v52, v53
    v_cvt_pk_bf16_f32 v79, v54, v55
    v_mfma_f32_32x32x16_bf16 v[40:55], a[12:15], v[136:139], 0
    buffer_load_dwordx4 a[144:147], v9, s[16:19], s83 offen offset:672 sc1
    v_exp_f32 v56, v56
    v_exp_f32 v57, v57
    v_exp_f32 v58, v58
    v_exp_f32 v59, v59
    v_cvt_pk_bf16_f32 v80, v56, v57
    v_mfma_f32_32x32x16_bf16 v[192:207], a[44:47], v[72:75], v[192:207]
    buffer_load_dwordx4 a[116:119], v36, s[16:19], s80 offen offset:3072 sc1
    v_exp_f32 v60, v60
    v_exp_f32 v61, v61
    v_exp_f32 v62, v62
    v_exp_f32 v63, v63
    v_cvt_pk_bf16_f32 v81, v58, v59
    v_cvt_pk_bf16_f32 v82, v60, v61
    v_mfma_f32_32x32x8_bf16 v[40:55], a[18:19], v[142:143], v[40:55]
    s_add_u32 s48, s48, s77
    v_exp_f32 v64, v64
    v_exp_f32 v65, v65
    v_exp_f32 v66, v66
    v_exp_f32 v67, v67
    v_cvt_pk_bf16_f32 v83, v62, v63
    v_cvt_pk_bf16_f32 v84, v64, v65
    v_mfma_f32_32x32x16_bf16 v[192:207], a[48:51], v[76:79], v[192:207]
    s_add_u32 s48, s48, 393216
    v_exp_f32 v68, v68
    v_exp_f32 v69, v69
    v_exp_f32 v70, v70
    v_exp_f32 v71, v71
    v_cvt_pk_bf16_f32 v85, v66, v67
    v_cvt_pk_bf16_f32 v86, v68, v69
    v_cvt_pk_bf16_f32 v87, v70, v71
    v_mfma_f32_32x32x16_bf16 v[56:71], a[12:15], v[144:147], 0
    buffer_load_dwordx4 a[148:151], v9, s[16:19], s83 offen offset:1344 sc1
    v_exp_f32 v40, v40
    v_exp_f32 v41, v41
    v_exp_f32 v42, v42
    v_exp_f32 v43, v43
    v_cvt_pk_bf16_f32 v72, v40, v41
    v_mfma_f32_32x32x16_bf16 v[208:223], a[44:47], v[80:83], v[208:223]
    buffer_load_dwordx4 a[152:155], v9, s[16:19], s83 offen offset:2016 sc1
    v_exp_f32 v44, v44
    v_exp_f32 v45, v45
    v_exp_f32 v46, v46
    v_exp_f32 v47, v47
    v_cvt_pk_bf16_f32 v73, v42, v43
    v_cvt_pk_bf16_f32 v74, v44, v45
    v_mfma_f32_32x32x8_bf16 v[56:71], a[18:19], v[150:151], v[56:71]
    s_waitcnt vmcnt(16)
    v_exp_f32 v48, v48
    v_exp_f32 v49, v49
    v_exp_f32 v50, v50
    v_exp_f32 v51, v51
    v_cvt_pk_bf16_f32 v75, v46, v47
    v_cvt_pk_bf16_f32 v76, v48, v49
    v_mfma_f32_32x32x16_bf16 v[208:223], a[48:51], v[84:87], v[208:223]
    s_add_u32 s49, s48, 4096
    v_exp_f32 v52, v52
    v_lshlrev_b32 v33, 6, v1
    v_exp_f32 v53, v53
    v_exp_f32 v54, v54
    v_exp_f32 v55, v55
    v_cvt_pk_bf16_f32 v77, v50, v51
    v_cvt_pk_bf16_f32 v78, v52, v53
    v_cvt_pk_bf16_f32 v79, v54, v55
    v_mfma_f32_32x32x16_bf16 v[40:55], a[52:55], v[120:123], 0
    s_mul_i32 s76, s37, 204800
    s_mul_i32 s77, s38, 51200
    v_exp_f32 v56, v56
    v_exp_f32 v57, v57
    v_exp_f32 v58, v58
    v_exp_f32 v59, v59
    v_cvt_pk_bf16_f32 v80, v56, v57
    v_mfma_f32_32x32x16_bf16 v[224:239], a[44:47], v[72:75], v[224:239]
    v_exp_f32 v60, v60
    v_exp_f32 v61, v61
    v_exp_f32 v62, v62
    v_exp_f32 v63, v63
    v_cvt_pk_bf16_f32 v81, v58, v59
    v_cvt_pk_bf16_f32 v82, v60, v61
    v_mfma_f32_32x32x8_bf16 v[40:55], a[68:69], v[124:125], v[40:55]
    v_exp_f32 v64, v64
    v_exp_f32 v65, v65
    v_exp_f32 v66, v66
    v_exp_f32 v67, v67
    v_cvt_pk_bf16_f32 v83, v62, v63
    v_cvt_pk_bf16_f32 v84, v64, v65
    v_mfma_f32_32x32x16_bf16 v[224:239], a[48:51], v[76:79], v[224:239]
    v_exp_f32 v68, v68
    v_exp_f32 v69, v69
    v_exp_f32 v70, v70
    v_exp_f32 v71, v71
    v_cvt_pk_bf16_f32 v85, v66, v67
    v_cvt_pk_bf16_f32 v86, v68, v69
    v_cvt_pk_bf16_f32 v87, v70, v71
    v_mfma_f32_32x32x16_bf16 v[56:71], a[52:55], v[128:131], 0
    s_add_u32 s76, s76, s77
    s_add_u32 s50, s76, 9437184
    v_exp_f32 v40, v40
    v_exp_f32 v41, v41
    v_exp_f32 v42, v42
    v_exp_f32 v43, v43
    v_cvt_pk_bf16_f32 v72, v40, v41
    v_mfma_f32_32x32x16_bf16 v[240:255], a[44:47], v[80:83], v[240:255]
    s_waitcnt vmcnt(14)
    v_exp_f32 v44, v44
    v_exp_f32 v45, v45
    v_exp_f32 v46, v46
    v_exp_f32 v47, v47
    v_cvt_pk_bf16_f32 v73, v42, v43
    v_cvt_pk_bf16_f32 v74, v44, v45
    v_mfma_f32_32x32x8_bf16 v[56:71], a[68:69], v[132:133], v[56:71]
    v_exp_f32 v48, v48
    v_exp_f32 v49, v49
    v_exp_f32 v50, v50
    v_exp_f32 v51, v51
    v_cvt_pk_bf16_f32 v75, v46, v47
    v_cvt_pk_bf16_f32 v76, v48, v49
    v_mfma_f32_32x32x16_bf16 v[240:255], a[48:51], v[84:87], v[240:255]
    ds_read_b64_tr_b16 v[96:97], v91 offset:0
    v_exp_f32 v52, v52
    v_exp_f32 v53, v53
    v_exp_f32 v54, v54
    v_exp_f32 v55, v55
    v_cvt_pk_bf16_f32 v77, v50, v51
    v_cvt_pk_bf16_f32 v78, v52, v53
    v_cvt_pk_bf16_f32 v79, v54, v55
    v_mfma_f32_32x32x16_bf16 v[40:55], a[52:55], v[136:139], 0
    s_add_u32 s51, s76, 9449472
    s_add_u32 s52, s76, 9461760
    v_exp_f32 v56, v56
    v_exp_f32 v57, v57
    v_exp_f32 v58, v58
    v_exp_f32 v59, v59
    v_cvt_pk_bf16_f32 v80, v56, v57
    v_mfma_f32_32x32x16_bf16 v[192:207], a[72:75], v[72:75], v[192:207]
    ds_read_b64_tr_b16 v[98:99], v91 offset:640
    ds_read_b64_tr_b16 v[100:101], v92 offset:0
    v_exp_f32 v60, v60
    v_exp_f32 v61, v61
    v_exp_f32 v62, v62
    v_exp_f32 v63, v63
    v_cvt_pk_bf16_f32 v81, v58, v59
    v_cvt_pk_bf16_f32 v82, v60, v61
    v_mfma_f32_32x32x8_bf16 v[40:55], a[68:69], v[140:141], v[40:55]
    v_exp_f32 v64, v64
    v_exp_f32 v65, v65
    v_exp_f32 v66, v66
    v_exp_f32 v67, v67
    v_cvt_pk_bf16_f32 v83, v62, v63
    v_cvt_pk_bf16_f32 v84, v64, v65
    v_mfma_f32_32x32x16_bf16 v[192:207], a[76:79], v[76:79], v[192:207]
    v_exp_f32 v68, v68
    v_exp_f32 v69, v69
    v_exp_f32 v70, v70
    v_exp_f32 v71, v71
    v_cvt_pk_bf16_f32 v85, v66, v67
    v_cvt_pk_bf16_f32 v86, v68, v69
    v_cvt_pk_bf16_f32 v87, v70, v71
    v_mfma_f32_32x32x16_bf16 v[56:71], a[52:55], v[144:147], 0
    s_add_u32 s53, s76, 9474048
    s_add_u32 s54, s76, 9486336
    v_exp_f32 v40, v40
    v_exp_f32 v41, v41
    v_exp_f32 v42, v42
    v_exp_f32 v43, v43
    v_cvt_pk_bf16_f32 v72, v40, v41
    v_mfma_f32_32x32x16_bf16 v[208:223], a[72:75], v[80:83], v[208:223]
    ds_read_b64_tr_b16 v[102:103], v92 offset:640
    v_exp_f32 v44, v44
    v_exp_f32 v45, v45
    v_exp_f32 v46, v46
    v_exp_f32 v47, v47
    v_cvt_pk_bf16_f32 v73, v42, v43
    v_cvt_pk_bf16_f32 v74, v44, v45
    v_mfma_f32_32x32x8_bf16 v[56:71], a[68:69], v[148:149], v[56:71]
    v_exp_f32 v48, v48
    v_exp_f32 v49, v49
    v_exp_f32 v50, v50
    v_exp_f32 v51, v51
    v_cvt_pk_bf16_f32 v75, v46, v47
    v_cvt_pk_bf16_f32 v76, v48, v49
    v_mfma_f32_32x32x16_bf16 v[208:223], a[76:79], v[84:87], v[208:223]
    s_waitcnt lgkmcnt(2)
    buffer_store_dwordx4 v[96:99], v93, s[16:19], 0 offen sc1
    v_exp_f32 v52, v52
    v_exp_f32 v53, v53
    v_exp_f32 v54, v54
    v_exp_f32 v55, v55
    v_cvt_pk_bf16_f32 v77, v50, v51
    v_cvt_pk_bf16_f32 v78, v52, v53
    v_cvt_pk_bf16_f32 v79, v54, v55
    v_mfma_f32_32x32x16_bf16 v[40:55], a[56:59], v[120:123], 0
    s_lshl_b32 s76, s36, 2
    s_add_u32 s76, s76, s39
    v_exp_f32 v56, v56
    v_exp_f32 v57, v57
    v_exp_f32 v58, v58
    v_exp_f32 v59, v59
    v_cvt_pk_bf16_f32 v80, v56, v57
    v_mfma_f32_32x32x16_bf16 v[224:239], a[72:75], v[72:75], v[224:239]
    s_waitcnt lgkmcnt(0)
    buffer_store_dwordx4 v[100:103], v94, s[16:19], 0 offen sc1
    v_exp_f32 v60, v60
    v_exp_f32 v61, v61
    v_exp_f32 v62, v62
    v_exp_f32 v63, v63
    v_cvt_pk_bf16_f32 v81, v58, v59
    v_cvt_pk_bf16_f32 v82, v60, v61
    v_mfma_f32_32x32x8_bf16 v[40:55], a[68:69], v[126:127], v[40:55]
    v_exp_f32 v64, v64
    v_exp_f32 v65, v65
    v_exp_f32 v66, v66
    v_exp_f32 v67, v67
    v_cvt_pk_bf16_f32 v83, v62, v63
    v_cvt_pk_bf16_f32 v84, v64, v65
    v_mfma_f32_32x32x16_bf16 v[224:239], a[76:79], v[76:79], v[224:239]
    v_exp_f32 v68, v68
    v_exp_f32 v69, v69
    v_exp_f32 v70, v70
    v_exp_f32 v71, v71
    v_cvt_pk_bf16_f32 v85, v66, v67
    v_cvt_pk_bf16_f32 v86, v68, v69
    v_cvt_pk_bf16_f32 v87, v70, v71
    v_mfma_f32_32x32x16_bf16 v[56:71], a[56:59], v[128:131], 0
    s_mul_i32 s76, s76, 81920
    s_mul_i32 s77, s38, 10240
    v_exp_f32 v40, v40
    v_exp_f32 v41, v41
    v_exp_f32 v42, v42
    v_exp_f32 v43, v43
    v_cvt_pk_bf16_f32 v72, v40, v41
    v_mfma_f32_32x32x16_bf16 v[240:255], a[72:75], v[80:83], v[240:255]
    v_exp_f32 v44, v44
    v_exp_f32 v45, v45
    v_exp_f32 v46, v46
    v_exp_f32 v47, v47
    v_cvt_pk_bf16_f32 v73, v42, v43
    v_cvt_pk_bf16_f32 v74, v44, v45
    v_mfma_f32_32x32x8_bf16 v[56:71], a[68:69], v[134:135], v[56:71]
    v_exp_f32 v48, v48
    v_exp_f32 v49, v49
    v_exp_f32 v50, v50
    v_exp_f32 v51, v51
    v_cvt_pk_bf16_f32 v75, v46, v47
    v_cvt_pk_bf16_f32 v76, v48, v49
    v_mfma_f32_32x32x16_bf16 v[240:255], a[76:79], v[84:87], v[240:255]
    v_exp_f32 v52, v52
    v_exp_f32 v53, v53
    v_exp_f32 v54, v54
    v_exp_f32 v55, v55
    v_cvt_pk_bf16_f32 v77, v50, v51
    v_cvt_pk_bf16_f32 v78, v52, v53
    v_cvt_pk_bf16_f32 v79, v54, v55
    v_mfma_f32_32x32x16_bf16 v[40:55], a[56:59], v[136:139], 0
    s_add_u32 s76, s76, s77
    s_add_u32 s64, s76, 2097152
    v_exp_f32 v56, v56
    v_exp_f32 v57, v57
    v_exp_f32 v58, v58
    v_exp_f32 v59, v59
    v_cvt_pk_bf16_f32 v80, v56, v57
    v_mfma_f32_32x32x16_bf16 v[192:207], a[80:83], v[72:75], v[192:207]
    v_exp_f32 v60, v60
    v_exp_f32 v61, v61
    v_exp_f32 v62, v62
    v_exp_f32 v63, v63
    v_cvt_pk_bf16_f32 v81, v58, v59
    v_cvt_pk_bf16_f32 v82, v60, v61
    v_mfma_f32_32x32x8_bf16 v[40:55], a[68:69], v[142:143], v[40:55]
    v_exp_f32 v64, v64
    v_exp_f32 v65, v65
    v_exp_f32 v66, v66
    v_exp_f32 v67, v67
    v_cvt_pk_bf16_f32 v83, v62, v63
    v_cvt_pk_bf16_f32 v84, v64, v65
    v_mfma_f32_32x32x16_bf16 v[192:207], a[84:87], v[76:79], v[192:207]
    v_exp_f32 v68, v68
    v_exp_f32 v69, v69
    v_exp_f32 v70, v70
    v_exp_f32 v71, v71
    v_cvt_pk_bf16_f32 v85, v66, v67
    v_cvt_pk_bf16_f32 v86, v68, v69
    v_cvt_pk_bf16_f32 v87, v70, v71
    v_mfma_f32_32x32x16_bf16 v[56:71], a[56:59], v[144:147], 0
    s_add_u32 s65, s76, 2138112
    s_add_u32 s66, s76, 2260992
    v_exp_f32 v40, v40
    v_exp_f32 v41, v41
    v_exp_f32 v42, v42
    v_exp_f32 v43, v43
    v_cvt_pk_bf16_f32 v72, v40, v41
    v_mfma_f32_32x32x16_bf16 v[208:223], a[80:83], v[80:83], v[208:223]
    v_exp_f32 v44, v44
    v_exp_f32 v45, v45
    v_exp_f32 v46, v46
    v_exp_f32 v47, v47
    v_cvt_pk_bf16_f32 v73, v42, v43
    v_cvt_pk_bf16_f32 v74, v44, v45
    v_mfma_f32_32x32x8_bf16 v[56:71], a[68:69], v[150:151], v[56:71]
    v_exp_f32 v48, v48
    v_exp_f32 v49, v49
    v_exp_f32 v50, v50
    v_exp_f32 v51, v51
    v_cvt_pk_bf16_f32 v75, v46, v47
    v_cvt_pk_bf16_f32 v76, v48, v49
    v_mfma_f32_32x32x16_bf16 v[208:223], a[84:87], v[84:87], v[208:223]
    v_exp_f32 v52, v52
    v_exp_f32 v53, v53
    v_exp_f32 v54, v54
    v_exp_f32 v55, v55
    v_cvt_pk_bf16_f32 v77, v50, v51
    v_cvt_pk_bf16_f32 v78, v52, v53
    v_cvt_pk_bf16_f32 v79, v54, v55
    v_mfma_f32_32x32x16_bf16 v[40:55], a[60:63], v[120:123], 0
    s_add_u32 s67, s76, 2301952
    v_exp_f32 v56, v56
    v_add_u32 v5, 0, v0
    v_exp_f32 v57, v57
    v_exp_f32 v58, v58
    v_exp_f32 v59, v59
    v_cvt_pk_bf16_f32 v80, v56, v57
    v_mfma_f32_32x32x16_bf16 v[224:239], a[80:83], v[72:75], v[224:239]
    v_exp_f32 v60, v60
    v_exp_f32 v61, v61
    v_exp_f32 v62, v62
    v_exp_f32 v63, v63
    v_cvt_pk_bf16_f32 v81, v58, v59
    v_cvt_pk_bf16_f32 v82, v60, v61
    v_mfma_f32_32x32x8_bf16 v[40:55], a[70:71], v[124:125], v[40:55]
    v_exp_f32 v64, v64
    v_exp_f32 v65, v65
    v_exp_f32 v66, v66
    v_exp_f32 v67, v67
    v_cvt_pk_bf16_f32 v83, v62, v63
    v_cvt_pk_bf16_f32 v84, v64, v65
    v_mfma_f32_32x32x16_bf16 v[224:239], a[84:87], v[76:79], v[224:239]
    v_exp_f32 v68, v68
    v_exp_f32 v69, v69
    v_exp_f32 v70, v70
    v_exp_f32 v71, v71
    v_cvt_pk_bf16_f32 v85, v66, v67
    v_cvt_pk_bf16_f32 v86, v68, v69
    v_cvt_pk_bf16_f32 v87, v70, v71
    v_mfma_f32_32x32x16_bf16 v[56:71], a[60:63], v[128:131], 0
    v_exp_f32 v40, v40
    v_lshlrev_b32 v29, 4, v5
    v_exp_f32 v41, v41
    v_lshlrev_b32 v31, 3, v5
    v_exp_f32 v42, v42
    v_exp_f32 v43, v43
    v_cvt_pk_bf16_f32 v72, v40, v41
    v_mfma_f32_32x32x16_bf16 v[240:255], a[80:83], v[80:83], v[240:255]
    v_exp_f32 v44, v44
    v_exp_f32 v45, v45
    v_exp_f32 v46, v46
    v_exp_f32 v47, v47
    v_cvt_pk_bf16_f32 v73, v42, v43
    v_cvt_pk_bf16_f32 v74, v44, v45
    v_mfma_f32_32x32x8_bf16 v[56:71], a[70:71], v[132:133], v[56:71]
    v_exp_f32 v48, v48
    v_exp_f32 v49, v49
    v_exp_f32 v50, v50
    v_exp_f32 v51, v51
    v_cvt_pk_bf16_f32 v75, v46, v47
    v_cvt_pk_bf16_f32 v76, v48, v49
    v_mfma_f32_32x32x16_bf16 v[240:255], a[84:87], v[84:87], v[240:255]
    v_exp_f32 v52, v52
    v_exp_f32 v53, v53
    v_exp_f32 v54, v54
    v_exp_f32 v55, v55
    v_cvt_pk_bf16_f32 v77, v50, v51
    v_cvt_pk_bf16_f32 v78, v52, v53
    v_cvt_pk_bf16_f32 v79, v54, v55
    v_mfma_f32_32x32x16_bf16 v[40:55], a[60:63], v[136:139], 0
    v_exp_f32 v56, v56
    v_add_u32 v31, 143360, v31
    v_exp_f32 v57, v57
    v_add_u32 v5, 256, v0
    v_exp_f32 v58, v58
    v_exp_f32 v59, v59
    v_cvt_pk_bf16_f32 v80, v56, v57
    v_mfma_f32_32x32x16_bf16 v[192:207], a[88:91], v[72:75], v[192:207]
    v_exp_f32 v60, v60
    v_exp_f32 v61, v61
    v_exp_f32 v62, v62
    v_exp_f32 v63, v63
    v_cvt_pk_bf16_f32 v81, v58, v59
    v_cvt_pk_bf16_f32 v82, v60, v61
    v_mfma_f32_32x32x8_bf16 v[40:55], a[70:71], v[140:141], v[40:55]
    v_exp_f32 v64, v64
    v_exp_f32 v65, v65
    v_exp_f32 v66, v66
    v_exp_f32 v67, v67
    v_cvt_pk_bf16_f32 v83, v62, v63
    v_cvt_pk_bf16_f32 v84, v64, v65
    v_mfma_f32_32x32x16_bf16 v[192:207], a[92:95], v[76:79], v[192:207]
    v_exp_f32 v68, v68
    v_exp_f32 v69, v69
    v_exp_f32 v70, v70
    v_exp_f32 v71, v71
    v_cvt_pk_bf16_f32 v85, v66, v67
    v_cvt_pk_bf16_f32 v86, v68, v69
    v_cvt_pk_bf16_f32 v87, v70, v71
    v_mfma_f32_32x32x16_bf16 v[56:71], a[60:63], v[144:147], 0
    v_exp_f32 v40, v40
    v_min_u32 v5, 420, v5
    v_exp_f32 v41, v41
    v_lshlrev_b32 v30, 4, v5
    v_exp_f32 v42, v42
    v_exp_f32 v43, v43
    v_cvt_pk_bf16_f32 v72, v40, v41
    v_mfma_f32_32x32x16_bf16 v[208:223], a[88:91], v[80:83], v[208:223]
    v_exp_f32 v44, v44
    v_exp_f32 v45, v45
    v_exp_f32 v46, v46
    v_exp_f32 v47, v47
    v_cvt_pk_bf16_f32 v73, v42, v43
    v_cvt_pk_bf16_f32 v74, v44, v45
    v_mfma_f32_32x32x8_bf16 v[56:71], a[70:71], v[148:149], v[56:71]
    v_exp_f32 v48, v48
    v_exp_f32 v49, v49
    v_exp_f32 v50, v50
    v_exp_f32 v51, v51
    v_cvt_pk_bf16_f32 v75, v46, v47
    v_cvt_pk_bf16_f32 v76, v48, v49
    v_mfma_f32_32x32x16_bf16 v[208:223], a[92:95], v[84:87], v[208:223]
    v_exp_f32 v52, v52
    v_exp_f32 v53, v53
    v_exp_f32 v54, v54
    v_exp_f32 v55, v55
    v_cvt_pk_bf16_f32 v77, v50, v51
    v_cvt_pk_bf16_f32 v78, v52, v53
    v_cvt_pk_bf16_f32 v79, v54, v55
    v_mfma_f32_32x32x16_bf16 v[40:55], a[64:67], v[120:123], 0
    v_exp_f32 v56, v56
    v_lshlrev_b32 v32, 3, v5
    v_exp_f32 v57, v57
    v_add_u32 v32, 143360, v32
    v_exp_f32 v58, v58
    v_exp_f32 v59, v59
    v_cvt_pk_bf16_f32 v80, v56, v57
    v_mfma_f32_32x32x16_bf16 v[224:239], a[88:91], v[72:75], v[224:239]
    v_exp_f32 v60, v60
    v_exp_f32 v61, v61
    v_exp_f32 v62, v62
    v_exp_f32 v63, v63
    v_cvt_pk_bf16_f32 v81, v58, v59
    v_cvt_pk_bf16_f32 v82, v60, v61
    v_mfma_f32_32x32x8_bf16 v[40:55], a[70:71], v[126:127], v[40:55]
    v_exp_f32 v64, v64
    v_exp_f32 v65, v65
    v_exp_f32 v66, v66
    v_exp_f32 v67, v67
    v_cvt_pk_bf16_f32 v83, v62, v63
    v_cvt_pk_bf16_f32 v84, v64, v65
    v_mfma_f32_32x32x16_bf16 v[224:239], a[92:95], v[76:79], v[224:239]
    v_exp_f32 v68, v68
    v_exp_f32 v69, v69
    v_exp_f32 v70, v70
    v_exp_f32 v71, v71
    v_cvt_pk_bf16_f32 v85, v66, v67
    v_cvt_pk_bf16_f32 v86, v68, v69
    v_cvt_pk_bf16_f32 v87, v70, v71
    v_mfma_f32_32x32x16_bf16 v[56:71], a[64:67], v[128:131], 0
    s_mul_i32 s55, s41, 6720
    s_add_u32 s55, s55, 262144
    v_exp_f32 v40, v40
    v_exp_f32 v41, v41
    v_exp_f32 v42, v42
    v_exp_f32 v43, v43
    v_cvt_pk_bf16_f32 v72, v40, v41
    v_mfma_f32_32x32x16_bf16 v[240:255], a[88:91], v[80:83], v[240:255]
    v_exp_f32 v44, v44
    v_exp_f32 v45, v45
    v_exp_f32 v46, v46
L_pd3857:
    s_cbranch_execz L_pd9118
    v_exp_f32 v47, v47
    v_cvt_pk_bf16_f32 v73, v42, v43
    v_cvt_pk_bf16_f32 v74, v44, v45
    v_mfma_f32_32x32x8_bf16 v[56:71], a[70:71], v[134:135], v[56:71]
    v_exp_f32 v48, v48
    v_exp_f32 v49, v49
    v_exp_f32 v50, v50
    v_exp_f32 v51, v51
    v_cvt_pk_bf16_f32 v75, v46, v47
    v_cvt_pk_bf16_f32 v76, v48, v49
    v_mfma_f32_32x32x16_bf16 v[240:255], a[92:95], v[84:87], v[240:255]
    v_exp_f32 v52, v52
    v_exp_f32 v53, v53
    v_exp_f32 v54, v54
    v_exp_f32 v55, v55
    v_cvt_pk_bf16_f32 v77, v50, v51
    v_cvt_pk_bf16_f32 v78, v52, v53
    v_cvt_pk_bf16_f32 v79, v54, v55
    v_mfma_f32_32x32x16_bf16 v[40:55], a[64:67], v[136:139], 0
    s_lshl_b32 s56, s37, 7
    s_add_u32 s56, s56, 245760
    v_exp_f32 v56, v56
    v_exp_f32 v57, v57
    v_exp_f32 v58, v58
    v_exp_f32 v59, v59
    v_cvt_pk_bf16_f32 v80, v56, v57
    v_mfma_f32_32x32x16_bf16 v[192:207], a[96:99], v[72:75], v[192:207]
    v_exp_f32 v60, v60
    v_exp_f32 v61, v61
    v_exp_f32 v62, v62
    v_exp_f32 v63, v63
    v_cvt_pk_bf16_f32 v81, v58, v59
    v_cvt_pk_bf16_f32 v82, v60, v61
    v_mfma_f32_32x32x8_bf16 v[40:55], a[70:71], v[142:143], v[40:55]
    v_exp_f32 v64, v64
    v_exp_f32 v65, v65
    v_exp_f32 v66, v66
    v_exp_f32 v67, v67
    v_cvt_pk_bf16_f32 v83, v62, v63
    v_cvt_pk_bf16_f32 v84, v64, v65
    v_mfma_f32_32x32x16_bf16 v[192:207], a[100:103], v[76:79], v[192:207]
    v_exp_f32 v68, v68
    v_exp_f32 v69, v69
    v_exp_f32 v70, v70
    v_exp_f32 v71, v71
    v_cvt_pk_bf16_f32 v85, v66, v67
    v_cvt_pk_bf16_f32 v86, v68, v69
    v_cvt_pk_bf16_f32 v87, v70, v71
    v_mfma_f32_32x32x16_bf16 v[56:71], a[64:67], v[144:147], 0
    s_waitcnt vmcnt(2)
    v_exp_f32 v40, v40
    v_exp_f32 v41, v41
    v_exp_f32 v42, v42
    v_exp_f32 v43, v43
    v_cvt_pk_bf16_f32 v72, v40, v41
    v_mfma_f32_32x32x16_bf16 v[208:223], a[96:99], v[80:83], v[208:223]
    v_exp_f32 v44, v44
    v_exp_f32 v45, v45
    v_exp_f32 v46, v46
    v_exp_f32 v47, v47
    v_cvt_pk_bf16_f32 v73, v42, v43
    v_cvt_pk_bf16_f32 v74, v44, v45
    v_mfma_f32_32x32x8_bf16 v[56:71], a[70:71], v[150:151], v[56:71]
    v_exp_f32 v48, v48
    v_exp_f32 v49, v49
    v_exp_f32 v50, v50
    v_exp_f32 v51, v51
    v_cvt_pk_bf16_f32 v75, v46, v47
    v_cvt_pk_bf16_f32 v76, v48, v49
    v_mfma_f32_32x32x16_bf16 v[208:223], a[100:103], v[84:87], v[208:223]
    v_exp_f32 v52, v52
    v_exp_f32 v53, v53
    v_exp_f32 v54, v54
    v_exp_f32 v55, v55
    v_cvt_pk_bf16_f32 v77, v50, v51
    v_cvt_pk_bf16_f32 v78, v52, v53
    v_cvt_pk_bf16_f32 v79, v54, v55
    v_mfma_f32_32x32x16_bf16 v[40:55], a[104:107], v[120:123], 0
    v_exp_f32 v56, v56
    v_exp_f32 v57, v57
    v_exp_f32 v58, v58
    v_exp_f32 v59, v59
    v_cvt_pk_bf16_f32 v80, v56, v57
    v_mfma_f32_32x32x16_bf16 v[224:239], a[96:99], v[72:75], v[224:239]
    v_exp_f32 v60, v60
    v_exp_f32 v61, v61
    v_exp_f32 v62, v62
    v_exp_f32 v63, v63
    v_cvt_pk_bf16_f32 v81, v58, v59
    v_cvt_pk_bf16_f32 v82, v60, v61
    v_mfma_f32_32x32x8_bf16 v[40:55], a[120:121], v[124:125], v[40:55]
    v_exp_f32 v64, v64
    v_exp_f32 v65, v65
    v_exp_f32 v66, v66
    v_exp_f32 v67, v67
    v_cvt_pk_bf16_f32 v83, v62, v63
    v_cvt_pk_bf16_f32 v84, v64, v65
    v_mfma_f32_32x32x16_bf16 v[224:239], a[100:103], v[76:79], v[224:239]
    v_exp_f32 v68, v68
    v_exp_f32 v69, v69
    v_exp_f32 v70, v70
    v_exp_f32 v71, v71
    v_cvt_pk_bf16_f32 v85, v66, v67
    v_cvt_pk_bf16_f32 v86, v68, v69
    v_cvt_pk_bf16_f32 v87, v70, v71
    s_waitcnt vmcnt(0)
    s_barrier
    s_branch L_p2
    s_nop 1
L_kv:
    s_mul_i32 s76, s64, 1920
    s_add_u32 s76, s76, s73
    s_add_u32 m0, s72, 32768
    s_nop 0
    buffer_load_dwordx4 v13, s[8:11], s76 offen offset:0 lds
    buffer_load_dwordx4 v14, s[8:11], s76 offen offset:1024 lds
    buffer_load_dwordx4 v15, s[8:11], s76 offen offset:2048 lds
    buffer_load_dwordx4 v16, s[8:11], s76 offen offset:3072 lds
    s_add_u32 m0, s72, 36864
    s_nop 0
    buffer_load_dwordx4 v17, s[8:11], s76 offen offset:0 lds
    v_mov_b32 v6, 0x80000000
    v_cmp_gt_u32 vcc, 50, v1
    s_nop 1
    v_cndmask_b32 v5, v6, v36, vcc
    s_lshl_b32 s76, s37, 2
    s_add_u32 s76, s76, s38
    s_mul_i32 s76, s76, 800
    s_add_u32 m0, s72, 37888
    s_nop 0
    buffer_load_dwordx4 v5, s[28:31], s76 offen lds
    s_mul_i32 s76, s64, 1920
    s_add_u32 s76, s76, s74
    s_add_u32 m0, s72, 65536
    s_nop 0
    buffer_load_dwordx4 v18, s[8:11], s76 offen offset:0 lds
    buffer_load_dwordx4 v19, s[8:11], s76 offen offset:1024 lds
    buffer_load_dwordx4 v20, s[8:11], s76 offen offset:2048 lds
    buffer_load_dwordx4 v21, s[8:11], s76 offen offset:3072 lds
    s_add_u32 m0, s72, 69632
    s_nop 0
    buffer_load_dwordx4 v22, s[8:11], s76 offen offset:0 lds
    s_add_u32 s76, s70, s65
    s_add_u32 m0, s72, 98304
    s_nop 0
    buffer_load_dwordx4 v23, s[4:7], s76 offen offset:0 lds
    buffer_load_dwordx4 v24, s[4:7], s76 offen offset:1024 lds
    buffer_load_dwordx4 v25, s[4:7], s76 offen offset:2048 lds
    buffer_load_dwordx4 v26, s[4:7], s76 offen offset:3072 lds
    s_add_u32 s76, s71, s65
    s_add_u32 m0, s72, 102400
    s_nop 0
    buffer_load_dwordx4 v23, s[4:7], s76 offen offset:0 lds
    buffer_load_dwordx4 v24, s[4:7], s76 offen offset:1024 lds
    buffer_load_dwordx4 v25, s[4:7], s76 offen offset:2048 lds
    buffer_load_dwordx4 v26, s[4:7], s76 offen offset:3072 lds
    v_xor_b32 v5, v37, v38
    v_lshlrev_b32 v6, 8, v38
    v_add_u32 v6, s72, v6
    v_xor_b32 v7, 0, v5
    v_lshl_add_u32 v27, v7, 4, v6
    v_xor_b32 v7, 4, v5
    v_lshl_add_u32 v28, v7, 4, v6
    v_xor_b32 v7, 8, v5
    v_lshl_add_u32 v29, v7, 4, v6
    v_xor_b32 v7, 12, v5
    v_lshl_add_u32 v30, v7, 4, v6
    v_and_b32 v5, 3, v1
    v_lshrrev_b32 v6, 2, v38
    v_lshrrev_b32 v7, 1, v37
    v_lshl_add_u32 v6, v7, 4, v6
    v_and_b32 v7, 1, v37
    v_lshl_add_u32 v6, v7, 2, v6
    v_mul_u32_u24 v6, 160, v6
    v_mul_u32_u24 v7, 40, v5
    v_add_u32 v10, v6, v7
    v_add_u32 v11, 0x10000, v10
    v_add_u32 v12, 0x20000, v10
    v_mov_b32 v252, 0
    v_mov_b32 v253, 0
    v_mov_b32 v254, 0
    v_mov_b32 v255, 0
    s_lshl_b32 s76, s38, 3
    s_lshr_b32 s76, 0x65724310, s76
    s_and_b32 s76, s76, 0xff
    s_or_b32 s76, s76, 0x9800
    v_add_u32 v5, 0, v1
    v_mul_u32_u24 v6, 205, v5
    v_lshrrev_b32 v6, 11, v6
    v_mul_u32_u24 v7, 10, v6
    v_sub_u32 v7, v5, v7
    v_and_b32 v8, 12, v6
    v_lshrrev_b32 v8, v8, s76
    v_and_b32 v8, 15, v8
    v_and_b32 v6, 3, v6
    v_lshl_add_u32 v6, v8, 2, v6
    v_mul_u32_u24 v6, 1280, v6
    v_lshl_add_u32 v224, v7, 4, v6
    v_add_u32 v5, 64, v1
    v_mul_u32_u24 v6, 205, v5
    v_lshrrev_b32 v6, 11, v6
    v_mul_u32_u24 v7, 10, v6
    v_sub_u32 v7, v5, v7
    v_and_b32 v8, 12, v6
    v_lshrrev_b32 v8, v8, s76
    v_and_b32 v8, 15, v8
    v_and_b32 v6, 3, v6
    v_lshl_add_u32 v6, v8, 2, v6
    v_mul_u32_u24 v6, 1280, v6
    v_lshl_add_u32 v225, v7, 4, v6
    v_add_u32 v5, 128, v1
    v_mul_u32_u24 v6, 205, v5
    v_lshrrev_b32 v6, 11, v6
    v_mul_u32_u24 v7, 10, v6
    v_sub_u32 v7, v5, v7
    v_and_b32 v8, 12, v6
    v_lshrrev_b32 v8, v8, s76
    v_and_b32 v8, 15, v8
    v_and_b32 v6, 3, v6
    v_lshl_add_u32 v6, v8, 2, v6
    v_mul_u32_u24 v6, 1280, v6
    v_lshl_add_u32 v226, v7, 4, v6
    v_mov_b32 v9, 0x80000000
    v_cmp_gt_u32 vcc, 160, v5
    s_nop 1
    v_cndmask_b32 v226, v9, v226, vcc
    s_lshr_b32 s76, s36, 2
    s_mul_i32 s76, s76, 20
    s_mul_i32 s77, s36, 5
    s_add_u32 s76, s76, s77
    s_mul_i32 s77, s39, 20
    s_add_u32 s76, s76, s77
    s_mul_i32 s77, s37, 204800
    s_add_u32 s77, s77, 9437184
    v_lshrrev_b32 v2, 2, v38
    v_mul_u32_u24 v2, 160, v2
    v_and_b32 v3, 3, v1
    v_mul_u32_u24 v3, 40, v3
    v_add3_u32 v2, v2, v3, s72
    v_add_u32 v2, 98304, v2
    v_mov_b32 v6, s38
    v_mov_b32 v7, v37
    v_lshl_add_u32 v227, v7, 3, v2
    v_add_u32 v6, s76, v6
    v_lshrrev_b32 v8, 2, v6
    v_mul_u32_u24 v8, 5120, v8
    v_lshl_add_u32 v8, v7, 10, v8
    v_and_b32 v6, 3, v6
    v_lshl_add_u32 v8, v6, 8, v8
    v_lshl_add_u32 v8, v38, 4, v8
    v_add_u32 v229, s77, v8
    v_mov_b32 v6, s38
    v_cmp_eq_u32 vcc, 1, v37
    s_nop 1
    v_cndmask_b32 v7, 4, v6, vcc
    v_cmp_eq_u32 vcc, 0, v37
    s_nop 1
    v_cndmask_b32 v6, 4, v6, vcc
    v_mov_b32 v3, 1280
    v_cndmask_b32 v3, v3, 0, vcc
    v_add_u32 v2, v2, v3
    v_lshl_add_u32 v228, v7, 3, v2
    v_add_u32 v6, s76, v6
    v_lshrrev_b32 v8, 2, v6
    v_mul_u32_u24 v8, 5120, v8
    v_lshl_add_u32 v8, v7, 10, v8
    v_and_b32 v6, 3, v6
    v_lshl_add_u32 v8, v6, 8, v8
    v_lshl_add_u32 v8, v38, 4, v8
    v_add_u32 v230, s77, v8
    s_cmp_eq_u32 s38, 0
    s_cselect_b32 s76, 3, 2
    v_cmp_gt_u32 vcc, s76, v37
    s_nop 1
    v_cndmask_b32 v230, v9, v230, vcc
    v_accvgpr_write_b32 a212, v224
    v_accvgpr_write_b32 a213, v225
    v_accvgpr_write_b32 a214, v226
    v_accvgpr_write_b32 a215, v227
    v_accvgpr_write_b32 a216, v228
    v_accvgpr_write_b32 a217, v229
    v_accvgpr_write_b32 a218, v230
    v_add_u32 v2, s72, v36
    ds_write_b128 v2, v[252:255] offset:38912
    s_mov_b64 exec, 0
    s_cmp_eq_u32 s38, 0
    s_cbranch_scc1 L_padk0
    s_cmp_eq_u32 s38, 1
    s_cbranch_scc1 L_padk1
    s_cmp_eq_u32 s38, 2
    s_cbranch_scc1 L_padk2
    s_branch L_padk3
L_padretk:
    s_mov_b64 exec, -1
    s_waitcnt vmcnt(19)
    ds_read_b128 a[0:3], v27 offset:0
    ds_read_b128 a[80:83], v27 offset:4096
    ds_read_b128 a[4:7], v28 offset:0
    ds_read_b128 a[84:87], v28 offset:4096
    ds_read_b128 a[8:11], v29 offset:0
    ds_read_b128 a[88:91], v29 offset:4096
    ds_read_b128 a[12:15], v30 offset:0
    ds_read_b128 a[92:95], v30 offset:4096
    s_waitcnt vmcnt(14)
    s_waitcnt lgkmcnt(0)
    s_barrier
    ds_read_b64_tr_b16 v[120:121], v10 offset:32768
    ds_read_b64_tr_b16 v[122:123], v10 offset:34048
    ds_read_b64_tr_b16 v[124:125], v10 offset:32776
    ds_read_b64_tr_b16 v[126:127], v10 offset:34056
    ds_read_b64_tr_b16 v[128:129], v10 offset:32784
    ds_read_b64_tr_b16 v[130:131], v10 offset:34064
    ds_read_b64_tr_b16 v[132:133], v10 offset:32792
    ds_read_b64_tr_b16 v[134:135], v10 offset:34072
    ds_read_b64_tr_b16 v[136:137], v10 offset:32800
    ds_read_b64_tr_b16 v[138:139], v10 offset:34080
    s_waitcnt lgkmcnt(8)
    v_mfma_f32_16x16x32_bf16 v[80:83], v[120:123], a[0:3], 0
    s_mul_i32 s76, s65, 1920
    s_add_u32 s76, s76, s73
    ds_read_b64_tr_b16 v[140:141], v10 offset:40960
    v_mfma_f32_16x16x32_bf16 v[100:103], v[120:123], a[80:83], 0
    ds_read_b64_tr_b16 v[142:143], v10 offset:42240
    s_waitcnt lgkmcnt(8)
    v_mfma_f32_16x16x32_bf16 v[84:87], v[124:127], a[0:3], 0
    ds_read_b64_tr_b16 v[144:145], v10 offset:40968
    s_add_u32 m0, s72, 131072
    v_mfma_f32_16x16x32_bf16 v[104:107], v[124:127], a[80:83], 0
    ds_read_b64_tr_b16 v[146:147], v10 offset:42248
    s_waitcnt lgkmcnt(8)
    v_mfma_f32_16x16x32_bf16 v[88:91], v[128:131], a[0:3], 0
    ds_read_b64_tr_b16 v[148:149], v10 offset:40976
    v_mfma_f32_16x16x32_bf16 v[108:111], v[128:131], a[80:83], 0
    buffer_load_dwordx4 v13, s[8:11], s76 offen offset:0 lds
    ds_read_b64_tr_b16 v[150:151], v10 offset:42256
    s_waitcnt lgkmcnt(8)
    v_mfma_f32_16x16x32_bf16 v[92:95], v[132:135], a[0:3], 0
    ds_read_b64_tr_b16 v[152:153], v10 offset:40984
    v_mfma_f32_16x16x32_bf16 v[112:115], v[132:135], a[80:83], 0
    ds_read_b64_tr_b16 v[154:155], v10 offset:42264
    buffer_load_dwordx4 v14, s[8:11], s76 offen offset:1024 lds
    s_waitcnt lgkmcnt(8)
    v_mfma_f32_16x16x32_bf16 v[96:99], v[136:139], a[0:3], 0
    ds_read_b64_tr_b16 v[156:157], v10 offset:40992
    v_mfma_f32_16x16x32_bf16 v[116:119], v[136:139], a[80:83], 0
    ds_read_b64_tr_b16 v[158:159], v10 offset:42272
    s_waitcnt lgkmcnt(8)
    v_mfma_f32_16x16x32_bf16 v[80:83], v[140:143], a[4:7], v[80:83]
    buffer_load_dwordx4 v15, s[8:11], s76 offen offset:2048 lds
    ds_read_b64_tr_b16 v[120:121], v10 offset:49152
    v_mfma_f32_16x16x32_bf16 v[100:103], v[140:143], a[84:87], v[100:103]
    ds_read_b64_tr_b16 v[122:123], v10 offset:50432
    s_waitcnt lgkmcnt(8)
    v_mfma_f32_16x16x32_bf16 v[84:87], v[144:147], a[4:7], v[84:87]
    ds_read_b64_tr_b16 v[124:125], v10 offset:49160
    buffer_load_dwordx4 v16, s[8:11], s76 offen offset:3072 lds
    v_mfma_f32_16x16x32_bf16 v[104:107], v[144:147], a[84:87], v[104:107]
    ds_read_b64_tr_b16 v[126:127], v10 offset:50440
    s_waitcnt lgkmcnt(8)
    v_mfma_f32_16x16x32_bf16 v[88:91], v[148:151], a[4:7], v[88:91]
    ds_read_b64_tr_b16 v[128:129], v10 offset:49168
    v_mfma_f32_16x16x32_bf16 v[108:111], v[148:151], a[84:87], v[108:111]
    s_add_u32 m0, s72, 135168
    ds_read_b64_tr_b16 v[130:131], v10 offset:50448
    s_waitcnt lgkmcnt(8)
    v_mfma_f32_16x16x32_bf16 v[92:95], v[152:155], a[4:7], v[92:95]
    ds_read_b64_tr_b16 v[132:133], v10 offset:49176
    v_mfma_f32_16x16x32_bf16 v[112:115], v[152:155], a[84:87], v[112:115]
    ds_read_b64_tr_b16 v[134:135], v10 offset:50456
    buffer_load_dwordx4 v17, s[8:11], s76 offen offset:0 lds
    s_waitcnt lgkmcnt(8)
    v_mfma_f32_16x16x32_bf16 v[96:99], v[156:159], a[4:7], v[96:99]
    ds_read_b64_tr_b16 v[136:137], v10 offset:49184
    v_mfma_f32_16x16x32_bf16 v[116:119], v[156:159], a[84:87], v[116:119]
    ds_read_b64_tr_b16 v[138:139], v10 offset:50464
    s_waitcnt lgkmcnt(8)
    v_mfma_f32_16x16x32_bf16 v[80:83], v[120:123], a[8:11], v[80:83]
    s_mul_i32 s76, s65, 1920
    s_add_u32 s76, s76, s74
    ds_read_b64_tr_b16 v[140:141], v10 offset:57344
    v_mfma_f32_16x16x32_bf16 v[100:103], v[120:123], a[88:91], v[100:103]
    ds_read_b64_tr_b16 v[142:143], v10 offset:58624
    s_waitcnt lgkmcnt(8)
    v_mfma_f32_16x16x32_bf16 v[84:87], v[124:127], a[8:11], v[84:87]
    ds_read_b64_tr_b16 v[144:145], v10 offset:57352
    s_add_u32 m0, s72, 0
    v_mfma_f32_16x16x32_bf16 v[104:107], v[124:127], a[88:91], v[104:107]
    ds_read_b64_tr_b16 v[146:147], v10 offset:58632
    s_waitcnt lgkmcnt(8)
    v_mfma_f32_16x16x32_bf16 v[88:91], v[128:131], a[8:11], v[88:91]
    ds_read_b64_tr_b16 v[148:149], v10 offset:57360
    v_mfma_f32_16x16x32_bf16 v[108:111], v[128:131], a[88:91], v[108:111]
    buffer_load_dwordx4 v18, s[8:11], s76 offen offset:0 lds
    ds_read_b64_tr_b16 v[150:151], v10 offset:58640
    s_waitcnt lgkmcnt(8)
    v_mfma_f32_16x16x32_bf16 v[92:95], v[132:135], a[8:11], v[92:95]
    ds_read_b64_tr_b16 v[152:153], v10 offset:57368
    v_mfma_f32_16x16x32_bf16 v[112:115], v[132:135], a[88:91], v[112:115]
    ds_read_b64_tr_b16 v[154:155], v10 offset:58648
    buffer_load_dwordx4 v19, s[8:11], s76 offen offset:1024 lds
    s_waitcnt lgkmcnt(8)
    v_mfma_f32_16x16x32_bf16 v[96:99], v[136:139], a[8:11], v[96:99]
    ds_read_b64_tr_b16 v[156:157], v10 offset:57376
    v_mfma_f32_16x16x32_bf16 v[116:119], v[136:139], a[88:91], v[116:119]
    ds_read_b64_tr_b16 v[158:159], v10 offset:58656
    s_waitcnt vmcnt(15)
    s_waitcnt lgkmcnt(0)
    s_barrier
    v_mfma_f32_16x16x32_bf16 v[80:83], v[140:143], a[12:15], v[80:83]
    buffer_load_dwordx4 v20, s[8:11], s76 offen offset:2048 lds
    ds_read_b64_tr_b16 v[120:121], v11 offset:0
    v_mfma_f32_16x16x32_bf16 v[100:103], v[140:143], a[92:95], v[100:103]
    ds_read_b64_tr_b16 v[122:123], v11 offset:1280
    v_mfma_f32_16x16x32_bf16 v[84:87], v[144:147], a[12:15], v[84:87]
    ds_read_b64_tr_b16 v[124:125], v11 offset:8
    buffer_load_dwordx4 v21, s[8:11], s76 offen offset:3072 lds
    v_mfma_f32_16x16x32_bf16 v[104:107], v[144:147], a[92:95], v[104:107]
    ds_read_b64_tr_b16 v[126:127], v11 offset:1288
    v_mfma_f32_16x16x32_bf16 v[88:91], v[148:151], a[12:15], v[88:91]
    ds_read_b64_tr_b16 v[128:129], v11 offset:16
    v_mfma_f32_16x16x32_bf16 v[108:111], v[148:151], a[92:95], v[108:111]
    s_add_u32 m0, s72, 4096
    ds_read_b64_tr_b16 v[130:131], v11 offset:1296
    v_mfma_f32_16x16x32_bf16 v[92:95], v[152:155], a[12:15], v[92:95]
    ds_read_b64_tr_b16 v[132:133], v11 offset:24
    v_mfma_f32_16x16x32_bf16 v[112:115], v[152:155], a[92:95], v[112:115]
    ds_read_b64_tr_b16 v[134:135], v11 offset:1304
    buffer_load_dwordx4 v22, s[8:11], s76 offen offset:0 lds
    v_mfma_f32_16x16x32_bf16 v[96:99], v[156:159], a[12:15], v[96:99]
    ds_read_b64_tr_b16 v[136:137], v11 offset:32
    v_mfma_f32_16x16x32_bf16 v[116:119], v[156:159], a[92:95], v[116:119]
    ds_read_b64_tr_b16 v[138:139], v11 offset:1312
    s_waitcnt lgkmcnt(8)
    v_mfma_f32_16x16x32_bf16 v[40:43], v[120:123], a[0:3], 0
    ds_read_b64_tr_b16 v[140:141], v11 offset:8192
    v_mfma_f32_16x16x32_bf16 v[60:63], v[120:123], a[80:83], 0
    ds_read_b64_tr_b16 v[142:143], v11 offset:9472
    s_waitcnt lgkmcnt(8)
    v_mfma_f32_16x16x32_bf16 v[44:47], v[124:127], a[0:3], 0
    ds_read_b64_tr_b16 v[144:145], v11 offset:8200
    v_mfma_f32_16x16x32_bf16 v[64:67], v[124:127], a[80:83], 0
    ds_read_b64_tr_b16 v[146:147], v11 offset:9480
    s_waitcnt lgkmcnt(8)
    v_mfma_f32_16x16x32_bf16 v[48:51], v[128:131], a[0:3], 0
    ds_read_b64_tr_b16 v[148:149], v11 offset:8208
    v_mfma_f32_16x16x32_bf16 v[68:71], v[128:131], a[80:83], 0
    ds_read_b64_tr_b16 v[150:151], v11 offset:9488
    s_waitcnt lgkmcnt(8)
    v_mfma_f32_16x16x32_bf16 v[52:55], v[132:135], a[0:3], 0
    ds_read_b64_tr_b16 v[152:153], v11 offset:8216
    v_mfma_f32_16x16x32_bf16 v[72:75], v[132:135], a[80:83], 0
    ds_read_b64_tr_b16 v[154:155], v11 offset:9496
    s_waitcnt lgkmcnt(8)
    v_mfma_f32_16x16x32_bf16 v[56:59], v[136:139], a[0:3], 0
    ds_read_b64_tr_b16 v[156:157], v11 offset:8224
    v_mfma_f32_16x16x32_bf16 v[76:79], v[136:139], a[80:83], 0
    ds_read_b64_tr_b16 v[158:159], v11 offset:9504
    s_waitcnt lgkmcnt(8)
    v_mfma_f32_16x16x32_bf16 v[40:43], v[140:143], a[4:7], v[40:43]
    ds_read_b64_tr_b16 v[120:121], v11 offset:16384
    v_mfma_f32_16x16x32_bf16 v[60:63], v[140:143], a[84:87], v[60:63]
    ds_read_b64_tr_b16 v[122:123], v11 offset:17664
    s_waitcnt lgkmcnt(8)
    v_mfma_f32_16x16x32_bf16 v[44:47], v[144:147], a[4:7], v[44:47]
    ds_read_b64_tr_b16 v[124:125], v11 offset:16392
    v_mfma_f32_16x16x32_bf16 v[64:67], v[144:147], a[84:87], v[64:67]
    ds_read_b64_tr_b16 v[126:127], v11 offset:17672
    s_waitcnt lgkmcnt(8)
    v_mfma_f32_16x16x32_bf16 v[48:51], v[148:151], a[4:7], v[48:51]
    ds_read_b64_tr_b16 v[128:129], v11 offset:16400
    v_mfma_f32_16x16x32_bf16 v[68:71], v[148:151], a[84:87], v[68:71]
    ds_read_b64_tr_b16 v[130:131], v11 offset:17680
    s_waitcnt lgkmcnt(8)
    v_mfma_f32_16x16x32_bf16 v[52:55], v[152:155], a[4:7], v[52:55]
    ds_read_b64_tr_b16 v[132:133], v11 offset:16408
    v_mfma_f32_16x16x32_bf16 v[72:75], v[152:155], a[84:87], v[72:75]
    ds_read_b64_tr_b16 v[134:135], v11 offset:17688
    s_waitcnt lgkmcnt(8)
    v_mfma_f32_16x16x32_bf16 v[56:59], v[156:159], a[4:7], v[56:59]
    ds_read_b64_tr_b16 v[136:137], v11 offset:16416
    v_mfma_f32_16x16x32_bf16 v[76:79], v[156:159], a[84:87], v[76:79]
    ds_read_b64_tr_b16 v[138:139], v11 offset:17696
    s_waitcnt lgkmcnt(8)
    v_mfma_f32_16x16x32_bf16 v[40:43], v[120:123], a[8:11], v[40:43]
    v_add_u32 v31, 65536, v27
    ds_read_b64_tr_b16 v[140:141], v11 offset:24576
    v_add_u32 v32, 65536, v28
    v_mfma_f32_16x16x32_bf16 v[60:63], v[120:123], a[88:91], v[60:63]
    ds_read_b64_tr_b16 v[142:143], v11 offset:25856
    v_add_u32 v33, 65536, v29
    s_waitcnt lgkmcnt(8)
    v_mfma_f32_16x16x32_bf16 v[44:47], v[124:127], a[8:11], v[44:47]
    v_add_u32 v34, 65536, v30
    ds_read_b64_tr_b16 v[144:145], v11 offset:24584
    v_mfma_f32_16x16x32_bf16 v[64:67], v[124:127], a[88:91], v[64:67]
    s_waitcnt vmcnt(10)
    ds_read_b64_tr_b16 v[146:147], v11 offset:25864
    ds_read_b128 a[16:19], v31 offset:32768
    s_waitcnt lgkmcnt(9)
    v_mfma_f32_16x16x32_bf16 v[48:51], v[128:131], a[8:11], v[48:51]
    ds_read_b64_tr_b16 v[148:149], v11 offset:24592
    ds_read_b128 a[96:99], v31 offset:36864
    v_mfma_f32_16x16x32_bf16 v[68:71], v[128:131], a[88:91], v[68:71]
    ds_read_b128 a[20:23], v32 offset:32768
    ds_read_b64_tr_b16 v[150:151], v11 offset:25872
    s_waitcnt lgkmcnt(11)
    v_mfma_f32_16x16x32_bf16 v[52:55], v[132:135], a[8:11], v[52:55]
    ds_read_b128 a[100:103], v32 offset:36864
    ds_read_b64_tr_b16 v[152:153], v11 offset:24600
    ds_read_b128 a[24:27], v33 offset:32768
    v_mfma_f32_16x16x32_bf16 v[72:75], v[132:135], a[88:91], v[72:75]
    ds_read_b64_tr_b16 v[154:155], v11 offset:25880
    ds_read_b128 a[104:107], v33 offset:36864
    s_waitcnt lgkmcnt(14)
    v_mfma_f32_16x16x32_bf16 v[56:59], v[136:139], a[8:11], v[56:59]
    ds_read_b128 a[28:31], v34 offset:32768
    ds_read_b64_tr_b16 v[156:157], v11 offset:24608
    v_mfma_f32_16x16x32_bf16 v[76:79], v[136:139], a[88:91], v[76:79]
    ds_read_b128 a[108:111], v34 offset:36864
    ds_read_b64_tr_b16 v[158:159], v11 offset:25888
    s_waitcnt vmcnt(5)
    s_waitcnt lgkmcnt(0)
    s_barrier
    v_mfma_f32_16x16x32_bf16 v[40:43], v[140:143], a[12:15], v[40:43]
    s_add_u32 s76, s70, s66
    s_add_u32 m0, s72, 98304
    ds_read_b64_tr_b16 v[120:121], v12 offset:0
    v_mfma_f32_16x16x32_bf16 v[60:63], v[140:143], a[92:95], v[60:63]
    ds_read_b64_tr_b16 v[122:123], v12 offset:1280
    v_mfma_f32_16x16x32_bf16 v[44:47], v[144:147], a[12:15], v[44:47]
    ds_read_b64_tr_b16 v[124:125], v12 offset:8
    buffer_load_dwordx4 v23, s[4:7], s76 offen offset:0 lds
    v_mfma_f32_16x16x32_bf16 v[64:67], v[144:147], a[92:95], v[64:67]
    ds_read_b64_tr_b16 v[126:127], v12 offset:1288
    v_mfma_f32_16x16x32_bf16 v[48:51], v[148:151], a[12:15], v[48:51]
    ds_read_b64_tr_b16 v[128:129], v12 offset:16
    v_mfma_f32_16x16x32_bf16 v[68:71], v[148:151], a[92:95], v[68:71]
    buffer_load_dwordx4 v24, s[4:7], s76 offen offset:1024 lds
    ds_read_b64_tr_b16 v[130:131], v12 offset:1296
    v_mfma_f32_16x16x32_bf16 v[52:55], v[152:155], a[12:15], v[52:55]
    ds_read_b64_tr_b16 v[132:133], v12 offset:24
    v_mfma_f32_16x16x32_bf16 v[72:75], v[152:155], a[92:95], v[72:75]
    ds_read_b64_tr_b16 v[134:135], v12 offset:1304
    buffer_load_dwordx4 v25, s[4:7], s76 offen offset:2048 lds
    v_mfma_f32_16x16x32_bf16 v[56:59], v[156:159], a[12:15], v[56:59]
    ds_read_b64_tr_b16 v[136:137], v12 offset:32
    v_mfma_f32_16x16x32_bf16 v[76:79], v[156:159], a[92:95], v[76:79]
    ds_read_b64_tr_b16 v[138:139], v12 offset:1312
    s_waitcnt lgkmcnt(8)
    v_mfma_f32_16x16x32_bf16 v[80:83], v[120:123], a[16:19], v[80:83]
    buffer_load_dwordx4 v26, s[4:7], s76 offen offset:3072 lds
    ds_read_b64_tr_b16 v[140:141], v12 offset:8192
    v_mfma_f32_16x16x32_bf16 v[100:103], v[120:123], a[96:99], v[100:103]
    ds_read_b64_tr_b16 v[142:143], v12 offset:9472
    s_waitcnt lgkmcnt(8)
    v_mfma_f32_16x16x32_bf16 v[84:87], v[124:127], a[16:19], v[84:87]
    ds_read_b64_tr_b16 v[144:145], v12 offset:8200
    v_mfma_f32_16x16x32_bf16 v[104:107], v[124:127], a[96:99], v[104:107]
    s_add_u32 s76, s71, s66
    s_add_u32 m0, s72, 102400
    ds_read_b64_tr_b16 v[146:147], v12 offset:9480
    s_waitcnt lgkmcnt(8)
    v_mfma_f32_16x16x32_bf16 v[88:91], v[128:131], a[16:19], v[88:91]
    ds_read_b64_tr_b16 v[148:149], v12 offset:8208
    v_mfma_f32_16x16x32_bf16 v[108:111], v[128:131], a[96:99], v[108:111]
    ds_read_b64_tr_b16 v[150:151], v12 offset:9488
    s_waitcnt lgkmcnt(8)
    v_mfma_f32_16x16x32_bf16 v[92:95], v[132:135], a[16:19], v[92:95]
    ds_read_b64_tr_b16 v[152:153], v12 offset:8216
    buffer_load_dwordx4 v23, s[4:7], s76 offen offset:0 lds
    v_mfma_f32_16x16x32_bf16 v[112:115], v[132:135], a[96:99], v[112:115]
    ds_read_b64_tr_b16 v[154:155], v12 offset:9496
    s_waitcnt lgkmcnt(8)
    v_mfma_f32_16x16x32_bf16 v[96:99], v[136:139], a[16:19], v[96:99]
    ds_read_b64_tr_b16 v[156:157], v12 offset:8224
    v_mfma_f32_16x16x32_bf16 v[116:119], v[136:139], a[96:99], v[116:119]
    ds_read_b64_tr_b16 v[158:159], v12 offset:9504
    s_waitcnt lgkmcnt(8)
    v_mfma_f32_16x16x32_bf16 v[80:83], v[140:143], a[20:23], v[80:83]
    buffer_load_dwordx4 v24, s[4:7], s76 offen offset:1024 lds
    ds_read_b64_tr_b16 v[120:121], v12 offset:16384
    v_mfma_f32_16x16x32_bf16 v[100:103], v[140:143], a[100:103], v[100:103]
    ds_read_b64_tr_b16 v[122:123], v12 offset:17664
    s_waitcnt lgkmcnt(8)
    v_mfma_f32_16x16x32_bf16 v[84:87], v[144:147], a[20:23], v[84:87]
    ds_read_b64_tr_b16 v[124:125], v12 offset:16392
    v_mfma_f32_16x16x32_bf16 v[104:107], v[144:147], a[100:103], v[104:107]
    buffer_load_dwordx4 v25, s[4:7], s76 offen offset:2048 lds
    ds_read_b64_tr_b16 v[126:127], v12 offset:17672
    s_waitcnt lgkmcnt(8)
    v_mfma_f32_16x16x32_bf16 v[88:91], v[148:151], a[20:23], v[88:91]
    ds_read_b64_tr_b16 v[128:129], v12 offset:16400
    v_mfma_f32_16x16x32_bf16 v[108:111], v[148:151], a[100:103], v[108:111]
    ds_read_b64_tr_b16 v[130:131], v12 offset:17680
    s_waitcnt lgkmcnt(8)
    v_mfma_f32_16x16x32_bf16 v[92:95], v[152:155], a[20:23], v[92:95]
    ds_read_b64_tr_b16 v[132:133], v12 offset:16408
    buffer_load_dwordx4 v26, s[4:7], s76 offen offset:3072 lds
    v_mfma_f32_16x16x32_bf16 v[112:115], v[152:155], a[100:103], v[112:115]
    ds_read_b64_tr_b16 v[134:135], v12 offset:17688
    s_waitcnt lgkmcnt(8)
    v_mfma_f32_16x16x32_bf16 v[96:99], v[156:159], a[20:23], v[96:99]
    ds_read_b64_tr_b16 v[136:137], v12 offset:16416
    v_mfma_f32_16x16x32_bf16 v[116:119], v[156:159], a[100:103], v[116:119]
    ds_read_b64_tr_b16 v[138:139], v12 offset:17696
    s_waitcnt lgkmcnt(8)
    v_mfma_f32_16x16x32_bf16 v[80:83], v[120:123], a[24:27], v[80:83]
    s_mul_i32 s76, s66, 1920
    s_add_u32 s76, s76, s73
    ds_read_b64_tr_b16 v[140:141], v12 offset:24576
    v_mfma_f32_16x16x32_bf16 v[100:103], v[120:123], a[104:107], v[100:103]
    ds_read_b64_tr_b16 v[142:143], v12 offset:25856
    s_waitcnt lgkmcnt(8)
    v_mfma_f32_16x16x32_bf16 v[84:87], v[124:127], a[24:27], v[84:87]
    ds_read_b64_tr_b16 v[144:145], v12 offset:24584
    s_add_u32 m0, s72, 32768
    v_mfma_f32_16x16x32_bf16 v[104:107], v[124:127], a[104:107], v[104:107]
    ds_read_b64_tr_b16 v[146:147], v12 offset:25864
    s_waitcnt lgkmcnt(8)
    v_mfma_f32_16x16x32_bf16 v[88:91], v[128:131], a[24:27], v[88:91]
    ds_read_b64_tr_b16 v[148:149], v12 offset:24592
    v_mfma_f32_16x16x32_bf16 v[108:111], v[128:131], a[104:107], v[108:111]
    buffer_load_dwordx4 v13, s[8:11], s76 offen offset:0 lds
    ds_read_b64_tr_b16 v[150:151], v12 offset:25872
L_padk0:
L_pd4482:
    s_cbranch_execz L_pd6979
    s_waitcnt lgkmcnt(8)
    v_mfma_f32_16x16x32_bf16 v[92:95], v[132:135], a[24:27], v[92:95]
    ds_read_b64_tr_b16 v[152:153], v12 offset:24600
    v_mfma_f32_16x16x32_bf16 v[112:115], v[132:135], a[104:107], v[112:115]
    ds_read_b64_tr_b16 v[154:155], v12 offset:25880
    buffer_load_dwordx4 v14, s[8:11], s76 offen offset:1024 lds
    s_waitcnt lgkmcnt(8)
    v_mfma_f32_16x16x32_bf16 v[96:99], v[136:139], a[24:27], v[96:99]
    ds_read_b64_tr_b16 v[156:157], v12 offset:24608
    v_mfma_f32_16x16x32_bf16 v[116:119], v[136:139], a[104:107], v[116:119]
    ds_read_b64_tr_b16 v[158:159], v12 offset:25888
    s_waitcnt vmcnt(10)
    s_waitcnt lgkmcnt(0)
    s_barrier
    v_mfma_f32_16x16x32_bf16 v[80:83], v[140:143], a[28:31], v[80:83]
    buffer_load_dwordx4 v15, s[8:11], s76 offen offset:2048 lds
    ds_read_b64_tr_b16 v[120:121], v10 offset:0
    v_mfma_f32_16x16x32_bf16 v[100:103], v[140:143], a[108:111], v[100:103]
    ds_read_b64_tr_b16 v[122:123], v10 offset:1280
    v_mfma_f32_16x16x32_bf16 v[84:87], v[144:147], a[28:31], v[84:87]
    ds_read_b64_tr_b16 v[124:125], v10 offset:8
    buffer_load_dwordx4 v16, s[8:11], s76 offen offset:3072 lds
    v_mfma_f32_16x16x32_bf16 v[104:107], v[144:147], a[108:111], v[104:107]
    ds_read_b64_tr_b16 v[126:127], v10 offset:1288
    v_mfma_f32_16x16x32_bf16 v[88:91], v[148:151], a[28:31], v[88:91]
    ds_read_b64_tr_b16 v[128:129], v10 offset:16
    v_mfma_f32_16x16x32_bf16 v[108:111], v[148:151], a[108:111], v[108:111]
    s_add_u32 m0, s72, 36864
    ds_read_b64_tr_b16 v[130:131], v10 offset:1296
    v_mfma_f32_16x16x32_bf16 v[92:95], v[152:155], a[28:31], v[92:95]
    ds_read_b64_tr_b16 v[132:133], v10 offset:24
    v_mfma_f32_16x16x32_bf16 v[112:115], v[152:155], a[108:111], v[112:115]
    ds_read_b64_tr_b16 v[134:135], v10 offset:1304
    buffer_load_dwordx4 v17, s[8:11], s76 offen offset:0 lds
    v_mfma_f32_16x16x32_bf16 v[96:99], v[156:159], a[28:31], v[96:99]
    ds_read_b64_tr_b16 v[136:137], v10 offset:32
    v_mfma_f32_16x16x32_bf16 v[116:119], v[156:159], a[108:111], v[116:119]
    ds_read_b64_tr_b16 v[138:139], v10 offset:1312
    s_waitcnt lgkmcnt(8)
    v_mfma_f32_16x16x32_bf16 v[40:43], v[120:123], a[16:19], v[40:43]
    s_mul_i32 s76, s66, 1920
    s_add_u32 s76, s76, s74
    ds_read_b64_tr_b16 v[140:141], v10 offset:8192
    v_mfma_f32_16x16x32_bf16 v[60:63], v[120:123], a[96:99], v[60:63]
    ds_read_b64_tr_b16 v[142:143], v10 offset:9472
    s_waitcnt lgkmcnt(8)
    v_mfma_f32_16x16x32_bf16 v[44:47], v[124:127], a[16:19], v[44:47]
    ds_read_b64_tr_b16 v[144:145], v10 offset:8200
    s_add_u32 m0, s72, 65536
    v_mfma_f32_16x16x32_bf16 v[64:67], v[124:127], a[96:99], v[64:67]
    ds_read_b64_tr_b16 v[146:147], v10 offset:9480
    s_waitcnt lgkmcnt(8)
    v_mfma_f32_16x16x32_bf16 v[48:51], v[128:131], a[16:19], v[48:51]
    ds_read_b64_tr_b16 v[148:149], v10 offset:8208
    v_mfma_f32_16x16x32_bf16 v[68:71], v[128:131], a[96:99], v[68:71]
    buffer_load_dwordx4 v18, s[8:11], s76 offen offset:0 lds
    ds_read_b64_tr_b16 v[150:151], v10 offset:9488
    s_waitcnt lgkmcnt(8)
    v_mfma_f32_16x16x32_bf16 v[52:55], v[132:135], a[16:19], v[52:55]
    ds_read_b64_tr_b16 v[152:153], v10 offset:8216
    v_mfma_f32_16x16x32_bf16 v[72:75], v[132:135], a[96:99], v[72:75]
    ds_read_b64_tr_b16 v[154:155], v10 offset:9496
    buffer_load_dwordx4 v19, s[8:11], s76 offen offset:1024 lds
    s_waitcnt lgkmcnt(8)
    v_mfma_f32_16x16x32_bf16 v[56:59], v[136:139], a[16:19], v[56:59]
    ds_read_b64_tr_b16 v[156:157], v10 offset:8224
    v_mfma_f32_16x16x32_bf16 v[76:79], v[136:139], a[96:99], v[76:79]
    ds_read_b64_tr_b16 v[158:159], v10 offset:9504
    s_waitcnt lgkmcnt(8)
    v_mfma_f32_16x16x32_bf16 v[40:43], v[140:143], a[20:23], v[40:43]
    buffer_load_dwordx4 v20, s[8:11], s76 offen offset:2048 lds
    ds_read_b64_tr_b16 v[120:121], v10 offset:16384
    v_mfma_f32_16x16x32_bf16 v[60:63], v[140:143], a[100:103], v[60:63]
    ds_read_b64_tr_b16 v[122:123], v10 offset:17664
    s_waitcnt lgkmcnt(8)
    v_mfma_f32_16x16x32_bf16 v[44:47], v[144:147], a[20:23], v[44:47]
    ds_read_b64_tr_b16 v[124:125], v10 offset:16392
    buffer_load_dwordx4 v21, s[8:11], s76 offen offset:3072 lds
    v_mfma_f32_16x16x32_bf16 v[64:67], v[144:147], a[100:103], v[64:67]
    ds_read_b64_tr_b16 v[126:127], v10 offset:17672
    s_waitcnt lgkmcnt(8)
    v_mfma_f32_16x16x32_bf16 v[48:51], v[148:151], a[20:23], v[48:51]
    ds_read_b64_tr_b16 v[128:129], v10 offset:16400
    v_mfma_f32_16x16x32_bf16 v[68:71], v[148:151], a[100:103], v[68:71]
    s_add_u32 m0, s72, 69632
    ds_read_b64_tr_b16 v[130:131], v10 offset:17680
    s_waitcnt lgkmcnt(8)
    v_mfma_f32_16x16x32_bf16 v[52:55], v[152:155], a[20:23], v[52:55]
    ds_read_b64_tr_b16 v[132:133], v10 offset:16408
    v_mfma_f32_16x16x32_bf16 v[72:75], v[152:155], a[100:103], v[72:75]
    ds_read_b64_tr_b16 v[134:135], v10 offset:17688
    buffer_load_dwordx4 v22, s[8:11], s76 offen offset:0 lds
    s_waitcnt lgkmcnt(8)
    v_mfma_f32_16x16x32_bf16 v[56:59], v[156:159], a[20:23], v[56:59]
    ds_read_b64_tr_b16 v[136:137], v10 offset:16416
    v_mfma_f32_16x16x32_bf16 v[76:79], v[156:159], a[100:103], v[76:79]
    ds_read_b64_tr_b16 v[138:139], v10 offset:17696
    s_waitcnt lgkmcnt(8)
    v_mfma_f32_16x16x32_bf16 v[40:43], v[120:123], a[24:27], v[40:43]
    v_add_u32 v31, 65536, v27
    s_add_u32 s76, s70, s67
    s_add_u32 m0, s72, 131072
    v_add_u32 v32, 65536, v28
    ds_read_b64_tr_b16 v[140:141], v10 offset:24576
    v_mfma_f32_16x16x32_bf16 v[60:63], v[120:123], a[104:107], v[60:63]
    v_add_u32 v33, 65536, v29
    ds_read_b64_tr_b16 v[142:143], v10 offset:25856
    s_waitcnt lgkmcnt(8)
    v_mfma_f32_16x16x32_bf16 v[44:47], v[124:127], a[24:27], v[44:47]
    v_add_u32 v34, 65536, v30
    ds_read_b64_tr_b16 v[144:145], v10 offset:24584
    v_mfma_f32_16x16x32_bf16 v[64:67], v[124:127], a[104:107], v[64:67]
    s_waitcnt vmcnt(10)
    buffer_load_dwordx4 v23, s[4:7], s76 offen offset:0 lds
    ds_read_b128 a[32:35], v31 offset:32768
    ds_read_b64_tr_b16 v[146:147], v10 offset:25864
    s_waitcnt lgkmcnt(9)
    v_mfma_f32_16x16x32_bf16 v[48:51], v[128:131], a[24:27], v[48:51]
    ds_read_b128 a[112:115], v31 offset:36864
    ds_read_b64_tr_b16 v[148:149], v10 offset:24592
    v_mfma_f32_16x16x32_bf16 v[68:71], v[128:131], a[104:107], v[68:71]
    ds_read_b128 a[36:39], v32 offset:32768
    ds_read_b64_tr_b16 v[150:151], v10 offset:25872
    s_waitcnt lgkmcnt(11)
    v_mfma_f32_16x16x32_bf16 v[52:55], v[132:135], a[24:27], v[52:55]
    ds_read_b128 a[116:119], v32 offset:36864
    ds_read_b64_tr_b16 v[152:153], v10 offset:24600
    ds_read_b128 a[40:43], v33 offset:32768
    buffer_load_dwordx4 v24, s[4:7], s76 offen offset:1024 lds
    v_mfma_f32_16x16x32_bf16 v[72:75], v[132:135], a[104:107], v[72:75]
    ds_read_b128 a[120:123], v33 offset:36864
    ds_read_b64_tr_b16 v[154:155], v10 offset:25880
    s_waitcnt lgkmcnt(14)
    v_mfma_f32_16x16x32_bf16 v[56:59], v[136:139], a[24:27], v[56:59]
    ds_read_b128 a[44:47], v34 offset:32768
    ds_read_b64_tr_b16 v[156:157], v10 offset:24608
    v_mfma_f32_16x16x32_bf16 v[76:79], v[136:139], a[104:107], v[76:79]
    ds_read_b128 a[124:127], v34 offset:36864
    ds_read_b64_tr_b16 v[158:159], v10 offset:25888
    s_waitcnt vmcnt(7)
    s_waitcnt lgkmcnt(0)
    s_barrier
    v_mfma_f32_16x16x32_bf16 v[40:43], v[140:143], a[28:31], v[40:43]
    buffer_load_dwordx4 v25, s[4:7], s76 offen offset:2048 lds
    ds_read_b64_tr_b16 v[120:121], v10 offset:32768
    v_mfma_f32_16x16x32_bf16 v[60:63], v[140:143], a[108:111], v[60:63]
    ds_read_b64_tr_b16 v[122:123], v10 offset:34048
    v_mfma_f32_16x16x32_bf16 v[44:47], v[144:147], a[28:31], v[44:47]
    ds_read_b64_tr_b16 v[124:125], v10 offset:32776
    buffer_load_dwordx4 v26, s[4:7], s76 offen offset:3072 lds
    v_mfma_f32_16x16x32_bf16 v[64:67], v[144:147], a[108:111], v[64:67]
    ds_read_b64_tr_b16 v[126:127], v10 offset:34056
    v_mfma_f32_16x16x32_bf16 v[48:51], v[148:151], a[28:31], v[48:51]
    ds_read_b64_tr_b16 v[128:129], v10 offset:32784
    v_mfma_f32_16x16x32_bf16 v[68:71], v[148:151], a[108:111], v[68:71]
    s_add_u32 s76, s71, s67
    s_add_u32 m0, s72, 135168
    ds_read_b64_tr_b16 v[130:131], v10 offset:34064
    v_mfma_f32_16x16x32_bf16 v[52:55], v[152:155], a[28:31], v[52:55]
    ds_read_b64_tr_b16 v[132:133], v10 offset:32792
    v_mfma_f32_16x16x32_bf16 v[72:75], v[152:155], a[108:111], v[72:75]
    ds_read_b64_tr_b16 v[134:135], v10 offset:34072
    buffer_load_dwordx4 v23, s[4:7], s76 offen offset:0 lds
    v_mfma_f32_16x16x32_bf16 v[56:59], v[156:159], a[28:31], v[56:59]
    ds_read_b64_tr_b16 v[136:137], v10 offset:32800
    v_mfma_f32_16x16x32_bf16 v[76:79], v[156:159], a[108:111], v[76:79]
    ds_read_b64_tr_b16 v[138:139], v10 offset:34080
    s_waitcnt lgkmcnt(8)
    v_mfma_f32_16x16x32_bf16 v[80:83], v[120:123], a[32:35], v[80:83]
    buffer_load_dwordx4 v24, s[4:7], s76 offen offset:1024 lds
    ds_read_b64_tr_b16 v[140:141], v10 offset:40960
    v_mfma_f32_16x16x32_bf16 v[100:103], v[120:123], a[112:115], v[100:103]
    ds_read_b64_tr_b16 v[142:143], v10 offset:42240
    s_waitcnt lgkmcnt(8)
    v_mfma_f32_16x16x32_bf16 v[84:87], v[124:127], a[32:35], v[84:87]
    ds_read_b64_tr_b16 v[144:145], v10 offset:40968
    v_mfma_f32_16x16x32_bf16 v[104:107], v[124:127], a[112:115], v[104:107]
    ds_read_b64_tr_b16 v[146:147], v10 offset:42248
    s_waitcnt lgkmcnt(8)
    v_mfma_f32_16x16x32_bf16 v[88:91], v[128:131], a[32:35], v[88:91]
    ds_read_b64_tr_b16 v[148:149], v10 offset:40976
    v_mfma_f32_16x16x32_bf16 v[108:111], v[128:131], a[112:115], v[108:111]
    buffer_load_dwordx4 v25, s[4:7], s76 offen offset:2048 lds
    ds_read_b64_tr_b16 v[150:151], v10 offset:42256
    s_waitcnt lgkmcnt(8)
    v_mfma_f32_16x16x32_bf16 v[92:95], v[132:135], a[32:35], v[92:95]
    ds_read_b64_tr_b16 v[152:153], v10 offset:40984
    v_mfma_f32_16x16x32_bf16 v[112:115], v[132:135], a[112:115], v[112:115]
    ds_read_b64_tr_b16 v[154:155], v10 offset:42264
    s_waitcnt lgkmcnt(8)
    v_mfma_f32_16x16x32_bf16 v[96:99], v[136:139], a[32:35], v[96:99]
    ds_read_b64_tr_b16 v[156:157], v10 offset:40992
    v_mfma_f32_16x16x32_bf16 v[116:119], v[136:139], a[112:115], v[116:119]
    ds_read_b64_tr_b16 v[158:159], v10 offset:42272
    s_waitcnt lgkmcnt(8)
    v_mfma_f32_16x16x32_bf16 v[80:83], v[140:143], a[36:39], v[80:83]
    buffer_load_dwordx4 v26, s[4:7], s76 offen offset:3072 lds
    ds_read_b64_tr_b16 v[120:121], v10 offset:49152
    v_mfma_f32_16x16x32_bf16 v[100:103], v[140:143], a[116:119], v[100:103]
    ds_read_b64_tr_b16 v[122:123], v10 offset:50432
    s_waitcnt lgkmcnt(8)
    v_mfma_f32_16x16x32_bf16 v[84:87], v[144:147], a[36:39], v[84:87]
    s_mul_i32 s76, s67, 1920
    s_add_u32 s76, s76, s73
    ds_read_b64_tr_b16 v[124:125], v10 offset:49160
    v_mfma_f32_16x16x32_bf16 v[104:107], v[144:147], a[116:119], v[104:107]
    ds_read_b64_tr_b16 v[126:127], v10 offset:50440
    s_waitcnt lgkmcnt(8)
    v_mfma_f32_16x16x32_bf16 v[88:91], v[148:151], a[36:39], v[88:91]
    s_add_u32 m0, s72, 98304
    ds_read_b64_tr_b16 v[128:129], v10 offset:49168
    v_mfma_f32_16x16x32_bf16 v[108:111], v[148:151], a[116:119], v[108:111]
    ds_read_b64_tr_b16 v[130:131], v10 offset:50448
    s_waitcnt lgkmcnt(8)
    v_mfma_f32_16x16x32_bf16 v[92:95], v[152:155], a[36:39], v[92:95]
    buffer_load_dwordx4 v13, s[8:11], s76 offen offset:0 lds
    ds_read_b64_tr_b16 v[132:133], v10 offset:49176
    v_mfma_f32_16x16x32_bf16 v[112:115], v[152:155], a[116:119], v[112:115]
    ds_read_b64_tr_b16 v[134:135], v10 offset:50456
    s_waitcnt lgkmcnt(8)
    v_mfma_f32_16x16x32_bf16 v[96:99], v[156:159], a[36:39], v[96:99]
    buffer_load_dwordx4 v14, s[8:11], s76 offen offset:1024 lds
    ds_read_b64_tr_b16 v[136:137], v10 offset:49184
    v_mfma_f32_16x16x32_bf16 v[116:119], v[156:159], a[116:119], v[116:119]
    ds_read_b64_tr_b16 v[138:139], v10 offset:50464
    s_waitcnt lgkmcnt(8)
    v_mfma_f32_16x16x32_bf16 v[80:83], v[120:123], a[40:43], v[80:83]
    buffer_load_dwordx4 v15, s[8:11], s76 offen offset:2048 lds
    ds_read_b64_tr_b16 v[140:141], v10 offset:57344
    v_mfma_f32_16x16x32_bf16 v[100:103], v[120:123], a[120:123], v[100:103]
    ds_read_b64_tr_b16 v[142:143], v10 offset:58624
    s_waitcnt lgkmcnt(8)
    v_mfma_f32_16x16x32_bf16 v[84:87], v[124:127], a[40:43], v[84:87]
    ds_read_b64_tr_b16 v[144:145], v10 offset:57352
    v_mfma_f32_16x16x32_bf16 v[104:107], v[124:127], a[120:123], v[104:107]
    ds_read_b64_tr_b16 v[146:147], v10 offset:58632
    s_waitcnt lgkmcnt(8)
    v_mfma_f32_16x16x32_bf16 v[88:91], v[128:131], a[40:43], v[88:91]
    ds_read_b64_tr_b16 v[148:149], v10 offset:57360
    v_mfma_f32_16x16x32_bf16 v[108:111], v[128:131], a[120:123], v[108:111]
    buffer_load_dwordx4 v16, s[8:11], s76 offen offset:3072 lds
    ds_read_b64_tr_b16 v[150:151], v10 offset:58640
    s_waitcnt lgkmcnt(8)
    v_mfma_f32_16x16x32_bf16 v[92:95], v[132:135], a[40:43], v[92:95]
    ds_read_b64_tr_b16 v[152:153], v10 offset:57368
    v_mfma_f32_16x16x32_bf16 v[112:115], v[132:135], a[120:123], v[112:115]
    ds_read_b64_tr_b16 v[154:155], v10 offset:58648
    s_waitcnt lgkmcnt(8)
    v_mfma_f32_16x16x32_bf16 v[96:99], v[136:139], a[40:43], v[96:99]
    ds_read_b64_tr_b16 v[156:157], v10 offset:57376
    v_mfma_f32_16x16x32_bf16 v[116:119], v[136:139], a[120:123], v[116:119]
    ds_read_b64_tr_b16 v[158:159], v10 offset:58656
    s_waitcnt vmcnt(12)
    s_waitcnt lgkmcnt(0)
    s_barrier
    v_mfma_f32_16x16x32_bf16 v[80:83], v[140:143], a[44:47], v[80:83]
    s_add_u32 m0, s72, 102400
    ds_read_b64_tr_b16 v[120:121], v11 offset:0
    v_mfma_f32_16x16x32_bf16 v[100:103], v[140:143], a[124:127], v[100:103]
    ds_read_b64_tr_b16 v[122:123], v11 offset:1280
    buffer_load_dwordx4 v17, s[8:11], s76 offen offset:0 lds
    v_mfma_f32_16x16x32_bf16 v[84:87], v[144:147], a[44:47], v[84:87]
    ds_read_b64_tr_b16 v[124:125], v11 offset:8
    v_mfma_f32_16x16x32_bf16 v[104:107], v[144:147], a[124:127], v[104:107]
    s_mul_i32 s76, s67, 1920
    s_add_u32 s76, s76, s74
    ds_read_b64_tr_b16 v[126:127], v11 offset:1288
    v_mfma_f32_16x16x32_bf16 v[88:91], v[148:151], a[44:47], v[88:91]
    ds_read_b64_tr_b16 v[128:129], v11 offset:16
    v_mfma_f32_16x16x32_bf16 v[108:111], v[148:151], a[124:127], v[108:111]
    s_add_u32 m0, s72, 0
    ds_read_b64_tr_b16 v[130:131], v11 offset:1296
    v_mfma_f32_16x16x32_bf16 v[92:95], v[152:155], a[44:47], v[92:95]
    ds_read_b64_tr_b16 v[132:133], v11 offset:24
    buffer_load_dwordx4 v18, s[8:11], s76 offen offset:0 lds
    v_mfma_f32_16x16x32_bf16 v[112:115], v[152:155], a[124:127], v[112:115]
    ds_read_b64_tr_b16 v[134:135], v11 offset:1304
    v_mfma_f32_16x16x32_bf16 v[96:99], v[156:159], a[44:47], v[96:99]
    buffer_load_dwordx4 v19, s[8:11], s76 offen offset:1024 lds
    ds_read_b64_tr_b16 v[136:137], v11 offset:32
    v_mfma_f32_16x16x32_bf16 v[116:119], v[156:159], a[124:127], v[116:119]
    ds_read_b64_tr_b16 v[138:139], v11 offset:1312
    s_waitcnt lgkmcnt(8)
    v_mfma_f32_16x16x32_bf16 v[40:43], v[120:123], a[32:35], v[40:43]
    buffer_load_dwordx4 v20, s[8:11], s76 offen offset:2048 lds
    ds_read_b64_tr_b16 v[140:141], v11 offset:8192
    v_mfma_f32_16x16x32_bf16 v[60:63], v[120:123], a[112:115], v[60:63]
    ds_read_b64_tr_b16 v[142:143], v11 offset:9472
    s_waitcnt lgkmcnt(8)
    v_mfma_f32_16x16x32_bf16 v[44:47], v[124:127], a[32:35], v[44:47]
    ds_read_b64_tr_b16 v[144:145], v11 offset:8200
    v_mfma_f32_16x16x32_bf16 v[64:67], v[124:127], a[112:115], v[64:67]
    ds_read_b64_tr_b16 v[146:147], v11 offset:9480
    s_waitcnt lgkmcnt(8)
    v_mfma_f32_16x16x32_bf16 v[48:51], v[128:131], a[32:35], v[48:51]
    ds_read_b64_tr_b16 v[148:149], v11 offset:8208
    v_mfma_f32_16x16x32_bf16 v[68:71], v[128:131], a[112:115], v[68:71]
    buffer_load_dwordx4 v21, s[8:11], s76 offen offset:3072 lds
    ds_read_b64_tr_b16 v[150:151], v11 offset:9488
    s_waitcnt lgkmcnt(8)
    v_mfma_f32_16x16x32_bf16 v[52:55], v[132:135], a[32:35], v[52:55]
    ds_read_b64_tr_b16 v[152:153], v11 offset:8216
    v_mfma_f32_16x16x32_bf16 v[72:75], v[132:135], a[112:115], v[72:75]
    ds_read_b64_tr_b16 v[154:155], v11 offset:9496
    s_waitcnt lgkmcnt(8)
    v_mfma_f32_16x16x32_bf16 v[56:59], v[136:139], a[32:35], v[56:59]
    ds_read_b64_tr_b16 v[156:157], v11 offset:8224
    v_mfma_f32_16x16x32_bf16 v[76:79], v[136:139], a[112:115], v[76:79]
    ds_read_b64_tr_b16 v[158:159], v11 offset:9504
    s_waitcnt lgkmcnt(8)
    v_mfma_f32_16x16x32_bf16 v[40:43], v[140:143], a[36:39], v[40:43]
    s_add_u32 m0, s72, 4096
    ds_read_b64_tr_b16 v[120:121], v11 offset:16384
    v_mfma_f32_16x16x32_bf16 v[60:63], v[140:143], a[116:119], v[60:63]
    ds_read_b64_tr_b16 v[122:123], v11 offset:17664
    s_waitcnt lgkmcnt(8)
    v_mfma_f32_16x16x32_bf16 v[44:47], v[144:147], a[36:39], v[44:47]
    ds_read_b64_tr_b16 v[124:125], v11 offset:16392
    v_mfma_f32_16x16x32_bf16 v[64:67], v[144:147], a[116:119], v[64:67]
    ds_read_b64_tr_b16 v[126:127], v11 offset:17672
    s_waitcnt lgkmcnt(8)
    v_mfma_f32_16x16x32_bf16 v[48:51], v[148:151], a[36:39], v[48:51]
    ds_read_b64_tr_b16 v[128:129], v11 offset:16400
    v_mfma_f32_16x16x32_bf16 v[68:71], v[148:151], a[116:119], v[68:71]
    buffer_load_dwordx4 v22, s[8:11], s76 offen offset:0 lds
    ds_read_b64_tr_b16 v[130:131], v11 offset:17680
    s_waitcnt lgkmcnt(8)
    v_mfma_f32_16x16x32_bf16 v[52:55], v[152:155], a[36:39], v[52:55]
    ds_read_b64_tr_b16 v[132:133], v11 offset:16408
    v_mfma_f32_16x16x32_bf16 v[72:75], v[152:155], a[116:119], v[72:75]
    ds_read_b64_tr_b16 v[134:135], v11 offset:17688
    s_waitcnt lgkmcnt(8)
    v_mfma_f32_16x16x32_bf16 v[56:59], v[156:159], a[36:39], v[56:59]
    ds_read_b64_tr_b16 v[136:137], v11 offset:16416
    v_mfma_f32_16x16x32_bf16 v[76:79], v[156:159], a[116:119], v[76:79]
    ds_read_b64_tr_b16 v[138:139], v11 offset:17696
    s_waitcnt lgkmcnt(8)
    v_mfma_f32_16x16x32_bf16 v[40:43], v[120:123], a[40:43], v[40:43]
    v_add_u32 v31, 131072, v27
    ds_read_b64_tr_b16 v[140:141], v11 offset:24576
    v_add_u32 v32, 131072, v28
    v_mfma_f32_16x16x32_bf16 v[60:63], v[120:123], a[120:123], v[60:63]
    ds_read_b64_tr_b16 v[142:143], v11 offset:25856
    v_add_u32 v33, 131072, v29
    s_waitcnt lgkmcnt(8)
    v_mfma_f32_16x16x32_bf16 v[44:47], v[124:127], a[40:43], v[44:47]
    v_add_u32 v34, 131072, v30
    ds_read_b64_tr_b16 v[144:145], v11 offset:24584
    v_mfma_f32_16x16x32_bf16 v[64:67], v[124:127], a[120:123], v[64:67]
    s_waitcnt vmcnt(10)
    ds_read_b64_tr_b16 v[146:147], v11 offset:25864
    ds_read_b128 a[48:51], v31 offset:0
    s_waitcnt lgkmcnt(9)
    v_mfma_f32_16x16x32_bf16 v[48:51], v[128:131], a[40:43], v[48:51]
    ds_read_b64_tr_b16 v[148:149], v11 offset:24592
    ds_read_b128 a[128:131], v31 offset:4096
    v_mfma_f32_16x16x32_bf16 v[68:71], v[128:131], a[120:123], v[68:71]
    ds_read_b128 a[52:55], v32 offset:0
    ds_read_b64_tr_b16 v[150:151], v11 offset:25872
    s_waitcnt lgkmcnt(11)
    v_mfma_f32_16x16x32_bf16 v[52:55], v[132:135], a[40:43], v[52:55]
    ds_read_b128 a[132:135], v32 offset:4096
    ds_read_b64_tr_b16 v[152:153], v11 offset:24600
    ds_read_b128 a[56:59], v33 offset:0
    v_mfma_f32_16x16x32_bf16 v[72:75], v[132:135], a[120:123], v[72:75]
    ds_read_b64_tr_b16 v[154:155], v11 offset:25880
    ds_read_b128 a[136:139], v33 offset:4096
    s_waitcnt lgkmcnt(14)
    v_mfma_f32_16x16x32_bf16 v[56:59], v[136:139], a[40:43], v[56:59]
    ds_read_b128 a[60:63], v34 offset:0
    ds_read_b64_tr_b16 v[156:157], v11 offset:24608
    v_mfma_f32_16x16x32_bf16 v[76:79], v[136:139], a[120:123], v[76:79]
    ds_read_b128 a[140:143], v34 offset:4096
    ds_read_b64_tr_b16 v[158:159], v11 offset:25888
    s_waitcnt vmcnt(5)
    s_waitcnt lgkmcnt(0)
    s_barrier
    v_mfma_f32_16x16x32_bf16 v[40:43], v[140:143], a[44:47], v[40:43]
    s_add_u32 s76, s70, s68
    s_add_u32 m0, s72, 131072
    ds_read_b64_tr_b16 v[120:121], v11 offset:32768
    v_mfma_f32_16x16x32_bf16 v[60:63], v[140:143], a[124:127], v[60:63]
    ds_read_b64_tr_b16 v[122:123], v11 offset:34048
    v_mfma_f32_16x16x32_bf16 v[44:47], v[144:147], a[44:47], v[44:47]
    ds_read_b64_tr_b16 v[124:125], v11 offset:32776
    buffer_load_dwordx4 v23, s[4:7], s76 offen offset:0 lds
    v_mfma_f32_16x16x32_bf16 v[64:67], v[144:147], a[124:127], v[64:67]
    ds_read_b64_tr_b16 v[126:127], v11 offset:34056
    v_mfma_f32_16x16x32_bf16 v[48:51], v[148:151], a[44:47], v[48:51]
    ds_read_b64_tr_b16 v[128:129], v11 offset:32784
    v_mfma_f32_16x16x32_bf16 v[68:71], v[148:151], a[124:127], v[68:71]
    buffer_load_dwordx4 v24, s[4:7], s76 offen offset:1024 lds
    ds_read_b64_tr_b16 v[130:131], v11 offset:34064
    v_mfma_f32_16x16x32_bf16 v[52:55], v[152:155], a[44:47], v[52:55]
    ds_read_b64_tr_b16 v[132:133], v11 offset:32792
    v_mfma_f32_16x16x32_bf16 v[72:75], v[152:155], a[124:127], v[72:75]
    ds_read_b64_tr_b16 v[134:135], v11 offset:34072
    buffer_load_dwordx4 v25, s[4:7], s76 offen offset:2048 lds
    v_mfma_f32_16x16x32_bf16 v[56:59], v[156:159], a[44:47], v[56:59]
    ds_read_b64_tr_b16 v[136:137], v11 offset:32800
    v_mfma_f32_16x16x32_bf16 v[76:79], v[156:159], a[124:127], v[76:79]
    ds_read_b64_tr_b16 v[138:139], v11 offset:34080
    s_waitcnt lgkmcnt(8)
    v_mfma_f32_16x16x32_bf16 v[80:83], v[120:123], a[48:51], v[80:83]
    buffer_load_dwordx4 v26, s[4:7], s76 offen offset:3072 lds
    ds_read_b64_tr_b16 v[140:141], v11 offset:40960
    v_mfma_f32_16x16x32_bf16 v[100:103], v[120:123], a[128:131], v[100:103]
    ds_read_b64_tr_b16 v[142:143], v11 offset:42240
    s_waitcnt lgkmcnt(8)
    v_mfma_f32_16x16x32_bf16 v[84:87], v[124:127], a[48:51], v[84:87]
    ds_read_b64_tr_b16 v[144:145], v11 offset:40968
    v_mfma_f32_16x16x32_bf16 v[104:107], v[124:127], a[128:131], v[104:107]
    s_add_u32 s76, s71, s68
    s_add_u32 m0, s72, 135168
    ds_read_b64_tr_b16 v[146:147], v11 offset:42248
    s_waitcnt lgkmcnt(8)
    v_mfma_f32_16x16x32_bf16 v[88:91], v[128:131], a[48:51], v[88:91]
    ds_read_b64_tr_b16 v[148:149], v11 offset:40976
    v_mfma_f32_16x16x32_bf16 v[108:111], v[128:131], a[128:131], v[108:111]
    ds_read_b64_tr_b16 v[150:151], v11 offset:42256
    s_waitcnt lgkmcnt(8)
    v_mfma_f32_16x16x32_bf16 v[92:95], v[132:135], a[48:51], v[92:95]
    ds_read_b64_tr_b16 v[152:153], v11 offset:40984
    buffer_load_dwordx4 v23, s[4:7], s76 offen offset:0 lds
    v_mfma_f32_16x16x32_bf16 v[112:115], v[132:135], a[128:131], v[112:115]
    ds_read_b64_tr_b16 v[154:155], v11 offset:42264
    s_waitcnt lgkmcnt(8)
    v_mfma_f32_16x16x32_bf16 v[96:99], v[136:139], a[48:51], v[96:99]
    ds_read_b64_tr_b16 v[156:157], v11 offset:40992
    v_mfma_f32_16x16x32_bf16 v[116:119], v[136:139], a[128:131], v[116:119]
    ds_read_b64_tr_b16 v[158:159], v11 offset:42272
    s_waitcnt lgkmcnt(8)
    v_mfma_f32_16x16x32_bf16 v[80:83], v[140:143], a[52:55], v[80:83]
    buffer_load_dwordx4 v24, s[4:7], s76 offen offset:1024 lds
    ds_read_b64_tr_b16 v[120:121], v11 offset:49152
    v_mfma_f32_16x16x32_bf16 v[100:103], v[140:143], a[132:135], v[100:103]
    ds_read_b64_tr_b16 v[122:123], v11 offset:50432
    s_waitcnt lgkmcnt(8)
    v_mfma_f32_16x16x32_bf16 v[84:87], v[144:147], a[52:55], v[84:87]
    ds_read_b64_tr_b16 v[124:125], v11 offset:49160
    v_mfma_f32_16x16x32_bf16 v[104:107], v[144:147], a[132:135], v[104:107]
    buffer_load_dwordx4 v25, s[4:7], s76 offen offset:2048 lds
    ds_read_b64_tr_b16 v[126:127], v11 offset:50440
    s_waitcnt lgkmcnt(8)
    v_mfma_f32_16x16x32_bf16 v[88:91], v[148:151], a[52:55], v[88:91]
    ds_read_b64_tr_b16 v[128:129], v11 offset:49168
    v_mfma_f32_16x16x32_bf16 v[108:111], v[148:151], a[132:135], v[108:111]
    ds_read_b64_tr_b16 v[130:131], v11 offset:50448
    s_waitcnt lgkmcnt(8)
    v_mfma_f32_16x16x32_bf16 v[92:95], v[152:155], a[52:55], v[92:95]
    ds_read_b64_tr_b16 v[132:133], v11 offset:49176
    buffer_load_dwordx4 v26, s[4:7], s76 offen offset:3072 lds
    v_mfma_f32_16x16x32_bf16 v[112:115], v[152:155], a[132:135], v[112:115]
    ds_read_b64_tr_b16 v[134:135], v11 offset:50456
    s_waitcnt lgkmcnt(8)
    v_mfma_f32_16x16x32_bf16 v[96:99], v[156:159], a[52:55], v[96:99]
    ds_read_b64_tr_b16 v[136:137], v11 offset:49184
    v_mfma_f32_16x16x32_bf16 v[116:119], v[156:159], a[132:135], v[116:119]
    ds_read_b64_tr_b16 v[138:139], v11 offset:50464
    s_waitcnt lgkmcnt(8)
    v_mfma_f32_16x16x32_bf16 v[80:83], v[120:123], a[56:59], v[80:83]
    s_mul_i32 s76, s68, 1920
    s_add_u32 s76, s76, s73
    ds_read_b64_tr_b16 v[140:141], v11 offset:57344
    v_mfma_f32_16x16x32_bf16 v[100:103], v[120:123], a[136:139], v[100:103]
    ds_read_b64_tr_b16 v[142:143], v11 offset:58624
    s_waitcnt lgkmcnt(8)
    v_mfma_f32_16x16x32_bf16 v[84:87], v[124:127], a[56:59], v[84:87]
    ds_read_b64_tr_b16 v[144:145], v11 offset:57352
    s_add_u32 m0, s72, 32768
    v_mfma_f32_16x16x32_bf16 v[104:107], v[124:127], a[136:139], v[104:107]
    ds_read_b64_tr_b16 v[146:147], v11 offset:58632
    s_waitcnt lgkmcnt(8)
    v_mfma_f32_16x16x32_bf16 v[88:91], v[128:131], a[56:59], v[88:91]
    ds_read_b64_tr_b16 v[148:149], v11 offset:57360
    v_mfma_f32_16x16x32_bf16 v[108:111], v[128:131], a[136:139], v[108:111]
    buffer_load_dwordx4 v13, s[8:11], s76 offen offset:0 lds
    ds_read_b64_tr_b16 v[150:151], v11 offset:58640
    s_waitcnt lgkmcnt(8)
    v_mfma_f32_16x16x32_bf16 v[92:95], v[132:135], a[56:59], v[92:95]
    ds_read_b64_tr_b16 v[152:153], v11 offset:57368
    v_mfma_f32_16x16x32_bf16 v[112:115], v[132:135], a[136:139], v[112:115]
    ds_read_b64_tr_b16 v[154:155], v11 offset:58648
    buffer_load_dwordx4 v14, s[8:11], s76 offen offset:1024 lds
    s_waitcnt lgkmcnt(8)
    v_mfma_f32_16x16x32_bf16 v[96:99], v[136:139], a[56:59], v[96:99]
    ds_read_b64_tr_b16 v[156:157], v11 offset:57376
    v_mfma_f32_16x16x32_bf16 v[116:119], v[136:139], a[136:139], v[116:119]
    ds_read_b64_tr_b16 v[158:159], v11 offset:58656
    s_waitcnt vmcnt(10)
    s_waitcnt lgkmcnt(0)
    s_barrier
    v_mfma_f32_16x16x32_bf16 v[80:83], v[140:143], a[60:63], v[80:83]
    buffer_load_dwordx4 v15, s[8:11], s76 offen offset:2048 lds
    ds_read_b64_tr_b16 v[120:121], v10 offset:0
    v_mfma_f32_16x16x32_bf16 v[100:103], v[140:143], a[140:143], v[100:103]
    ds_read_b64_tr_b16 v[122:123], v10 offset:1280
    v_mfma_f32_16x16x32_bf16 v[84:87], v[144:147], a[60:63], v[84:87]
    ds_read_b64_tr_b16 v[124:125], v10 offset:8
    buffer_load_dwordx4 v16, s[8:11], s76 offen offset:3072 lds
    v_mfma_f32_16x16x32_bf16 v[104:107], v[144:147], a[140:143], v[104:107]
    ds_read_b64_tr_b16 v[126:127], v10 offset:1288
    v_mfma_f32_16x16x32_bf16 v[88:91], v[148:151], a[60:63], v[88:91]
    ds_read_b64_tr_b16 v[128:129], v10 offset:16
    v_mfma_f32_16x16x32_bf16 v[108:111], v[148:151], a[140:143], v[108:111]
    s_add_u32 m0, s72, 36864
    ds_read_b64_tr_b16 v[130:131], v10 offset:1296
    v_mfma_f32_16x16x32_bf16 v[92:95], v[152:155], a[60:63], v[92:95]
    ds_read_b64_tr_b16 v[132:133], v10 offset:24
    v_mfma_f32_16x16x32_bf16 v[112:115], v[152:155], a[140:143], v[112:115]
    ds_read_b64_tr_b16 v[134:135], v10 offset:1304
    buffer_load_dwordx4 v17, s[8:11], s76 offen offset:0 lds
    v_mfma_f32_16x16x32_bf16 v[96:99], v[156:159], a[60:63], v[96:99]
    ds_read_b64_tr_b16 v[136:137], v10 offset:32
    v_mfma_f32_16x16x32_bf16 v[116:119], v[156:159], a[140:143], v[116:119]
    ds_read_b64_tr_b16 v[138:139], v10 offset:1312
    s_waitcnt lgkmcnt(8)
    v_mfma_f32_16x16x32_bf16 v[40:43], v[120:123], a[48:51], v[40:43]
    s_lshl_b32 s78, s38, 9
    s_lshl_b32 s79, s75, 8
    s_add_u32 s78, s78, s79
    v_lshlrev_b32 v23, 4, v38
    v_add_u32 v23, s78, v23
    v_xor_b32 v24, 0x100, v23
    v_mul_u32_u24 v26, 6144, v37
    v_add_u32 v25, v23, v26
    v_add_u32 v26, v24, v26
    s_mul_i32 s76, s68, 1920
    s_add_u32 s76, s76, s74
    ds_read_b64_tr_b16 v[140:141], v10 offset:8192
    v_mfma_f32_16x16x32_bf16 v[60:63], v[120:123], a[128:131], v[60:63]
    ds_read_b64_tr_b16 v[142:143], v10 offset:9472
    s_waitcnt lgkmcnt(8)
    v_mfma_f32_16x16x32_bf16 v[44:47], v[124:127], a[48:51], v[44:47]
    ds_read_b64_tr_b16 v[144:145], v10 offset:8200
    s_add_u32 m0, s72, 65536
    v_mfma_f32_16x16x32_bf16 v[64:67], v[124:127], a[128:131], v[64:67]
    ds_read_b64_tr_b16 v[146:147], v10 offset:9480
    s_waitcnt lgkmcnt(8)
    v_mfma_f32_16x16x32_bf16 v[48:51], v[128:131], a[48:51], v[48:51]
    ds_read_b64_tr_b16 v[148:149], v10 offset:8208
    v_mfma_f32_16x16x32_bf16 v[68:71], v[128:131], a[128:131], v[68:71]
    buffer_load_dwordx4 v18, s[8:11], s76 offen offset:0 lds
    ds_read_b64_tr_b16 v[150:151], v10 offset:9488
    s_waitcnt lgkmcnt(8)
    v_mfma_f32_16x16x32_bf16 v[52:55], v[132:135], a[48:51], v[52:55]
    ds_read_b64_tr_b16 v[152:153], v10 offset:8216
    v_mfma_f32_16x16x32_bf16 v[72:75], v[132:135], a[128:131], v[72:75]
    ds_read_b64_tr_b16 v[154:155], v10 offset:9496
    buffer_load_dwordx4 v19, s[8:11], s76 offen offset:1024 lds
    s_waitcnt lgkmcnt(8)
    v_mfma_f32_16x16x32_bf16 v[56:59], v[136:139], a[48:51], v[56:59]
    ds_read_b64_tr_b16 v[156:157], v10 offset:8224
    v_mfma_f32_16x16x32_bf16 v[76:79], v[136:139], a[128:131], v[76:79]
    ds_read_b64_tr_b16 v[158:159], v10 offset:9504
    s_waitcnt lgkmcnt(8)
    v_mfma_f32_16x16x32_bf16 v[40:43], v[140:143], a[52:55], v[40:43]
    buffer_load_dwordx4 v20, s[8:11], s76 offen offset:2048 lds
    ds_read_b64_tr_b16 v[120:121], v10 offset:16384
    v_mfma_f32_16x16x32_bf16 v[60:63], v[140:143], a[132:135], v[60:63]
    ds_read_b64_tr_b16 v[122:123], v10 offset:17664
    s_waitcnt lgkmcnt(8)
    v_mfma_f32_16x16x32_bf16 v[44:47], v[144:147], a[52:55], v[44:47]
L_padk1:
L_pd5046:
    s_cbranch_execz L_pd7535
    ds_read_b64_tr_b16 v[124:125], v10 offset:16392
    buffer_load_dwordx4 v21, s[8:11], s76 offen offset:3072 lds
    v_mfma_f32_16x16x32_bf16 v[64:67], v[144:147], a[132:135], v[64:67]
    ds_read_b64_tr_b16 v[126:127], v10 offset:17672
    s_waitcnt lgkmcnt(8)
    v_mfma_f32_16x16x32_bf16 v[48:51], v[148:151], a[52:55], v[48:51]
    ds_read_b64_tr_b16 v[128:129], v10 offset:16400
    v_mfma_f32_16x16x32_bf16 v[68:71], v[148:151], a[132:135], v[68:71]
    s_add_u32 m0, s72, 69632
    ds_read_b64_tr_b16 v[130:131], v10 offset:17680
    s_waitcnt lgkmcnt(8)
    v_mfma_f32_16x16x32_bf16 v[52:55], v[152:155], a[52:55], v[52:55]
    ds_read_b64_tr_b16 v[132:133], v10 offset:16408
    v_mfma_f32_16x16x32_bf16 v[72:75], v[152:155], a[132:135], v[72:75]
    ds_read_b64_tr_b16 v[134:135], v10 offset:17688
    buffer_load_dwordx4 v22, s[8:11], s76 offen offset:0 lds
    s_waitcnt lgkmcnt(8)
    v_mfma_f32_16x16x32_bf16 v[56:59], v[156:159], a[52:55], v[56:59]
    ds_read_b64_tr_b16 v[136:137], v10 offset:16416
    v_mfma_f32_16x16x32_bf16 v[76:79], v[156:159], a[132:135], v[76:79]
    ds_read_b64_tr_b16 v[138:139], v10 offset:17696
    s_waitcnt lgkmcnt(8)
    v_mfma_f32_16x16x32_bf16 v[40:43], v[120:123], a[56:59], v[40:43]
    v_add_u32 v31, 131072, v27
    ds_read_b64_tr_b16 v[140:141], v10 offset:24576
    v_add_u32 v32, 131072, v28
    v_mfma_f32_16x16x32_bf16 v[60:63], v[120:123], a[136:139], v[60:63]
    ds_read_b64_tr_b16 v[142:143], v10 offset:25856
    v_add_u32 v33, 131072, v29
    s_waitcnt lgkmcnt(8)
    v_mfma_f32_16x16x32_bf16 v[44:47], v[124:127], a[56:59], v[44:47]
    v_add_u32 v34, 131072, v30
    ds_read_b64_tr_b16 v[144:145], v10 offset:24584
    v_mfma_f32_16x16x32_bf16 v[64:67], v[124:127], a[136:139], v[64:67]
    s_waitcnt vmcnt(10)
    ds_read_b64_tr_b16 v[146:147], v10 offset:25864
    ds_read_b128 a[64:67], v31 offset:0
    s_waitcnt lgkmcnt(9)
    v_mfma_f32_16x16x32_bf16 v[48:51], v[128:131], a[56:59], v[48:51]
    ds_read_b64_tr_b16 v[148:149], v10 offset:24592
    ds_read_b128 a[144:147], v31 offset:4096
    v_mfma_f32_16x16x32_bf16 v[68:71], v[128:131], a[136:139], v[68:71]
    ds_read_b128 a[68:71], v32 offset:0
    ds_read_b64_tr_b16 v[150:151], v10 offset:25872
    s_waitcnt lgkmcnt(11)
    v_mfma_f32_16x16x32_bf16 v[52:55], v[132:135], a[56:59], v[52:55]
    ds_read_b128 a[148:151], v32 offset:4096
    ds_read_b64_tr_b16 v[152:153], v10 offset:24600
    ds_read_b128 a[72:75], v33 offset:0
    v_mfma_f32_16x16x32_bf16 v[72:75], v[132:135], a[136:139], v[72:75]
    ds_read_b64_tr_b16 v[154:155], v10 offset:25880
    ds_read_b128 a[152:155], v33 offset:4096
    s_waitcnt lgkmcnt(14)
    v_mfma_f32_16x16x32_bf16 v[56:59], v[136:139], a[56:59], v[56:59]
    ds_read_b128 a[76:79], v34 offset:0
    ds_read_b64_tr_b16 v[156:157], v10 offset:24608
    v_mfma_f32_16x16x32_bf16 v[76:79], v[136:139], a[136:139], v[76:79]
    ds_read_b128 a[156:159], v34 offset:4096
    ds_read_b64_tr_b16 v[158:159], v10 offset:25888
    s_waitcnt vmcnt(5)
    s_waitcnt lgkmcnt(0)
    s_barrier
    v_mfma_f32_16x16x32_bf16 v[40:43], v[140:143], a[60:63], v[40:43]
    ds_read_b64_tr_b16 v[120:121], v10 offset:32768
    v_mfma_f32_16x16x32_bf16 v[60:63], v[140:143], a[140:143], v[60:63]
    ds_read_b64_tr_b16 v[122:123], v10 offset:34048
    v_mfma_f32_16x16x32_bf16 v[44:47], v[144:147], a[60:63], v[44:47]
    ds_read_b64_tr_b16 v[124:125], v10 offset:32776
    v_mfma_f32_16x16x32_bf16 v[64:67], v[144:147], a[140:143], v[64:67]
    ds_read_b64_tr_b16 v[126:127], v10 offset:34056
    v_mfma_f32_16x16x32_bf16 v[48:51], v[148:151], a[60:63], v[48:51]
    ds_read_b64_tr_b16 v[128:129], v10 offset:32784
    v_mfma_f32_16x16x32_bf16 v[68:71], v[148:151], a[140:143], v[68:71]
    ds_read_b64_tr_b16 v[130:131], v10 offset:34064
    v_mfma_f32_16x16x32_bf16 v[52:55], v[152:155], a[60:63], v[52:55]
    ds_read_b64_tr_b16 v[132:133], v10 offset:32792
    v_mfma_f32_16x16x32_bf16 v[72:75], v[152:155], a[140:143], v[72:75]
    ds_read_b64_tr_b16 v[134:135], v10 offset:34072
    v_mfma_f32_16x16x32_bf16 v[56:59], v[156:159], a[60:63], v[56:59]
    ds_read_b64_tr_b16 v[136:137], v10 offset:32800
    v_mfma_f32_16x16x32_bf16 v[76:79], v[156:159], a[140:143], v[76:79]
    ds_read_b64_tr_b16 v[138:139], v10 offset:34080
    s_waitcnt lgkmcnt(8)
    v_mfma_f32_16x16x32_bf16 v[80:83], v[120:123], a[64:67], v[80:83]
    ds_read_b64_tr_b16 v[140:141], v10 offset:40960
    v_mfma_f32_16x16x32_bf16 v[100:103], v[120:123], a[144:147], v[100:103]
    ds_read_b64_tr_b16 v[142:143], v10 offset:42240
    s_waitcnt lgkmcnt(8)
    v_mfma_f32_16x16x32_bf16 v[84:87], v[124:127], a[64:67], v[84:87]
    ds_read_b64_tr_b16 v[144:145], v10 offset:40968
    v_mfma_f32_16x16x32_bf16 v[104:107], v[124:127], a[144:147], v[104:107]
    ds_read_b64_tr_b16 v[146:147], v10 offset:42248
    s_waitcnt lgkmcnt(8)
    v_mfma_f32_16x16x32_bf16 v[88:91], v[128:131], a[64:67], v[88:91]
    ds_read_b64_tr_b16 v[148:149], v10 offset:40976
    v_mfma_f32_16x16x32_bf16 v[108:111], v[128:131], a[144:147], v[108:111]
    ds_read_b64_tr_b16 v[150:151], v10 offset:42256
    s_waitcnt lgkmcnt(8)
    v_mfma_f32_16x16x32_bf16 v[92:95], v[132:135], a[64:67], v[92:95]
    ds_read_b64_tr_b16 v[152:153], v10 offset:40984
    v_mfma_f32_16x16x32_bf16 v[112:115], v[132:135], a[144:147], v[112:115]
    ds_read_b64_tr_b16 v[154:155], v10 offset:42264
    s_waitcnt lgkmcnt(8)
    v_mfma_f32_16x16x32_bf16 v[96:99], v[136:139], a[64:67], v[96:99]
    ds_read_b64_tr_b16 v[156:157], v10 offset:40992
    v_mfma_f32_16x16x32_bf16 v[116:119], v[136:139], a[144:147], v[116:119]
    ds_read_b64_tr_b16 v[158:159], v10 offset:42272
    s_waitcnt lgkmcnt(8)
    v_mfma_f32_16x16x32_bf16 v[80:83], v[140:143], a[68:71], v[80:83]
    ds_read_b64_tr_b16 v[120:121], v10 offset:49152
    v_mfma_f32_16x16x32_bf16 v[100:103], v[140:143], a[148:151], v[100:103]
    ds_read_b64_tr_b16 v[122:123], v10 offset:50432
    s_waitcnt lgkmcnt(8)
    v_mfma_f32_16x16x32_bf16 v[84:87], v[144:147], a[68:71], v[84:87]
    ds_read_b64_tr_b16 v[124:125], v10 offset:49160
    v_mfma_f32_16x16x32_bf16 v[104:107], v[144:147], a[148:151], v[104:107]
    ds_read_b64_tr_b16 v[126:127], v10 offset:50440
    s_waitcnt lgkmcnt(8)
    v_mfma_f32_16x16x32_bf16 v[88:91], v[148:151], a[68:71], v[88:91]
    ds_read_b64_tr_b16 v[128:129], v10 offset:49168
    v_mfma_f32_16x16x32_bf16 v[108:111], v[148:151], a[148:151], v[108:111]
    ds_read_b64_tr_b16 v[130:131], v10 offset:50448
    s_waitcnt lgkmcnt(8)
    v_mfma_f32_16x16x32_bf16 v[92:95], v[152:155], a[68:71], v[92:95]
    ds_read_b64_tr_b16 v[132:133], v10 offset:49176
    v_mfma_f32_16x16x32_bf16 v[112:115], v[152:155], a[148:151], v[112:115]
    ds_read_b64_tr_b16 v[134:135], v10 offset:50456
    s_waitcnt lgkmcnt(8)
    v_mfma_f32_16x16x32_bf16 v[96:99], v[156:159], a[68:71], v[96:99]
    ds_read_b64_tr_b16 v[136:137], v10 offset:49184
    v_mfma_f32_16x16x32_bf16 v[116:119], v[156:159], a[148:151], v[116:119]
    ds_read_b64_tr_b16 v[138:139], v10 offset:50464
    s_waitcnt lgkmcnt(8)
    v_mfma_f32_16x16x32_bf16 v[80:83], v[120:123], a[72:75], v[80:83]
    ds_read_b64_tr_b16 v[140:141], v10 offset:57344
    v_mfma_f32_16x16x32_bf16 v[100:103], v[120:123], a[152:155], v[100:103]
    ds_read_b64_tr_b16 v[142:143], v10 offset:58624
    s_waitcnt lgkmcnt(8)
    v_mfma_f32_16x16x32_bf16 v[84:87], v[124:127], a[72:75], v[84:87]
    ds_read_b64_tr_b16 v[144:145], v10 offset:57352
    v_mfma_f32_16x16x32_bf16 v[104:107], v[124:127], a[152:155], v[104:107]
    ds_read_b64_tr_b16 v[146:147], v10 offset:58632
    s_waitcnt lgkmcnt(8)
    v_mfma_f32_16x16x32_bf16 v[88:91], v[128:131], a[72:75], v[88:91]
    ds_read_b64_tr_b16 v[148:149], v10 offset:57360
    v_mfma_f32_16x16x32_bf16 v[108:111], v[128:131], a[152:155], v[108:111]
    ds_read_b64_tr_b16 v[150:151], v10 offset:58640
    s_waitcnt lgkmcnt(8)
    v_mfma_f32_16x16x32_bf16 v[92:95], v[132:135], a[72:75], v[92:95]
    ds_read_b64_tr_b16 v[152:153], v10 offset:57368
    v_mfma_f32_16x16x32_bf16 v[112:115], v[132:135], a[152:155], v[112:115]
    ds_read_b64_tr_b16 v[154:155], v10 offset:58648
    s_waitcnt lgkmcnt(8)
    v_mfma_f32_16x16x32_bf16 v[96:99], v[136:139], a[72:75], v[96:99]
    ds_read_b64_tr_b16 v[156:157], v10 offset:57376
    v_mfma_f32_16x16x32_bf16 v[116:119], v[136:139], a[152:155], v[116:119]
    ds_read_b64_tr_b16 v[158:159], v10 offset:58656
    s_waitcnt vmcnt(0)
    s_waitcnt lgkmcnt(0)
    s_barrier
    v_mfma_f32_16x16x32_bf16 v[80:83], v[140:143], a[76:79], v[80:83]
    ds_read_b64_tr_b16 v[120:121], v11 offset:0
    v_mfma_f32_16x16x32_bf16 v[100:103], v[140:143], a[156:159], v[100:103]
    ds_read_b64_tr_b16 v[122:123], v11 offset:1280
    v_mfma_f32_16x16x32_bf16 v[84:87], v[144:147], a[76:79], v[84:87]
    ds_read_b64_tr_b16 v[124:125], v11 offset:8
    v_mfma_f32_16x16x32_bf16 v[104:107], v[144:147], a[156:159], v[104:107]
    ds_read_b64_tr_b16 v[126:127], v11 offset:1288
    v_mfma_f32_16x16x32_bf16 v[88:91], v[148:151], a[76:79], v[88:91]
    ds_read_b64_tr_b16 v[128:129], v11 offset:16
    v_mfma_f32_16x16x32_bf16 v[108:111], v[148:151], a[156:159], v[108:111]
    ds_read_b64_tr_b16 v[130:131], v11 offset:1296
    v_mfma_f32_16x16x32_bf16 v[92:95], v[152:155], a[76:79], v[92:95]
    ds_read_b64_tr_b16 v[132:133], v11 offset:24
    v_mfma_f32_16x16x32_bf16 v[112:115], v[152:155], a[156:159], v[112:115]
    ds_read_b64_tr_b16 v[134:135], v11 offset:1304
    v_mfma_f32_16x16x32_bf16 v[96:99], v[156:159], a[76:79], v[96:99]
    ds_read_b64_tr_b16 v[136:137], v11 offset:32
    v_mfma_f32_16x16x32_bf16 v[116:119], v[156:159], a[156:159], v[116:119]
    ds_read_b64_tr_b16 v[138:139], v11 offset:1312
    s_waitcnt lgkmcnt(8)
    v_mfma_f32_16x16x32_bf16 v[40:43], v[120:123], a[64:67], v[40:43]
    v_cvt_pk_bf16_f32 v160, v80, v81
    ds_read_b64_tr_b16 v[140:141], v11 offset:8192
    v_cvt_pk_bf16_f32 v161, v82, v83
    v_mfma_f32_16x16x32_bf16 v[60:63], v[120:123], a[144:147], v[60:63]
    v_cvt_pk_bf16_f32 v162, v84, v85
    ds_read_b64_tr_b16 v[142:143], v11 offset:9472
    v_cvt_pk_bf16_f32 v163, v86, v87
    s_waitcnt lgkmcnt(8)
    v_mfma_f32_16x16x32_bf16 v[44:47], v[124:127], a[64:67], v[44:47]
    ds_read_b64_tr_b16 v[144:145], v11 offset:8200
    v_cvt_pk_bf16_f32 v164, v88, v89
    v_mfma_f32_16x16x32_bf16 v[64:67], v[124:127], a[144:147], v[64:67]
    v_cvt_pk_bf16_f32 v165, v90, v91
    ds_read_b64_tr_b16 v[146:147], v11 offset:9480
    v_cvt_pk_bf16_f32 v166, v92, v93
    s_waitcnt lgkmcnt(8)
    v_mfma_f32_16x16x32_bf16 v[48:51], v[128:131], a[64:67], v[48:51]
    v_cvt_pk_bf16_f32 v167, v94, v95
    ds_read_b64_tr_b16 v[148:149], v11 offset:8208
    v_mfma_f32_16x16x32_bf16 v[68:71], v[128:131], a[144:147], v[68:71]
    v_cvt_pk_bf16_f32 v168, v96, v97
    ds_read_b64_tr_b16 v[150:151], v11 offset:9488
    v_cvt_pk_bf16_f32 v169, v98, v99
    s_waitcnt lgkmcnt(8)
    v_mfma_f32_16x16x32_bf16 v[52:55], v[132:135], a[64:67], v[52:55]
    v_mov_b32 v170, 0x3f80
    ds_read_b64_tr_b16 v[152:153], v11 offset:8216
    v_mov_b32 v171, 0
    v_mfma_f32_16x16x32_bf16 v[72:75], v[132:135], a[144:147], v[72:75]
    ds_read_b64_tr_b16 v[154:155], v11 offset:9496
    v_cvt_pk_bf16_f32 v172, v100, v101
    s_waitcnt lgkmcnt(8)
    v_mfma_f32_16x16x32_bf16 v[56:59], v[136:139], a[64:67], v[56:59]
    v_cvt_pk_bf16_f32 v173, v102, v103
    ds_read_b64_tr_b16 v[156:157], v11 offset:8224
    v_cvt_pk_bf16_f32 v174, v104, v105
    v_mfma_f32_16x16x32_bf16 v[76:79], v[136:139], a[144:147], v[76:79]
    v_cvt_pk_bf16_f32 v175, v106, v107
    ds_read_b64_tr_b16 v[158:159], v11 offset:9504
    s_waitcnt lgkmcnt(8)
    v_mfma_f32_16x16x32_bf16 v[40:43], v[140:143], a[68:71], v[40:43]
    v_cvt_pk_bf16_f32 v176, v108, v109
    ds_read_b64_tr_b16 v[120:121], v11 offset:16384
    v_mfma_f32_16x16x32_bf16 v[60:63], v[140:143], a[148:151], v[60:63]
    v_cvt_pk_bf16_f32 v177, v110, v111
    ds_read_b64_tr_b16 v[122:123], v11 offset:17664
    s_waitcnt lgkmcnt(8)
    v_mfma_f32_16x16x32_bf16 v[44:47], v[144:147], a[68:71], v[44:47]
    v_cvt_pk_bf16_f32 v178, v112, v113
    ds_read_b64_tr_b16 v[124:125], v11 offset:16392
    v_mfma_f32_16x16x32_bf16 v[64:67], v[144:147], a[148:151], v[64:67]
    v_cvt_pk_bf16_f32 v179, v114, v115
    ds_read_b64_tr_b16 v[126:127], v11 offset:17672
    s_waitcnt lgkmcnt(8)
    v_mfma_f32_16x16x32_bf16 v[48:51], v[148:151], a[68:71], v[48:51]
    v_cvt_pk_bf16_f32 v180, v116, v117
    ds_read_b64_tr_b16 v[128:129], v11 offset:16400
    v_mfma_f32_16x16x32_bf16 v[68:71], v[148:151], a[148:151], v[68:71]
    v_cvt_pk_bf16_f32 v181, v118, v119
    ds_read_b64_tr_b16 v[130:131], v11 offset:17680
    s_waitcnt lgkmcnt(8)
    v_mfma_f32_16x16x32_bf16 v[52:55], v[152:155], a[68:71], v[52:55]
    v_mov_b32 v182, 0x3f80
    ds_read_b64_tr_b16 v[132:133], v11 offset:16408
    v_mfma_f32_16x16x32_bf16 v[72:75], v[152:155], a[148:151], v[72:75]
    v_mov_b32 v183, 0
    ds_read_b64_tr_b16 v[134:135], v11 offset:17688
    s_waitcnt lgkmcnt(8)
    v_mfma_f32_16x16x32_bf16 v[56:59], v[156:159], a[68:71], v[56:59]
    v_lshrrev_b32 v254, 2, v38
    ds_read_b64_tr_b16 v[136:137], v11 offset:16416
    v_mfma_f32_16x16x32_bf16 v[76:79], v[156:159], a[148:151], v[76:79]
    v_mul_u32_u24 v254, 40, v254
    ds_read_b64_tr_b16 v[138:139], v11 offset:17696
    s_waitcnt lgkmcnt(8)
    v_mfma_f32_16x16x32_bf16 v[40:43], v[120:123], a[72:75], v[40:43]
    v_lshl_add_u32 v254, v37, 13, v254
    ds_read_b64_tr_b16 v[140:141], v11 offset:24576
    s_add_u32 s54, s72, 1024
    v_mfma_f32_16x16x32_bf16 v[60:63], v[120:123], a[152:155], v[60:63]
    v_and_b32 v255, 3, v1
    ds_read_b64_tr_b16 v[142:143], v11 offset:25856
    v_cmp_eq_u32 s[56:57], v255, v37
    s_waitcnt lgkmcnt(8)
    v_mfma_f32_16x16x32_bf16 v[44:47], v[124:127], a[72:75], v[44:47]
    ds_read_b64_tr_b16 v[144:145], v11 offset:24584
    v_mov_b32 v255, s54
    v_mfma_f32_16x16x32_bf16 v[64:67], v[124:127], a[152:155], v[64:67]
    v_cndmask_b32 v254, v255, v254, s[56:57]
    ds_read_b64_tr_b16 v[146:147], v11 offset:25864
    ds_read_b64_tr_b16 v[204:205], v254 offset:37888
    s_waitcnt lgkmcnt(9)
    v_mfma_f32_16x16x32_bf16 v[48:51], v[128:131], a[72:75], v[48:51]
    ds_read_b64_tr_b16 v[206:207], v254 offset:38048
    ds_read_b64_tr_b16 v[148:149], v11 offset:24592
    v_mfma_f32_16x16x32_bf16 v[68:71], v[128:131], a[152:155], v[68:71]
    ds_read_b64_tr_b16 v[208:209], v254 offset:38208
    ds_read_b64_tr_b16 v[150:151], v11 offset:25872
    ds_read_b64_tr_b16 v[210:211], v254 offset:38368
    s_waitcnt lgkmcnt(12)
    v_mfma_f32_16x16x32_bf16 v[52:55], v[132:135], a[72:75], v[52:55]
    ds_read_b64_tr_b16 v[212:213], v254 offset:38528
    ds_read_b64_tr_b16 v[152:153], v11 offset:24600
    ds_read_b64_tr_b16 v[214:215], v254 offset:37896
    v_mfma_f32_16x16x32_bf16 v[72:75], v[132:135], a[152:155], v[72:75]
    ds_read_b64_tr_b16 v[154:155], v11 offset:25880
    ds_read_b64_tr_b16 v[216:217], v254 offset:38056
    s_waitcnt lgkmcnt(15)
    v_mfma_f32_16x16x32_bf16 v[56:59], v[136:139], a[72:75], v[56:59]
    ds_read_b64_tr_b16 v[218:219], v254 offset:38216
    ds_read_b64_tr_b16 v[156:157], v11 offset:24608
    ds_read_b64_tr_b16 v[220:221], v254 offset:38376
    v_mfma_f32_16x16x32_bf16 v[76:79], v[136:139], a[152:155], v[76:79]
    ds_read_b64_tr_b16 v[222:223], v254 offset:38536
    ds_read_b64_tr_b16 v[158:159], v11 offset:25888
    s_waitcnt lgkmcnt(15)
    v_mfma_f32_16x16x32_bf16 v[40:43], v[140:143], a[76:79], v[40:43]
    ds_read_b64_tr_b16 v[224:225], v254 offset:37904
    ds_read_b64_tr_b16 v[226:227], v254 offset:38064
    v_mfma_f32_16x16x32_bf16 v[60:63], v[140:143], a[156:159], v[60:63]
    ds_read_b64_tr_b16 v[228:229], v254 offset:38224
    v_mfma_f32_16x16x32_bf16 v[44:47], v[144:147], a[76:79], v[44:47]
    ds_read_b64_tr_b16 v[230:231], v254 offset:38384
    ds_read_b64_tr_b16 v[232:233], v254 offset:38544
    v_mfma_f32_16x16x32_bf16 v[64:67], v[144:147], a[156:159], v[64:67]
    ds_read_b64_tr_b16 v[234:235], v254 offset:37912
    s_waitcnt lgkmcnt(15)
    v_mfma_f32_16x16x32_bf16 v[48:51], v[148:151], a[76:79], v[48:51]
    ds_read_b64_tr_b16 v[236:237], v254 offset:38072
    ds_read_b64_tr_b16 v[238:239], v254 offset:38232
    v_mfma_f32_16x16x32_bf16 v[68:71], v[148:151], a[156:159], v[68:71]
    ds_read_b64_tr_b16 v[240:241], v254 offset:38392
    s_waitcnt lgkmcnt(15)
    v_mfma_f32_16x16x32_bf16 v[52:55], v[152:155], a[76:79], v[52:55]
    ds_read_b64_tr_b16 v[242:243], v254 offset:38552
    ds_read_b64_tr_b16 v[244:245], v254 offset:37920
    v_mfma_f32_16x16x32_bf16 v[72:75], v[152:155], a[156:159], v[72:75]
    ds_read_b64_tr_b16 v[246:247], v254 offset:38080
    s_waitcnt lgkmcnt(12)
    v_mfma_f32_16x16x32_bf16 v[56:59], v[156:159], a[76:79], v[56:59]
    ds_read_b64_tr_b16 v[248:249], v254 offset:38240
    ds_read_b64_tr_b16 v[250:251], v254 offset:38400
    v_mfma_f32_16x16x32_bf16 v[76:79], v[156:159], a[156:159], v[76:79]
    ds_read_b64_tr_b16 v[252:253], v254 offset:38560
    s_waitcnt lgkmcnt(0)
    s_barrier
    v_cvt_pk_bf16_f32 v184, v40, v41
    v_cvt_pk_bf16_f32 v185, v42, v43
    v_cvt_pk_bf16_f32 v186, v44, v45
    v_cvt_pk_bf16_f32 v187, v46, v47
    v_cvt_pk_bf16_f32 v188, v48, v49
    v_cvt_pk_bf16_f32 v189, v50, v51
    v_cvt_pk_bf16_f32 v190, v52, v53
    v_cvt_pk_bf16_f32 v191, v54, v55
    v_cvt_pk_bf16_f32 v192, v56, v57
    v_cvt_pk_bf16_f32 v193, v58, v59
    v_mfma_f32_16x16x32_bf16 v[40:43], v[204:207], v[184:187], 0
    v_cvt_pk_bf16_f32 v194, v60, v61
    v_cvt_pk_bf16_f32 v195, v62, v63
    v_mfma_f32_16x16x32_bf16 v[44:47], v[214:217], v[184:187], 0
    v_cvt_pk_bf16_f32 v196, v64, v65
    v_mfma_f32_16x16x32_bf16 v[48:51], v[224:227], v[184:187], 0
    v_cvt_pk_bf16_f32 v197, v66, v67
    v_mfma_f32_16x16x32_bf16 v[52:55], v[234:237], v[184:187], 0
    v_cvt_pk_bf16_f32 v198, v68, v69
    v_cvt_pk_bf16_f32 v199, v70, v71
    v_mfma_f32_16x16x32_bf16 v[56:59], v[244:247], v[184:187], 0
    v_cvt_pk_bf16_f32 v200, v72, v73
    v_mfma_f32_16x16x32_bf16 v[40:43], v[208:211], v[188:191], v[40:43]
    v_cvt_pk_bf16_f32 v201, v74, v75
    v_mfma_f32_16x16x32_bf16 v[44:47], v[218:221], v[188:191], v[44:47]
    v_cvt_pk_bf16_f32 v202, v76, v77
    v_cvt_pk_bf16_f32 v203, v78, v79
    v_mfma_f32_16x16x32_bf16 v[48:51], v[228:231], v[188:191], v[48:51]
    s_mov_b32 s54, 0x3fb8aa3b
    v_mfma_f32_16x16x32_bf16 v[52:55], v[238:241], v[188:191], v[52:55]
    v_lshrrev_b32 v27, 1, v37
    v_mfma_f32_16x16x32_bf16 v[56:59], v[248:251], v[188:191], v[56:59]
    v_lshlrev_b32 v27, 16, v27
    v_and_b32 v28, 1, v37
    v_mfma_f32_16x16x16_bf16 v[40:43], v[212:213], v[192:193], v[40:43]
    v_mul_u32_u24 v28, 10240, v28
    v_mfma_f32_16x16x16_bf16 v[44:47], v[222:223], v[192:193], v[44:47]
    v_add3_u32 v27, v27, v28, v23
    v_mfma_f32_16x16x16_bf16 v[48:51], v[232:233], v[192:193], v[48:51]
    v_xor_b32 v28, 0x100, v27
    ds_write_b128 v25, v[160:163] offset:32768
    v_mfma_f32_16x16x16_bf16 v[52:55], v[242:243], v[192:193], v[52:55]
    ds_write_b128 v25, v[164:167] offset:34816
    v_mfma_f32_16x16x16_bf16 v[56:59], v[252:253], v[192:193], v[56:59]
    ds_write_b128 v25, v[168:171] offset:36864
    v_mfma_f32_16x16x32_bf16 v[60:63], v[204:207], v[194:197], 0
    v_mfma_f32_16x16x32_bf16 v[64:67], v[214:217], v[194:197], 0
    v_mfma_f32_16x16x32_bf16 v[68:71], v[224:227], v[194:197], 0
    v_mfma_f32_16x16x32_bf16 v[72:75], v[234:237], v[194:197], 0
    ds_write_b128 v26, v[172:175] offset:32768
    ds_write_b128 v26, v[176:179] offset:34816
    ds_write_b128 v26, v[180:183] offset:36864
    v_mfma_f32_16x16x32_bf16 v[76:79], v[244:247], v[194:197], 0
    v_max3_f32 v2, v40, v41, v42
    v_min3_f32 v4, v40, v41, v42
    v_mfma_f32_16x16x32_bf16 v[60:63], v[208:211], v[198:201], v[60:63]
    v_max3_f32 v2, v2, v43, v44
    v_min3_f32 v4, v4, v43, v44
    v_mfma_f32_16x16x32_bf16 v[64:67], v[218:221], v[198:201], v[64:67]
    v_max3_f32 v2, v2, v45, v46
    v_min3_f32 v4, v4, v45, v46
    v_mfma_f32_16x16x32_bf16 v[68:71], v[228:231], v[198:201], v[68:71]
    v_max3_f32 v2, v2, v47, v48
    v_min3_f32 v4, v4, v47, v48
    v_mfma_f32_16x16x32_bf16 v[72:75], v[238:241], v[198:201], v[72:75]
    v_max3_f32 v2, v2, v49, v50
    v_min3_f32 v4, v4, v49, v50
    v_mfma_f32_16x16x32_bf16 v[76:79], v[248:251], v[198:201], v[76:79]
    v_max3_f32 v2, v2, v51, v52
    v_min3_f32 v4, v4, v51, v52
    v_mfma_f32_16x16x16_bf16 v[60:63], v[212:213], v[202:203], v[60:63]
    v_max3_f32 v2, v2, v53, v54
    v_min3_f32 v4, v4, v53, v54
    v_mfma_f32_16x16x16_bf16 v[64:67], v[222:223], v[202:203], v[64:67]
    v_max3_f32 v2, v2, v55, v56
    v_min3_f32 v4, v4, v55, v56
    v_mfma_f32_16x16x16_bf16 v[68:71], v[232:233], v[202:203], v[68:71]
    v_max3_f32 v2, v2, v57, v58
    v_min3_f32 v4, v4, v57, v58
    v_mfma_f32_16x16x16_bf16 v[72:75], v[242:243], v[202:203], v[72:75]
    v_max_f32 v2, v2, v59
    v_min_f32 v4, v4, v59
    v_mfma_f32_16x16x16_bf16 v[76:79], v[252:253], v[202:203], v[76:79]
    v_mul_f32 v2, 0xbfb8aa3b, v2
    v_mul_f32 v4, s54, v4
    v_pk_fma_f32 v[204:205], v[40:41], s[54:55], v[2:3] op_sel_hi:[1,0,0]
    v_pk_fma_f32 v[224:225], v[40:41], s[54:55], v[4:5] op_sel_hi:[1,0,0] neg_lo:[1,0,0] neg_hi:[1,0,0]
    v_pk_fma_f32 v[206:207], v[42:43], s[54:55], v[2:3] op_sel_hi:[1,0,0]
    v_pk_fma_f32 v[226:227], v[42:43], s[54:55], v[4:5] op_sel_hi:[1,0,0] neg_lo:[1,0,0] neg_hi:[1,0,0]
    v_pk_fma_f32 v[208:209], v[44:45], s[54:55], v[2:3] op_sel_hi:[1,0,0]
    v_pk_fma_f32 v[228:229], v[44:45], s[54:55], v[4:5] op_sel_hi:[1,0,0] neg_lo:[1,0,0] neg_hi:[1,0,0]
    v_pk_fma_f32 v[210:211], v[46:47], s[54:55], v[2:3] op_sel_hi:[1,0,0]
    v_pk_fma_f32 v[230:231], v[46:47], s[54:55], v[4:5] op_sel_hi:[1,0,0] neg_lo:[1,0,0] neg_hi:[1,0,0]
    v_pk_fma_f32 v[212:213], v[48:49], s[54:55], v[2:3] op_sel_hi:[1,0,0]
    v_pk_fma_f32 v[232:233], v[48:49], s[54:55], v[4:5] op_sel_hi:[1,0,0] neg_lo:[1,0,0] neg_hi:[1,0,0]
    v_pk_fma_f32 v[214:215], v[50:51], s[54:55], v[2:3] op_sel_hi:[1,0,0]
    v_pk_fma_f32 v[234:235], v[50:51], s[54:55], v[4:5] op_sel_hi:[1,0,0] neg_lo:[1,0,0] neg_hi:[1,0,0]
    v_pk_fma_f32 v[216:217], v[52:53], s[54:55], v[2:3] op_sel_hi:[1,0,0]
    v_pk_fma_f32 v[236:237], v[52:53], s[54:55], v[4:5] op_sel_hi:[1,0,0] neg_lo:[1,0,0] neg_hi:[1,0,0]
    v_pk_fma_f32 v[218:219], v[54:55], s[54:55], v[2:3] op_sel_hi:[1,0,0]
    v_pk_fma_f32 v[238:239], v[54:55], s[54:55], v[4:5] op_sel_hi:[1,0,0] neg_lo:[1,0,0] neg_hi:[1,0,0]
    v_pk_fma_f32 v[220:221], v[56:57], s[54:55], v[2:3] op_sel_hi:[1,0,0]
    v_pk_fma_f32 v[240:241], v[56:57], s[54:55], v[4:5] op_sel_hi:[1,0,0] neg_lo:[1,0,0] neg_hi:[1,0,0]
    v_pk_fma_f32 v[222:223], v[58:59], s[54:55], v[2:3] op_sel_hi:[1,0,0]
    v_pk_fma_f32 v[242:243], v[58:59], s[54:55], v[4:5] op_sel_hi:[1,0,0] neg_lo:[1,0,0] neg_hi:[1,0,0]
    v_exp_f32 v204, v204
    v_exp_f32 v205, v205
    v_exp_f32 v206, v206
    v_exp_f32 v207, v207
    v_exp_f32 v208, v208
    v_exp_f32 v209, v209
    v_exp_f32 v210, v210
    v_exp_f32 v211, v211
    v_exp_f32 v212, v212
    v_exp_f32 v213, v213
    v_exp_f32 v214, v214
    v_exp_f32 v215, v215
    v_exp_f32 v216, v216
    v_exp_f32 v217, v217
    v_exp_f32 v218, v218
    v_exp_f32 v219, v219
    v_exp_f32 v220, v220
    v_exp_f32 v221, v221
    v_exp_f32 v222, v222
    v_exp_f32 v223, v223
    v_exp_f32 v224, v224
    v_exp_f32 v225, v225
    v_exp_f32 v226, v226
    v_exp_f32 v227, v227
    v_exp_f32 v228, v228
    v_exp_f32 v229, v229
    v_exp_f32 v230, v230
    v_exp_f32 v231, v231
    v_exp_f32 v232, v232
    v_exp_f32 v233, v233
    v_exp_f32 v234, v234
    v_exp_f32 v235, v235
    v_exp_f32 v236, v236
    v_exp_f32 v237, v237
    v_exp_f32 v238, v238
    v_exp_f32 v239, v239
    v_exp_f32 v240, v240
    v_exp_f32 v241, v241
    v_exp_f32 v242, v242
    v_exp_f32 v243, v243
    s_lshl_b32 s78, s38, 6
    v_lshlrev_b32 v31, 2, v1
    v_add_u32 v31, s78, v31
    s_lshl_b32 s78, s36, 4
    s_lshr_b32 s79, s37, 1
    s_lshl_b32 s79, s79, 2
    s_add_u32 s78, s78, s79
    v_writelane_b32 v31, s78, 16
    s_mov_b64 exec, 0x1ffff
    buffer_load_dword v39, v31, s[20:23], 0 offen sc1
    s_mov_b64 exec, -1
    v_pk_add_f32 v[248:249], v[204:205], v[206:207]
    v_pk_add_f32 v[250:251], v[224:225], v[226:227]
    v_pk_add_f32 v[248:249], v[248:249], v[208:209]
    v_pk_add_f32 v[250:251], v[250:251], v[228:229]
    v_pk_add_f32 v[248:249], v[248:249], v[210:211]
    v_pk_add_f32 v[250:251], v[250:251], v[230:231]
    v_pk_add_f32 v[248:249], v[248:249], v[212:213]
    v_pk_add_f32 v[250:251], v[250:251], v[232:233]
    v_pk_add_f32 v[248:249], v[248:249], v[214:215]
    v_pk_add_f32 v[250:251], v[250:251], v[234:235]
    v_pk_add_f32 v[248:249], v[248:249], v[216:217]
    v_pk_add_f32 v[250:251], v[250:251], v[236:237]
    v_pk_add_f32 v[248:249], v[248:249], v[218:219]
    v_pk_add_f32 v[250:251], v[250:251], v[238:239]
    v_pk_add_f32 v[248:249], v[248:249], v[220:221]
    v_pk_add_f32 v[250:251], v[250:251], v[240:241]
    v_pk_add_f32 v[248:249], v[248:249], v[222:223]
    v_pk_add_f32 v[250:251], v[250:251], v[242:243]
    v_add_f32 v248, v248, v249
    v_add_f32 v250, v250, v251
    v_rcp_f32 v248, v248
    v_rcp_f32 v250, v250
    v_pk_mul_f32 v[204:205], v[204:205], v[248:249] op_sel_hi:[1,0]
    v_pk_mul_f32 v[224:225], v[224:225], v[250:251] op_sel_hi:[1,0]
    v_pk_mul_f32 v[206:207], v[206:207], v[248:249] op_sel_hi:[1,0]
    v_pk_mul_f32 v[226:227], v[226:227], v[250:251] op_sel_hi:[1,0]
    v_pk_mul_f32 v[208:209], v[208:209], v[248:249] op_sel_hi:[1,0]
    v_pk_mul_f32 v[228:229], v[228:229], v[250:251] op_sel_hi:[1,0]
    v_pk_mul_f32 v[210:211], v[210:211], v[248:249] op_sel_hi:[1,0]
    v_pk_mul_f32 v[230:231], v[230:231], v[250:251] op_sel_hi:[1,0]
    v_pk_mul_f32 v[212:213], v[212:213], v[248:249] op_sel_hi:[1,0]
    v_pk_mul_f32 v[232:233], v[232:233], v[250:251] op_sel_hi:[1,0]
    v_pk_mul_f32 v[214:215], v[214:215], v[248:249] op_sel_hi:[1,0]
    v_pk_mul_f32 v[234:235], v[234:235], v[250:251] op_sel_hi:[1,0]
    v_pk_mul_f32 v[216:217], v[216:217], v[248:249] op_sel_hi:[1,0]
    v_pk_mul_f32 v[236:237], v[236:237], v[250:251] op_sel_hi:[1,0]
    v_pk_mul_f32 v[218:219], v[218:219], v[248:249] op_sel_hi:[1,0]
    v_pk_mul_f32 v[238:239], v[238:239], v[250:251] op_sel_hi:[1,0]
    v_pk_mul_f32 v[220:221], v[220:221], v[248:249] op_sel_hi:[1,0]
    v_pk_mul_f32 v[240:241], v[240:241], v[250:251] op_sel_hi:[1,0]
    v_pk_mul_f32 v[222:223], v[222:223], v[248:249] op_sel_hi:[1,0]
    v_pk_mul_f32 v[242:243], v[242:243], v[250:251] op_sel_hi:[1,0]
    v_cvt_pk_bf16_f32 v184, v204, v205
    v_cvt_pk_bf16_f32 v185, v206, v207
    v_cvt_pk_bf16_f32 v186, v208, v209
    v_cvt_pk_bf16_f32 v187, v210, v211
    ds_write_b128 v27, v[184:187] offset:0
    v_cvt_pk_bf16_f32 v188, v212, v213
    v_cvt_pk_bf16_f32 v189, v214, v215
    v_cvt_pk_bf16_f32 v190, v216, v217
    v_cvt_pk_bf16_f32 v191, v218, v219
    ds_write_b128 v27, v[188:191] offset:2048
    v_cvt_pk_bf16_f32 v192, v220, v221
    v_cvt_pk_bf16_f32 v193, v222, v223
    v_cvt_pk_bf16_f32 v194, v224, v225
    v_cvt_pk_bf16_f32 v195, v226, v227
    ds_write_b128 v27, v[192:195] offset:4096
    v_cvt_pk_bf16_f32 v196, v228, v229
    v_cvt_pk_bf16_f32 v197, v230, v231
    v_cvt_pk_bf16_f32 v198, v232, v233
    v_cvt_pk_bf16_f32 v199, v234, v235
    ds_write_b128 v27, v[196:199] offset:6144
    v_cvt_pk_bf16_f32 v200, v236, v237
    v_cvt_pk_bf16_f32 v201, v238, v239
    v_cvt_pk_bf16_f32 v202, v240, v241
    v_cvt_pk_bf16_f32 v203, v242, v243
    ds_write_b128 v27, v[200:203] offset:8192
    v_max3_f32 v2, v60, v61, v62
    v_min3_f32 v4, v60, v61, v62
    v_max3_f32 v2, v2, v63, v64
    v_min3_f32 v4, v4, v63, v64
    v_max3_f32 v2, v2, v65, v66
    s_waitcnt vmcnt(0)
    s_mov_b64 exec, 0x1ffff
    v_cmp_gt_u32 vcc, 2, v39
    s_mov_b64 exec, -1
    s_nop 3
    s_cbranch_vccnz L_kpoll1
L_kpoll1_ok:
    s_lshl_b32 s46, s36, 3
    s_add_u32 s46, s46, s37
    s_lshl_b32 s47, s46, 6
    s_add_u32 s47, s47, 249856
    v_mov_b32 v31, 0
    buffer_load_dword v39, v31, s[16:19], s47 offen sc1
    v_and_b32 v5, 31, v1
    v_cmp_lt_u32 vcc, 20, v5
    v_lshrrev_b32 v6, 5, v1
    v_mul_u32_u24 v6, 336, v6
    v_lshl_add_u32 v5, v5, 4, v6
    v_add_u32 v5, 131072, v5
    v_mov_b32 v6, 0x80000000
L_padk2:
L_pd5623:
    s_cbranch_execz L_pd7689
    v_cndmask_b32 v9, v5, v6, vcc
    v_min3_f32 v4, v4, v65, v66
    s_add_u32 s80, s69, 0
    s_and_b32 s80, s80, 3
    s_lshl_b32 s81, s38, 2
    s_add_u32 s80, s80, s81
    s_lshl_b32 s81, s80, 10
    s_add_u32 s81, s81, 65536
    s_mul_i32 s82, s80, 5376
    s_add_u32 s83, s82, 2688
    s_lshl_b32 s80, s80, 12
    v_max3_f32 v2, v2, v67, v68
    v_min3_f32 v4, v4, v67, v68
    v_max3_f32 v2, v2, v69, v70
    v_min3_f32 v4, v4, v69, v70
    v_max3_f32 v2, v2, v71, v72
    buffer_load_dwordx4 a[160:163], v36, s[16:19], s80 offen offset:0 sc1
    v_min3_f32 v4, v4, v71, v72
    v_max3_f32 v2, v2, v73, v74
    v_min3_f32 v4, v4, v73, v74
    v_max3_f32 v2, v2, v75, v76
    v_min3_f32 v4, v4, v75, v76
    buffer_load_dwordx4 a[176:179], v36, s[16:19], s81 offen sc1
    v_max3_f32 v2, v2, v77, v78
    v_min3_f32 v4, v4, v77, v78
    v_max_f32 v2, v2, v79
    v_min_f32 v4, v4, v79
    v_mul_f32 v2, 0xbfb8aa3b, v2
    buffer_load_dwordx4 a[180:183], v9, s[16:19], s82 offen offset:0 sc1
    v_mul_f32 v4, s54, v4
    v_pk_fma_f32 v[204:205], v[60:61], s[54:55], v[2:3] op_sel_hi:[1,0,0]
    v_pk_fma_f32 v[224:225], v[60:61], s[54:55], v[4:5] op_sel_hi:[1,0,0] neg_lo:[1,0,0] neg_hi:[1,0,0]
    v_pk_fma_f32 v[206:207], v[62:63], s[54:55], v[2:3] op_sel_hi:[1,0,0]
    v_pk_fma_f32 v[226:227], v[62:63], s[54:55], v[4:5] op_sel_hi:[1,0,0] neg_lo:[1,0,0] neg_hi:[1,0,0]
    buffer_load_dwordx4 a[184:187], v9, s[16:19], s82 offen offset:672 sc1
    v_pk_fma_f32 v[208:209], v[64:65], s[54:55], v[2:3] op_sel_hi:[1,0,0]
    v_pk_fma_f32 v[228:229], v[64:65], s[54:55], v[4:5] op_sel_hi:[1,0,0] neg_lo:[1,0,0] neg_hi:[1,0,0]
    v_pk_fma_f32 v[210:211], v[66:67], s[54:55], v[2:3] op_sel_hi:[1,0,0]
    v_pk_fma_f32 v[230:231], v[66:67], s[54:55], v[4:5] op_sel_hi:[1,0,0] neg_lo:[1,0,0] neg_hi:[1,0,0]
    v_pk_fma_f32 v[212:213], v[68:69], s[54:55], v[2:3] op_sel_hi:[1,0,0]
    buffer_load_dwordx4 a[164:167], v36, s[16:19], s80 offen offset:1024 sc1
    v_pk_fma_f32 v[232:233], v[68:69], s[54:55], v[4:5] op_sel_hi:[1,0,0] neg_lo:[1,0,0] neg_hi:[1,0,0]
    v_pk_fma_f32 v[214:215], v[70:71], s[54:55], v[2:3] op_sel_hi:[1,0,0]
    v_pk_fma_f32 v[234:235], v[70:71], s[54:55], v[4:5] op_sel_hi:[1,0,0] neg_lo:[1,0,0] neg_hi:[1,0,0]
    v_pk_fma_f32 v[216:217], v[72:73], s[54:55], v[2:3] op_sel_hi:[1,0,0]
    v_pk_fma_f32 v[236:237], v[72:73], s[54:55], v[4:5] op_sel_hi:[1,0,0] neg_lo:[1,0,0] neg_hi:[1,0,0]
    buffer_load_dwordx4 a[188:191], v9, s[16:19], s82 offen offset:1344 sc1
    v_pk_fma_f32 v[218:219], v[74:75], s[54:55], v[2:3] op_sel_hi:[1,0,0]
    v_pk_fma_f32 v[238:239], v[74:75], s[54:55], v[4:5] op_sel_hi:[1,0,0] neg_lo:[1,0,0] neg_hi:[1,0,0]
    v_pk_fma_f32 v[220:221], v[76:77], s[54:55], v[2:3] op_sel_hi:[1,0,0]
    v_pk_fma_f32 v[240:241], v[76:77], s[54:55], v[4:5] op_sel_hi:[1,0,0] neg_lo:[1,0,0] neg_hi:[1,0,0]
    v_pk_fma_f32 v[222:223], v[78:79], s[54:55], v[2:3] op_sel_hi:[1,0,0]
    s_waitcnt vmcnt(6)
    s_mov_b64 exec, 1
    v_cmp_ne_u32 vcc, 1, v39
    s_mov_b64 exec, -1
    s_nop 3
    s_cbranch_vccnz L_pollq
L_pollq_ok:
    s_mul_i32 s46, s46, 12288
    s_mul_i32 s47, s38, 3072
    s_add_u32 s46, s46, s47
    s_add_u32 s46, s46, 11534336
    s_add_u32 m0, s47, 131072
    s_nop 0
    buffer_load_dwordx4 v36, s[16:19], s46 offen offset:0 sc1 lds
    buffer_load_dwordx4 v36, s[16:19], s46 offen offset:1024 sc1 lds
    buffer_load_dwordx4 v36, s[16:19], s46 offen offset:2048 sc1 lds
    v_pk_fma_f32 v[242:243], v[78:79], s[54:55], v[4:5] op_sel_hi:[1,0,0] neg_lo:[1,0,0] neg_hi:[1,0,0]
    buffer_load_dwordx4 a[192:195], v9, s[16:19], s82 offen offset:2016 sc1
    v_exp_f32 v204, v204
    v_exp_f32 v205, v205
    v_exp_f32 v206, v206
    v_exp_f32 v207, v207
    v_exp_f32 v208, v208
    v_exp_f32 v209, v209
    v_exp_f32 v210, v210
    v_exp_f32 v211, v211
    v_exp_f32 v212, v212
    buffer_load_dwordx4 a[168:171], v36, s[16:19], s80 offen offset:2048 sc1
    v_exp_f32 v213, v213
    v_exp_f32 v214, v214
    v_exp_f32 v215, v215
    v_exp_f32 v216, v216
    v_exp_f32 v217, v217
    v_exp_f32 v218, v218
    v_exp_f32 v219, v219
    v_exp_f32 v220, v220
    v_exp_f32 v221, v221
    buffer_load_dwordx4 a[196:199], v9, s[16:19], s83 offen offset:0 sc1
    v_exp_f32 v222, v222
    v_exp_f32 v223, v223
    v_exp_f32 v224, v224
    v_exp_f32 v225, v225
    v_exp_f32 v226, v226
    v_exp_f32 v227, v227
    v_exp_f32 v228, v228
    v_exp_f32 v229, v229
    v_exp_f32 v230, v230
    buffer_load_dwordx4 a[200:203], v9, s[16:19], s83 offen offset:672 sc1
    v_exp_f32 v231, v231
    v_exp_f32 v232, v232
    v_exp_f32 v233, v233
    v_exp_f32 v234, v234
    v_exp_f32 v235, v235
    v_exp_f32 v236, v236
    v_exp_f32 v237, v237
    v_exp_f32 v238, v238
    v_exp_f32 v239, v239
    buffer_load_dwordx4 a[172:175], v36, s[16:19], s80 offen offset:3072 sc1
    v_exp_f32 v240, v240
    v_exp_f32 v241, v241
    v_exp_f32 v242, v242
    v_exp_f32 v243, v243
    v_pk_add_f32 v[248:249], v[204:205], v[206:207]
    v_pk_add_f32 v[250:251], v[224:225], v[226:227]
    v_pk_add_f32 v[248:249], v[248:249], v[208:209]
    v_pk_add_f32 v[250:251], v[250:251], v[228:229]
    v_pk_add_f32 v[248:249], v[248:249], v[210:211]
    v_pk_add_f32 v[250:251], v[250:251], v[230:231]
    v_pk_add_f32 v[248:249], v[248:249], v[212:213]
    v_pk_add_f32 v[250:251], v[250:251], v[232:233]
    buffer_load_dwordx4 a[204:207], v9, s[16:19], s83 offen offset:1344 sc1
    v_pk_add_f32 v[248:249], v[248:249], v[214:215]
    v_pk_add_f32 v[250:251], v[250:251], v[234:235]
    v_pk_add_f32 v[248:249], v[248:249], v[216:217]
    v_pk_add_f32 v[250:251], v[250:251], v[236:237]
    v_pk_add_f32 v[248:249], v[248:249], v[218:219]
    v_pk_add_f32 v[250:251], v[250:251], v[238:239]
    v_pk_add_f32 v[248:249], v[248:249], v[220:221]
    v_pk_add_f32 v[250:251], v[250:251], v[240:241]
    v_pk_add_f32 v[248:249], v[248:249], v[222:223]
    v_pk_add_f32 v[250:251], v[250:251], v[242:243]
    v_add_f32 v248, v248, v249
    v_add_f32 v250, v250, v251
    buffer_load_dwordx4 a[208:211], v9, s[16:19], s83 offen offset:2016 sc1
    v_rcp_f32 v248, v248
    v_rcp_f32 v250, v250
    v_pk_mul_f32 v[204:205], v[204:205], v[248:249] op_sel_hi:[1,0]
    v_pk_mul_f32 v[224:225], v[224:225], v[250:251] op_sel_hi:[1,0]
    v_pk_mul_f32 v[206:207], v[206:207], v[248:249] op_sel_hi:[1,0]
    v_pk_mul_f32 v[226:227], v[226:227], v[250:251] op_sel_hi:[1,0]
    v_pk_mul_f32 v[208:209], v[208:209], v[248:249] op_sel_hi:[1,0]
    v_pk_mul_f32 v[228:229], v[228:229], v[250:251] op_sel_hi:[1,0]
    v_pk_mul_f32 v[210:211], v[210:211], v[248:249] op_sel_hi:[1,0]
    v_pk_mul_f32 v[230:231], v[230:231], v[250:251] op_sel_hi:[1,0]
    v_pk_mul_f32 v[212:213], v[212:213], v[248:249] op_sel_hi:[1,0]
    v_lshrrev_b32 v10, 5, v1
    v_and_b32 v11, 31, v1
    v_lshlrev_b32 v5, 4, v11
    v_add_u32 v5, 131072, v5
    v_lshl_add_u32 v16, v10, 11, v5
    v_lshl_add_u32 v17, v10, 3, v5
    v_xor_b32 v18, 8, v17
    s_waitcnt vmcnt(7)
    s_waitcnt lgkmcnt(0)
    s_barrier
    v_pk_mul_f32 v[232:233], v[232:233], v[250:251] op_sel_hi:[1,0]
    ds_read_b128 v[120:123], v16 offset:0
    v_pk_mul_f32 v[214:215], v[214:215], v[248:249] op_sel_hi:[1,0]
    v_pk_mul_f32 v[234:235], v[234:235], v[250:251] op_sel_hi:[1,0]
    v_pk_mul_f32 v[216:217], v[216:217], v[248:249] op_sel_hi:[1,0]
    ds_read_b64 v[124:125], v17 offset:4096
    v_pk_mul_f32 v[236:237], v[236:237], v[250:251] op_sel_hi:[1,0]
    v_pk_mul_f32 v[218:219], v[218:219], v[248:249] op_sel_hi:[1,0]
    v_pk_mul_f32 v[238:239], v[238:239], v[250:251] op_sel_hi:[1,0]
    ds_read_b64 v[126:127], v18 offset:4096
    v_pk_mul_f32 v[220:221], v[220:221], v[248:249] op_sel_hi:[1,0]
    v_pk_mul_f32 v[240:241], v[240:241], v[250:251] op_sel_hi:[1,0]
    v_pk_mul_f32 v[222:223], v[222:223], v[248:249] op_sel_hi:[1,0]
    ds_read_b128 v[128:131], v16 offset:512
    v_pk_mul_f32 v[242:243], v[242:243], v[250:251] op_sel_hi:[1,0]
    v_cvt_pk_bf16_f32 v40, v204, v205
    v_cvt_pk_bf16_f32 v41, v206, v207
    ds_read_b64 v[132:133], v17 offset:4608
    v_cvt_pk_bf16_f32 v42, v208, v209
    v_cvt_pk_bf16_f32 v43, v210, v211
    ds_write_b128 v28, v[40:43] offset:0
    ds_read_b64 v[134:135], v18 offset:4608
    v_cvt_pk_bf16_f32 v44, v212, v213
    v_cvt_pk_bf16_f32 v45, v214, v215
    v_cvt_pk_bf16_f32 v46, v216, v217
    ds_read_b128 v[136:139], v16 offset:6144
    v_cvt_pk_bf16_f32 v47, v218, v219
    ds_write_b128 v28, v[44:47] offset:2048
    v_cvt_pk_bf16_f32 v48, v220, v221
    ds_read_b64 v[140:141], v17 offset:10240
    v_cvt_pk_bf16_f32 v49, v222, v223
    v_cvt_pk_bf16_f32 v50, v224, v225
    v_cvt_pk_bf16_f32 v51, v226, v227
    ds_read_b64 v[142:143], v18 offset:10240
    ds_write_b128 v28, v[48:51] offset:4096
    v_cvt_pk_bf16_f32 v52, v228, v229
    v_cvt_pk_bf16_f32 v53, v230, v231
    ds_read_b128 v[144:147], v16 offset:6656
    v_cvt_pk_bf16_f32 v54, v232, v233
    v_cvt_pk_bf16_f32 v55, v234, v235
    ds_write_b128 v28, v[52:55] offset:6144
    ds_read_b64 v[148:149], v17 offset:10752
    v_cvt_pk_bf16_f32 v56, v236, v237
    v_cvt_pk_bf16_f32 v57, v238, v239
    v_cvt_pk_bf16_f32 v58, v240, v241
    ds_read_b64 v[150:151], v18 offset:10752
    v_cvt_pk_bf16_f32 v59, v242, v243
    ds_write_b128 v28, v[56:59] offset:8192
    s_waitcnt lgkmcnt(15)
    v_mfma_f32_32x32x16_bf16 v[40:55], a[160:163], v[120:123], 0
    s_nop 9
    v_mfma_f32_32x32x8_bf16 v[40:55], a[176:177], v[124:125], v[40:55]
    s_waitcnt lgkmcnt(13)
    v_mfma_f32_32x32x16_bf16 v[56:71], a[160:163], v[128:131], 0
    s_add_u32 s80, s69, 1
    s_and_b32 s80, s80, 3
    s_nop 7
    v_exp_f32 v40, v40
    v_exp_f32 v41, v41
    v_exp_f32 v42, v42
    v_exp_f32 v43, v43
    v_cvt_pk_bf16_f32 v72, v40, v41
    v_exp_f32 v44, v44
    v_exp_f32 v45, v45
    v_exp_f32 v46, v46
    v_exp_f32 v47, v47
    v_cvt_pk_bf16_f32 v73, v42, v43
    v_cvt_pk_bf16_f32 v74, v44, v45
    s_waitcnt lgkmcnt(12)
    v_mfma_f32_32x32x8_bf16 v[56:71], a[176:177], v[132:133], v[56:71]
    s_lshl_b32 s81, s38, 2
    v_exp_f32 v48, v48
    v_exp_f32 v49, v49
    v_exp_f32 v50, v50
    v_exp_f32 v51, v51
    v_cvt_pk_bf16_f32 v75, v46, v47
    v_cvt_pk_bf16_f32 v76, v48, v49
    v_exp_f32 v52, v52
    v_exp_f32 v53, v53
    v_exp_f32 v54, v54
    v_exp_f32 v55, v55
    v_cvt_pk_bf16_f32 v77, v50, v51
    v_cvt_pk_bf16_f32 v78, v52, v53
    v_cvt_pk_bf16_f32 v79, v54, v55
    s_waitcnt lgkmcnt(0)
    s_barrier
    v_mfma_f32_32x32x16_bf16 v[40:55], a[160:163], v[136:139], 0
    s_add_u32 s80, s80, s81
    s_lshl_b32 s81, s80, 10
    v_exp_f32 v56, v56
    v_and_b32 v186, 3, v1
    v_add_u32 v12, 0x1000, v36
    v_exp_f32 v57, v57
    v_lshrrev_b32 v187, 2, v38
    v_add_u32 v13, 0x2000, v36
    v_exp_f32 v58, v58
    v_lshl_add_u32 v187, v37, 3, v187
    v_mov_b32 v34, 1
    v_exp_f32 v59, v59
    v_lshlrev_b32 v187, 4, v187
    v_cvt_pk_bf16_f32 v80, v56, v57
    v_mfma_f32_32x32x16_bf16 v[192:207], a[180:183], v[72:75], 0
    s_add_u32 s81, s81, 65536
    v_exp_f32 v60, v60
    v_lshrrev_b32 v188, 1, v186
    v_exp_f32 v61, v61
    v_lshl_add_u32 v187, v188, 11, v187
    v_exp_f32 v62, v62
    v_and_b32 v188, 1, v186
    v_exp_f32 v63, v63
    v_lshl_add_u32 v187, v188, 3, v187
    v_cvt_pk_bf16_f32 v81, v58, v59
    v_cvt_pk_bf16_f32 v82, v60, v61
    v_mfma_f32_32x32x8_bf16 v[40:55], a[176:177], v[140:141], v[40:55]
    v_exp_f32 v64, v64
    v_exp_f32 v65, v65
    v_exp_f32 v66, v66
    v_exp_f32 v67, v67
    v_cvt_pk_bf16_f32 v83, v62, v63
    v_cvt_pk_bf16_f32 v84, v64, v65
    v_mfma_f32_32x32x16_bf16 v[192:207], a[184:187], v[76:79], v[192:207]
    v_exp_f32 v68, v68
    v_exp_f32 v69, v69
    v_exp_f32 v70, v70
    v_exp_f32 v71, v71
    v_cvt_pk_bf16_f32 v85, v66, v67
    v_cvt_pk_bf16_f32 v86, v68, v69
    v_cvt_pk_bf16_f32 v87, v70, v71
    v_mfma_f32_32x32x16_bf16 v[56:71], a[160:163], v[144:147], 0
    s_mul_i32 s82, s80, 5376
    s_add_u32 s83, s82, 2688
    v_exp_f32 v40, v40
    v_mov_b32 v8, 0
    v_exp_f32 v41, v41
    v_exp_f32 v42, v42
    v_exp_f32 v43, v43
    v_cvt_pk_bf16_f32 v72, v40, v41
    v_mfma_f32_32x32x16_bf16 v[208:223], a[180:183], v[80:83], 0
    s_lshl_b32 s80, s80, 12
    s_lshr_b32 s62, s38, 1
    v_exp_f32 v44, v44
    v_exp_f32 v45, v45
    v_exp_f32 v46, v46
    v_exp_f32 v47, v47
    v_cvt_pk_bf16_f32 v73, v42, v43
    v_cvt_pk_bf16_f32 v74, v44, v45
    v_mfma_f32_32x32x8_bf16 v[56:71], a[176:177], v[148:149], v[56:71]
    s_lshl_b32 s62, s62, 16
    v_exp_f32 v48, v48
    v_exp_f32 v49, v49
    v_exp_f32 v50, v50
    v_exp_f32 v51, v51
    v_cvt_pk_bf16_f32 v75, v46, v47
    v_cvt_pk_bf16_f32 v76, v48, v49
    v_mfma_f32_32x32x16_bf16 v[208:223], a[184:187], v[84:87], v[208:223]
    s_and_b32 s63, s38, 1
    s_mul_i32 s63, s63, 10240
    v_exp_f32 v52, v52
    v_exp_f32 v53, v53
    v_exp_f32 v54, v54
    v_exp_f32 v55, v55
    v_cvt_pk_bf16_f32 v77, v50, v51
    v_cvt_pk_bf16_f32 v78, v52, v53
    v_cvt_pk_bf16_f32 v79, v54, v55
    s_add_u32 s62, s62, s63
    v_add_u32 v184, s62, v187
    s_mul_i32 s62, s38, 6144
    s_add_u32 s62, s62, 32768
    v_mfma_f32_32x32x16_bf16 v[40:55], a[164:167], v[120:123], 0
    buffer_load_dwordx4 a[0:3], v36, s[16:19], s80 offen offset:0 sc1
    v_exp_f32 v56, v56
    v_add_u32 v185, s62, v187
    v_exp_f32 v57, v57
    v_exp_f32 v58, v58
    v_exp_f32 v59, v59
    v_cvt_pk_bf16_f32 v80, v56, v57
    v_mfma_f32_32x32x16_bf16 v[224:239], a[180:183], v[72:75], 0
    buffer_load_dwordx4 a[16:19], v36, s[16:19], s81 offen sc1
    v_exp_f32 v60, v60
    v_exp_f32 v61, v61
    v_exp_f32 v62, v62
    v_exp_f32 v63, v63
    v_cvt_pk_bf16_f32 v81, v58, v59
    v_cvt_pk_bf16_f32 v82, v60, v61
    v_mfma_f32_32x32x8_bf16 v[40:55], a[176:177], v[126:127], v[40:55]
    s_mul_i32 s76, s38, 3072
    v_exp_f32 v64, v64
    v_add_u32 v14, s76, v36
    v_exp_f32 v65, v65
    v_add_u32 v15, 69632, v14
    v_exp_f32 v66, v66
    v_exp_f32 v67, v67
    v_cvt_pk_bf16_f32 v83, v62, v63
    v_cvt_pk_bf16_f32 v84, v64, v65
    v_mfma_f32_32x32x16_bf16 v[224:239], a[184:187], v[76:79], v[224:239]
    buffer_load_dwordx4 a[20:23], v9, s[16:19], s82 offen offset:0 sc1
    v_exp_f32 v68, v68
    v_exp_f32 v69, v69
    v_exp_f32 v70, v70
    v_exp_f32 v71, v71
    v_cvt_pk_bf16_f32 v85, v66, v67
    v_cvt_pk_bf16_f32 v86, v68, v69
    v_cvt_pk_bf16_f32 v87, v70, v71
    ds_read_b64_tr_b16 v[88:89], v185 offset:0
    ds_read_b64_tr_b16 v[90:91], v185 offset:64
    ds_read_b64_tr_b16 v[92:93], v185 offset:4096
    ds_read_b64_tr_b16 v[94:95], v185 offset:4160
    ds_read_b64_tr_b16 v[96:97], v184 offset:0
    ds_read_b64_tr_b16 v[98:99], v184 offset:64
    ds_read_b64_tr_b16 v[100:101], v184 offset:4096
    v_mfma_f32_32x32x16_bf16 v[56:71], a[164:167], v[128:131], 0
    buffer_load_dwordx4 a[24:27], v9, s[16:19], s82 offen offset:672 sc1
    v_exp_f32 v40, v40
    v_exp_f32 v41, v41
    v_exp_f32 v42, v42
    v_exp_f32 v43, v43
    v_cvt_pk_bf16_f32 v72, v40, v41
    v_mfma_f32_32x32x16_bf16 v[240:255], a[180:183], v[80:83], 0
    buffer_load_dwordx4 a[4:7], v36, s[16:19], s80 offen offset:1024 sc1
    v_exp_f32 v44, v44
    v_exp_f32 v45, v45
    v_exp_f32 v46, v46
    v_exp_f32 v47, v47
    v_cvt_pk_bf16_f32 v73, v42, v43
    v_cvt_pk_bf16_f32 v74, v44, v45
    v_mfma_f32_32x32x8_bf16 v[56:71], a[176:177], v[134:135], v[56:71]
    s_lshl_b32 s41, s37, 1
    v_exp_f32 v48, v48
    v_exp_f32 v49, v49
    v_exp_f32 v50, v50
    v_exp_f32 v51, v51
    v_cvt_pk_bf16_f32 v75, v46, v47
    v_cvt_pk_bf16_f32 v76, v48, v49
    v_mfma_f32_32x32x16_bf16 v[240:255], a[184:187], v[84:87], v[240:255]
    ds_read_b64_tr_b16 v[102:103], v184 offset:4160
    ds_read_b64_tr_b16 v[104:105], v184 offset:8192
    ds_read_b64_tr_b16 v[106:107], v184 offset:8256
    ds_read_b64_tr_b16 v[108:109], v185 offset:512
    ds_read_b64_tr_b16 v[110:111], v185 offset:576
    ds_read_b64_tr_b16 v[112:113], v185 offset:4608
    ds_read_b64_tr_b16 v[114:115], v185 offset:4672
    ds_read_b64_tr_b16 v[116:117], v184 offset:512
    v_exp_f32 v52, v52
    v_exp_f32 v53, v53
    v_exp_f32 v54, v54
    v_exp_f32 v55, v55
    v_cvt_pk_bf16_f32 v77, v50, v51
    v_cvt_pk_bf16_f32 v78, v52, v53
    v_cvt_pk_bf16_f32 v79, v54, v55
    v_mfma_f32_32x32x16_bf16 v[40:55], a[164:167], v[136:139], 0
    buffer_load_dwordx4 a[28:31], v9, s[16:19], s82 offen offset:1344 sc1
    v_exp_f32 v56, v56
    v_exp_f32 v57, v57
    v_exp_f32 v58, v58
    v_exp_f32 v59, v59
    v_cvt_pk_bf16_f32 v80, v56, v57
    v_mfma_f32_32x32x16_bf16 v[192:207], a[188:191], v[72:75], v[192:207]
    buffer_load_dwordx4 a[32:35], v9, s[16:19], s82 offen offset:2016 sc1
    v_exp_f32 v60, v60
    v_exp_f32 v61, v61
    v_exp_f32 v62, v62
    v_exp_f32 v63, v63
    v_cvt_pk_bf16_f32 v81, v58, v59
    v_cvt_pk_bf16_f32 v82, v60, v61
    v_mfma_f32_32x32x8_bf16 v[40:55], a[176:177], v[142:143], v[40:55]
    s_add_u32 s41, s41, s39
    v_exp_f32 v64, v64
    v_exp_f32 v65, v65
    v_exp_f32 v66, v66
    v_exp_f32 v67, v67
    v_cvt_pk_bf16_f32 v83, v62, v63
    v_cvt_pk_bf16_f32 v84, v64, v65
    s_waitcnt vmcnt(13)
    v_mfma_f32_32x32x16_bf16 v[192:207], a[192:195], v[76:79], v[192:207]
    ds_read_b64_tr_b16 v[118:119], v184 offset:576
    ds_read_b64_tr_b16 v[176:177], v184 offset:4608
    ds_read_b64_tr_b16 v[178:179], v184 offset:4672
    ds_read_b64_tr_b16 v[180:181], v184 offset:8704
    ds_read_b64_tr_b16 v[182:183], v184 offset:8768
    v_exp_f32 v68, v68
    v_lshrrev_b32 v191, 3, v38
    v_exp_f32 v69, v69
    v_lshlrev_b32 v191, 31, v191
    v_exp_f32 v70, v70
    v_lshlrev_b32 v186, 3, v37
    v_exp_f32 v71, v71
    v_cvt_pk_bf16_f32 v85, v66, v67
    v_cvt_pk_bf16_f32 v86, v68, v69
    v_cvt_pk_bf16_f32 v87, v70, v71
    v_mfma_f32_32x32x16_bf16 v[56:71], a[164:167], v[144:147], 0
    buffer_load_dwordx4 a[8:11], v36, s[16:19], s80 offen offset:2048 sc1
    v_exp_f32 v40, v40
    v_exp_f32 v41, v41
    v_exp_f32 v42, v42
    v_exp_f32 v43, v43
    v_cvt_pk_bf16_f32 v72, v40, v41
    v_mfma_f32_32x32x16_bf16 v[208:223], a[188:191], v[80:83], v[208:223]
    buffer_load_dwordx4 a[36:39], v9, s[16:19], s83 offen offset:0 sc1
    v_exp_f32 v44, v44
    v_exp_f32 v45, v45
    v_exp_f32 v46, v46
    v_exp_f32 v47, v47
    v_cvt_pk_bf16_f32 v73, v42, v43
    v_cvt_pk_bf16_f32 v74, v44, v45
    v_mfma_f32_32x32x8_bf16 v[56:71], a[176:177], v[150:151], v[56:71]
    s_mov_b32 s62, 0x04100800
    v_exp_f32 v48, v48
    v_lshrrev_b32 v186, v186, s62
    v_exp_f32 v49, v49
    v_and_b32 v186, 0xff, v186
    v_exp_f32 v50, v50
    v_mul_u32_u24 v186, 160, v186
    v_exp_f32 v51, v51
    v_lshl_add_u32 v186, v38, 2, v186
    v_cvt_pk_bf16_f32 v75, v46, v47
    v_lshlrev_b32 v188, 3, v37
    v_cvt_pk_bf16_f32 v76, v48, v49
    v_mfma_f32_32x32x16_bf16 v[208:223], a[192:195], v[84:87], v[208:223]
    s_mov_b32 s62, 0x0000140c
    s_lshr_b32 s42, s38, 1
    v_exp_f32 v52, v52
    v_lshrrev_b32 v188, v188, s62
    v_exp_f32 v53, v53
    v_exp_f32 v54, v54
    v_exp_f32 v55, v55
    v_cvt_pk_bf16_f32 v77, v50, v51
    v_cvt_pk_bf16_f32 v78, v52, v53
    v_cvt_pk_bf16_f32 v79, v54, v55
    s_waitcnt vmcnt(14)
    v_mfma_f32_32x32x16_bf16 v[40:55], a[168:171], v[120:123], 0
    buffer_load_dwordx4 a[40:43], v9, s[16:19], s83 offen offset:672 sc1
    v_exp_f32 v56, v56
    v_and_b32 v188, 0xff, v188
    v_exp_f32 v57, v57
    v_mul_u32_u24 v188, 160, v188
    v_exp_f32 v58, v58
    v_lshl_add_u32 v188, v38, 2, v188
    v_exp_f32 v59, v59
    v_lshl_or_b32 v188, v10, 31, v188
    v_cvt_pk_bf16_f32 v80, v56, v57
    v_mfma_f32_32x32x16_bf16 v[224:239], a[188:191], v[72:75], v[224:239]
    buffer_load_dwordx4 a[12:15], v36, s[16:19], s80 offen offset:3072 sc1
    v_exp_f32 v60, v60
    v_lshl_or_b32 v190, v37, 31, v188
    v_exp_f32 v61, v61
    v_or_b32 v187, v186, v191
    v_exp_f32 v62, v62
    v_or_b32 v189, v188, v191
    v_exp_f32 v63, v63
    v_or_b32 v191, v190, v191
    v_cvt_pk_bf16_f32 v81, v58, v59
    v_cvt_pk_bf16_f32 v82, v60, v61
    v_mfma_f32_32x32x8_bf16 v[40:55], a[178:179], v[124:125], v[40:55]
    s_and_b32 s43, s38, 1
    v_exp_f32 v64, v64
    v_min_u32 v5, 20, v11
    v_exp_f32 v65, v65
    v_mul_u32_u24 v5, 80, v5
    v_exp_f32 v66, v66
    v_exp_f32 v67, v67
    v_cvt_pk_bf16_f32 v83, v62, v63
    v_cvt_pk_bf16_f32 v84, v64, v65
    v_mfma_f32_32x32x16_bf16 v[224:239], a[192:195], v[76:79], v[224:239]
    v_exp_f32 v68, v68
    v_exp_f32 v69, v69
    v_exp_f32 v70, v70
    v_exp_f32 v71, v71
    v_cvt_pk_bf16_f32 v85, v66, v67
    v_cvt_pk_bf16_f32 v86, v68, v69
    v_cvt_pk_bf16_f32 v87, v70, v71
    v_mfma_f32_32x32x16_bf16 v[56:71], a[168:171], v[128:131], 0
    buffer_load_dwordx4 a[44:47], v9, s[16:19], s83 offen offset:1344 sc1
    v_exp_f32 v40, v40
    v_exp_f32 v41, v41
    v_exp_f32 v42, v42
    v_exp_f32 v43, v43
    v_cvt_pk_bf16_f32 v72, v40, v41
    v_mfma_f32_32x32x16_bf16 v[240:255], a[188:191], v[80:83], v[240:255]
    buffer_load_dwordx4 a[48:51], v9, s[16:19], s83 offen offset:2016 sc1
    v_exp_f32 v44, v44
    v_exp_f32 v45, v45
    v_exp_f32 v46, v46
    v_exp_f32 v47, v47
    v_cvt_pk_bf16_f32 v73, v42, v43
    v_cvt_pk_bf16_f32 v74, v44, v45
    v_mfma_f32_32x32x8_bf16 v[56:71], a[178:179], v[132:133], v[56:71]
    s_lshl_b32 s57, s37, 2
    v_exp_f32 v48, v48
    v_exp_f32 v49, v49
    v_exp_f32 v50, v50
    v_exp_f32 v51, v51
    v_cvt_pk_bf16_f32 v75, v46, v47
    v_cvt_pk_bf16_f32 v76, v48, v49
    v_mfma_f32_32x32x16_bf16 v[240:255], a[192:195], v[84:87], v[240:255]
    s_add_u32 s57, s57, s38
    s_mul_i32 s57, s57, 3360
    v_exp_f32 v52, v52
    v_exp_f32 v53, v53
    v_exp_f32 v54, v54
    v_exp_f32 v55, v55
    v_cvt_pk_bf16_f32 v77, v50, v51
    v_cvt_pk_bf16_f32 v78, v52, v53
    v_cvt_pk_bf16_f32 v79, v54, v55
    s_add_u32 s57, s57, 262144
    v_mfma_f32_32x32x16_bf16 v[40:55], a[168:171], v[136:139], 0
    s_add_u32 s80, s69, 2
    s_and_b32 s80, s80, 3
    v_exp_f32 v56, v56
    v_exp_f32 v57, v57
    v_exp_f32 v58, v58
    s_waitcnt lgkmcnt(14)
    v_mfma_f32_16x16x32_bf16 v[152:155], v[88:91], v[96:99], 0
    s_mul_i32 s76, s42, 1680
    s_add_u32 s76, s76, 143360
    v_add_u32 v5, s76, v5
    v_exp_f32 v59, v59
    v_cvt_pk_bf16_f32 v80, v56, v57
    s_waitcnt vmcnt(17)
    v_mfma_f32_32x32x16_bf16 v[192:207], a[196:199], v[72:75], v[192:207]
    v_exp_f32 v60, v60
    v_exp_f32 v61, v61
    v_exp_f32 v62, v62
    s_waitcnt lgkmcnt(12)
    v_mfma_f32_16x16x32_bf16 v[156:159], v[88:91], v[100:103], 0
    v_exp_f32 v63, v63
    v_cvt_pk_bf16_f32 v81, v58, v59
    v_cvt_pk_bf16_f32 v82, v60, v61
    v_mfma_f32_32x32x8_bf16 v[40:55], a[178:179], v[140:141], v[40:55]
    v_exp_f32 v64, v64
    v_exp_f32 v65, v65
    v_exp_f32 v66, v66
    s_waitcnt lgkmcnt(10)
    v_mfma_f32_16x16x32_bf16 v[160:163], v[88:91], v[104:107], 0
    v_exp_f32 v67, v67
    v_cvt_pk_bf16_f32 v83, v62, v63
    v_cvt_pk_bf16_f32 v84, v64, v65
    s_waitcnt vmcnt(16)
    v_mfma_f32_32x32x16_bf16 v[192:207], a[200:203], v[76:79], v[192:207]
    v_exp_f32 v68, v68
    v_exp_f32 v69, v69
    v_exp_f32 v70, v70
    v_mfma_f32_16x16x32_bf16 v[164:167], v[92:95], v[96:99], 0
    v_exp_f32 v71, v71
    v_cvt_pk_bf16_f32 v85, v66, v67
    v_cvt_pk_bf16_f32 v86, v68, v69
    v_cvt_pk_bf16_f32 v87, v70, v71
    v_mfma_f32_32x32x16_bf16 v[56:71], a[168:171], v[144:147], 0
    s_lshl_b32 s81, s38, 2
    s_add_u32 s80, s80, s81
    v_exp_f32 v40, v40
    v_lshl_add_u32 v21, v10, 4, v5
    v_exp_f32 v41, v41
    v_lshl_add_u32 v22, v10, 3, v5
    v_exp_f32 v42, v42
    v_mfma_f32_16x16x32_bf16 v[168:171], v[92:95], v[100:103], 0
    s_mul_i32 s76, s42, 10240
    v_exp_f32 v43, v43
    v_cvt_pk_bf16_f32 v72, v40, v41
    v_mfma_f32_32x32x16_bf16 v[208:223], a[196:199], v[80:83], v[208:223]
    v_exp_f32 v44, v44
    v_exp_f32 v45, v45
    v_exp_f32 v46, v46
    v_mfma_f32_16x16x32_bf16 v[172:175], v[92:95], v[104:107], 0
    ds_read_b64_tr_b16 v[88:89], v185 offset:1024
    ds_read_b64_tr_b16 v[90:91], v185 offset:1088
    ds_read_b64_tr_b16 v[92:93], v185 offset:5120
    ds_read_b64_tr_b16 v[94:95], v185 offset:5184
    ds_read_b64_tr_b16 v[96:97], v184 offset:1024
    ds_read_b64_tr_b16 v[98:99], v184 offset:1088
    ds_read_b64_tr_b16 v[100:101], v184 offset:5120
    ds_read_b64_tr_b16 v[102:103], v184 offset:5184
    v_exp_f32 v47, v47
    v_cvt_pk_bf16_f32 v73, v42, v43
    v_cvt_pk_bf16_f32 v74, v44, v45
    v_mfma_f32_32x32x8_bf16 v[56:71], a[178:179], v[148:149], v[56:71]
    v_exp_f32 v48, v48
    v_exp_f32 v49, v49
    v_exp_f32 v50, v50
    v_exp_f32 v51, v51
    v_cvt_pk_bf16_f32 v75, v46, v47
    v_cvt_pk_bf16_f32 v76, v48, v49
    v_mfma_f32_32x32x16_bf16 v[208:223], a[200:203], v[84:87], v[208:223]
    v_exp_f32 v52, v52
    v_exp_f32 v53, v53
    v_exp_f32 v54, v54
    v_exp_f32 v55, v55
    v_cvt_pk_bf16_f32 v77, v50, v51
    v_cvt_pk_bf16_f32 v78, v52, v53
    v_cvt_pk_bf16_f32 v79, v54, v55
    s_waitcnt vmcnt(15)
    v_mfma_f32_32x32x16_bf16 v[40:55], a[172:175], v[120:123], 0
    s_lshl_b32 s81, s80, 10
    s_add_u32 s81, s81, 65536
    v_exp_f32 v56, v56
    v_exp_f32 v57, v57
    v_exp_f32 v58, v58
    v_exp_f32 v59, v59
    v_cvt_pk_bf16_f32 v80, v56, v57
    v_mfma_f32_32x32x16_bf16 v[224:239], a[196:199], v[72:75], v[224:239]
    ds_read_b64_tr_b16 v[104:105], v184 offset:9216
    ds_read_b64_tr_b16 v[106:107], v184 offset:9280
    v_exp_f32 v60, v60
    v_exp_f32 v61, v61
    v_exp_f32 v62, v62
    s_waitcnt lgkmcnt(14)
    v_mfma_f32_16x16x32_bf16 v[152:155], v[108:111], v[116:119], v[152:155]
    s_lshl_b32 s77, s43, 9
    s_add_u32 s76, s76, s77
    v_lshlrev_b32 v5, 4, v11
    v_exp_f32 v63, v63
    v_cvt_pk_bf16_f32 v81, v58, v59
    v_cvt_pk_bf16_f32 v82, v60, v61
L_padk3:
L_pd6293:
    s_cbranch_execz L_pd8396
    v_mfma_f32_32x32x8_bf16 v[40:55], a[178:179], v[126:127], v[40:55]
    v_exp_f32 v64, v64
    v_exp_f32 v65, v65
    v_exp_f32 v66, v66
    s_waitcnt lgkmcnt(12)
    v_mfma_f32_16x16x32_bf16 v[156:159], v[108:111], v[176:179], v[156:159]
    v_exp_f32 v67, v67
    v_cvt_pk_bf16_f32 v83, v62, v63
    v_cvt_pk_bf16_f32 v84, v64, v65
    v_mfma_f32_32x32x16_bf16 v[224:239], a[200:203], v[76:79], v[224:239]
    v_exp_f32 v68, v68
    v_exp_f32 v69, v69
    v_exp_f32 v70, v70
    s_waitcnt lgkmcnt(10)
    v_mfma_f32_16x16x32_bf16 v[160:163], v[108:111], v[180:183], v[160:163]
    v_exp_f32 v71, v71
    v_cvt_pk_bf16_f32 v85, v66, v67
    v_cvt_pk_bf16_f32 v86, v68, v69
    v_cvt_pk_bf16_f32 v87, v70, v71
    v_mfma_f32_32x32x16_bf16 v[56:71], a[172:175], v[128:131], 0
    s_mul_i32 s82, s80, 5376
    s_add_u32 s83, s82, 2688
    v_exp_f32 v40, v40
    v_add_u32 v5, s76, v5
    v_exp_f32 v41, v41
    v_lshl_add_u32 v23, v10, 11, v5
    v_exp_f32 v42, v42
    v_mfma_f32_16x16x32_bf16 v[164:167], v[112:115], v[116:119], v[164:167]
    v_lshl_add_u32 v24, v10, 3, v5
    v_exp_f32 v43, v43
    v_cvt_pk_bf16_f32 v72, v40, v41
    v_mfma_f32_32x32x16_bf16 v[240:255], a[196:199], v[80:83], v[240:255]
    v_exp_f32 v44, v44
    v_exp_f32 v45, v45
    v_exp_f32 v46, v46
    v_mfma_f32_16x16x32_bf16 v[168:171], v[112:115], v[176:179], v[168:171]
    v_exp_f32 v47, v47
    v_cvt_pk_bf16_f32 v73, v42, v43
    v_cvt_pk_bf16_f32 v74, v44, v45
    v_mfma_f32_32x32x8_bf16 v[56:71], a[178:179], v[134:135], v[56:71]
    v_exp_f32 v48, v48
    v_exp_f32 v49, v49
    v_exp_f32 v50, v50
    v_mfma_f32_16x16x32_bf16 v[172:175], v[112:115], v[180:183], v[172:175]
    ds_read_b64_tr_b16 v[108:109], v185 offset:1536
    ds_read_b64_tr_b16 v[110:111], v185 offset:1600
    ds_read_b64_tr_b16 v[112:113], v185 offset:5632
    ds_read_b64_tr_b16 v[114:115], v185 offset:5696
    ds_read_b64_tr_b16 v[116:117], v184 offset:1536
    ds_read_b64_tr_b16 v[118:119], v184 offset:1600
    ds_read_b64_tr_b16 v[176:177], v184 offset:5632
    ds_read_b64_tr_b16 v[178:179], v184 offset:5696
    ds_read_b64_tr_b16 v[180:181], v184 offset:9728
    ds_read_b64_tr_b16 v[182:183], v184 offset:9792
    v_exp_f32 v51, v51
    v_cvt_pk_bf16_f32 v75, v46, v47
    v_cvt_pk_bf16_f32 v76, v48, v49
    v_mfma_f32_32x32x16_bf16 v[240:255], a[200:203], v[84:87], v[240:255]
    v_exp_f32 v52, v52
    v_exp_f32 v53, v53
    v_exp_f32 v54, v54
    v_exp_f32 v55, v55
    v_cvt_pk_bf16_f32 v77, v50, v51
    v_cvt_pk_bf16_f32 v78, v52, v53
    v_cvt_pk_bf16_f32 v79, v54, v55
    v_mfma_f32_32x32x16_bf16 v[40:55], a[172:175], v[136:139], 0
    s_lshl_b32 s80, s80, 12
    s_mul_i32 s76, s38, 12288
    v_exp_f32 v56, v56
    v_exp_f32 v57, v57
    v_exp_f32 v58, v58
    s_waitcnt lgkmcnt(14)
    v_mfma_f32_16x16x32_bf16 v[152:155], v[88:91], v[96:99], v[152:155]
    buffer_load_dwordx4 a[52:55], v36, s[16:19], s80 offen offset:0 sc1
    v_exp_f32 v59, v59
    v_cvt_pk_bf16_f32 v80, v56, v57
    s_waitcnt vmcnt(15)
    v_mfma_f32_32x32x16_bf16 v[192:207], a[204:207], v[72:75], v[192:207]
    s_add_u32 s76, s76, 32768
    s_cmp_eq_u32 s38, 0
    s_cselect_b32 s76, 20480, s76
    v_exp_f32 v60, v60
    v_exp_f32 v61, v61
    v_exp_f32 v62, v62
    s_waitcnt lgkmcnt(12)
    v_mfma_f32_16x16x32_bf16 v[156:159], v[88:91], v[100:103], v[156:159]
    v_exp_f32 v63, v63
    v_cvt_pk_bf16_f32 v81, v58, v59
    v_cvt_pk_bf16_f32 v82, v60, v61
    v_mfma_f32_32x32x8_bf16 v[40:55], a[178:179], v[142:143], v[40:55]
    v_exp_f32 v64, v64
    v_exp_f32 v65, v65
    v_exp_f32 v66, v66
    s_waitcnt lgkmcnt(10)
    v_mfma_f32_16x16x32_bf16 v[160:163], v[88:91], v[104:107], v[160:163]
    v_exp_f32 v67, v67
    v_cvt_pk_bf16_f32 v83, v62, v63
    v_cvt_pk_bf16_f32 v84, v64, v65
    s_waitcnt vmcnt(14)
    v_mfma_f32_32x32x16_bf16 v[192:207], a[208:211], v[76:79], v[192:207]
    v_exp_f32 v68, v68
    v_exp_f32 v69, v69
    v_exp_f32 v70, v70
    v_mfma_f32_16x16x32_bf16 v[164:167], v[92:95], v[96:99], v[164:167]
    v_exp_f32 v71, v71
    v_cvt_pk_bf16_f32 v85, v66, v67
    v_cvt_pk_bf16_f32 v86, v68, v69
    v_cvt_pk_bf16_f32 v87, v70, v71
    v_mfma_f32_16x16x32_bf16 v[168:171], v[92:95], v[100:103], v[168:171]
    v_mfma_f32_16x16x32_bf16 v[172:175], v[92:95], v[104:107], v[172:175]
    s_waitcnt lgkmcnt(4)
    v_mfma_f32_16x16x32_bf16 v[152:155], v[108:111], v[116:119], v[152:155]
    s_waitcnt lgkmcnt(2)
    v_mfma_f32_16x16x32_bf16 v[156:159], v[108:111], v[176:179], v[156:159]
    s_waitcnt lgkmcnt(0)
    v_mfma_f32_16x16x32_bf16 v[160:163], v[108:111], v[180:183], v[160:163]
    v_mfma_f32_16x16x32_bf16 v[164:167], v[112:115], v[116:119], v[164:167]
    v_mfma_f32_16x16x32_bf16 v[168:171], v[112:115], v[176:179], v[168:171]
    v_mfma_f32_16x16x32_bf16 v[172:175], v[112:115], v[180:183], v[172:175]
    v_mfma_f32_32x32x16_bf16 v[56:71], a[172:175], v[144:147], 0
    buffer_load_dwordx4 a[68:71], v36, s[16:19], s81 offen sc1
    v_exp_f32 v40, v40
    v_add_u32 v25, s76, v36
    v_exp_f32 v41, v41
    v_lshrrev_b32 v5, 4, v11
    v_exp_f32 v42, v42
    v_mul_u32_u24 v5, 40960, v5
    v_exp_f32 v43, v43
    v_cvt_pk_bf16_f32 v72, v40, v41
    v_mfma_f32_32x32x16_bf16 v[208:223], a[204:207], v[80:83], v[208:223]
    buffer_load_dwordx4 a[72:75], v9, s[16:19], s82 offen offset:0 sc1
    v_exp_f32 v44, v44
    v_exp_f32 v45, v45
    v_exp_f32 v46, v46
    v_exp_f32 v47, v47
    v_cvt_pk_bf16_f32 v73, v42, v43
    v_cvt_pk_bf16_f32 v74, v44, v45
    v_mfma_f32_32x32x8_bf16 v[56:71], a[178:179], v[150:151], v[56:71]
    s_waitcnt vmcnt(3)
    v_exp_f32 v48, v48
    v_exp_f32 v49, v49
    v_exp_f32 v50, v50
    v_exp_f32 v51, v51
    v_cvt_pk_bf16_f32 v75, v46, v47
    v_cvt_pk_bf16_f32 v76, v48, v49
    v_mfma_f32_32x32x16_bf16 v[208:223], a[208:211], v[84:87], v[208:223]
    buffer_atomic_add_f32 v152, v186, s[16:19], s57 offen offset:0 sc1
    v_exp_f32 v52, v52
    v_exp_f32 v53, v53
    v_exp_f32 v54, v54
    v_exp_f32 v55, v55
    v_cvt_pk_bf16_f32 v77, v50, v51
    v_cvt_pk_bf16_f32 v78, v52, v53
    v_cvt_pk_bf16_f32 v79, v54, v55
    v_mfma_f32_32x32x16_bf16 v[40:55], a[0:3], v[120:123], 0
    buffer_load_dwordx4 a[76:79], v9, s[16:19], s82 offen offset:672 sc1
    v_exp_f32 v56, v56
    v_lshl_add_u32 v5, v38, 4, v5
    v_accvgpr_read_b32 v88, a212
    v_exp_f32 v57, v57
    v_lshl_add_u32 v6, v10, 8, v5
    v_accvgpr_read_b32 v89, a213
    v_exp_f32 v58, v58
    v_accvgpr_read_b32 v90, a214
    v_exp_f32 v59, v59
    v_accvgpr_read_b32 v91, a215
    v_cvt_pk_bf16_f32 v80, v56, v57
    v_mfma_f32_32x32x16_bf16 v[224:239], a[204:207], v[72:75], v[224:239]
    buffer_load_dwordx4 a[56:59], v36, s[16:19], s80 offen offset:1024 sc1
    v_exp_f32 v60, v60
    v_exp_f32 v61, v61
    v_exp_f32 v62, v62
    v_exp_f32 v63, v63
    v_cvt_pk_bf16_f32 v81, v58, v59
    v_cvt_pk_bf16_f32 v82, v60, v61
    v_mfma_f32_32x32x8_bf16 v[40:55], a[16:17], v[124:125], v[40:55]
    s_mul_i32 s76, s42, 768
    v_exp_f32 v64, v64
    v_exp_f32 v65, v65
    v_exp_f32 v66, v66
    v_exp_f32 v67, v67
    v_cvt_pk_bf16_f32 v83, v62, v63
    v_cvt_pk_bf16_f32 v84, v64, v65
    v_mfma_f32_32x32x16_bf16 v[224:239], a[208:211], v[76:79], v[224:239]
    buffer_atomic_add_f32 v153, v186, s[16:19], s57 offen offset:160 sc1
    v_exp_f32 v68, v68
    v_exp_f32 v69, v69
    v_exp_f32 v70, v70
    v_exp_f32 v71, v71
    v_cvt_pk_bf16_f32 v85, v66, v67
    v_cvt_pk_bf16_f32 v86, v68, v69
    v_cvt_pk_bf16_f32 v87, v70, v71
    v_mfma_f32_32x32x16_bf16 v[56:71], a[0:3], v[128:131], 0
    buffer_load_dwordx4 a[80:83], v9, s[16:19], s82 offen offset:1344 sc1
    v_exp_f32 v40, v40
    v_add_u32 v26, s76, v6
    v_accvgpr_read_b32 v92, a216
    v_exp_f32 v41, v41
    v_accvgpr_read_b32 v93, a217
    v_exp_f32 v42, v42
    v_accvgpr_read_b32 v94, a218
    v_exp_f32 v43, v43
    v_cvt_pk_bf16_f32 v72, v40, v41
    v_mfma_f32_32x32x16_bf16 v[240:255], a[204:207], v[80:83], v[240:255]
    buffer_load_dwordx4 a[84:87], v9, s[16:19], s82 offen offset:2016 sc1
    v_exp_f32 v44, v44
    v_exp_f32 v45, v45
    v_exp_f32 v46, v46
    v_exp_f32 v47, v47
    v_cvt_pk_bf16_f32 v73, v42, v43
    v_cvt_pk_bf16_f32 v74, v44, v45
    v_mfma_f32_32x32x8_bf16 v[56:71], a[16:17], v[132:133], v[56:71]
    s_lshl_b32 s76, s42, 3
    v_exp_f32 v48, v48
    v_add_u32 v5, s76, v5
    v_exp_f32 v49, v49
    v_exp_f32 v50, v50
    v_exp_f32 v51, v51
    v_cvt_pk_bf16_f32 v75, v46, v47
    v_cvt_pk_bf16_f32 v76, v48, v49
    v_mfma_f32_32x32x16_bf16 v[240:255], a[208:211], v[84:87], v[240:255]
    buffer_atomic_add_f32 v154, v186, s[16:19], s57 offen offset:320 sc1
    v_exp_f32 v52, v52
    v_exp_f32 v53, v53
    v_exp_f32 v54, v54
    v_exp_f32 v55, v55
    v_cvt_pk_bf16_f32 v77, v50, v51
    v_cvt_pk_bf16_f32 v78, v52, v53
    v_cvt_pk_bf16_f32 v79, v54, v55
    s_mul_i32 s78, s36, 51200
    v_mfma_f32_32x32x16_bf16 v[40:55], a[0:3], v[136:139], 0
    buffer_load_dwordx4 a[60:63], v36, s[16:19], s80 offen offset:2048 sc1
    v_exp_f32 v56, v56
    v_lshl_or_b32 v27, v10, 31, v5
    v_exp_f32 v57, v57
    v_exp_f32 v58, v58
    v_exp_f32 v59, v59
    v_cvt_pk_bf16_f32 v80, v56, v57
    v_mfma_f32_32x32x16_bf16 v[192:207], a[20:23], v[72:75], v[192:207]
    buffer_load_dwordx4 a[88:91], v9, s[16:19], s83 offen offset:0 sc1
    v_exp_f32 v60, v60
    v_exp_f32 v61, v61
    v_exp_f32 v62, v62
    v_exp_f32 v63, v63
    v_cvt_pk_bf16_f32 v81, v58, v59
    v_cvt_pk_bf16_f32 v82, v60, v61
    v_mfma_f32_32x32x8_bf16 v[40:55], a[16:17], v[140:141], v[40:55]
    s_lshl_b32 s76, s36, 3
    v_exp_f32 v64, v64
    v_exp_f32 v65, v65
    v_exp_f32 v66, v66
    v_exp_f32 v67, v67
    v_cvt_pk_bf16_f32 v83, v62, v63
    v_cvt_pk_bf16_f32 v84, v64, v65
    v_mfma_f32_32x32x16_bf16 v[192:207], a[24:27], v[76:79], v[192:207]
    buffer_atomic_add_f32 v155, v186, s[16:19], s57 offen offset:480 sc1
    v_exp_f32 v68, v68
    v_exp_f32 v69, v69
    v_exp_f32 v70, v70
    v_exp_f32 v71, v71
    v_cvt_pk_bf16_f32 v85, v66, v67
    v_cvt_pk_bf16_f32 v86, v68, v69
    v_cvt_pk_bf16_f32 v87, v70, v71
    s_mul_i32 s79, s37, 160
    s_add_u32 s78, s78, s79
    s_lshl_b32 s79, s38, 13
    v_mfma_f32_32x32x16_bf16 v[56:71], a[0:3], v[144:147], 0
    buffer_load_dwordx4 a[92:95], v9, s[16:19], s83 offen offset:672 sc1
    v_exp_f32 v40, v40
    v_exp_f32 v41, v41
    v_exp_f32 v42, v42
    v_exp_f32 v43, v43
    v_cvt_pk_bf16_f32 v72, v40, v41
    v_mfma_f32_32x32x16_bf16 v[208:223], a[20:23], v[80:83], v[208:223]
    buffer_load_dwordx4 a[64:67], v36, s[16:19], s80 offen offset:3072 sc1
    v_exp_f32 v44, v44
    v_exp_f32 v45, v45
    v_exp_f32 v46, v46
    v_exp_f32 v47, v47
    v_cvt_pk_bf16_f32 v73, v42, v43
    v_cvt_pk_bf16_f32 v74, v44, v45
    v_mfma_f32_32x32x8_bf16 v[56:71], a[16:17], v[148:149], v[56:71]
    s_lshl_b32 s77, s43, 1
    v_exp_f32 v48, v48
    v_exp_f32 v49, v49
    v_exp_f32 v50, v50
    v_exp_f32 v51, v51
    v_cvt_pk_bf16_f32 v75, v46, v47
    v_cvt_pk_bf16_f32 v76, v48, v49
    v_mfma_f32_32x32x16_bf16 v[208:223], a[24:27], v[84:87], v[208:223]
    buffer_atomic_add_f32 v156, v186, s[16:19], s57 offen offset:64 sc1
    v_exp_f32 v52, v52
    v_exp_f32 v53, v53
    v_exp_f32 v54, v54
    v_exp_f32 v55, v55
    v_cvt_pk_bf16_f32 v77, v50, v51
    v_cvt_pk_bf16_f32 v78, v52, v53
    v_cvt_pk_bf16_f32 v79, v54, v55
    s_add_u32 m0, s79, 98304
    s_nop 0
    buffer_load_dwordx4 v88, s[32:35], s78 offen lds
    s_add_u32 m0, s79, 99328
    v_mfma_f32_32x32x16_bf16 v[40:55], a[4:7], v[120:123], 0
    buffer_load_dwordx4 a[96:99], v9, s[16:19], s83 offen offset:1344 sc1
    v_exp_f32 v56, v56
    v_exp_f32 v57, v57
    v_exp_f32 v58, v58
    v_exp_f32 v59, v59
    v_cvt_pk_bf16_f32 v80, v56, v57
    v_mfma_f32_32x32x16_bf16 v[224:239], a[20:23], v[72:75], v[224:239]
    buffer_load_dwordx4 a[100:103], v9, s[16:19], s83 offen offset:2016 sc1
    v_exp_f32 v60, v60
    v_exp_f32 v61, v61
    v_exp_f32 v62, v62
    v_exp_f32 v63, v63
    v_cvt_pk_bf16_f32 v81, v58, v59
    v_cvt_pk_bf16_f32 v82, v60, v61
    v_mfma_f32_32x32x8_bf16 v[40:55], a[16:17], v[126:127], v[40:55]
    s_add_u32 s76, s76, s77
    v_exp_f32 v64, v64
    v_exp_f32 v65, v65
    v_exp_f32 v66, v66
    v_exp_f32 v67, v67
    v_cvt_pk_bf16_f32 v83, v62, v63
    v_cvt_pk_bf16_f32 v84, v64, v65
    v_mfma_f32_32x32x16_bf16 v[224:239], a[24:27], v[76:79], v[224:239]
    buffer_atomic_add_f32 v157, v186, s[16:19], s57 offen offset:224 sc1
    v_exp_f32 v68, v68
    v_exp_f32 v69, v69
    v_exp_f32 v70, v70
    v_exp_f32 v71, v71
    v_cvt_pk_bf16_f32 v85, v66, v67
    v_cvt_pk_bf16_f32 v86, v68, v69
    v_cvt_pk_bf16_f32 v87, v70, v71
    buffer_load_dwordx4 v89, s[32:35], s78 offen lds
    s_add_u32 m0, s79, 100352
    s_nop 0
    buffer_load_dwordx4 v90, s[32:35], s78 offen lds
    v_mfma_f32_32x32x16_bf16 v[56:71], a[4:7], v[128:131], 0
    s_add_u32 s80, s69, 3
    s_and_b32 s80, s80, 3
    v_exp_f32 v40, v40
    v_exp_f32 v41, v41
    v_exp_f32 v42, v42
    v_exp_f32 v43, v43
    v_cvt_pk_bf16_f32 v72, v40, v41
    v_mfma_f32_32x32x16_bf16 v[240:255], a[20:23], v[80:83], v[240:255]
    buffer_atomic_add_f32 v158, v186, s[16:19], s57 offen offset:384 sc1
    v_exp_f32 v44, v44
    v_exp_f32 v45, v45
    v_exp_f32 v46, v46
    v_exp_f32 v47, v47
    v_cvt_pk_bf16_f32 v73, v42, v43
    v_cvt_pk_bf16_f32 v74, v44, v45
    v_mfma_f32_32x32x8_bf16 v[56:71], a[16:17], v[134:135], v[56:71]
    s_mul_i32 s76, s76, 40960
    v_exp_f32 v48, v48
    v_exp_f32 v49, v49
    v_exp_f32 v50, v50
    v_exp_f32 v51, v51
    v_cvt_pk_bf16_f32 v75, v46, v47
    v_cvt_pk_bf16_f32 v76, v48, v49
    v_mfma_f32_32x32x16_bf16 v[240:255], a[24:27], v[84:87], v[240:255]
    s_lshr_b32 s77, s41, 2
    s_mul_i32 s77, s77, 5120
    v_exp_f32 v52, v52
    v_exp_f32 v53, v53
    v_exp_f32 v54, v54
    v_exp_f32 v55, v55
    v_cvt_pk_bf16_f32 v77, v50, v51
    v_cvt_pk_bf16_f32 v78, v52, v53
    v_cvt_pk_bf16_f32 v79, v54, v55
    v_mfma_f32_32x32x16_bf16 v[40:55], a[4:7], v[136:139], 0
    s_lshl_b32 s81, s38, 2
    s_add_u32 s80, s80, s81
    v_exp_f32 v56, v56
    v_exp_f32 v57, v57
    v_exp_f32 v58, v58
    v_exp_f32 v59, v59
    v_cvt_pk_bf16_f32 v80, v56, v57
    v_mfma_f32_32x32x16_bf16 v[192:207], a[28:31], v[72:75], v[192:207]
    buffer_atomic_add_f32 v159, v186, s[16:19], s57 offen offset:544 sc1
    v_exp_f32 v60, v60
    v_exp_f32 v61, v61
    v_exp_f32 v62, v62
    v_exp_f32 v63, v63
    v_cvt_pk_bf16_f32 v81, v58, v59
    v_cvt_pk_bf16_f32 v82, v60, v61
    v_mfma_f32_32x32x8_bf16 v[40:55], a[16:17], v[142:143], v[40:55]
    s_add_u32 s76, s76, s77
    v_exp_f32 v64, v64
    v_exp_f32 v65, v65
    v_exp_f32 v66, v66
    v_exp_f32 v67, v67
    v_cvt_pk_bf16_f32 v83, v62, v63
    v_cvt_pk_bf16_f32 v84, v64, v65
    v_mfma_f32_32x32x16_bf16 v[192:207], a[32:35], v[76:79], v[192:207]
    s_mul_i32 s77, s41, 1280
    s_add_u32 s76, s76, s77
    v_exp_f32 v68, v68
    v_exp_f32 v69, v69
    v_exp_f32 v70, v70
    v_exp_f32 v71, v71
    v_cvt_pk_bf16_f32 v85, v66, v67
    v_cvt_pk_bf16_f32 v86, v68, v69
    v_cvt_pk_bf16_f32 v87, v70, v71
    v_mfma_f32_32x32x16_bf16 v[56:71], a[4:7], v[144:147], 0
    s_lshl_b32 s81, s80, 10
    s_add_u32 s81, s81, 65536
    v_exp_f32 v40, v40
    v_exp_f32 v41, v41
    v_exp_f32 v42, v42
    v_exp_f32 v43, v43
    v_cvt_pk_bf16_f32 v72, v40, v41
    v_mfma_f32_32x32x16_bf16 v[208:223], a[28:31], v[80:83], v[208:223]
    buffer_atomic_add_f32 v160, v187, s[16:19], s57 offen offset:128 sc1
    v_exp_f32 v44, v44
    v_exp_f32 v45, v45
    v_exp_f32 v46, v46
    v_exp_f32 v47, v47
    v_cvt_pk_bf16_f32 v73, v42, v43
    v_cvt_pk_bf16_f32 v74, v44, v45
    v_mfma_f32_32x32x8_bf16 v[56:71], a[16:17], v[150:151], v[56:71]
    s_add_u32 s44, s76, 2097152
    v_exp_f32 v48, v48
    v_exp_f32 v49, v49
    v_exp_f32 v50, v50
    v_exp_f32 v51, v51
    v_cvt_pk_bf16_f32 v75, v46, v47
    v_cvt_pk_bf16_f32 v76, v48, v49
    v_mfma_f32_32x32x16_bf16 v[208:223], a[32:35], v[84:87], v[208:223]
    s_add_u32 s45, s44, 163840
    s_add_u32 s72, s44, 5120
    v_exp_f32 v52, v52
    v_exp_f32 v53, v53
    v_exp_f32 v54, v54
    v_exp_f32 v55, v55
    v_cvt_pk_bf16_f32 v77, v50, v51
    v_cvt_pk_bf16_f32 v78, v52, v53
    v_cvt_pk_bf16_f32 v79, v54, v55
    v_mfma_f32_32x32x16_bf16 v[40:55], a[8:11], v[120:123], 0
    s_mul_i32 s82, s80, 5376
    s_add_u32 s83, s82, 2688
    v_exp_f32 v56, v56
    v_exp_f32 v57, v57
    v_exp_f32 v58, v58
    v_exp_f32 v59, v59
    v_cvt_pk_bf16_f32 v80, v56, v57
    v_mfma_f32_32x32x16_bf16 v[224:239], a[28:31], v[72:75], v[224:239]
    buffer_atomic_add_f32 v161, v187, s[16:19], s57 offen offset:288 sc1
    v_exp_f32 v60, v60
    v_exp_f32 v61, v61
    v_exp_f32 v62, v62
    v_exp_f32 v63, v63
    v_cvt_pk_bf16_f32 v81, v58, v59
    v_cvt_pk_bf16_f32 v82, v60, v61
    v_mfma_f32_32x32x8_bf16 v[40:55], a[18:19], v[124:125], v[40:55]
    s_add_u32 s73, s45, 5120
    v_exp_f32 v64, v64
    v_exp_f32 v65, v65
    v_exp_f32 v66, v66
    v_exp_f32 v67, v67
    v_cvt_pk_bf16_f32 v83, v62, v63
    v_cvt_pk_bf16_f32 v84, v64, v65
    v_mfma_f32_32x32x16_bf16 v[224:239], a[32:35], v[76:79], v[224:239]
    s_lshl_b32 s76, s36, 9
    s_lshl_b32 s77, s43, 7
    v_exp_f32 v68, v68
    v_exp_f32 v69, v69
    v_exp_f32 v70, v70
    v_exp_f32 v71, v71
    v_cvt_pk_bf16_f32 v85, v66, v67
    v_cvt_pk_bf16_f32 v86, v68, v69
    v_cvt_pk_bf16_f32 v87, v70, v71
    v_mfma_f32_32x32x16_bf16 v[56:71], a[8:11], v[128:131], 0
    s_lshl_b32 s80, s80, 12
    s_add_u32 s76, s76, s77
    v_exp_f32 v40, v40
    v_exp_f32 v41, v41
    v_exp_f32 v42, v42
    v_exp_f32 v43, v43
    v_cvt_pk_bf16_f32 v72, v40, v41
    v_mfma_f32_32x32x16_bf16 v[240:255], a[28:31], v[80:83], v[240:255]
    buffer_load_dwordx4 a[104:107], v36, s[16:19], s80 offen offset:0 sc1
    v_exp_f32 v44, v44
    v_exp_f32 v45, v45
    v_exp_f32 v46, v46
    v_exp_f32 v47, v47
    v_cvt_pk_bf16_f32 v73, v42, v43
    v_cvt_pk_bf16_f32 v74, v44, v45
    v_mfma_f32_32x32x8_bf16 v[56:71], a[18:19], v[132:133], v[56:71]
    s_add_u32 s76, s76, 229376
    v_exp_f32 v48, v48
    v_lshlrev_b32 v5, 2, v11
    v_exp_f32 v49, v49
    v_exp_f32 v50, v50
    v_exp_f32 v51, v51
    v_cvt_pk_bf16_f32 v75, v46, v47
    v_cvt_pk_bf16_f32 v76, v48, v49
    v_mfma_f32_32x32x16_bf16 v[240:255], a[32:35], v[84:87], v[240:255]
    buffer_atomic_add_f32 v162, v187, s[16:19], s57 offen offset:448 sc1
    v_exp_f32 v52, v52
    v_exp_f32 v53, v53
    v_exp_f32 v54, v54
    v_exp_f32 v55, v55
    v_cvt_pk_bf16_f32 v77, v50, v51
    v_cvt_pk_bf16_f32 v78, v52, v53
    v_cvt_pk_bf16_f32 v79, v54, v55
    v_mfma_f32_32x32x16_bf16 v[40:55], a[8:11], v[136:139], 0
    buffer_load_dwordx4 a[120:123], v36, s[16:19], s81 offen sc1
    v_exp_f32 v56, v56
    v_lshl_add_u32 v5, v10, 8, v5
    v_exp_f32 v57, v57
    v_exp_f32 v58, v58
    v_exp_f32 v59, v59
    v_cvt_pk_bf16_f32 v80, v56, v57
    v_mfma_f32_32x32x16_bf16 v[192:207], a[36:39], v[72:75], v[192:207]
    buffer_load_dwordx4 a[124:127], v9, s[16:19], s82 offen offset:0 sc1
    v_exp_f32 v60, v60
    v_exp_f32 v61, v61
    v_exp_f32 v62, v62
    v_exp_f32 v63, v63
    v_cvt_pk_bf16_f32 v81, v58, v59
    v_cvt_pk_bf16_f32 v82, v60, v61
    v_mfma_f32_32x32x8_bf16 v[40:55], a[18:19], v[140:141], v[40:55]
    v_exp_f32 v64, v64
    v_exp_f32 v65, v65
    v_exp_f32 v66, v66
    v_exp_f32 v67, v67
    v_cvt_pk_bf16_f32 v83, v62, v63
    v_cvt_pk_bf16_f32 v84, v64, v65
    v_mfma_f32_32x32x16_bf16 v[192:207], a[40:43], v[76:79], v[192:207]
    buffer_atomic_add_f32 v163, v187, s[16:19], s57 offen offset:608 sc1
    v_exp_f32 v68, v68
    v_exp_f32 v69, v69
    v_exp_f32 v70, v70
    v_exp_f32 v71, v71
    v_cvt_pk_bf16_f32 v85, v66, v67
    v_cvt_pk_bf16_f32 v86, v68, v69
    v_cvt_pk_bf16_f32 v87, v70, v71
    v_mfma_f32_32x32x16_bf16 v[56:71], a[8:11], v[144:147], 0
    buffer_load_dwordx4 a[128:131], v9, s[16:19], s82 offen offset:672 sc1
    v_exp_f32 v40, v40
    v_exp_f32 v41, v41
    v_exp_f32 v42, v42
    v_exp_f32 v43, v43
    v_cvt_pk_bf16_f32 v72, v40, v41
    v_mfma_f32_32x32x16_bf16 v[208:223], a[36:39], v[80:83], v[208:223]
    buffer_load_dwordx4 a[108:111], v36, s[16:19], s80 offen offset:1024 sc1
    v_exp_f32 v44, v44
    v_exp_f32 v45, v45
    v_exp_f32 v46, v46
    v_exp_f32 v47, v47
    v_cvt_pk_bf16_f32 v73, v42, v43
    v_cvt_pk_bf16_f32 v74, v44, v45
    v_mfma_f32_32x32x8_bf16 v[56:71], a[18:19], v[148:149], v[56:71]
    v_exp_f32 v48, v48
    v_exp_f32 v49, v49
    v_exp_f32 v50, v50
    v_exp_f32 v51, v51
    v_cvt_pk_bf16_f32 v75, v46, v47
    v_cvt_pk_bf16_f32 v76, v48, v49
    v_mfma_f32_32x32x16_bf16 v[208:223], a[40:43], v[84:87], v[208:223]
    buffer_atomic_add_f32 v164, v188, s[16:19], s57 offen offset:0 sc1
    v_exp_f32 v52, v52
    v_exp_f32 v53, v53
    v_exp_f32 v54, v54
    v_exp_f32 v55, v55
    v_cvt_pk_bf16_f32 v77, v50, v51
    v_cvt_pk_bf16_f32 v78, v52, v53
    v_cvt_pk_bf16_f32 v79, v54, v55
    v_mfma_f32_32x32x16_bf16 v[40:55], a[12:15], v[120:123], 0
    buffer_load_dwordx4 a[132:135], v9, s[16:19], s82 offen offset:1344 sc1
    v_exp_f32 v56, v56
    v_exp_f32 v57, v57
    v_exp_f32 v58, v58
    v_exp_f32 v59, v59
    v_cvt_pk_bf16_f32 v80, v56, v57
    v_mfma_f32_32x32x16_bf16 v[224:239], a[36:39], v[72:75], v[224:239]
    buffer_load_dwordx4 a[136:139], v9, s[16:19], s82 offen offset:2016 sc1
    v_exp_f32 v60, v60
    v_exp_f32 v61, v61
    v_exp_f32 v62, v62
    v_exp_f32 v63, v63
    v_cvt_pk_bf16_f32 v81, v58, v59
    v_cvt_pk_bf16_f32 v82, v60, v61
    v_mfma_f32_32x32x8_bf16 v[40:55], a[18:19], v[126:127], v[40:55]
    v_exp_f32 v64, v64
    v_exp_f32 v65, v65
    v_exp_f32 v66, v66
    v_exp_f32 v67, v67
    v_cvt_pk_bf16_f32 v83, v62, v63
    v_cvt_pk_bf16_f32 v84, v64, v65
    v_mfma_f32_32x32x16_bf16 v[224:239], a[40:43], v[76:79], v[224:239]
    buffer_atomic_add_f32 v165, v190, s[16:19], s57 offen offset:160 sc1
    v_exp_f32 v68, v68
    v_exp_f32 v69, v69
    v_exp_f32 v70, v70
    v_exp_f32 v71, v71
    v_cvt_pk_bf16_f32 v85, v66, v67
    v_cvt_pk_bf16_f32 v86, v68, v69
    v_cvt_pk_bf16_f32 v87, v70, v71
    v_mfma_f32_32x32x16_bf16 v[56:71], a[12:15], v[128:131], 0
    buffer_load_dwordx4 a[112:115], v36, s[16:19], s80 offen offset:2048 sc1
    v_exp_f32 v40, v40
    v_exp_f32 v41, v41
    v_exp_f32 v42, v42
    v_exp_f32 v43, v43
    v_cvt_pk_bf16_f32 v72, v40, v41
    v_mfma_f32_32x32x16_bf16 v[240:255], a[36:39], v[80:83], v[240:255]
    buffer_load_dwordx4 a[140:143], v9, s[16:19], s83 offen offset:0 sc1
    v_exp_f32 v44, v44
    v_exp_f32 v45, v45
    v_exp_f32 v46, v46
    v_exp_f32 v47, v47
    v_cvt_pk_bf16_f32 v73, v42, v43
    v_cvt_pk_bf16_f32 v74, v44, v45
    v_mfma_f32_32x32x8_bf16 v[56:71], a[18:19], v[134:135], v[56:71]
    v_exp_f32 v48, v48
    v_exp_f32 v49, v49
    v_exp_f32 v50, v50
    v_exp_f32 v51, v51
    v_cvt_pk_bf16_f32 v75, v46, v47
    v_cvt_pk_bf16_f32 v76, v48, v49
    v_mfma_f32_32x32x16_bf16 v[240:255], a[40:43], v[84:87], v[240:255]
    buffer_atomic_add_f32 v166, v190, s[16:19], s57 offen offset:320 sc1
    v_exp_f32 v52, v52
    v_exp_f32 v53, v53
    v_exp_f32 v54, v54
    v_exp_f32 v55, v55
    v_cvt_pk_bf16_f32 v77, v50, v51
    v_cvt_pk_bf16_f32 v78, v52, v53
    v_cvt_pk_bf16_f32 v79, v54, v55
    v_mfma_f32_32x32x16_bf16 v[40:55], a[12:15], v[136:139], 0
    buffer_load_dwordx4 a[144:147], v9, s[16:19], s83 offen offset:672 sc1
    v_exp_f32 v56, v56
    v_exp_f32 v57, v57
    v_exp_f32 v58, v58
    v_exp_f32 v59, v59
    v_cvt_pk_bf16_f32 v80, v56, v57
    v_mfma_f32_32x32x16_bf16 v[192:207], a[44:47], v[72:75], v[192:207]
    buffer_load_dwordx4 a[116:119], v36, s[16:19], s80 offen offset:3072 sc1
    v_exp_f32 v60, v60
    v_exp_f32 v61, v61
    v_exp_f32 v62, v62
    v_exp_f32 v63, v63
    v_cvt_pk_bf16_f32 v81, v58, v59
    v_cvt_pk_bf16_f32 v82, v60, v61
    v_mfma_f32_32x32x8_bf16 v[40:55], a[18:19], v[142:143], v[40:55]
    v_exp_f32 v64, v64
    v_exp_f32 v65, v65
    v_exp_f32 v66, v66
    v_exp_f32 v67, v67
    v_cvt_pk_bf16_f32 v83, v62, v63
    v_cvt_pk_bf16_f32 v84, v64, v65
    v_mfma_f32_32x32x16_bf16 v[192:207], a[48:51], v[76:79], v[192:207]
    buffer_atomic_add_f32 v167, v190, s[16:19], s57 offen offset:480 sc1
    v_exp_f32 v68, v68
    v_exp_f32 v69, v69
    v_exp_f32 v70, v70
    v_exp_f32 v71, v71
    v_cvt_pk_bf16_f32 v85, v66, v67
    v_cvt_pk_bf16_f32 v86, v68, v69
    v_cvt_pk_bf16_f32 v87, v70, v71
    v_mfma_f32_32x32x16_bf16 v[56:71], a[12:15], v[144:147], 0
    buffer_load_dwordx4 a[148:151], v9, s[16:19], s83 offen offset:1344 sc1
    v_exp_f32 v40, v40
    v_exp_f32 v41, v41
    v_exp_f32 v42, v42
    v_exp_f32 v43, v43
    v_cvt_pk_bf16_f32 v72, v40, v41
    v_mfma_f32_32x32x16_bf16 v[208:223], a[44:47], v[80:83], v[208:223]
    buffer_load_dwordx4 a[152:155], v9, s[16:19], s83 offen offset:2016 sc1
    v_exp_f32 v44, v44
    v_exp_f32 v45, v45
    v_exp_f32 v46, v46
    v_exp_f32 v47, v47
    v_cvt_pk_bf16_f32 v73, v42, v43
    v_cvt_pk_bf16_f32 v74, v44, v45
    v_mfma_f32_32x32x8_bf16 v[56:71], a[18:19], v[150:151], v[56:71]
    s_waitcnt vmcnt(26)
    v_exp_f32 v48, v48
    v_exp_f32 v49, v49
    v_exp_f32 v50, v50
    v_exp_f32 v51, v51
L_pd6979:
    s_cbranch_execz L_pd9118
    v_cvt_pk_bf16_f32 v75, v46, v47
    v_cvt_pk_bf16_f32 v76, v48, v49
    v_mfma_f32_32x32x16_bf16 v[208:223], a[48:51], v[84:87], v[208:223]
    buffer_atomic_add_f32 v168, v188, s[16:19], s57 offen offset:64 sc1
    v_exp_f32 v52, v52
    v_exp_f32 v53, v53
    v_exp_f32 v54, v54
    v_exp_f32 v55, v55
    v_cvt_pk_bf16_f32 v77, v50, v51
    v_cvt_pk_bf16_f32 v78, v52, v53
    v_cvt_pk_bf16_f32 v79, v54, v55
    v_mfma_f32_32x32x16_bf16 v[40:55], a[52:55], v[120:123], 0
    buffer_atomic_add_f32 v169, v190, s[16:19], s57 offen offset:224 sc1
    v_exp_f32 v56, v56
    v_exp_f32 v57, v57
    v_exp_f32 v58, v58
    v_exp_f32 v59, v59
    v_cvt_pk_bf16_f32 v80, v56, v57
    v_mfma_f32_32x32x16_bf16 v[224:239], a[44:47], v[72:75], v[224:239]
    buffer_load_dword v19, v5, s[16:19], s76 offen sc1
    v_exp_f32 v60, v60
    v_exp_f32 v61, v61
    v_exp_f32 v62, v62
    v_exp_f32 v63, v63
    v_cvt_pk_bf16_f32 v81, v58, v59
    v_cvt_pk_bf16_f32 v82, v60, v61
    v_mfma_f32_32x32x8_bf16 v[40:55], a[68:69], v[124:125], v[40:55]
    s_lshl_b32 s76, s36, 13
    v_exp_f32 v64, v64
    v_exp_f32 v65, v65
    v_exp_f32 v66, v66
    v_exp_f32 v67, v67
    v_cvt_pk_bf16_f32 v83, v62, v63
    v_cvt_pk_bf16_f32 v84, v64, v65
    v_mfma_f32_32x32x16_bf16 v[224:239], a[48:51], v[76:79], v[224:239]
    s_lshl_b32 s77, s43, 11
    s_add_u32 s46, s76, s77
    v_exp_f32 v68, v68
    v_exp_f32 v69, v69
    v_exp_f32 v70, v70
    v_exp_f32 v71, v71
    v_cvt_pk_bf16_f32 v85, v66, v67
    v_cvt_pk_bf16_f32 v86, v68, v69
    v_cvt_pk_bf16_f32 v87, v70, v71
    v_mfma_f32_32x32x16_bf16 v[56:71], a[52:55], v[128:131], 0
    buffer_atomic_add_f32 v170, v190, s[16:19], s57 offen offset:384 sc1
    v_exp_f32 v40, v40
    v_exp_f32 v41, v41
    v_exp_f32 v42, v42
    v_exp_f32 v43, v43
    v_cvt_pk_bf16_f32 v72, v40, v41
    v_mfma_f32_32x32x16_bf16 v[240:255], a[44:47], v[80:83], v[240:255]
    s_lshl_b32 s77, s41, 7
    s_add_u32 s46, s46, s77
    v_exp_f32 v44, v44
    v_exp_f32 v45, v45
    v_exp_f32 v46, v46
    v_exp_f32 v47, v47
    v_cvt_pk_bf16_f32 v73, v42, v43
    v_cvt_pk_bf16_f32 v74, v44, v45
    v_mfma_f32_32x32x8_bf16 v[56:71], a[68:69], v[132:133], v[56:71]
    s_lshl_b32 s77, s42, 6
    v_exp_f32 v48, v48
    v_exp_f32 v49, v49
    v_exp_f32 v50, v50
    v_exp_f32 v51, v51
    v_cvt_pk_bf16_f32 v75, v46, v47
    v_cvt_pk_bf16_f32 v76, v48, v49
    v_mfma_f32_32x32x16_bf16 v[240:255], a[48:51], v[84:87], v[240:255]
    s_add_u32 s46, s46, s77
    s_waitcnt vmcnt(27)
    v_exp_f32 v52, v52
    v_exp_f32 v53, v53
    v_exp_f32 v54, v54
    v_exp_f32 v55, v55
    v_cvt_pk_bf16_f32 v77, v50, v51
    v_cvt_pk_bf16_f32 v78, v52, v53
    v_cvt_pk_bf16_f32 v79, v54, v55
    ds_read_b64_tr_b16 v[96:97], v91 offset:0
    v_mfma_f32_32x32x16_bf16 v[40:55], a[52:55], v[136:139], 0
    buffer_atomic_add_f32 v171, v190, s[16:19], s57 offen offset:544 sc1
    v_exp_f32 v56, v56
    v_exp_f32 v57, v57
    v_exp_f32 v58, v58
    v_exp_f32 v59, v59
    v_cvt_pk_bf16_f32 v80, v56, v57
    v_mfma_f32_32x32x16_bf16 v[192:207], a[72:75], v[72:75], v[192:207]
    s_add_u32 s46, s46, 393216
    s_add_u32 s47, s46, 4096
    v_exp_f32 v60, v60
    v_exp_f32 v61, v61
    v_exp_f32 v62, v62
    v_exp_f32 v63, v63
    v_cvt_pk_bf16_f32 v81, v58, v59
    v_cvt_pk_bf16_f32 v82, v60, v61
    v_mfma_f32_32x32x8_bf16 v[40:55], a[68:69], v[140:141], v[40:55]
    s_lshl_b32 s77, s39, 11
    v_exp_f32 v64, v64
    v_exp_f32 v65, v65
    v_exp_f32 v66, v66
    v_exp_f32 v67, v67
    v_cvt_pk_bf16_f32 v83, v62, v63
    v_cvt_pk_bf16_f32 v84, v64, v65
    v_mfma_f32_32x32x16_bf16 v[192:207], a[76:79], v[76:79], v[192:207]
    ds_read_b64_tr_b16 v[98:99], v91 offset:640
    ds_read_b64_tr_b16 v[100:101], v92 offset:0
    v_exp_f32 v68, v68
    v_exp_f32 v69, v69
    v_exp_f32 v70, v70
    v_exp_f32 v71, v71
    v_cvt_pk_bf16_f32 v85, v66, v67
    v_cvt_pk_bf16_f32 v86, v68, v69
    v_cvt_pk_bf16_f32 v87, v70, v71
    v_mfma_f32_32x32x16_bf16 v[56:71], a[52:55], v[144:147], 0
    buffer_atomic_add_f32 v172, v189, s[16:19], s57 offen offset:128 sc1
    v_exp_f32 v40, v40
    v_exp_f32 v41, v41
    v_exp_f32 v42, v42
    v_exp_f32 v43, v43
    v_cvt_pk_bf16_f32 v72, v40, v41
    v_mfma_f32_32x32x16_bf16 v[208:223], a[72:75], v[80:83], v[208:223]
    s_add_u32 s48, s76, s77
    s_lshl_b32 s77, s38, 9
    v_exp_f32 v44, v44
    v_exp_f32 v45, v45
    v_exp_f32 v46, v46
    v_exp_f32 v47, v47
    v_cvt_pk_bf16_f32 v73, v42, v43
    v_cvt_pk_bf16_f32 v74, v44, v45
    v_mfma_f32_32x32x8_bf16 v[56:71], a[68:69], v[148:149], v[56:71]
    s_add_u32 s48, s48, s77
    v_exp_f32 v48, v48
    v_exp_f32 v49, v49
    v_exp_f32 v50, v50
    v_exp_f32 v51, v51
    v_cvt_pk_bf16_f32 v75, v46, v47
    v_cvt_pk_bf16_f32 v76, v48, v49
    v_mfma_f32_32x32x16_bf16 v[208:223], a[76:79], v[84:87], v[208:223]
    ds_read_b64_tr_b16 v[102:103], v92 offset:640
    v_exp_f32 v52, v52
    v_exp_f32 v53, v53
    v_exp_f32 v54, v54
    v_exp_f32 v55, v55
    v_cvt_pk_bf16_f32 v77, v50, v51
    v_cvt_pk_bf16_f32 v78, v52, v53
    v_cvt_pk_bf16_f32 v79, v54, v55
    s_waitcnt lgkmcnt(2)
    buffer_store_dwordx4 v[96:99], v93, s[16:19], 0 offen sc1
    v_mfma_f32_32x32x16_bf16 v[40:55], a[56:59], v[120:123], 0
    buffer_atomic_add_f32 v173, v191, s[16:19], s57 offen offset:288 sc1
    v_exp_f32 v56, v56
    v_exp_f32 v57, v57
    v_exp_f32 v58, v58
    v_exp_f32 v59, v59
    v_cvt_pk_bf16_f32 v80, v56, v57
    v_mfma_f32_32x32x16_bf16 v[224:239], a[72:75], v[72:75], v[224:239]
    s_add_u32 s48, s48, 393216
    s_add_u32 s49, s48, 4096
    v_exp_f32 v60, v60
    v_lshlrev_b32 v33, 6, v1
    v_exp_f32 v61, v61
    v_exp_f32 v62, v62
    v_exp_f32 v63, v63
    v_cvt_pk_bf16_f32 v81, v58, v59
    v_cvt_pk_bf16_f32 v82, v60, v61
    v_mfma_f32_32x32x8_bf16 v[40:55], a[68:69], v[126:127], v[40:55]
    v_exp_f32 v64, v64
    v_exp_f32 v65, v65
    v_exp_f32 v66, v66
    v_exp_f32 v67, v67
    v_cvt_pk_bf16_f32 v83, v62, v63
    v_cvt_pk_bf16_f32 v84, v64, v65
    v_mfma_f32_32x32x16_bf16 v[224:239], a[76:79], v[76:79], v[224:239]
    s_waitcnt lgkmcnt(0)
    buffer_store_dwordx4 v[100:103], v94, s[16:19], 0 offen sc1
    v_exp_f32 v68, v68
    v_exp_f32 v69, v69
    v_exp_f32 v70, v70
    v_exp_f32 v71, v71
    v_cvt_pk_bf16_f32 v85, v66, v67
    v_cvt_pk_bf16_f32 v86, v68, v69
    v_cvt_pk_bf16_f32 v87, v70, v71
    v_mfma_f32_32x32x16_bf16 v[56:71], a[56:59], v[128:131], 0
    buffer_atomic_add_f32 v174, v191, s[16:19], s57 offen offset:448 sc1
    v_exp_f32 v40, v40
    v_exp_f32 v41, v41
    v_exp_f32 v42, v42
    v_exp_f32 v43, v43
    v_cvt_pk_bf16_f32 v72, v40, v41
    v_mfma_f32_32x32x16_bf16 v[240:255], a[72:75], v[80:83], v[240:255]
    s_mul_i32 s76, s37, 204800
    s_mul_i32 s77, s38, 51200
    v_exp_f32 v44, v44
    v_exp_f32 v45, v45
    v_exp_f32 v46, v46
    v_exp_f32 v47, v47
    v_cvt_pk_bf16_f32 v73, v42, v43
    v_cvt_pk_bf16_f32 v74, v44, v45
    v_mfma_f32_32x32x8_bf16 v[56:71], a[68:69], v[134:135], v[56:71]
    s_add_u32 s76, s76, s77
    v_exp_f32 v48, v48
    v_exp_f32 v49, v49
    v_exp_f32 v50, v50
    v_exp_f32 v51, v51
    v_cvt_pk_bf16_f32 v75, v46, v47
    v_cvt_pk_bf16_f32 v76, v48, v49
    v_mfma_f32_32x32x16_bf16 v[240:255], a[76:79], v[84:87], v[240:255]
    v_exp_f32 v52, v52
    v_exp_f32 v53, v53
    v_exp_f32 v54, v54
    v_exp_f32 v55, v55
    v_cvt_pk_bf16_f32 v77, v50, v51
    v_cvt_pk_bf16_f32 v78, v52, v53
    v_cvt_pk_bf16_f32 v79, v54, v55
    v_mfma_f32_32x32x16_bf16 v[40:55], a[56:59], v[136:139], 0
    buffer_atomic_add_f32 v175, v191, s[16:19], s57 offen offset:608 sc1
    v_exp_f32 v56, v56
    v_exp_f32 v57, v57
    v_exp_f32 v58, v58
    v_exp_f32 v59, v59
    v_cvt_pk_bf16_f32 v80, v56, v57
    v_mfma_f32_32x32x16_bf16 v[192:207], a[80:83], v[72:75], v[192:207]
    s_add_u32 s50, s76, 9437184
    s_add_u32 s51, s76, 9449472
    v_exp_f32 v60, v60
    v_exp_f32 v61, v61
    v_exp_f32 v62, v62
    v_exp_f32 v63, v63
    v_cvt_pk_bf16_f32 v81, v58, v59
    v_cvt_pk_bf16_f32 v82, v60, v61
    v_mfma_f32_32x32x8_bf16 v[40:55], a[68:69], v[142:143], v[40:55]
    s_add_u32 s52, s76, 9461760
    v_exp_f32 v64, v64
    v_exp_f32 v65, v65
    v_exp_f32 v66, v66
    v_exp_f32 v67, v67
    v_cvt_pk_bf16_f32 v83, v62, v63
    v_cvt_pk_bf16_f32 v84, v64, v65
    v_mfma_f32_32x32x16_bf16 v[192:207], a[84:87], v[76:79], v[192:207]
    v_exp_f32 v68, v68
    v_exp_f32 v69, v69
    v_exp_f32 v70, v70
    v_exp_f32 v71, v71
    v_cvt_pk_bf16_f32 v85, v66, v67
    v_cvt_pk_bf16_f32 v86, v68, v69
    v_cvt_pk_bf16_f32 v87, v70, v71
    v_mfma_f32_32x32x16_bf16 v[56:71], a[56:59], v[144:147], 0
    s_add_u32 s53, s76, 9474048
    s_add_u32 s54, s76, 9486336
    v_exp_f32 v40, v40
    v_exp_f32 v41, v41
    v_exp_f32 v42, v42
    v_exp_f32 v43, v43
    v_cvt_pk_bf16_f32 v72, v40, v41
    v_mfma_f32_32x32x16_bf16 v[208:223], a[80:83], v[80:83], v[208:223]
    s_lshl_b32 s76, s36, 2
    v_exp_f32 v44, v44
    v_exp_f32 v45, v45
    v_exp_f32 v46, v46
    v_exp_f32 v47, v47
    v_cvt_pk_bf16_f32 v73, v42, v43
    v_cvt_pk_bf16_f32 v74, v44, v45
    v_mfma_f32_32x32x8_bf16 v[56:71], a[68:69], v[150:151], v[56:71]
    v_exp_f32 v48, v48
    v_exp_f32 v49, v49
    v_exp_f32 v50, v50
    v_exp_f32 v51, v51
    v_cvt_pk_bf16_f32 v75, v46, v47
    v_cvt_pk_bf16_f32 v76, v48, v49
    v_mfma_f32_32x32x16_bf16 v[208:223], a[84:87], v[84:87], v[208:223]
    v_exp_f32 v52, v52
    v_exp_f32 v53, v53
    v_exp_f32 v54, v54
    v_exp_f32 v55, v55
    v_cvt_pk_bf16_f32 v77, v50, v51
    v_cvt_pk_bf16_f32 v78, v52, v53
    v_cvt_pk_bf16_f32 v79, v54, v55
    v_mfma_f32_32x32x16_bf16 v[40:55], a[60:63], v[120:123], 0
    s_add_u32 s76, s76, s39
    s_mul_i32 s76, s76, 81920
    v_exp_f32 v56, v56
    v_exp_f32 v57, v57
    v_exp_f32 v58, v58
    v_exp_f32 v59, v59
    v_cvt_pk_bf16_f32 v80, v56, v57
    v_mfma_f32_32x32x16_bf16 v[224:239], a[80:83], v[72:75], v[224:239]
    s_mul_i32 s77, s38, 10240
    v_exp_f32 v60, v60
    v_exp_f32 v61, v61
    v_exp_f32 v62, v62
    v_exp_f32 v63, v63
    v_cvt_pk_bf16_f32 v81, v58, v59
    v_cvt_pk_bf16_f32 v82, v60, v61
    v_mfma_f32_32x32x8_bf16 v[40:55], a[70:71], v[124:125], v[40:55]
    v_exp_f32 v64, v64
    v_exp_f32 v65, v65
    v_exp_f32 v66, v66
    v_exp_f32 v67, v67
    v_cvt_pk_bf16_f32 v83, v62, v63
    v_cvt_pk_bf16_f32 v84, v64, v65
    v_mfma_f32_32x32x16_bf16 v[224:239], a[84:87], v[76:79], v[224:239]
    v_exp_f32 v68, v68
    v_exp_f32 v69, v69
    v_exp_f32 v70, v70
    v_exp_f32 v71, v71
    v_cvt_pk_bf16_f32 v85, v66, v67
    v_cvt_pk_bf16_f32 v86, v68, v69
    v_cvt_pk_bf16_f32 v87, v70, v71
    v_mfma_f32_32x32x16_bf16 v[56:71], a[60:63], v[128:131], 0
    s_add_u32 s76, s76, s77
    s_add_u32 s64, s76, 2097152
    v_exp_f32 v40, v40
    v_exp_f32 v41, v41
    v_exp_f32 v42, v42
    v_exp_f32 v43, v43
    v_cvt_pk_bf16_f32 v72, v40, v41
    v_mfma_f32_32x32x16_bf16 v[240:255], a[80:83], v[80:83], v[240:255]
    s_add_u32 s65, s76, 2138112
    v_exp_f32 v44, v44
    v_exp_f32 v45, v45
    v_exp_f32 v46, v46
    v_exp_f32 v47, v47
    v_cvt_pk_bf16_f32 v73, v42, v43
    v_cvt_pk_bf16_f32 v74, v44, v45
    v_mfma_f32_32x32x8_bf16 v[56:71], a[70:71], v[132:133], v[56:71]
    v_exp_f32 v48, v48
    v_exp_f32 v49, v49
    v_exp_f32 v50, v50
    v_exp_f32 v51, v51
    v_cvt_pk_bf16_f32 v75, v46, v47
    v_cvt_pk_bf16_f32 v76, v48, v49
    v_mfma_f32_32x32x16_bf16 v[240:255], a[84:87], v[84:87], v[240:255]
    v_exp_f32 v52, v52
    v_exp_f32 v53, v53
    v_exp_f32 v54, v54
    v_exp_f32 v55, v55
    v_cvt_pk_bf16_f32 v77, v50, v51
    v_cvt_pk_bf16_f32 v78, v52, v53
    v_cvt_pk_bf16_f32 v79, v54, v55
    v_mfma_f32_32x32x16_bf16 v[40:55], a[60:63], v[136:139], 0
    s_add_u32 s66, s76, 2260992
    s_add_u32 s67, s76, 2301952
    v_exp_f32 v56, v56
    v_add_u32 v5, 0, v0
    v_exp_f32 v57, v57
    v_exp_f32 v58, v58
    v_exp_f32 v59, v59
    v_cvt_pk_bf16_f32 v80, v56, v57
    v_mfma_f32_32x32x16_bf16 v[192:207], a[88:91], v[72:75], v[192:207]
    v_exp_f32 v60, v60
    v_exp_f32 v61, v61
    v_exp_f32 v62, v62
    v_exp_f32 v63, v63
    v_cvt_pk_bf16_f32 v81, v58, v59
    v_cvt_pk_bf16_f32 v82, v60, v61
    v_mfma_f32_32x32x8_bf16 v[40:55], a[70:71], v[140:141], v[40:55]
    v_exp_f32 v64, v64
    v_exp_f32 v65, v65
    v_exp_f32 v66, v66
    v_exp_f32 v67, v67
    v_cvt_pk_bf16_f32 v83, v62, v63
    v_cvt_pk_bf16_f32 v84, v64, v65
    v_mfma_f32_32x32x16_bf16 v[192:207], a[92:95], v[76:79], v[192:207]
    v_exp_f32 v68, v68
    v_exp_f32 v69, v69
    v_exp_f32 v70, v70
    v_exp_f32 v71, v71
    v_cvt_pk_bf16_f32 v85, v66, v67
    v_cvt_pk_bf16_f32 v86, v68, v69
    v_cvt_pk_bf16_f32 v87, v70, v71
    v_mfma_f32_32x32x16_bf16 v[56:71], a[60:63], v[144:147], 0
    v_exp_f32 v40, v40
    v_lshlrev_b32 v29, 4, v5
    v_exp_f32 v41, v41
    v_lshlrev_b32 v31, 3, v5
    v_exp_f32 v42, v42
    v_add_u32 v31, 143360, v31
    v_exp_f32 v43, v43
    v_cvt_pk_bf16_f32 v72, v40, v41
    v_mfma_f32_32x32x16_bf16 v[208:223], a[88:91], v[80:83], v[208:223]
    v_exp_f32 v44, v44
    v_exp_f32 v45, v45
    v_exp_f32 v46, v46
    v_exp_f32 v47, v47
    v_cvt_pk_bf16_f32 v73, v42, v43
    v_cvt_pk_bf16_f32 v74, v44, v45
    v_mfma_f32_32x32x8_bf16 v[56:71], a[70:71], v[148:149], v[56:71]
    v_exp_f32 v48, v48
    v_exp_f32 v49, v49
    v_exp_f32 v50, v50
    v_exp_f32 v51, v51
    v_cvt_pk_bf16_f32 v75, v46, v47
    v_cvt_pk_bf16_f32 v76, v48, v49
    v_mfma_f32_32x32x16_bf16 v[208:223], a[92:95], v[84:87], v[208:223]
    v_exp_f32 v52, v52
    v_exp_f32 v53, v53
    v_exp_f32 v54, v54
    v_exp_f32 v55, v55
    v_cvt_pk_bf16_f32 v77, v50, v51
    v_cvt_pk_bf16_f32 v78, v52, v53
    v_cvt_pk_bf16_f32 v79, v54, v55
    v_mfma_f32_32x32x16_bf16 v[40:55], a[64:67], v[120:123], 0
    v_exp_f32 v56, v56
    v_add_u32 v5, 256, v0
    v_exp_f32 v57, v57
    v_min_u32 v5, 420, v5
    v_exp_f32 v58, v58
    v_lshlrev_b32 v30, 4, v5
    v_exp_f32 v59, v59
    v_cvt_pk_bf16_f32 v80, v56, v57
    v_mfma_f32_32x32x16_bf16 v[224:239], a[88:91], v[72:75], v[224:239]
    v_exp_f32 v60, v60
    v_exp_f32 v61, v61
    v_exp_f32 v62, v62
    v_exp_f32 v63, v63
    v_cvt_pk_bf16_f32 v81, v58, v59
    v_cvt_pk_bf16_f32 v82, v60, v61
    v_mfma_f32_32x32x8_bf16 v[40:55], a[70:71], v[126:127], v[40:55]
    v_exp_f32 v64, v64
    v_exp_f32 v65, v65
    v_exp_f32 v66, v66
    v_exp_f32 v67, v67
    v_cvt_pk_bf16_f32 v83, v62, v63
    v_cvt_pk_bf16_f32 v84, v64, v65
    v_mfma_f32_32x32x16_bf16 v[224:239], a[92:95], v[76:79], v[224:239]
    v_exp_f32 v68, v68
    v_exp_f32 v69, v69
    v_exp_f32 v70, v70
    v_exp_f32 v71, v71
    v_cvt_pk_bf16_f32 v85, v66, v67
    v_cvt_pk_bf16_f32 v86, v68, v69
    v_cvt_pk_bf16_f32 v87, v70, v71
    v_mfma_f32_32x32x16_bf16 v[56:71], a[64:67], v[128:131], 0
    v_exp_f32 v40, v40
    v_lshlrev_b32 v32, 3, v5
    v_exp_f32 v41, v41
    v_add_u32 v32, 143360, v32
    v_exp_f32 v42, v42
    v_exp_f32 v43, v43
    v_cvt_pk_bf16_f32 v72, v40, v41
    v_mfma_f32_32x32x16_bf16 v[240:255], a[88:91], v[80:83], v[240:255]
    s_mul_i32 s55, s41, 6720
    v_exp_f32 v44, v44
    v_exp_f32 v45, v45
    v_exp_f32 v46, v46
    v_exp_f32 v47, v47
    v_cvt_pk_bf16_f32 v73, v42, v43
    v_cvt_pk_bf16_f32 v74, v44, v45
    v_mfma_f32_32x32x8_bf16 v[56:71], a[70:71], v[134:135], v[56:71]
    v_exp_f32 v48, v48
    v_exp_f32 v49, v49
    v_exp_f32 v50, v50
    v_exp_f32 v51, v51
    v_cvt_pk_bf16_f32 v75, v46, v47
    v_cvt_pk_bf16_f32 v76, v48, v49
    v_mfma_f32_32x32x16_bf16 v[240:255], a[92:95], v[84:87], v[240:255]
    v_exp_f32 v52, v52
    v_exp_f32 v53, v53
    v_exp_f32 v54, v54
    v_exp_f32 v55, v55
    v_cvt_pk_bf16_f32 v77, v50, v51
    v_cvt_pk_bf16_f32 v78, v52, v53
    v_cvt_pk_bf16_f32 v79, v54, v55
    v_mfma_f32_32x32x16_bf16 v[40:55], a[64:67], v[136:139], 0
    s_add_u32 s55, s55, 262144
    s_lshl_b32 s56, s37, 7
    v_exp_f32 v56, v56
    v_exp_f32 v57, v57
    v_exp_f32 v58, v58
    v_exp_f32 v59, v59
    v_cvt_pk_bf16_f32 v80, v56, v57
    v_mfma_f32_32x32x16_bf16 v[192:207], a[96:99], v[72:75], v[192:207]
    s_add_u32 s56, s56, 245760
    v_exp_f32 v60, v60
    v_exp_f32 v61, v61
    v_exp_f32 v62, v62
    v_exp_f32 v63, v63
    v_cvt_pk_bf16_f32 v81, v58, v59
    v_cvt_pk_bf16_f32 v82, v60, v61
    v_mfma_f32_32x32x8_bf16 v[40:55], a[70:71], v[142:143], v[40:55]
    v_exp_f32 v64, v64
    v_exp_f32 v65, v65
    v_exp_f32 v66, v66
    v_exp_f32 v67, v67
    v_cvt_pk_bf16_f32 v83, v62, v63
    v_cvt_pk_bf16_f32 v84, v64, v65
    v_mfma_f32_32x32x16_bf16 v[192:207], a[100:103], v[76:79], v[192:207]
    v_exp_f32 v68, v68
    v_exp_f32 v69, v69
    v_exp_f32 v70, v70
    v_exp_f32 v71, v71
    v_cvt_pk_bf16_f32 v85, v66, v67
    v_cvt_pk_bf16_f32 v86, v68, v69
    v_cvt_pk_bf16_f32 v87, v70, v71
    v_mfma_f32_32x32x16_bf16 v[56:71], a[64:67], v[144:147], 0
    s_waitcnt vmcnt(11)
    v_exp_f32 v40, v40
    v_exp_f32 v41, v41
    v_exp_f32 v42, v42
    v_exp_f32 v43, v43
    v_cvt_pk_bf16_f32 v72, v40, v41
    v_mfma_f32_32x32x16_bf16 v[208:223], a[96:99], v[80:83], v[208:223]
    v_exp_f32 v44, v44
    v_exp_f32 v45, v45
    v_exp_f32 v46, v46
    v_exp_f32 v47, v47
    v_cvt_pk_bf16_f32 v73, v42, v43
    v_cvt_pk_bf16_f32 v74, v44, v45
    v_mfma_f32_32x32x8_bf16 v[56:71], a[70:71], v[150:151], v[56:71]
    v_exp_f32 v48, v48
    v_exp_f32 v49, v49
    v_exp_f32 v50, v50
    v_exp_f32 v51, v51
    v_cvt_pk_bf16_f32 v75, v46, v47
    v_cvt_pk_bf16_f32 v76, v48, v49
    v_mfma_f32_32x32x16_bf16 v[208:223], a[100:103], v[84:87], v[208:223]
    v_exp_f32 v52, v52
    v_exp_f32 v53, v53
    v_exp_f32 v54, v54
    v_exp_f32 v55, v55
    v_cvt_pk_bf16_f32 v77, v50, v51
    v_cvt_pk_bf16_f32 v78, v52, v53
    v_cvt_pk_bf16_f32 v79, v54, v55
    v_mfma_f32_32x32x16_bf16 v[40:55], a[104:107], v[120:123], 0
    v_exp_f32 v56, v56
    v_exp_f32 v57, v57
    v_exp_f32 v58, v58
    v_exp_f32 v59, v59
    v_cvt_pk_bf16_f32 v80, v56, v57
    v_mfma_f32_32x32x16_bf16 v[224:239], a[96:99], v[72:75], v[224:239]
    v_exp_f32 v60, v60
    v_exp_f32 v61, v61
    v_exp_f32 v62, v62
    v_exp_f32 v63, v63
    v_cvt_pk_bf16_f32 v81, v58, v59
    v_cvt_pk_bf16_f32 v82, v60, v61
    v_mfma_f32_32x32x8_bf16 v[40:55], a[120:121], v[124:125], v[40:55]
    v_exp_f32 v64, v64
    v_exp_f32 v65, v65
    v_exp_f32 v66, v66
    v_exp_f32 v67, v67
    v_cvt_pk_bf16_f32 v83, v62, v63
    v_cvt_pk_bf16_f32 v84, v64, v65
    v_mfma_f32_32x32x16_bf16 v[224:239], a[100:103], v[76:79], v[224:239]
    v_exp_f32 v68, v68
    v_exp_f32 v69, v69
    v_exp_f32 v70, v70
    v_exp_f32 v71, v71
    v_cvt_pk_bf16_f32 v85, v66, v67
    v_cvt_pk_bf16_f32 v86, v68, v69
    v_cvt_pk_bf16_f32 v87, v70, v71
    s_waitcnt vmcnt(0)
    s_barrier
    s_nop 7
L_p2:
L_pd7535:
    s_cbranch_execz L_pd9824
    s_cmp_eq_u32 s38, 0
    s_cselect_b32 s76, s56, 0x80000000
    v_mov_b32 v5, s76
    s_mov_b64 exec, 1
    buffer_atomic_add v34, v5, s[16:19], 0 offen sc1
    s_mov_b64 exec, -1
    v_mfma_f32_32x32x16_bf16 v[56:71], a[104:107], v[128:131], 0
    v_exp_f32 v40, v40
    v_exp_f32 v41, v41
    v_exp_f32 v42, v42
    v_exp_f32 v43, v43
    v_cvt_pk_bf16_f32 v72, v40, v41
    v_mfma_f32_32x32x16_bf16 v[240:255], a[96:99], v[80:83], v[240:255]
    v_exp_f32 v44, v44
    v_exp_f32 v45, v45
    v_exp_f32 v46, v46
    v_exp_f32 v47, v47
    v_cvt_pk_bf16_f32 v73, v42, v43
    v_cvt_pk_bf16_f32 v74, v44, v45
    v_mfma_f32_32x32x8_bf16 v[56:71], a[120:121], v[132:133], v[56:71]
    v_exp_f32 v48, v48
    v_exp_f32 v49, v49
    v_exp_f32 v50, v50
    v_exp_f32 v51, v51
    v_cvt_pk_bf16_f32 v75, v46, v47
    v_cvt_pk_bf16_f32 v76, v48, v49
    v_mfma_f32_32x32x16_bf16 v[240:255], a[100:103], v[84:87], v[240:255]
    v_exp_f32 v52, v52
    v_exp_f32 v53, v53
    v_exp_f32 v54, v54
    v_exp_f32 v55, v55
    v_cvt_pk_bf16_f32 v77, v50, v51
    v_cvt_pk_bf16_f32 v78, v52, v53
    v_cvt_pk_bf16_f32 v79, v54, v55
    v_mfma_f32_32x32x16_bf16 v[40:55], a[104:107], v[136:139], 0
    ds_read_b128 v[88:91], v16 offset:1024
    ds_read_b64 v[92:93], v17 offset:5120
    v_exp_f32 v56, v56
    v_sub_f32 v20, 1.0, v19
    v_mov_b32 v184, -1
    v_exp_f32 v57, v57
    v_mov_b32 v185, -1
    v_exp_f32 v58, v58
    v_exp_f32 v59, v59
    v_cvt_pk_bf16_f32 v80, v56, v57
    v_mfma_f32_32x32x16_bf16 v[192:207], a[124:127], v[72:75], v[192:207]
    v_exp_f32 v60, v60
    v_exp_f32 v61, v61
    v_exp_f32 v62, v62
    v_exp_f32 v63, v63
    v_cvt_pk_bf16_f32 v81, v58, v59
    v_cvt_pk_bf16_f32 v82, v60, v61
    v_mfma_f32_32x32x8_bf16 v[40:55], a[120:121], v[140:141], v[40:55]
    v_exp_f32 v64, v64
    v_exp_f32 v65, v65
    v_exp_f32 v66, v66
    v_exp_f32 v67, v67
    v_cvt_pk_bf16_f32 v83, v62, v63
    v_cvt_pk_bf16_f32 v84, v64, v65
    v_mfma_f32_32x32x16_bf16 v[192:207], a[128:131], v[76:79], v[192:207]
    v_exp_f32 v68, v68
    v_exp_f32 v69, v69
    v_exp_f32 v70, v70
    v_exp_f32 v71, v71
    v_cvt_pk_bf16_f32 v85, v66, v67
    v_cvt_pk_bf16_f32 v86, v68, v69
    v_cvt_pk_bf16_f32 v87, v70, v71
    v_mfma_f32_32x32x16_bf16 v[56:71], a[104:107], v[144:147], 0
    ds_read_b64 v[94:95], v18 offset:5120
    v_exp_f32 v40, v40
    v_sub_f32 v28, 1.0, v19
    v_mov_b32 v186, -1
    v_exp_f32 v41, v41
    v_mov_b32 v187, -1
    v_exp_f32 v42, v42
    v_exp_f32 v43, v43
    v_cvt_pk_bf16_f32 v72, v40, v41
    v_mfma_f32_32x32x16_bf16 v[208:223], a[124:127], v[80:83], v[208:223]
    v_exp_f32 v44, v44
    v_exp_f32 v45, v45
    v_exp_f32 v46, v46
    v_exp_f32 v47, v47
    v_cvt_pk_bf16_f32 v73, v42, v43
    v_cvt_pk_bf16_f32 v74, v44, v45
    v_mfma_f32_32x32x8_bf16 v[56:71], a[120:121], v[148:149], v[56:71]
    v_exp_f32 v48, v48
    v_exp_f32 v49, v49
    v_exp_f32 v50, v50
    v_exp_f32 v51, v51
    v_cvt_pk_bf16_f32 v75, v46, v47
    v_cvt_pk_bf16_f32 v76, v48, v49
    v_mfma_f32_32x32x16_bf16 v[208:223], a[128:131], v[84:87], v[208:223]
    v_exp_f32 v52, v52
    v_exp_f32 v53, v53
    v_exp_f32 v54, v54
    v_exp_f32 v55, v55
    v_cvt_pk_bf16_f32 v77, v50, v51
    v_cvt_pk_bf16_f32 v78, v52, v53
    v_cvt_pk_bf16_f32 v79, v54, v55
    v_mfma_f32_32x32x16_bf16 v[40:55], a[108:111], v[120:123], 0
    ds_read_b128 v[96:99], v16 offset:1536
    v_exp_f32 v56, v56
    v_permlane32_swap_b32 v20, v28
    v_exp_f32 v57, v57
    v_exp_f32 v58, v58
    v_exp_f32 v59, v59
    v_cvt_pk_bf16_f32 v80, v56, v57
    v_mfma_f32_32x32x16_bf16 v[224:239], a[124:127], v[72:75], v[224:239]
    buffer_store_dwordx4 v[184:187], v26, s[16:19], s73 offen sc1
    v_exp_f32 v60, v60
    v_exp_f32 v61, v61
    v_exp_f32 v62, v62
    v_exp_f32 v63, v63
    v_cvt_pk_bf16_f32 v81, v58, v59
    v_cvt_pk_bf16_f32 v82, v60, v61
    v_mfma_f32_32x32x8_bf16 v[40:55], a[120:121], v[126:127], v[40:55]
    v_exp_f32 v64, v64
    v_exp_f32 v65, v65
    v_exp_f32 v66, v66
    v_exp_f32 v67, v67
    v_cvt_pk_bf16_f32 v83, v62, v63
    v_cvt_pk_bf16_f32 v84, v64, v65
    v_mfma_f32_32x32x16_bf16 v[224:239], a[128:131], v[76:79], v[224:239]
    buffer_store_dwordx2 v[184:185], v27, s[16:19], s73 offen offset:512 sc1
    v_exp_f32 v68, v68
    v_exp_f32 v69, v69
    v_exp_f32 v70, v70
    v_exp_f32 v71, v71
    v_cvt_pk_bf16_f32 v85, v66, v67
    v_cvt_pk_bf16_f32 v86, v68, v69
    v_cvt_pk_bf16_f32 v87, v70, v71
    v_mfma_f32_32x32x16_bf16 v[56:71], a[108:111], v[128:131], 0
    ds_read_b64 v[100:101], v17 offset:5632
    v_exp_f32 v40, v40
    v_exp_f32 v41, v41
    v_exp_f32 v42, v42
    v_exp_f32 v43, v43
    v_cvt_pk_bf16_f32 v72, v40, v41
    v_mfma_f32_32x32x16_bf16 v[240:255], a[124:127], v[80:83], v[240:255]
    v_exp_f32 v44, v44
    v_exp_f32 v45, v45
    v_exp_f32 v46, v46
    v_exp_f32 v47, v47
    v_cvt_pk_bf16_f32 v73, v42, v43
    v_cvt_pk_bf16_f32 v74, v44, v45
    v_mfma_f32_32x32x8_bf16 v[56:71], a[120:121], v[134:135], v[56:71]
    v_exp_f32 v48, v48
    v_exp_f32 v49, v49
    v_exp_f32 v50, v50
    v_exp_f32 v51, v51
    v_cvt_pk_bf16_f32 v75, v46, v47
    v_cvt_pk_bf16_f32 v76, v48, v49
    v_mfma_f32_32x32x16_bf16 v[240:255], a[128:131], v[84:87], v[240:255]
L_pd7689:
    s_cbranch_execz L_pd10456
    v_exp_f32 v52, v52
    v_exp_f32 v53, v53
    v_exp_f32 v54, v54
    v_exp_f32 v55, v55
    v_cvt_pk_bf16_f32 v77, v50, v51
    v_cvt_pk_bf16_f32 v78, v52, v53
    v_cvt_pk_bf16_f32 v79, v54, v55
    v_mfma_f32_32x32x16_bf16 v[40:55], a[108:111], v[136:139], 0
    ds_read_b64 v[102:103], v18 offset:5632
    v_exp_f32 v56, v56
    v_exp_f32 v57, v57
    v_exp_f32 v58, v58
    v_exp_f32 v59, v59
    v_cvt_pk_bf16_f32 v80, v56, v57
    v_mfma_f32_32x32x16_bf16 v[192:207], a[132:135], v[72:75], v[192:207]
    v_exp_f32 v60, v60
    v_exp_f32 v61, v61
    v_exp_f32 v62, v62
    v_exp_f32 v63, v63
    v_cvt_pk_bf16_f32 v81, v58, v59
    v_cvt_pk_bf16_f32 v82, v60, v61
    v_mfma_f32_32x32x8_bf16 v[40:55], a[120:121], v[142:143], v[40:55]
    v_exp_f32 v64, v64
    v_exp_f32 v65, v65
    v_exp_f32 v66, v66
    v_exp_f32 v67, v67
    v_cvt_pk_bf16_f32 v83, v62, v63
    v_cvt_pk_bf16_f32 v84, v64, v65
    v_mfma_f32_32x32x16_bf16 v[192:207], a[136:139], v[76:79], v[192:207]
    v_exp_f32 v68, v68
    v_exp_f32 v69, v69
    v_exp_f32 v70, v70
    v_exp_f32 v71, v71
    v_cvt_pk_bf16_f32 v85, v66, v67
    v_cvt_pk_bf16_f32 v86, v68, v69
    v_cvt_pk_bf16_f32 v87, v70, v71
    v_mfma_f32_32x32x16_bf16 v[56:71], a[108:111], v[144:147], 0
    ds_read_b128 v[104:107], v16 offset:7168
    v_exp_f32 v40, v40
    v_exp_f32 v41, v41
    v_exp_f32 v42, v42
    v_exp_f32 v43, v43
    v_cvt_pk_bf16_f32 v72, v40, v41
    v_mfma_f32_32x32x16_bf16 v[208:223], a[132:135], v[80:83], v[208:223]
    v_exp_f32 v44, v44
    v_exp_f32 v45, v45
    v_exp_f32 v46, v46
    v_exp_f32 v47, v47
    v_cvt_pk_bf16_f32 v73, v42, v43
    v_cvt_pk_bf16_f32 v74, v44, v45
    v_mfma_f32_32x32x8_bf16 v[56:71], a[120:121], v[150:151], v[56:71]
    v_exp_f32 v48, v48
    v_exp_f32 v49, v49
    v_exp_f32 v50, v50
    v_exp_f32 v51, v51
    v_cvt_pk_bf16_f32 v75, v46, v47
    v_cvt_pk_bf16_f32 v76, v48, v49
    v_mfma_f32_32x32x16_bf16 v[208:223], a[136:139], v[84:87], v[208:223]
    v_exp_f32 v52, v52
    v_exp_f32 v53, v53
    v_exp_f32 v54, v54
    v_exp_f32 v55, v55
    v_cvt_pk_bf16_f32 v77, v50, v51
    v_cvt_pk_bf16_f32 v78, v52, v53
    v_cvt_pk_bf16_f32 v79, v54, v55
    v_mfma_f32_32x32x16_bf16 v[40:55], a[112:115], v[120:123], 0
    ds_read_b64 v[108:109], v17 offset:11264
    v_exp_f32 v56, v56
    v_exp_f32 v57, v57
    v_exp_f32 v58, v58
    v_exp_f32 v59, v59
    v_cvt_pk_bf16_f32 v80, v56, v57
    v_mfma_f32_32x32x16_bf16 v[224:239], a[132:135], v[72:75], v[224:239]
    v_exp_f32 v60, v60
    v_exp_f32 v61, v61
    v_exp_f32 v62, v62
    v_exp_f32 v63, v63
    v_cvt_pk_bf16_f32 v81, v58, v59
    v_cvt_pk_bf16_f32 v82, v60, v61
    v_mfma_f32_32x32x8_bf16 v[40:55], a[122:123], v[124:125], v[40:55]
    v_exp_f32 v64, v64
    v_exp_f32 v65, v65
    v_exp_f32 v66, v66
    v_exp_f32 v67, v67
    v_cvt_pk_bf16_f32 v83, v62, v63
    v_cvt_pk_bf16_f32 v84, v64, v65
    v_mfma_f32_32x32x16_bf16 v[224:239], a[136:139], v[76:79], v[224:239]
    v_exp_f32 v68, v68
    v_exp_f32 v69, v69
    v_exp_f32 v70, v70
    v_exp_f32 v71, v71
    v_cvt_pk_bf16_f32 v85, v66, v67
    v_cvt_pk_bf16_f32 v86, v68, v69
    v_cvt_pk_bf16_f32 v87, v70, v71
    v_mfma_f32_32x32x16_bf16 v[56:71], a[112:115], v[128:131], 0
    ds_read_b64 v[110:111], v18 offset:11264
    v_exp_f32 v40, v40
    v_exp_f32 v41, v41
    v_exp_f32 v42, v42
    v_exp_f32 v43, v43
    v_cvt_pk_bf16_f32 v72, v40, v41
    v_mfma_f32_32x32x16_bf16 v[240:255], a[132:135], v[80:83], v[240:255]
    v_exp_f32 v44, v44
    v_exp_f32 v45, v45
    v_exp_f32 v46, v46
    v_exp_f32 v47, v47
    v_cvt_pk_bf16_f32 v73, v42, v43
    v_cvt_pk_bf16_f32 v74, v44, v45
    v_mfma_f32_32x32x8_bf16 v[56:71], a[122:123], v[132:133], v[56:71]
    v_exp_f32 v48, v48
    v_exp_f32 v49, v49
    v_exp_f32 v50, v50
    v_exp_f32 v51, v51
    v_cvt_pk_bf16_f32 v75, v46, v47
    v_cvt_pk_bf16_f32 v76, v48, v49
    v_mfma_f32_32x32x16_bf16 v[240:255], a[136:139], v[84:87], v[240:255]
    v_exp_f32 v52, v52
    v_exp_f32 v53, v53
    v_exp_f32 v54, v54
    v_exp_f32 v55, v55
    v_cvt_pk_bf16_f32 v77, v50, v51
    v_cvt_pk_bf16_f32 v78, v52, v53
    v_cvt_pk_bf16_f32 v79, v54, v55
    v_mfma_f32_32x32x16_bf16 v[40:55], a[112:115], v[136:139], 0
    ds_read_b128 v[112:115], v16 offset:7680
    v_exp_f32 v56, v56
    v_exp_f32 v57, v57
    v_exp_f32 v58, v58
    v_exp_f32 v59, v59
    v_cvt_pk_bf16_f32 v80, v56, v57
    v_mfma_f32_32x32x16_bf16 v[192:207], a[140:143], v[72:75], v[192:207]
    v_exp_f32 v60, v60
    v_exp_f32 v61, v61
    v_exp_f32 v62, v62
    v_exp_f32 v63, v63
    v_cvt_pk_bf16_f32 v81, v58, v59
    v_cvt_pk_bf16_f32 v82, v60, v61
    v_mfma_f32_32x32x8_bf16 v[40:55], a[122:123], v[140:141], v[40:55]
    v_exp_f32 v64, v64
    v_exp_f32 v65, v65
    v_exp_f32 v66, v66
    v_exp_f32 v67, v67
    v_cvt_pk_bf16_f32 v83, v62, v63
    v_cvt_pk_bf16_f32 v84, v64, v65
    v_mfma_f32_32x32x16_bf16 v[192:207], a[144:147], v[76:79], v[192:207]
    v_exp_f32 v68, v68
    v_exp_f32 v69, v69
    v_exp_f32 v70, v70
    v_exp_f32 v71, v71
    v_cvt_pk_bf16_f32 v85, v66, v67
    v_cvt_pk_bf16_f32 v86, v68, v69
    v_cvt_pk_bf16_f32 v87, v70, v71
    v_mfma_f32_32x32x16_bf16 v[56:71], a[112:115], v[144:147], 0
    ds_read_b64 v[116:117], v17 offset:11776
    v_exp_f32 v40, v40
    v_exp_f32 v41, v41
    v_exp_f32 v42, v42
    v_exp_f32 v43, v43
    v_cvt_pk_bf16_f32 v72, v40, v41
    v_mfma_f32_32x32x16_bf16 v[208:223], a[140:143], v[80:83], v[208:223]
    v_exp_f32 v44, v44
    v_exp_f32 v45, v45
    v_exp_f32 v46, v46
    v_exp_f32 v47, v47
    v_cvt_pk_bf16_f32 v73, v42, v43
    v_cvt_pk_bf16_f32 v74, v44, v45
    v_mfma_f32_32x32x8_bf16 v[56:71], a[122:123], v[148:149], v[56:71]
    v_exp_f32 v48, v48
    v_exp_f32 v49, v49
    v_exp_f32 v50, v50
    v_exp_f32 v51, v51
    v_cvt_pk_bf16_f32 v75, v46, v47
    v_cvt_pk_bf16_f32 v76, v48, v49
    v_mfma_f32_32x32x16_bf16 v[208:223], a[144:147], v[84:87], v[208:223]
    v_exp_f32 v52, v52
    v_exp_f32 v53, v53
    v_exp_f32 v54, v54
    v_exp_f32 v55, v55
    v_cvt_pk_bf16_f32 v77, v50, v51
    v_cvt_pk_bf16_f32 v78, v52, v53
    v_cvt_pk_bf16_f32 v79, v54, v55
    v_mfma_f32_32x32x16_bf16 v[40:55], a[116:119], v[120:123], 0
    ds_read_b64 v[118:119], v18 offset:11776
    v_exp_f32 v56, v56
    v_exp_f32 v57, v57
    v_exp_f32 v58, v58
    v_exp_f32 v59, v59
    v_cvt_pk_bf16_f32 v80, v56, v57
    v_mfma_f32_32x32x16_bf16 v[224:239], a[140:143], v[72:75], v[224:239]
    v_exp_f32 v60, v60
    v_exp_f32 v61, v61
    v_exp_f32 v62, v62
    v_exp_f32 v63, v63
    v_cvt_pk_bf16_f32 v81, v58, v59
    v_cvt_pk_bf16_f32 v82, v60, v61
    v_mfma_f32_32x32x8_bf16 v[40:55], a[122:123], v[126:127], v[40:55]
    v_exp_f32 v64, v64
    v_exp_f32 v65, v65
    v_exp_f32 v66, v66
    v_exp_f32 v67, v67
    v_cvt_pk_bf16_f32 v83, v62, v63
    v_cvt_pk_bf16_f32 v84, v64, v65
    v_mfma_f32_32x32x16_bf16 v[224:239], a[144:147], v[76:79], v[224:239]
    v_exp_f32 v68, v68
    v_exp_f32 v69, v69
    v_exp_f32 v70, v70
    v_exp_f32 v71, v71
    v_cvt_pk_bf16_f32 v85, v66, v67
    v_cvt_pk_bf16_f32 v86, v68, v69
    v_cvt_pk_bf16_f32 v87, v70, v71
    v_mfma_f32_32x32x16_bf16 v[56:71], a[116:119], v[128:131], 0
    buffer_load_dword v39, v8, s[16:19], s56 offen sc1
    v_exp_f32 v40, v40
    v_exp_f32 v41, v41
    v_exp_f32 v42, v42
    v_exp_f32 v43, v43
    v_cvt_pk_bf16_f32 v72, v40, v41
    v_mfma_f32_32x32x16_bf16 v[240:255], a[140:143], v[80:83], v[240:255]
    v_exp_f32 v44, v44
    v_exp_f32 v45, v45
    v_exp_f32 v46, v46
    v_exp_f32 v47, v47
    v_cvt_pk_bf16_f32 v73, v42, v43
    v_cvt_pk_bf16_f32 v74, v44, v45
    v_mfma_f32_32x32x8_bf16 v[56:71], a[122:123], v[134:135], v[56:71]
    v_exp_f32 v48, v48
    v_exp_f32 v49, v49
    v_exp_f32 v50, v50
    v_exp_f32 v51, v51
    v_cvt_pk_bf16_f32 v75, v46, v47
    v_cvt_pk_bf16_f32 v76, v48, v49
    v_mfma_f32_32x32x16_bf16 v[240:255], a[144:147], v[84:87], v[240:255]
    v_exp_f32 v52, v52
    v_exp_f32 v53, v53
    v_exp_f32 v54, v54
    v_exp_f32 v55, v55
    v_cvt_pk_bf16_f32 v77, v50, v51
    v_cvt_pk_bf16_f32 v78, v52, v53
    v_cvt_pk_bf16_f32 v79, v54, v55
    v_mfma_f32_32x32x16_bf16 v[40:55], a[116:119], v[136:139], 0
    v_exp_f32 v56, v56
    v_exp_f32 v57, v57
    v_exp_f32 v58, v58
    v_exp_f32 v59, v59
    v_cvt_pk_bf16_f32 v80, v56, v57
    v_mfma_f32_32x32x16_bf16 v[192:207], a[148:151], v[72:75], v[192:207]
    v_exp_f32 v60, v60
    v_exp_f32 v61, v61
    v_exp_f32 v62, v62
    v_exp_f32 v63, v63
    v_cvt_pk_bf16_f32 v81, v58, v59
    v_cvt_pk_bf16_f32 v82, v60, v61
    v_mfma_f32_32x32x8_bf16 v[40:55], a[122:123], v[142:143], v[40:55]
    v_exp_f32 v64, v64
    v_exp_f32 v65, v65
    v_exp_f32 v66, v66
    v_exp_f32 v67, v67
    v_cvt_pk_bf16_f32 v83, v62, v63
    v_cvt_pk_bf16_f32 v84, v64, v65
    v_mfma_f32_32x32x16_bf16 v[192:207], a[152:155], v[76:79], v[192:207]
    v_exp_f32 v68, v68
    v_exp_f32 v69, v69
    v_exp_f32 v70, v70
    v_exp_f32 v71, v71
    v_cvt_pk_bf16_f32 v85, v66, v67
    v_cvt_pk_bf16_f32 v86, v68, v69
    v_cvt_pk_bf16_f32 v87, v70, v71
    v_mfma_f32_32x32x16_bf16 v[56:71], a[116:119], v[144:147], 0
    s_nop 3
    ds_write_b128 v14, v[192:195] offset:20480
    v_exp_f32 v40, v40
    v_exp_f32 v41, v41
    v_exp_f32 v42, v42
    v_exp_f32 v43, v43
    v_cvt_pk_bf16_f32 v72, v40, v41
    v_mfma_f32_32x32x16_bf16 v[208:223], a[148:151], v[80:83], v[208:223]
    ds_write_b128 v14, v[196:199] offset:21504
    v_exp_f32 v44, v44
    v_exp_f32 v45, v45
    v_exp_f32 v46, v46
    v_exp_f32 v47, v47
    v_cvt_pk_bf16_f32 v73, v42, v43
    v_cvt_pk_bf16_f32 v74, v44, v45
    v_mfma_f32_32x32x8_bf16 v[56:71], a[122:123], v[150:151], v[56:71]
    v_exp_f32 v48, v48
    v_exp_f32 v49, v49
    v_exp_f32 v50, v50
    v_exp_f32 v51, v51
    v_cvt_pk_bf16_f32 v75, v46, v47
    v_cvt_pk_bf16_f32 v76, v48, v49
    v_mfma_f32_32x32x16_bf16 v[208:223], a[152:155], v[84:87], v[208:223]
    v_exp_f32 v52, v52
    v_exp_f32 v53, v53
    v_exp_f32 v54, v54
    v_exp_f32 v55, v55
    v_cvt_pk_bf16_f32 v77, v50, v51
    v_cvt_pk_bf16_f32 v78, v52, v53
    v_cvt_pk_bf16_f32 v79, v54, v55
    s_waitcnt lgkmcnt(13)
    v_mfma_f32_32x32x16_bf16 v[40:55], a[160:163], v[88:91], 0
    ds_write_b128 v14, v[200:203] offset:22528
    v_exp_f32 v56, v56
    v_exp_f32 v57, v57
    v_exp_f32 v58, v58
    v_exp_f32 v59, v59
    v_cvt_pk_bf16_f32 v80, v56, v57
    v_mfma_f32_32x32x16_bf16 v[224:239], a[148:151], v[72:75], v[224:239]
    ds_write_b128 v14, v[208:211] offset:45056
    v_exp_f32 v60, v60
    v_exp_f32 v61, v61
    v_exp_f32 v62, v62
    v_exp_f32 v63, v63
    v_cvt_pk_bf16_f32 v81, v58, v59
    v_cvt_pk_bf16_f32 v82, v60, v61
    s_waitcnt lgkmcnt(14)
    v_mfma_f32_32x32x8_bf16 v[40:55], a[176:177], v[92:93], v[40:55]
    v_exp_f32 v64, v64
    v_exp_f32 v65, v65
    v_exp_f32 v66, v66
    v_exp_f32 v67, v67
    v_cvt_pk_bf16_f32 v83, v62, v63
    v_cvt_pk_bf16_f32 v84, v64, v65
    v_mfma_f32_32x32x16_bf16 v[224:239], a[152:155], v[76:79], v[224:239]
    ds_write_b128 v14, v[212:215] offset:46080
    v_exp_f32 v68, v68
    v_exp_f32 v69, v69
    v_exp_f32 v70, v70
    v_exp_f32 v71, v71
    v_cvt_pk_bf16_f32 v85, v66, v67
    v_cvt_pk_bf16_f32 v86, v68, v69
    v_cvt_pk_bf16_f32 v87, v70, v71
    s_waitcnt lgkmcnt(13)
    v_mfma_f32_32x32x16_bf16 v[56:71], a[160:163], v[96:99], 0
    ds_write_b128 v14, v[216:219] offset:47104
    v_exp_f32 v40, v40
    v_exp_f32 v41, v41
    v_exp_f32 v42, v42
    v_exp_f32 v43, v43
    v_cvt_pk_bf16_f32 v72, v40, v41
    v_mfma_f32_32x32x16_bf16 v[240:255], a[148:151], v[80:83], v[240:255]
    ds_write_b128 v14, v[224:227] offset:57344
    v_exp_f32 v44, v44
    v_exp_f32 v45, v45
    v_exp_f32 v46, v46
    v_exp_f32 v47, v47
    v_cvt_pk_bf16_f32 v73, v42, v43
    v_cvt_pk_bf16_f32 v74, v44, v45
    s_waitcnt lgkmcnt(14)
    v_mfma_f32_32x32x8_bf16 v[56:71], a[176:177], v[100:101], v[56:71]
    v_exp_f32 v48, v48
    v_exp_f32 v49, v49
    v_exp_f32 v50, v50
    v_exp_f32 v51, v51
    v_cvt_pk_bf16_f32 v75, v46, v47
    v_cvt_pk_bf16_f32 v76, v48, v49
    v_mfma_f32_32x32x16_bf16 v[240:255], a[152:155], v[84:87], v[240:255]
    ds_write_b128 v14, v[228:231] offset:58368
    v_exp_f32 v52, v52
    v_exp_f32 v53, v53
    v_exp_f32 v54, v54
    v_exp_f32 v55, v55
    v_cvt_pk_bf16_f32 v77, v50, v51
    v_cvt_pk_bf16_f32 v78, v52, v53
    v_cvt_pk_bf16_f32 v79, v54, v55
    s_waitcnt lgkmcnt(13)
    v_mfma_f32_32x32x16_bf16 v[40:55], a[160:163], v[104:107], 0
    ds_write_b128 v14, v[232:235] offset:59392
    v_exp_f32 v56, v56
    v_exp_f32 v57, v57
    v_exp_f32 v58, v58
    v_exp_f32 v59, v59
    v_cvt_pk_bf16_f32 v80, v56, v57
    v_mfma_f32_32x32x16_bf16 v[192:207], a[180:183], v[72:75], 0
    ds_write_b128 v15, v[240:243] offset:0
    v_exp_f32 v60, v60
    v_exp_f32 v61, v61
    v_exp_f32 v62, v62
    v_exp_f32 v63, v63
    v_cvt_pk_bf16_f32 v81, v58, v59
    v_cvt_pk_bf16_f32 v82, v60, v61
    s_waitcnt lgkmcnt(14)
    v_mfma_f32_32x32x8_bf16 v[40:55], a[176:177], v[108:109], v[40:55]
    v_exp_f32 v64, v64
    v_exp_f32 v65, v65
    v_exp_f32 v66, v66
    v_exp_f32 v67, v67
    v_cvt_pk_bf16_f32 v83, v62, v63
    v_cvt_pk_bf16_f32 v84, v64, v65
    v_mfma_f32_32x32x16_bf16 v[192:207], a[184:187], v[76:79], v[192:207]
    ds_write_b128 v15, v[244:247] offset:1024
    v_exp_f32 v68, v68
    v_exp_f32 v69, v69
    v_exp_f32 v70, v70
    v_exp_f32 v71, v71
    v_cvt_pk_bf16_f32 v85, v66, v67
    v_cvt_pk_bf16_f32 v86, v68, v69
    v_cvt_pk_bf16_f32 v87, v70, v71
    s_waitcnt vmcnt(0)
    s_mov_b64 exec, 1
    v_cmp_ne_u32 vcc, 32, v39
    s_mov_b64 exec, -1
    s_nop 3
    s_cbranch_vccnz L_poll2
L_poll2_ok:
    s_waitcnt lgkmcnt(13)
    v_mfma_f32_32x32x16_bf16 v[56:71], a[160:163], v[112:115], 0
    ds_write_b128 v15, v[248:251] offset:2048
    v_exp_f32 v40, v40
    v_exp_f32 v41, v41
    v_exp_f32 v42, v42
    v_exp_f32 v43, v43
    v_cvt_pk_bf16_f32 v72, v40, v41
    v_mfma_f32_32x32x16_bf16 v[208:223], a[180:183], v[80:83], 0
    s_lshl_b32 s76, s36, 4
    s_add_u32 s76, s76, s41
    v_exp_f32 v44, v44
    v_exp_f32 v45, v45
    v_exp_f32 v46, v46
    v_exp_f32 v47, v47
    v_cvt_pk_bf16_f32 v73, v42, v43
    v_cvt_pk_bf16_f32 v74, v44, v45
    s_waitcnt lgkmcnt(13)
    v_mfma_f32_32x32x8_bf16 v[56:71], a[176:177], v[116:117], v[56:71]
    s_mul_i32 s76, s76, 20480
    s_mul_i32 s77, s38, 5120
    v_exp_f32 v48, v48
    v_exp_f32 v49, v49
    v_exp_f32 v50, v50
    v_exp_f32 v51, v51
    v_cvt_pk_bf16_f32 v75, v46, v47
    v_cvt_pk_bf16_f32 v76, v48, v49
    v_mfma_f32_32x32x16_bf16 v[208:223], a[184:187], v[84:87], v[208:223]
    s_add_u32 s76, s76, s77
    s_add_u32 s76, s76, 20971520
    v_exp_f32 v52, v52
    v_exp_f32 v53, v53
    v_exp_f32 v54, v54
    v_exp_f32 v55, v55
    v_cvt_pk_bf16_f32 v77, v50, v51
    v_cvt_pk_bf16_f32 v78, v52, v53
    v_cvt_pk_bf16_f32 v79, v54, v55
    v_mfma_f32_32x32x16_bf16 v[40:55], a[164:167], v[88:91], 0
    s_add_u32 m0, s77, 0
    v_exp_f32 v56, v56
    v_exp_f32 v57, v57
    v_exp_f32 v58, v58
    v_exp_f32 v59, v59
    v_cvt_pk_bf16_f32 v80, v56, v57
    v_mfma_f32_32x32x16_bf16 v[224:239], a[180:183], v[72:75], 0
    buffer_load_dwordx4 v36, s[16:19], s76 offen offset:0 sc1 lds
    v_exp_f32 v60, v60
    v_exp_f32 v61, v61
    v_exp_f32 v62, v62
    v_exp_f32 v63, v63
    v_cvt_pk_bf16_f32 v81, v58, v59
    v_cvt_pk_bf16_f32 v82, v60, v61
    v_mfma_f32_32x32x8_bf16 v[40:55], a[176:177], v[94:95], v[40:55]
    v_exp_f32 v64, v64
    v_exp_f32 v65, v65
    v_exp_f32 v66, v66
    v_exp_f32 v67, v67
    v_cvt_pk_bf16_f32 v83, v62, v63
    v_cvt_pk_bf16_f32 v84, v64, v65
    v_mfma_f32_32x32x16_bf16 v[224:239], a[184:187], v[76:79], v[224:239]
    buffer_load_dwordx4 v36, s[16:19], s76 offen offset:1024 sc1 lds
    v_exp_f32 v68, v68
    v_exp_f32 v69, v69
    v_exp_f32 v70, v70
    v_exp_f32 v71, v71
    v_cvt_pk_bf16_f32 v85, v66, v67
    v_cvt_pk_bf16_f32 v86, v68, v69
    v_cvt_pk_bf16_f32 v87, v70, v71
    v_mfma_f32_32x32x16_bf16 v[56:71], a[164:167], v[96:99], 0
    buffer_load_dwordx4 v36, s[16:19], s76 offen offset:2048 sc1 lds
    v_exp_f32 v40, v40
    v_exp_f32 v41, v41
    v_exp_f32 v42, v42
    v_exp_f32 v43, v43
    v_cvt_pk_bf16_f32 v72, v40, v41
    v_mfma_f32_32x32x16_bf16 v[240:255], a[180:183], v[80:83], 0
    buffer_load_dwordx4 v36, s[16:19], s76 offen offset:3072 sc1 lds
    v_exp_f32 v44, v44
    v_exp_f32 v45, v45
    v_exp_f32 v46, v46
    v_exp_f32 v47, v47
    v_cvt_pk_bf16_f32 v73, v42, v43
    v_cvt_pk_bf16_f32 v74, v44, v45
    v_mfma_f32_32x32x8_bf16 v[56:71], a[176:177], v[102:103], v[56:71]
    s_add_u32 m0, s77, 4096
    v_exp_f32 v48, v48
    v_exp_f32 v49, v49
    v_exp_f32 v50, v50
    v_exp_f32 v51, v51
    v_cvt_pk_bf16_f32 v75, v46, v47
    v_cvt_pk_bf16_f32 v76, v48, v49
    v_mfma_f32_32x32x16_bf16 v[240:255], a[184:187], v[84:87], v[240:255]
    v_exp_f32 v52, v52
    v_exp_f32 v53, v53
    v_exp_f32 v54, v54
    v_exp_f32 v55, v55
    v_cvt_pk_bf16_f32 v77, v50, v51
    v_cvt_pk_bf16_f32 v78, v52, v53
    v_cvt_pk_bf16_f32 v79, v54, v55
    v_mfma_f32_32x32x16_bf16 v[40:55], a[164:167], v[104:107], 0
    buffer_load_dwordx4 v12, s[16:19], s76 offen offset:0 sc1 lds
    v_exp_f32 v56, v56
    v_exp_f32 v57, v57
    v_exp_f32 v58, v58
    v_exp_f32 v59, v59
    v_cvt_pk_bf16_f32 v80, v56, v57
    v_mfma_f32_32x32x16_bf16 v[192:207], a[188:191], v[72:75], v[192:207]
    buffer_load_dwordx4 v[184:187], v29, s[16:19], s55 offen sc1
    v_exp_f32 v60, v60
    v_exp_f32 v61, v61
    v_exp_f32 v62, v62
    v_exp_f32 v63, v63
    v_cvt_pk_bf16_f32 v81, v58, v59
    v_cvt_pk_bf16_f32 v82, v60, v61
    v_mfma_f32_32x32x8_bf16 v[40:55], a[176:177], v[110:111], v[40:55]
    v_exp_f32 v64, v64
    v_exp_f32 v65, v65
    v_exp_f32 v66, v66
    v_exp_f32 v67, v67
    v_cvt_pk_bf16_f32 v83, v62, v63
    v_cvt_pk_bf16_f32 v84, v64, v65
    v_mfma_f32_32x32x16_bf16 v[192:207], a[192:195], v[76:79], v[192:207]
    buffer_load_dwordx4 v[188:191], v30, s[16:19], s55 offen sc1
    v_exp_f32 v68, v68
    v_exp_f32 v69, v69
    v_exp_f32 v70, v70
    v_exp_f32 v71, v71
    v_cvt_pk_bf16_f32 v85, v66, v67
    v_cvt_pk_bf16_f32 v86, v68, v69
    v_cvt_pk_bf16_f32 v87, v70, v71
    v_mfma_f32_32x32x16_bf16 v[56:71], a[164:167], v[112:115], 0
    buffer_load_dwordx4 a[160:163], v36, s[16:19], s50 offen offset:0 sc1
    v_exp_f32 v40, v40
    v_exp_f32 v41, v41
    v_exp_f32 v42, v42
    v_exp_f32 v43, v43
    v_cvt_pk_bf16_f32 v72, v40, v41
    v_mfma_f32_32x32x16_bf16 v[208:223], a[188:191], v[80:83], v[208:223]
    buffer_load_dwordx4 a[180:183], v36, s[16:19], s50 offen offset:1024 sc1
    v_exp_f32 v44, v44
    v_exp_f32 v45, v45
    v_exp_f32 v46, v46
    v_exp_f32 v47, v47
    v_cvt_pk_bf16_f32 v73, v42, v43
    v_cvt_pk_bf16_f32 v74, v44, v45
    s_waitcnt lgkmcnt(12)
    v_mfma_f32_32x32x8_bf16 v[56:71], a[176:177], v[118:119], v[56:71]
    v_exp_f32 v48, v48
    v_exp_f32 v49, v49
    v_exp_f32 v50, v50
    v_exp_f32 v51, v51
    v_cvt_pk_bf16_f32 v75, v46, v47
    v_cvt_pk_bf16_f32 v76, v48, v49
    v_mfma_f32_32x32x16_bf16 v[208:223], a[192:195], v[84:87], v[208:223]
    v_exp_f32 v52, v52
    v_exp_f32 v53, v53
    v_exp_f32 v54, v54
    v_exp_f32 v55, v55
    v_cvt_pk_bf16_f32 v77, v50, v51
    v_cvt_pk_bf16_f32 v78, v52, v53
    v_cvt_pk_bf16_f32 v79, v54, v55
    v_mfma_f32_32x32x16_bf16 v[40:55], a[168:171], v[88:91], 0
    buffer_load_dwordx4 a[184:187], v36, s[16:19], s50 offen offset:2048 sc1
    v_exp_f32 v56, v56
    v_exp_f32 v57, v57
    v_exp_f32 v58, v58
    v_exp_f32 v59, v59
    v_cvt_pk_bf16_f32 v80, v56, v57
    v_mfma_f32_32x32x16_bf16 v[224:239], a[188:191], v[72:75], v[224:239]
    buffer_load_dwordx4 a[156:159], v36, s[16:19], s50 offen offset:3072 sc1
    v_exp_f32 v60, v60
    v_exp_f32 v61, v61
    v_exp_f32 v62, v62
    v_exp_f32 v63, v63
    v_cvt_pk_bf16_f32 v81, v58, v59
    v_cvt_pk_bf16_f32 v82, v60, v61
    v_mfma_f32_32x32x8_bf16 v[40:55], a[178:179], v[92:93], v[40:55]
    v_exp_f32 v64, v64
    v_exp_f32 v65, v65
    v_exp_f32 v66, v66
    v_exp_f32 v67, v67
    v_cvt_pk_bf16_f32 v83, v62, v63
    v_cvt_pk_bf16_f32 v84, v64, v65
    v_mfma_f32_32x32x16_bf16 v[224:239], a[192:195], v[76:79], v[224:239]
    v_exp_f32 v68, v68
    v_exp_f32 v69, v69
    v_exp_f32 v70, v70
    v_exp_f32 v71, v71
    v_cvt_pk_bf16_f32 v85, v66, v67
    v_cvt_pk_bf16_f32 v86, v68, v69
    v_cvt_pk_bf16_f32 v87, v70, v71
    v_mfma_f32_32x32x16_bf16 v[56:71], a[168:171], v[96:99], 0
    buffer_load_dwordx4 a[212:215], v12, s[16:19], s50 offen offset:0 sc1
    v_exp_f32 v40, v40
    v_exp_f32 v41, v41
    v_exp_f32 v42, v42
    v_exp_f32 v43, v43
    v_cvt_pk_bf16_f32 v72, v40, v41
    v_mfma_f32_32x32x16_bf16 v[240:255], a[188:191], v[80:83], v[240:255]
    buffer_load_dwordx4 a[216:219], v12, s[16:19], s50 offen offset:1024 sc1
    v_exp_f32 v44, v44
    v_exp_f32 v45, v45
    v_exp_f32 v46, v46
    v_exp_f32 v47, v47
    v_cvt_pk_bf16_f32 v73, v42, v43
    v_cvt_pk_bf16_f32 v74, v44, v45
    v_mfma_f32_32x32x8_bf16 v[56:71], a[178:179], v[100:101], v[56:71]
    v_exp_f32 v48, v48
    v_exp_f32 v49, v49
    v_exp_f32 v50, v50
    v_exp_f32 v51, v51
    v_cvt_pk_bf16_f32 v75, v46, v47
    v_cvt_pk_bf16_f32 v76, v48, v49
    v_mfma_f32_32x32x16_bf16 v[240:255], a[192:195], v[84:87], v[240:255]
    v_exp_f32 v52, v52
    v_exp_f32 v53, v53
    v_exp_f32 v54, v54
    v_exp_f32 v55, v55
    v_cvt_pk_bf16_f32 v77, v50, v51
    v_cvt_pk_bf16_f32 v78, v52, v53
    v_cvt_pk_bf16_f32 v79, v54, v55
    v_mfma_f32_32x32x16_bf16 v[40:55], a[168:171], v[104:107], 0
    buffer_load_dwordx4 a[220:223], v12, s[16:19], s50 offen offset:2048 sc1
    v_exp_f32 v56, v56
    v_exp_f32 v57, v57
    v_exp_f32 v58, v58
    v_exp_f32 v59, v59
    v_cvt_pk_bf16_f32 v80, v56, v57
    v_mfma_f32_32x32x16_bf16 v[192:207], a[196:199], v[72:75], v[192:207]
    buffer_load_dwordx4 a[224:227], v12, s[16:19], s50 offen offset:3072 sc1
    v_exp_f32 v60, v60
    v_exp_f32 v61, v61
    v_exp_f32 v62, v62
    v_exp_f32 v63, v63
    v_cvt_pk_bf16_f32 v81, v58, v59
    v_cvt_pk_bf16_f32 v82, v60, v61
    v_mfma_f32_32x32x8_bf16 v[40:55], a[178:179], v[108:109], v[40:55]
    v_exp_f32 v64, v64
    v_exp_f32 v65, v65
    v_exp_f32 v66, v66
    v_exp_f32 v67, v67
    v_cvt_pk_bf16_f32 v83, v62, v63
    v_cvt_pk_bf16_f32 v84, v64, v65
    v_mfma_f32_32x32x16_bf16 v[192:207], a[200:203], v[76:79], v[192:207]
    v_exp_f32 v68, v68
    v_exp_f32 v69, v69
    v_exp_f32 v70, v70
    v_exp_f32 v71, v71
    v_cvt_pk_bf16_f32 v85, v66, v67
    v_cvt_pk_bf16_f32 v86, v68, v69
    v_cvt_pk_bf16_f32 v87, v70, v71
    v_mfma_f32_32x32x16_bf16 v[56:71], a[168:171], v[112:115], 0
    buffer_load_dwordx4 a[228:231], v13, s[16:19], s50 offen offset:0 sc1
    v_exp_f32 v40, v40
    s_waitcnt vmcnt(10)
    v_cvt_pk_bf16_f32 v184, v184, v185
    v_exp_f32 v41, v41
    v_cvt_pk_bf16_f32 v185, v186, v187
    v_exp_f32 v42, v42
    v_exp_f32 v43, v43
    v_cvt_pk_bf16_f32 v72, v40, v41
    v_mfma_f32_32x32x16_bf16 v[208:223], a[196:199], v[80:83], v[208:223]
    ds_write_b64 v31, v[184:185]
    v_exp_f32 v44, v44
    v_exp_f32 v45, v45
    v_exp_f32 v46, v46
    v_exp_f32 v47, v47
    v_cvt_pk_bf16_f32 v73, v42, v43
    v_cvt_pk_bf16_f32 v74, v44, v45
    v_mfma_f32_32x32x8_bf16 v[56:71], a[178:179], v[116:117], v[56:71]
    v_exp_f32 v48, v48
    v_exp_f32 v49, v49
    v_exp_f32 v50, v50
    v_exp_f32 v51, v51
    v_cvt_pk_bf16_f32 v75, v46, v47
    v_cvt_pk_bf16_f32 v76, v48, v49
    v_mfma_f32_32x32x16_bf16 v[208:223], a[200:203], v[84:87], v[208:223]
    buffer_load_dwordx4 a[232:235], v13, s[16:19], s50 offen offset:1024 sc1
    v_exp_f32 v52, v52
    v_exp_f32 v53, v53
    v_exp_f32 v54, v54
    v_exp_f32 v55, v55
    v_cvt_pk_bf16_f32 v77, v50, v51
    v_cvt_pk_bf16_f32 v78, v52, v53
    v_cvt_pk_bf16_f32 v79, v54, v55
    v_mfma_f32_32x32x16_bf16 v[40:55], a[172:175], v[88:91], 0
    buffer_load_dwordx4 a[236:239], v13, s[16:19], s50 offen offset:2048 sc1
    v_exp_f32 v56, v56
    s_waitcnt vmcnt(11)
    v_cvt_pk_bf16_f32 v188, v188, v189
    v_exp_f32 v57, v57
    v_cvt_pk_bf16_f32 v189, v190, v191
    v_exp_f32 v58, v58
    v_exp_f32 v59, v59
    v_cvt_pk_bf16_f32 v80, v56, v57
    v_mfma_f32_32x32x16_bf16 v[224:239], a[196:199], v[72:75], v[224:239]
    ds_write_b64 v32, v[188:189]
    v_exp_f32 v60, v60
    v_exp_f32 v61, v61
    v_exp_f32 v62, v62
    v_exp_f32 v63, v63
    v_cvt_pk_bf16_f32 v81, v58, v59
L_pd8396:
    s_cbranch_execz L_padend
    v_cvt_pk_bf16_f32 v82, v60, v61
    v_mfma_f32_32x32x8_bf16 v[40:55], a[178:179], v[94:95], v[40:55]
    v_exp_f32 v64, v64
    v_exp_f32 v65, v65
    v_exp_f32 v66, v66
    v_exp_f32 v67, v67
    v_cvt_pk_bf16_f32 v83, v62, v63
    v_cvt_pk_bf16_f32 v84, v64, v65
    v_mfma_f32_32x32x16_bf16 v[224:239], a[200:203], v[76:79], v[224:239]
    buffer_load_dwordx4 a[240:243], v13, s[16:19], s50 offen offset:3072 sc1
    v_exp_f32 v68, v68
    v_exp_f32 v69, v69
    v_exp_f32 v70, v70
    v_exp_f32 v71, v71
    v_cvt_pk_bf16_f32 v85, v66, v67
    v_cvt_pk_bf16_f32 v86, v68, v69
    v_cvt_pk_bf16_f32 v87, v70, v71
    s_waitcnt lgkmcnt(0)
    s_barrier
    v_mfma_f32_32x32x16_bf16 v[56:71], a[172:175], v[96:99], 0
    ds_read_b128 v[128:131], v25 offset:2048
    ds_read_b128 v[140:143], v25 offset:5120
    ds_read_b128 v[152:155], v25 offset:8192
    ds_read_b128 v[164:167], v25 offset:11264
    ds_read_b128 v[120:123], v25 offset:0
    ds_read_b128 v[132:135], v25 offset:3072
    ds_read_b128 v[144:147], v25 offset:6144
    ds_read_b128 v[156:159], v25 offset:9216
    ds_read_b128 v[124:127], v25 offset:1024
    ds_read_b128 v[136:139], v25 offset:4096
    ds_read_b128 v[148:151], v25 offset:7168
    ds_read_b128 v[160:163], v25 offset:10240
    v_exp_f32 v40, v40
    v_exp_f32 v41, v41
    v_exp_f32 v42, v42
    v_exp_f32 v43, v43
    v_cvt_pk_bf16_f32 v72, v40, v41
    v_mfma_f32_32x32x16_bf16 v[240:255], a[196:199], v[80:83], v[240:255]
    buffer_load_dwordx4 a[244:247], v36, s[16:19], s51 offen offset:0 sc1
    v_exp_f32 v44, v44
    v_exp_f32 v45, v45
    v_exp_f32 v46, v46
    v_exp_f32 v47, v47
    v_cvt_pk_bf16_f32 v73, v42, v43
    v_cvt_pk_bf16_f32 v74, v44, v45
    v_mfma_f32_32x32x8_bf16 v[56:71], a[178:179], v[102:103], v[56:71]
    v_exp_f32 v48, v48
    v_exp_f32 v49, v49
    v_exp_f32 v50, v50
    v_exp_f32 v51, v51
    v_cvt_pk_bf16_f32 v75, v46, v47
    v_cvt_pk_bf16_f32 v76, v48, v49
    v_mfma_f32_32x32x16_bf16 v[240:255], a[200:203], v[84:87], v[240:255]
    buffer_load_dwordx4 a[248:251], v36, s[16:19], s51 offen offset:1024 sc1
    v_exp_f32 v52, v52
    v_exp_f32 v53, v53
    v_exp_f32 v54, v54
    v_exp_f32 v55, v55
    v_cvt_pk_bf16_f32 v77, v50, v51
    v_cvt_pk_bf16_f32 v78, v52, v53
    v_cvt_pk_bf16_f32 v79, v54, v55
    v_mfma_f32_32x32x16_bf16 v[40:55], a[172:175], v[104:107], 0
    buffer_load_dwordx4 a[252:255], v36, s[16:19], s51 offen offset:2048 sc1
    v_exp_f32 v56, v56
    s_waitcnt lgkmcnt(10)
    v_add_f32 v128, v128, v140
    v_exp_f32 v57, v57
    v_add_f32 v129, v129, v141
    v_exp_f32 v58, v58
    s_waitcnt lgkmcnt(8)
    v_add_f32 v152, v152, v164
    v_exp_f32 v59, v59
    v_add_f32 v153, v153, v165
    v_cvt_pk_bf16_f32 v80, v56, v57
    v_mfma_f32_32x32x16_bf16 v[192:207], a[204:207], v[72:75], v[192:207]
    buffer_load_dwordx4 a[164:167], v36, s[16:19], s51 offen offset:3072 sc1
    v_exp_f32 v60, v60
    v_add_f32 v128, v128, v152
    v_exp_f32 v61, v61
    v_add_f32 v129, v129, v153
    v_exp_f32 v62, v62
    v_mov_b32 v168, v128
    v_exp_f32 v63, v63
    v_mov_b32 v170, v128
    v_cvt_pk_bf16_f32 v81, v58, v59
    v_add_f32 v130, v130, v142
    v_cvt_pk_bf16_f32 v82, v60, v61
    v_mfma_f32_32x32x8_bf16 v[40:55], a[178:179], v[110:111], v[40:55]
    v_exp_f32 v64, v64
    v_add_f32 v131, v131, v143
    v_exp_f32 v65, v65
    v_add_f32 v154, v154, v166
    v_exp_f32 v66, v66
    v_exp_f32 v67, v67
    v_cvt_pk_bf16_f32 v83, v62, v63
    v_cvt_pk_bf16_f32 v84, v64, v65
    v_mfma_f32_32x32x16_bf16 v[192:207], a[208:211], v[76:79], v[192:207]
    v_exp_f32 v68, v68
    v_exp_f32 v69, v69
    v_exp_f32 v70, v70
    v_exp_f32 v71, v71
    v_cvt_pk_bf16_f32 v85, v66, v67
    v_cvt_pk_bf16_f32 v86, v68, v69
    v_cvt_pk_bf16_f32 v87, v70, v71
    v_mfma_f32_32x32x16_bf16 v[56:71], a[172:175], v[112:115], 0
    buffer_load_dwordx4 a[188:191], v12, s[16:19], s51 offen offset:0 sc1
    v_exp_f32 v40, v40
    v_add_f32 v155, v155, v167
    v_exp_f32 v41, v41
    v_add_f32 v130, v130, v154
    v_exp_f32 v42, v42
    v_add_f32 v131, v131, v155
    v_exp_f32 v43, v43
    v_permlane32_swap_b32 v168, v170
    v_cvt_pk_bf16_f32 v72, v40, v41
    v_mfma_f32_32x32x16_bf16 v[208:223], a[204:207], v[80:83], v[208:223]
    buffer_load_dwordx4 a[192:195], v12, s[16:19], s51 offen offset:1024 sc1
    v_exp_f32 v44, v44
    v_rcp_f32 v168, v170
    v_exp_f32 v45, v45
    s_waitcnt lgkmcnt(6)
    v_add_f32 v120, v120, v132
    v_exp_f32 v46, v46
    v_add_f32 v121, v121, v133
    v_exp_f32 v47, v47
    s_waitcnt lgkmcnt(4)
    v_add_f32 v144, v144, v156
    v_cvt_pk_bf16_f32 v73, v42, v43
    v_add_f32 v145, v145, v157
    v_cvt_pk_bf16_f32 v74, v44, v45
    v_mfma_f32_32x32x8_bf16 v[56:71], a[178:179], v[118:119], v[56:71]
    v_exp_f32 v48, v48
    v_add_f32 v120, v120, v144
    v_exp_f32 v49, v49
    v_add_f32 v121, v121, v145
    v_exp_f32 v50, v50
    v_exp_f32 v51, v51
    v_cvt_pk_bf16_f32 v75, v46, v47
    v_cvt_pk_bf16_f32 v76, v48, v49
    v_mfma_f32_32x32x16_bf16 v[208:223], a[208:211], v[84:87], v[208:223]
    v_exp_f32 v52, v52
    v_exp_f32 v53, v53
    v_exp_f32 v54, v54
    v_exp_f32 v55, v55
    v_cvt_pk_bf16_f32 v77, v50, v51
    v_cvt_pk_bf16_f32 v78, v52, v53
    v_cvt_pk_bf16_f32 v79, v54, v55
    v_mfma_f32_32x32x16_bf16 v[40:55], a[0:3], v[88:91], 0
    buffer_load_dwordx4 a[168:171], v12, s[16:19], s51 offen offset:2048 sc1
    v_exp_f32 v56, v56
    v_add_f32 v122, v122, v134
    v_exp_f32 v57, v57
    v_add_f32 v123, v123, v135
    v_exp_f32 v58, v58
    v_add_f32 v146, v146, v158
    v_exp_f32 v59, v59
    v_add_f32 v147, v147, v159
    v_cvt_pk_bf16_f32 v80, v56, v57
    v_mfma_f32_32x32x16_bf16 v[224:239], a[204:207], v[72:75], v[224:239]
    buffer_load_dwordx4 a[196:199], v12, s[16:19], s51 offen offset:3072 sc1
    v_exp_f32 v60, v60
    v_add_f32 v122, v122, v146
    v_exp_f32 v61, v61
    v_add_f32 v123, v123, v147
    v_exp_f32 v62, v62
    s_waitcnt lgkmcnt(2)
    v_add_f32 v124, v124, v136
    v_exp_f32 v63, v63
    v_add_f32 v125, v125, v137
    v_cvt_pk_bf16_f32 v81, v58, v59
    s_waitcnt lgkmcnt(0)
    v_add_f32 v148, v148, v160
    v_cvt_pk_bf16_f32 v82, v60, v61
    v_mfma_f32_32x32x8_bf16 v[40:55], a[16:17], v[92:93], v[40:55]
    v_exp_f32 v64, v64
    v_add_f32 v149, v149, v161
    v_exp_f32 v65, v65
    v_add_f32 v124, v124, v148
    v_exp_f32 v66, v66
    v_exp_f32 v67, v67
    v_cvt_pk_bf16_f32 v83, v62, v63
    v_cvt_pk_bf16_f32 v84, v64, v65
    v_mfma_f32_32x32x16_bf16 v[224:239], a[208:211], v[76:79], v[224:239]
    v_exp_f32 v68, v68
    v_exp_f32 v69, v69
    v_exp_f32 v70, v70
    v_exp_f32 v71, v71
    v_cvt_pk_bf16_f32 v85, v66, v67
    v_cvt_pk_bf16_f32 v86, v68, v69
    v_cvt_pk_bf16_f32 v87, v70, v71
    v_mfma_f32_32x32x16_bf16 v[56:71], a[0:3], v[96:99], 0
    buffer_load_dwordx4 a[200:203], v13, s[16:19], s51 offen offset:0 sc1
    v_exp_f32 v40, v40
    v_add_f32 v125, v125, v149
    v_exp_f32 v41, v41
    v_add_f32 v126, v126, v138
    v_exp_f32 v42, v42
    v_add_f32 v127, v127, v139
    v_exp_f32 v43, v43
    v_add_f32 v150, v150, v162
    v_cvt_pk_bf16_f32 v72, v40, v41
    v_mfma_f32_32x32x16_bf16 v[240:255], a[204:207], v[80:83], v[240:255]
    v_exp_f32 v44, v44
    v_add_f32 v151, v151, v163
    v_exp_f32 v45, v45
    v_add_f32 v126, v126, v150
    v_exp_f32 v46, v46
    v_add_f32 v127, v127, v151
    v_exp_f32 v47, v47
    v_add_f32 v144, v120, v122
    v_cvt_pk_bf16_f32 v73, v42, v43
    v_add_f32 v145, v121, v123
    v_cvt_pk_bf16_f32 v74, v44, v45
    v_mfma_f32_32x32x8_bf16 v[56:71], a[16:17], v[100:101], v[56:71]
    v_exp_f32 v48, v48
    v_add_f32 v146, v124, v126
    v_exp_f32 v49, v49
    v_add_f32 v147, v125, v127
    v_exp_f32 v50, v50
    v_exp_f32 v51, v51
    v_cvt_pk_bf16_f32 v75, v46, v47
    v_cvt_pk_bf16_f32 v76, v48, v49
    v_mfma_f32_32x32x16_bf16 v[240:255], a[208:211], v[84:87], v[240:255]
    v_exp_f32 v52, v52
    v_exp_f32 v53, v53
    v_exp_f32 v54, v54
    v_exp_f32 v55, v55
    v_cvt_pk_bf16_f32 v77, v50, v51
    v_cvt_pk_bf16_f32 v78, v52, v53
    v_cvt_pk_bf16_f32 v79, v54, v55
    v_mfma_f32_32x32x16_bf16 v[40:55], a[0:3], v[104:107], 0
    buffer_load_dwordx4 a[172:175], v13, s[16:19], s51 offen offset:1024 sc1
    v_exp_f32 v56, v56
    v_add_f32 v148, v128, v130
    v_exp_f32 v57, v57
    v_add_f32 v149, v129, v131
    v_exp_f32 v58, v58
    v_mul_f32 v172, v168, v20
    v_exp_f32 v59, v59
    v_mul_f32 v120, v120, v172
    v_cvt_pk_bf16_f32 v80, v56, v57
    v_mfma_f32_32x32x16_bf16 v[192:207], a[20:23], v[72:75], v[192:207]
    buffer_load_dwordx4 a[204:207], v13, s[16:19], s51 offen offset:2048 sc1
    v_exp_f32 v60, v60
    v_mul_f32 v121, v121, v172
    v_exp_f32 v61, v61
    v_mul_f32 v122, v122, v172
    v_exp_f32 v62, v62
    v_mul_f32 v123, v123, v172
    v_exp_f32 v63, v63
    v_mul_f32 v124, v124, v172
    v_cvt_pk_bf16_f32 v81, v58, v59
    v_mul_f32 v125, v125, v172
    v_cvt_pk_bf16_f32 v82, v60, v61
    v_mfma_f32_32x32x8_bf16 v[40:55], a[16:17], v[108:109], v[40:55]
    v_exp_f32 v64, v64
    v_mul_f32 v126, v126, v172
    v_exp_f32 v65, v65
    v_mul_f32 v127, v127, v172
    v_exp_f32 v66, v66
    v_exp_f32 v67, v67
    v_cvt_pk_bf16_f32 v83, v62, v63
    v_cvt_pk_bf16_f32 v84, v64, v65
    v_mfma_f32_32x32x16_bf16 v[192:207], a[24:27], v[76:79], v[192:207]
    v_exp_f32 v68, v68
    v_exp_f32 v69, v69
    v_exp_f32 v70, v70
    v_exp_f32 v71, v71
    v_cvt_pk_bf16_f32 v85, v66, v67
    v_cvt_pk_bf16_f32 v86, v68, v69
    v_cvt_pk_bf16_f32 v87, v70, v71
    v_mfma_f32_32x32x16_bf16 v[56:71], a[0:3], v[112:115], 0
    buffer_load_dwordx4 a[208:211], v13, s[16:19], s51 offen offset:3072 sc1
    v_exp_f32 v40, v40
    v_cvt_pk_bf16_f32 v132, v120, v121
    v_exp_f32 v41, v41
    v_cvt_pk_bf16_f32 v133, v122, v123
    v_exp_f32 v42, v42
    v_cvt_pk_bf16_f32 v134, v124, v125
    v_exp_f32 v43, v43
    v_cvt_pk_bf16_f32 v135, v126, v127
    v_cvt_pk_bf16_f32 v72, v40, v41
    v_mfma_f32_32x32x16_bf16 v[208:223], a[20:23], v[80:83], v[208:223]
    buffer_store_dwordx4 v[132:135], v26, s[16:19], s72 offen sc1
    v_exp_f32 v44, v44
    v_mul_f32 v128, v128, v172
    v_exp_f32 v45, v45
    v_mul_f32 v129, v129, v172
    v_exp_f32 v46, v46
    v_mul_f32 v130, v130, v172
    v_exp_f32 v47, v47
    v_mul_f32 v131, v131, v172
    v_cvt_pk_bf16_f32 v73, v42, v43
    v_cvt_pk_bf16_f32 v136, v128, v129
    v_cvt_pk_bf16_f32 v74, v44, v45
    v_mfma_f32_32x32x8_bf16 v[56:71], a[16:17], v[116:117], v[56:71]
    v_exp_f32 v48, v48
    v_cvt_pk_bf16_f32 v137, v130, v131
    v_exp_f32 v49, v49
    v_exp_f32 v50, v50
    v_exp_f32 v51, v51
    v_cvt_pk_bf16_f32 v75, v46, v47
    v_cvt_pk_bf16_f32 v76, v48, v49
    v_mfma_f32_32x32x16_bf16 v[208:223], a[24:27], v[84:87], v[208:223]
    buffer_load_dwordx4 a[176:179], v36, s[16:19], s52 offen offset:0 sc1
    v_exp_f32 v52, v52
    v_exp_f32 v53, v53
    v_exp_f32 v54, v54
    v_exp_f32 v55, v55
    v_cvt_pk_bf16_f32 v77, v50, v51
    v_cvt_pk_bf16_f32 v78, v52, v53
    v_cvt_pk_bf16_f32 v79, v54, v55
    v_mfma_f32_32x32x16_bf16 v[40:55], a[4:7], v[88:91], 0
    buffer_store_dwordx2 v[136:137], v27, s[16:19], s72 offen offset:512 sc1
    v_exp_f32 v56, v56
    v_add_f32 v144, v144, v146
    v_exp_f32 v57, v57
    v_add_f32 v145, v145, v147
    v_exp_f32 v58, v58
    v_add_f32 v144, v144, v148
    v_exp_f32 v59, v59
    v_add_f32 v145, v145, v149
    v_cvt_pk_bf16_f32 v80, v56, v57
    v_mfma_f32_32x32x16_bf16 v[224:239], a[20:23], v[72:75], v[224:239]
    v_exp_f32 v60, v60
    v_add_f32 v144, v144, v145
    v_exp_f32 v61, v61
    v_fmac_f32 v144, 0x5f800000, v170
    v_exp_f32 v62, v62
    v_fmac_f32 v144, 0x5f800000, v168
    v_exp_f32 v63, v63
    v_add_f32 v144, v144, v172
    v_cvt_pk_bf16_f32 v81, v58, v59
    v_mov_b32 v145, 0x207
    v_cvt_pk_bf16_f32 v82, v60, v61
    v_mfma_f32_32x32x8_bf16 v[40:55], a[16:17], v[94:95], v[40:55]
    v_exp_f32 v64, v64
    v_cmp_class_f32 s[60:61], v144, v145
    v_exp_f32 v65, v65
    v_exp_f32 v66, v66
    v_exp_f32 v67, v67
    v_cvt_pk_bf16_f32 v83, v62, v63
    v_cvt_pk_bf16_f32 v84, v64, v65
    v_mfma_f32_32x32x16_bf16 v[224:239], a[24:27], v[76:79], v[224:239]
    v_exp_f32 v68, v68
    v_exp_f32 v69, v69
    v_exp_f32 v70, v70
    v_exp_f32 v71, v71
    v_cvt_pk_bf16_f32 v85, v66, v67
    v_cvt_pk_bf16_f32 v86, v68, v69
    v_cvt_pk_bf16_f32 v87, v70, v71
    s_cmp_lg_u64 s[60:61], 0
    s_cbranch_scc1 L_slow0
L_slow0_ret:
    v_mfma_f32_32x32x16_bf16 v[56:71], a[4:7], v[96:99], 0
    ds_read_b128 v[152:155], v21
    ds_read_b128 v[162:165], v23 offset:0
    ds_read_b128 v[172:175], v23 offset:1024
    ds_read_b128 v[156:159], v21 offset:32
    v_exp_f32 v40, v40
    v_exp_f32 v41, v41
    v_exp_f32 v42, v42
    v_exp_f32 v43, v43
    v_cvt_pk_bf16_f32 v72, v40, v41
    v_mfma_f32_32x32x16_bf16 v[240:255], a[20:23], v[80:83], v[240:255]
    v_exp_f32 v44, v44
    v_exp_f32 v45, v45
    v_exp_f32 v46, v46
    v_exp_f32 v47, v47
    v_cvt_pk_bf16_f32 v73, v42, v43
    v_cvt_pk_bf16_f32 v74, v44, v45
    v_mfma_f32_32x32x8_bf16 v[56:71], a[16:17], v[102:103], v[56:71]
    v_exp_f32 v48, v48
    v_exp_f32 v49, v49
    v_exp_f32 v50, v50
    v_exp_f32 v51, v51
    v_cvt_pk_bf16_f32 v75, v46, v47
    v_cvt_pk_bf16_f32 v76, v48, v49
    v_mfma_f32_32x32x16_bf16 v[240:255], a[24:27], v[84:87], v[240:255]
    v_exp_f32 v52, v52
    v_exp_f32 v53, v53
    v_exp_f32 v54, v54
    v_exp_f32 v55, v55
    v_cvt_pk_bf16_f32 v77, v50, v51
    v_cvt_pk_bf16_f32 v78, v52, v53
    v_cvt_pk_bf16_f32 v79, v54, v55
    v_mfma_f32_32x32x16_bf16 v[40:55], a[4:7], v[104:107], 0
    ds_read_b128 v[166:169], v23 offset:4096
    ds_read_b128 v[176:179], v23 offset:5120
    ds_read_b64 v[160:161], v22 offset:64
    ds_read_b64 v[170:171], v24 offset:8192
    v_exp_f32 v56, v56
    v_exp_f32 v57, v57
    v_exp_f32 v58, v58
    v_exp_f32 v59, v59
    v_cvt_pk_bf16_f32 v80, v56, v57
    v_mfma_f32_32x32x16_bf16 v[192:207], a[28:31], v[72:75], v[192:207]
    buffer_load_dwordx4 a[0:3], v36, s[16:19], s52 offen offset:1024 sc1
    v_exp_f32 v60, v60
    v_exp_f32 v61, v61
    v_exp_f32 v62, v62
    v_exp_f32 v63, v63
    v_cvt_pk_bf16_f32 v81, v58, v59
    v_cvt_pk_bf16_f32 v82, v60, v61
    v_mfma_f32_32x32x8_bf16 v[40:55], a[16:17], v[110:111], v[40:55]
    v_exp_f32 v64, v64
    v_exp_f32 v65, v65
    v_exp_f32 v66, v66
    v_exp_f32 v67, v67
    v_cvt_pk_bf16_f32 v83, v62, v63
    v_cvt_pk_bf16_f32 v84, v64, v65
    v_mfma_f32_32x32x16_bf16 v[192:207], a[32:35], v[76:79], v[192:207]
    buffer_load_dwordx4 a[20:23], v36, s[16:19], s52 offen offset:2048 sc1
    v_exp_f32 v68, v68
    v_exp_f32 v69, v69
    v_exp_f32 v70, v70
    v_exp_f32 v71, v71
    v_cvt_pk_bf16_f32 v85, v66, v67
    v_cvt_pk_bf16_f32 v86, v68, v69
    v_cvt_pk_bf16_f32 v87, v70, v71
    v_mfma_f32_32x32x16_bf16 v[56:71], a[4:7], v[112:115], 0
    ds_read_b64 v[180:181], v24 offset:9216
    v_exp_f32 v40, v40
    v_exp_f32 v41, v41
    v_exp_f32 v42, v42
    s_waitcnt lgkmcnt(7)
    v_mfma_f32_32x32x16_bf16 v[120:135], v[152:155], v[162:165], 0
    buffer_load_dwordx4 a[24:27], v36, s[16:19], s52 offen offset:3072 sc1
    v_exp_f32 v43, v43
    v_cvt_pk_bf16_f32 v72, v40, v41
    v_mfma_f32_32x32x16_bf16 v[208:223], a[28:31], v[80:83], v[208:223]
    v_exp_f32 v44, v44
    v_exp_f32 v45, v45
    v_exp_f32 v46, v46
    s_waitcnt lgkmcnt(6)
    v_mfma_f32_32x32x16_bf16 v[136:151], v[152:155], v[172:175], 0
    v_exp_f32 v47, v47
    v_cvt_pk_bf16_f32 v73, v42, v43
    v_cvt_pk_bf16_f32 v74, v44, v45
    v_mfma_f32_32x32x8_bf16 v[56:71], a[16:17], v[118:119], v[56:71]
    v_exp_f32 v48, v48
    v_exp_f32 v49, v49
    v_exp_f32 v50, v50
    s_waitcnt lgkmcnt(4)
    v_mfma_f32_32x32x16_bf16 v[120:135], v[156:159], v[166:169], v[120:135]
    v_exp_f32 v51, v51
    v_cvt_pk_bf16_f32 v75, v46, v47
    v_cvt_pk_bf16_f32 v76, v48, v49
    v_mfma_f32_32x32x16_bf16 v[208:223], a[32:35], v[84:87], v[208:223]
    v_exp_f32 v52, v52
    v_exp_f32 v53, v53
    v_exp_f32 v54, v54
    v_exp_f32 v55, v55
    v_cvt_pk_bf16_f32 v77, v50, v51
    v_cvt_pk_bf16_f32 v78, v52, v53
    v_cvt_pk_bf16_f32 v79, v54, v55
    v_mfma_f32_32x32x16_bf16 v[40:55], a[8:11], v[88:91], 0
    v_exp_f32 v56, v56
    v_exp_f32 v57, v57
    v_exp_f32 v58, v58
    s_waitcnt lgkmcnt(3)
    v_mfma_f32_32x32x16_bf16 v[136:151], v[156:159], v[176:179], v[136:151]
    v_exp_f32 v59, v59
    v_cvt_pk_bf16_f32 v80, v56, v57
    v_mfma_f32_32x32x16_bf16 v[224:239], a[28:31], v[72:75], v[224:239]
    v_exp_f32 v60, v60
    v_exp_f32 v61, v61
    v_exp_f32 v62, v62
    s_waitcnt lgkmcnt(1)
    v_mfma_f32_32x32x8_bf16 v[120:135], v[160:161], v[170:171], v[120:135]
    v_exp_f32 v63, v63
    v_cvt_pk_bf16_f32 v81, v58, v59
    v_cvt_pk_bf16_f32 v82, v60, v61
    v_mfma_f32_32x32x8_bf16 v[40:55], a[18:19], v[92:93], v[40:55]
    v_exp_f32 v64, v64
    v_exp_f32 v65, v65
    v_exp_f32 v66, v66
    s_waitcnt lgkmcnt(0)
    v_mfma_f32_32x32x8_bf16 v[136:151], v[160:161], v[180:181], v[136:151]
    v_exp_f32 v67, v67
    v_cvt_pk_bf16_f32 v83, v62, v63
    v_cvt_pk_bf16_f32 v84, v64, v65
    v_mfma_f32_32x32x16_bf16 v[224:239], a[32:35], v[76:79], v[224:239]
    v_exp_f32 v68, v68
    v_exp_f32 v69, v69
    v_exp_f32 v70, v70
    v_exp_f32 v71, v71
    v_cvt_pk_bf16_f32 v85, v66, v67
    v_cvt_pk_bf16_f32 v86, v68, v69
    v_cvt_pk_bf16_f32 v87, v70, v71
    v_mfma_f32_32x32x16_bf16 v[56:71], a[8:11], v[96:99], 0
    v_exp_f32 v40, v40
    v_exp_f32 v41, v41
    v_exp_f32 v42, v42
    v_exp_f32 v43, v43
    v_cvt_pk_bf16_f32 v72, v40, v41
    v_mfma_f32_32x32x16_bf16 v[240:255], a[28:31], v[80:83], v[240:255]
    v_exp_f32 v44, v44
    v_exp_f32 v45, v45
    v_exp_f32 v46, v46
    v_exp_f32 v47, v47
    v_cvt_pk_bf16_f32 v73, v42, v43
    v_cvt_pk_bf16_f32 v74, v44, v45
    v_mfma_f32_32x32x8_bf16 v[56:71], a[18:19], v[100:101], v[56:71]
    v_exp_f32 v48, v48
    v_exp_f32 v49, v49
    v_exp_f32 v50, v50
    v_exp_f32 v51, v51
    v_cvt_pk_bf16_f32 v75, v46, v47
    v_cvt_pk_bf16_f32 v76, v48, v49
    v_mfma_f32_32x32x16_bf16 v[240:255], a[32:35], v[84:87], v[240:255]
    v_exp_f32 v52, v52
    v_exp_f32 v53, v53
    v_exp_f32 v54, v54
    v_exp_f32 v55, v55
    v_cvt_pk_bf16_f32 v77, v50, v51
    v_cvt_pk_bf16_f32 v78, v52, v53
    v_cvt_pk_bf16_f32 v79, v54, v55
    v_mfma_f32_32x32x16_bf16 v[40:55], a[8:11], v[104:107], 0
    buffer_load_dwordx4 a[4:7], v12, s[16:19], s52 offen offset:0 sc1
    v_exp_f32 v56, v56
    v_mov_b32 v182, v128
    v_exp_f32 v57, v57
    v_mov_b32 v184, v144
    v_exp_f32 v58, v58
    s_nop 0
    v_permlane32_swap_b32 v182, v184
    v_exp_f32 v59, v59
    v_add_f32 v184, 0x358637bd, v184
    v_cvt_pk_bf16_f32 v80, v56, v57
    v_mfma_f32_32x32x16_bf16 v[192:207], a[36:39], v[72:75], v[192:207]
    buffer_load_dwordx4 a[28:31], v12, s[16:19], s52 offen offset:1024 sc1
    v_exp_f32 v60, v60
    v_rcp_f32 v184, v184
    v_exp_f32 v61, v61
    v_mul_f32 v184, v184, v19
    v_exp_f32 v62, v62
    v_mov_b32 v182, v184
    v_exp_f32 v63, v63
    v_cvt_pk_bf16_f32 v81, v58, v59
    v_cvt_pk_bf16_f32 v82, v60, v61
    v_mfma_f32_32x32x8_bf16 v[40:55], a[18:19], v[108:109], v[40:55]
    v_exp_f32 v64, v64
    v_exp_f32 v65, v65
    v_exp_f32 v66, v66
    v_exp_f32 v67, v67
    v_cvt_pk_bf16_f32 v83, v62, v63
    v_cvt_pk_bf16_f32 v84, v64, v65
    v_mfma_f32_32x32x16_bf16 v[192:207], a[40:43], v[76:79], v[192:207]
    v_exp_f32 v68, v68
    v_exp_f32 v69, v69
    v_exp_f32 v70, v70
    v_exp_f32 v71, v71
    v_cvt_pk_bf16_f32 v85, v66, v67
    v_cvt_pk_bf16_f32 v86, v68, v69
    v_cvt_pk_bf16_f32 v87, v70, v71
    v_mfma_f32_32x32x16_bf16 v[56:71], a[8:11], v[112:115], 0
    buffer_load_dwordx4 a[32:35], v12, s[16:19], s52 offen offset:2048 sc1
    v_exp_f32 v40, v40
    v_permlane32_swap_b32 v182, v184
    v_exp_f32 v41, v41
    v_mul_f32 v120, v120, v182
    v_exp_f32 v42, v42
    v_mul_f32 v121, v121, v182
    v_exp_f32 v43, v43
    v_mul_f32 v122, v122, v182
    v_cvt_pk_bf16_f32 v72, v40, v41
    v_mfma_f32_32x32x16_bf16 v[208:223], a[36:39], v[80:83], v[208:223]
    v_exp_f32 v44, v44
    v_mul_f32 v123, v123, v182
    v_exp_f32 v45, v45
    v_mul_f32 v124, v124, v182
    v_exp_f32 v46, v46
    v_mul_f32 v125, v125, v182
    v_exp_f32 v47, v47
    v_cvt_pk_bf16_f32 v73, v42, v43
    v_cvt_pk_bf16_f32 v74, v44, v45
    v_mfma_f32_32x32x8_bf16 v[56:71], a[18:19], v[116:117], v[56:71]
    v_exp_f32 v48, v48
    v_exp_f32 v49, v49
    v_exp_f32 v50, v50
    v_exp_f32 v51, v51
    v_cvt_pk_bf16_f32 v75, v46, v47
    v_cvt_pk_bf16_f32 v76, v48, v49
    v_mfma_f32_32x32x16_bf16 v[208:223], a[40:43], v[84:87], v[208:223]
    v_exp_f32 v52, v52
    v_exp_f32 v53, v53
    v_exp_f32 v54, v54
    v_exp_f32 v55, v55
    v_cvt_pk_bf16_f32 v77, v50, v51
    v_cvt_pk_bf16_f32 v78, v52, v53
    v_cvt_pk_bf16_f32 v79, v54, v55
    v_mfma_f32_32x32x16_bf16 v[40:55], a[12:15], v[88:91], 0
    v_exp_f32 v56, v56
    v_mul_f32 v126, v126, v182
    v_exp_f32 v57, v57
    v_mul_f32 v127, v127, v182
    v_exp_f32 v58, v58
    v_mul_f32 v128, v128, v182
    v_exp_f32 v59, v59
    v_mul_f32 v129, v129, v182
    v_cvt_pk_bf16_f32 v80, v56, v57
    v_mfma_f32_32x32x16_bf16 v[224:239], a[36:39], v[72:75], v[224:239]
    v_exp_f32 v60, v60
    v_mul_f32 v130, v130, v182
    v_exp_f32 v61, v61
    v_mul_f32 v131, v131, v182
    v_exp_f32 v62, v62
    v_cvt_pk_bf16_f32 v120, v120, v121
    v_exp_f32 v63, v63
    v_cvt_pk_bf16_f32 v81, v58, v59
    v_cvt_pk_bf16_f32 v82, v60, v61
    v_mfma_f32_32x32x8_bf16 v[40:55], a[18:19], v[94:95], v[40:55]
    v_exp_f32 v64, v64
    v_exp_f32 v65, v65
    v_exp_f32 v66, v66
    v_exp_f32 v67, v67
    v_cvt_pk_bf16_f32 v83, v62, v63
    v_cvt_pk_bf16_f32 v84, v64, v65
    v_mfma_f32_32x32x16_bf16 v[224:239], a[40:43], v[76:79], v[224:239]
    v_exp_f32 v68, v68
    v_exp_f32 v69, v69
    v_exp_f32 v70, v70
    v_exp_f32 v71, v71
    v_cvt_pk_bf16_f32 v85, v66, v67
    v_cvt_pk_bf16_f32 v86, v68, v69
    v_cvt_pk_bf16_f32 v87, v70, v71
    v_mfma_f32_32x32x16_bf16 v[56:71], a[12:15], v[96:99], 0
    v_exp_f32 v40, v40
    v_cvt_pk_bf16_f32 v121, v122, v123
    v_exp_f32 v41, v41
    v_cvt_pk_bf16_f32 v122, v124, v125
    v_exp_f32 v42, v42
    v_cvt_pk_bf16_f32 v123, v126, v127
    v_exp_f32 v43, v43
    v_cvt_pk_bf16_f32 v124, v128, v129
    v_cvt_pk_bf16_f32 v72, v40, v41
    v_mfma_f32_32x32x16_bf16 v[240:255], a[36:39], v[80:83], v[240:255]
    v_exp_f32 v44, v44
    v_cvt_pk_bf16_f32 v125, v130, v131
    v_exp_f32 v45, v45
    v_exp_f32 v46, v46
    v_exp_f32 v47, v47
    v_cvt_pk_bf16_f32 v73, v42, v43
    v_cvt_pk_bf16_f32 v74, v44, v45
    v_mfma_f32_32x32x8_bf16 v[56:71], a[18:19], v[102:103], v[56:71]
    v_exp_f32 v48, v48
    v_exp_f32 v49, v49
    v_exp_f32 v50, v50
    v_exp_f32 v51, v51
    v_cvt_pk_bf16_f32 v75, v46, v47
    v_cvt_pk_bf16_f32 v76, v48, v49
    v_mfma_f32_32x32x16_bf16 v[240:255], a[40:43], v[84:87], v[240:255]
    buffer_store_dwordx4 v[120:123], v26, s[16:19], s44 offen sc1
    v_exp_f32 v52, v52
    v_exp_f32 v53, v53
    v_exp_f32 v54, v54
    v_exp_f32 v55, v55
    v_cvt_pk_bf16_f32 v77, v50, v51
    v_cvt_pk_bf16_f32 v78, v52, v53
    v_cvt_pk_bf16_f32 v79, v54, v55
    buffer_store_dwordx2 v[124:125], v27, s[16:19], s44 offen offset:512 sc1
    v_mfma_f32_32x32x16_bf16 v[40:55], a[12:15], v[104:107], 0
    buffer_load_dwordx4 a[8:11], v12, s[16:19], s52 offen offset:3072 sc1
    v_exp_f32 v56, v56
    v_mul_f32 v136, v136, v184
    v_exp_f32 v57, v57
    v_mul_f32 v137, v137, v184
    v_exp_f32 v58, v58
    v_mul_f32 v138, v138, v184
    v_exp_f32 v59, v59
    v_mul_f32 v139, v139, v184
    v_cvt_pk_bf16_f32 v80, v56, v57
    v_mfma_f32_32x32x16_bf16 v[192:207], a[44:47], v[72:75], v[192:207]
    buffer_load_dwordx4 a[36:39], v13, s[16:19], s52 offen offset:0 sc1
    v_exp_f32 v60, v60
    v_mul_f32 v140, v140, v184
    v_exp_f32 v61, v61
    v_mul_f32 v141, v141, v184
    v_exp_f32 v62, v62
    v_mul_f32 v142, v142, v184
    v_exp_f32 v63, v63
    v_cvt_pk_bf16_f32 v81, v58, v59
    v_cvt_pk_bf16_f32 v82, v60, v61
    v_mfma_f32_32x32x8_bf16 v[40:55], a[18:19], v[110:111], v[40:55]
    v_exp_f32 v64, v64
    v_exp_f32 v65, v65
    v_exp_f32 v66, v66
    v_exp_f32 v67, v67
    v_cvt_pk_bf16_f32 v83, v62, v63
    v_cvt_pk_bf16_f32 v84, v64, v65
    v_mfma_f32_32x32x16_bf16 v[192:207], a[48:51], v[76:79], v[192:207]
    v_exp_f32 v68, v68
    v_exp_f32 v69, v69
    v_exp_f32 v70, v70
    v_exp_f32 v71, v71
    v_cvt_pk_bf16_f32 v85, v66, v67
    v_cvt_pk_bf16_f32 v86, v68, v69
    v_cvt_pk_bf16_f32 v87, v70, v71
    v_mfma_f32_32x32x16_bf16 v[56:71], a[12:15], v[112:115], 0
    buffer_load_dwordx4 a[40:43], v13, s[16:19], s52 offen offset:1024 sc1
    v_exp_f32 v40, v40
    v_mul_f32 v143, v143, v184
    v_exp_f32 v41, v41
    v_mul_f32 v144, v144, v184
    v_exp_f32 v42, v42
    v_mul_f32 v145, v145, v184
    v_exp_f32 v43, v43
    v_mul_f32 v146, v146, v184
    v_cvt_pk_bf16_f32 v72, v40, v41
    v_mfma_f32_32x32x16_bf16 v[208:223], a[44:47], v[80:83], v[208:223]
    v_exp_f32 v44, v44
    v_mul_f32 v147, v147, v184
    v_exp_f32 v45, v45
    v_cvt_pk_bf16_f32 v136, v136, v137
    v_exp_f32 v46, v46
    v_cvt_pk_bf16_f32 v137, v138, v139
    v_exp_f32 v47, v47
    v_cvt_pk_bf16_f32 v73, v42, v43
    v_cvt_pk_bf16_f32 v74, v44, v45
    v_mfma_f32_32x32x8_bf16 v[56:71], a[18:19], v[118:119], v[56:71]
L_pd9118:
    s_cbranch_execz L_padend
    v_exp_f32 v48, v48
    v_exp_f32 v49, v49
    v_exp_f32 v50, v50
    v_exp_f32 v51, v51
    v_cvt_pk_bf16_f32 v75, v46, v47
    v_cvt_pk_bf16_f32 v76, v48, v49
    v_mfma_f32_32x32x16_bf16 v[208:223], a[48:51], v[84:87], v[208:223]
    v_exp_f32 v52, v52
    v_exp_f32 v53, v53
    v_exp_f32 v54, v54
    v_exp_f32 v55, v55
    v_cvt_pk_bf16_f32 v77, v50, v51
    v_cvt_pk_bf16_f32 v78, v52, v53
    v_cvt_pk_bf16_f32 v79, v54, v55
    v_mfma_f32_32x32x16_bf16 v[40:55], a[52:55], v[88:91], 0
    v_exp_f32 v56, v56
    v_cvt_pk_bf16_f32 v138, v140, v141
    v_exp_f32 v57, v57
    v_cvt_pk_bf16_f32 v139, v142, v143
    v_exp_f32 v58, v58
    v_cvt_pk_bf16_f32 v140, v144, v145
    v_exp_f32 v59, v59
    v_cvt_pk_bf16_f32 v141, v146, v147
    v_cvt_pk_bf16_f32 v80, v56, v57
    v_mfma_f32_32x32x16_bf16 v[224:239], a[44:47], v[72:75], v[224:239]
    buffer_store_dwordx4 v[136:139], v26, s[16:19], s45 offen sc1
    v_exp_f32 v60, v60
    v_exp_f32 v61, v61
    v_exp_f32 v62, v62
    v_exp_f32 v63, v63
    v_cvt_pk_bf16_f32 v81, v58, v59
    v_cvt_pk_bf16_f32 v82, v60, v61
    v_mfma_f32_32x32x8_bf16 v[40:55], a[68:69], v[92:93], v[40:55]
    v_exp_f32 v64, v64
    v_exp_f32 v65, v65
    v_exp_f32 v66, v66
    v_exp_f32 v67, v67
    v_cvt_pk_bf16_f32 v83, v62, v63
    v_cvt_pk_bf16_f32 v84, v64, v65
    v_mfma_f32_32x32x16_bf16 v[224:239], a[48:51], v[76:79], v[224:239]
    buffer_store_dwordx2 v[140:141], v27, s[16:19], s45 offen offset:512 sc1
    v_exp_f32 v68, v68
    v_exp_f32 v69, v69
    v_exp_f32 v70, v70
    v_exp_f32 v71, v71
    v_cvt_pk_bf16_f32 v85, v66, v67
    v_cvt_pk_bf16_f32 v86, v68, v69
    v_cvt_pk_bf16_f32 v87, v70, v71
    v_mfma_f32_32x32x16_bf16 v[56:71], a[52:55], v[96:99], 0
    v_exp_f32 v40, v40
    v_exp_f32 v41, v41
    v_exp_f32 v42, v42
    v_exp_f32 v43, v43
    v_cvt_pk_bf16_f32 v72, v40, v41
    v_mfma_f32_32x32x16_bf16 v[240:255], a[44:47], v[80:83], v[240:255]
    v_exp_f32 v44, v44
    v_exp_f32 v45, v45
    v_exp_f32 v46, v46
    v_exp_f32 v47, v47
    v_cvt_pk_bf16_f32 v73, v42, v43
    v_cvt_pk_bf16_f32 v74, v44, v45
    v_mfma_f32_32x32x8_bf16 v[56:71], a[68:69], v[100:101], v[56:71]
    v_exp_f32 v48, v48
    v_exp_f32 v49, v49
    v_exp_f32 v50, v50
    v_exp_f32 v51, v51
    v_cvt_pk_bf16_f32 v75, v46, v47
    v_cvt_pk_bf16_f32 v76, v48, v49
    v_mfma_f32_32x32x16_bf16 v[240:255], a[48:51], v[84:87], v[240:255]
    v_exp_f32 v52, v52
    v_exp_f32 v53, v53
    v_exp_f32 v54, v54
    v_exp_f32 v55, v55
    v_cvt_pk_bf16_f32 v77, v50, v51
    v_cvt_pk_bf16_f32 v78, v52, v53
    v_cvt_pk_bf16_f32 v79, v54, v55
    v_mfma_f32_32x32x16_bf16 v[40:55], a[52:55], v[104:107], 0
    buffer_load_dwordx4 a[12:15], v13, s[16:19], s52 offen offset:2048 sc1
    v_exp_f32 v56, v56
    v_exp_f32 v57, v57
    v_exp_f32 v58, v58
    v_exp_f32 v59, v59
    v_cvt_pk_bf16_f32 v80, v56, v57
    v_mfma_f32_32x32x16_bf16 v[192:207], a[72:75], v[72:75], v[192:207]
    buffer_load_dwordx4 a[44:47], v13, s[16:19], s52 offen offset:3072 sc1
    v_exp_f32 v60, v60
    v_exp_f32 v61, v61
    v_exp_f32 v62, v62
    v_exp_f32 v63, v63
    v_cvt_pk_bf16_f32 v81, v58, v59
    v_cvt_pk_bf16_f32 v82, v60, v61
    v_mfma_f32_32x32x8_bf16 v[40:55], a[68:69], v[108:109], v[40:55]
    v_exp_f32 v64, v64
    v_exp_f32 v65, v65
    v_exp_f32 v66, v66
    v_exp_f32 v67, v67
    v_cvt_pk_bf16_f32 v83, v62, v63
    v_cvt_pk_bf16_f32 v84, v64, v65
    v_mfma_f32_32x32x16_bf16 v[192:207], a[76:79], v[76:79], v[192:207]
    v_exp_f32 v68, v68
    v_exp_f32 v69, v69
    v_exp_f32 v70, v70
    v_exp_f32 v71, v71
    v_cvt_pk_bf16_f32 v85, v66, v67
    v_cvt_pk_bf16_f32 v86, v68, v69
    v_cvt_pk_bf16_f32 v87, v70, v71
    v_mfma_f32_32x32x16_bf16 v[56:71], a[52:55], v[112:115], 0
    buffer_load_dwordx4 a[48:51], v36, s[16:19], s53 offen offset:0 sc1
    v_exp_f32 v40, v40
    v_exp_f32 v41, v41
    v_exp_f32 v42, v42
    v_exp_f32 v43, v43
    v_cvt_pk_bf16_f32 v72, v40, v41
    v_mfma_f32_32x32x16_bf16 v[208:223], a[72:75], v[80:83], v[208:223]
    buffer_load_dwordx4 a[16:19], v36, s[16:19], s53 offen offset:1024 sc1
    v_exp_f32 v44, v44
    v_exp_f32 v45, v45
    v_exp_f32 v46, v46
    v_exp_f32 v47, v47
    v_cvt_pk_bf16_f32 v73, v42, v43
    v_cvt_pk_bf16_f32 v74, v44, v45
    v_mfma_f32_32x32x8_bf16 v[56:71], a[68:69], v[116:117], v[56:71]
    v_exp_f32 v48, v48
    v_exp_f32 v49, v49
    v_exp_f32 v50, v50
    v_exp_f32 v51, v51
    v_cvt_pk_bf16_f32 v75, v46, v47
    v_cvt_pk_bf16_f32 v76, v48, v49
    v_mfma_f32_32x32x16_bf16 v[208:223], a[76:79], v[84:87], v[208:223]
    v_exp_f32 v52, v52
    v_exp_f32 v53, v53
    v_exp_f32 v54, v54
    v_exp_f32 v55, v55
    v_cvt_pk_bf16_f32 v77, v50, v51
    v_cvt_pk_bf16_f32 v78, v52, v53
    v_cvt_pk_bf16_f32 v79, v54, v55
    v_mfma_f32_32x32x16_bf16 v[40:55], a[56:59], v[88:91], 0
    buffer_load_dwordx4 v[120:123], v36, s[16:19], s53 offen offset:2048 sc1
    v_exp_f32 v56, v56
    v_exp_f32 v57, v57
    v_exp_f32 v58, v58
    v_exp_f32 v59, v59
    v_cvt_pk_bf16_f32 v80, v56, v57
    v_mfma_f32_32x32x16_bf16 v[224:239], a[72:75], v[72:75], v[224:239]
    buffer_load_dwordx4 v[124:127], v36, s[16:19], s53 offen offset:3072 sc1
    v_exp_f32 v60, v60
    v_exp_f32 v61, v61
    v_exp_f32 v62, v62
    v_exp_f32 v63, v63
    v_cvt_pk_bf16_f32 v81, v58, v59
    v_cvt_pk_bf16_f32 v82, v60, v61
    v_mfma_f32_32x32x8_bf16 v[40:55], a[68:69], v[94:95], v[40:55]
    v_exp_f32 v64, v64
    v_exp_f32 v65, v65
    v_exp_f32 v66, v66
    v_exp_f32 v67, v67
    v_cvt_pk_bf16_f32 v83, v62, v63
    v_cvt_pk_bf16_f32 v84, v64, v65
    v_mfma_f32_32x32x16_bf16 v[224:239], a[76:79], v[76:79], v[224:239]
    v_exp_f32 v68, v68
    v_exp_f32 v69, v69
    v_exp_f32 v70, v70
    v_exp_f32 v71, v71
    v_cvt_pk_bf16_f32 v85, v66, v67
    v_cvt_pk_bf16_f32 v86, v68, v69
    v_cvt_pk_bf16_f32 v87, v70, v71
    v_mfma_f32_32x32x16_bf16 v[56:71], a[56:59], v[96:99], 0
    buffer_load_dwordx4 v[128:131], v12, s[16:19], s53 offen offset:0 sc1
    v_exp_f32 v40, v40
    v_exp_f32 v41, v41
    v_exp_f32 v42, v42
    v_exp_f32 v43, v43
    v_cvt_pk_bf16_f32 v72, v40, v41
    v_mfma_f32_32x32x16_bf16 v[240:255], a[72:75], v[80:83], v[240:255]
    buffer_load_dwordx4 v[132:135], v12, s[16:19], s53 offen offset:1024 sc1
    v_exp_f32 v44, v44
    v_exp_f32 v45, v45
    v_exp_f32 v46, v46
    v_exp_f32 v47, v47
    v_cvt_pk_bf16_f32 v73, v42, v43
    v_cvt_pk_bf16_f32 v74, v44, v45
    v_mfma_f32_32x32x8_bf16 v[56:71], a[68:69], v[102:103], v[56:71]
    v_exp_f32 v48, v48
    v_exp_f32 v49, v49
    v_exp_f32 v50, v50
    v_exp_f32 v51, v51
    v_cvt_pk_bf16_f32 v75, v46, v47
    v_cvt_pk_bf16_f32 v76, v48, v49
    v_mfma_f32_32x32x16_bf16 v[240:255], a[76:79], v[84:87], v[240:255]
    v_exp_f32 v52, v52
    v_exp_f32 v53, v53
    v_exp_f32 v54, v54
    v_exp_f32 v55, v55
    v_cvt_pk_bf16_f32 v77, v50, v51
    v_cvt_pk_bf16_f32 v78, v52, v53
    v_cvt_pk_bf16_f32 v79, v54, v55
    v_mfma_f32_32x32x16_bf16 v[40:55], a[56:59], v[104:107], 0
    buffer_load_dwordx4 v[136:139], v12, s[16:19], s53 offen offset:2048 sc1
    v_exp_f32 v56, v56
    v_exp_f32 v57, v57
    v_exp_f32 v58, v58
    v_exp_f32 v59, v59
    v_cvt_pk_bf16_f32 v80, v56, v57
    v_mfma_f32_32x32x16_bf16 v[192:207], a[80:83], v[72:75], v[192:207]
    buffer_load_dwordx4 v[140:143], v12, s[16:19], s53 offen offset:3072 sc1
    v_exp_f32 v60, v60
    v_exp_f32 v61, v61
    v_exp_f32 v62, v62
    v_exp_f32 v63, v63
    v_cvt_pk_bf16_f32 v81, v58, v59
    v_cvt_pk_bf16_f32 v82, v60, v61
    v_mfma_f32_32x32x8_bf16 v[40:55], a[68:69], v[110:111], v[40:55]
    v_exp_f32 v64, v64
    v_exp_f32 v65, v65
    v_exp_f32 v66, v66
    v_exp_f32 v67, v67
    v_cvt_pk_bf16_f32 v83, v62, v63
    v_cvt_pk_bf16_f32 v84, v64, v65
    v_mfma_f32_32x32x16_bf16 v[192:207], a[84:87], v[76:79], v[192:207]
    v_exp_f32 v68, v68
    v_exp_f32 v69, v69
    v_exp_f32 v70, v70
    v_exp_f32 v71, v71
    v_cvt_pk_bf16_f32 v85, v66, v67
    v_cvt_pk_bf16_f32 v86, v68, v69
    v_cvt_pk_bf16_f32 v87, v70, v71
    s_waitcnt vmcnt(10)
    s_mov_b64 exec, 1
    buffer_store_dword v34, v8, s[16:19], s46 offen sc1
    s_mov_b64 exec, -1
    v_mfma_f32_32x32x16_bf16 v[56:71], a[56:59], v[112:115], 0
    buffer_load_dwordx4 v[144:147], v13, s[16:19], s53 offen offset:0 sc1
    v_exp_f32 v40, v40
    v_exp_f32 v41, v41
    v_exp_f32 v42, v42
    v_exp_f32 v43, v43
    v_cvt_pk_bf16_f32 v72, v40, v41
    v_mfma_f32_32x32x16_bf16 v[208:223], a[80:83], v[80:83], v[208:223]
    buffer_load_dwordx4 v[148:151], v13, s[16:19], s53 offen offset:1024 sc1
    v_exp_f32 v44, v44
    v_exp_f32 v45, v45
    v_exp_f32 v46, v46
    v_exp_f32 v47, v47
    v_cvt_pk_bf16_f32 v73, v42, v43
    v_cvt_pk_bf16_f32 v74, v44, v45
    v_mfma_f32_32x32x8_bf16 v[56:71], a[68:69], v[118:119], v[56:71]
    v_exp_f32 v48, v48
    v_exp_f32 v49, v49
    v_exp_f32 v50, v50
    v_exp_f32 v51, v51
    v_cvt_pk_bf16_f32 v75, v46, v47
    v_cvt_pk_bf16_f32 v76, v48, v49
    v_mfma_f32_32x32x16_bf16 v[208:223], a[84:87], v[84:87], v[208:223]
    v_exp_f32 v52, v52
    v_exp_f32 v53, v53
    v_exp_f32 v54, v54
    v_exp_f32 v55, v55
    v_cvt_pk_bf16_f32 v77, v50, v51
    v_cvt_pk_bf16_f32 v78, v52, v53
    v_cvt_pk_bf16_f32 v79, v54, v55
    v_mfma_f32_32x32x16_bf16 v[40:55], a[60:63], v[88:91], 0
    buffer_load_dwordx4 v[152:155], v13, s[16:19], s53 offen offset:2048 sc1
    v_exp_f32 v56, v56
    v_exp_f32 v57, v57
    v_exp_f32 v58, v58
    v_exp_f32 v59, v59
    v_cvt_pk_bf16_f32 v80, v56, v57
    v_mfma_f32_32x32x16_bf16 v[224:239], a[80:83], v[72:75], v[224:239]
    buffer_load_dwordx4 v[156:159], v13, s[16:19], s53 offen offset:3072 sc1
    v_exp_f32 v60, v60
    v_exp_f32 v61, v61
    v_exp_f32 v62, v62
    v_exp_f32 v63, v63
    v_cvt_pk_bf16_f32 v81, v58, v59
    v_cvt_pk_bf16_f32 v82, v60, v61
    v_mfma_f32_32x32x8_bf16 v[40:55], a[70:71], v[92:93], v[40:55]
    v_exp_f32 v64, v64
    v_exp_f32 v65, v65
    v_exp_f32 v66, v66
    v_exp_f32 v67, v67
    v_cvt_pk_bf16_f32 v83, v62, v63
    v_cvt_pk_bf16_f32 v84, v64, v65
    v_mfma_f32_32x32x16_bf16 v[224:239], a[84:87], v[76:79], v[224:239]
    v_exp_f32 v68, v68
    v_exp_f32 v69, v69
    v_exp_f32 v70, v70
    v_exp_f32 v71, v71
    v_cvt_pk_bf16_f32 v85, v66, v67
    v_cvt_pk_bf16_f32 v86, v68, v69
    v_cvt_pk_bf16_f32 v87, v70, v71
    v_mfma_f32_32x32x16_bf16 v[56:71], a[60:63], v[96:99], 0
    buffer_load_dwordx4 v[160:163], v36, s[16:19], s54 offen offset:0 sc1
    v_exp_f32 v40, v40
    v_exp_f32 v41, v41
    v_exp_f32 v42, v42
    v_exp_f32 v43, v43
    v_cvt_pk_bf16_f32 v72, v40, v41
    v_mfma_f32_32x32x16_bf16 v[240:255], a[80:83], v[80:83], v[240:255]
    buffer_load_dwordx4 v[164:167], v36, s[16:19], s54 offen offset:1024 sc1
    v_exp_f32 v44, v44
    v_exp_f32 v45, v45
    v_exp_f32 v46, v46
    v_exp_f32 v47, v47
    v_cvt_pk_bf16_f32 v73, v42, v43
    v_cvt_pk_bf16_f32 v74, v44, v45
    v_mfma_f32_32x32x8_bf16 v[56:71], a[70:71], v[100:101], v[56:71]
    v_exp_f32 v48, v48
    v_exp_f32 v49, v49
    v_exp_f32 v50, v50
    v_exp_f32 v51, v51
    v_cvt_pk_bf16_f32 v75, v46, v47
    v_cvt_pk_bf16_f32 v76, v48, v49
    v_mfma_f32_32x32x16_bf16 v[240:255], a[84:87], v[84:87], v[240:255]
    v_exp_f32 v52, v52
    v_exp_f32 v53, v53
    v_exp_f32 v54, v54
    v_exp_f32 v55, v55
    v_cvt_pk_bf16_f32 v77, v50, v51
    v_cvt_pk_bf16_f32 v78, v52, v53
    v_cvt_pk_bf16_f32 v79, v54, v55
    v_mfma_f32_32x32x16_bf16 v[40:55], a[60:63], v[104:107], 0
    v_exp_f32 v56, v56
    v_exp_f32 v57, v57
    v_exp_f32 v58, v58
    v_exp_f32 v59, v59
    v_cvt_pk_bf16_f32 v80, v56, v57
    v_mfma_f32_32x32x16_bf16 v[192:207], a[88:91], v[72:75], v[192:207]
    v_exp_f32 v60, v60
    v_exp_f32 v61, v61
    v_exp_f32 v62, v62
    v_exp_f32 v63, v63
    v_cvt_pk_bf16_f32 v81, v58, v59
    v_cvt_pk_bf16_f32 v82, v60, v61
    v_mfma_f32_32x32x8_bf16 v[40:55], a[70:71], v[108:109], v[40:55]
    v_exp_f32 v64, v64
    v_exp_f32 v65, v65
    v_exp_f32 v66, v66
    v_exp_f32 v67, v67
    v_cvt_pk_bf16_f32 v83, v62, v63
    v_cvt_pk_bf16_f32 v84, v64, v65
    v_mfma_f32_32x32x16_bf16 v[192:207], a[92:95], v[76:79], v[192:207]
    v_exp_f32 v68, v68
    v_exp_f32 v69, v69
    v_exp_f32 v70, v70
    v_exp_f32 v71, v71
    v_cvt_pk_bf16_f32 v85, v66, v67
    v_cvt_pk_bf16_f32 v86, v68, v69
    v_cvt_pk_bf16_f32 v87, v70, v71
    v_mfma_f32_32x32x16_bf16 v[56:71], a[60:63], v[112:115], 0
    v_exp_f32 v40, v40
    v_exp_f32 v41, v41
    v_exp_f32 v42, v42
    v_exp_f32 v43, v43
    v_cvt_pk_bf16_f32 v72, v40, v41
    v_mfma_f32_32x32x16_bf16 v[208:223], a[88:91], v[80:83], v[208:223]
    v_exp_f32 v44, v44
    v_exp_f32 v45, v45
    v_exp_f32 v46, v46
    v_exp_f32 v47, v47
    v_cvt_pk_bf16_f32 v73, v42, v43
    v_cvt_pk_bf16_f32 v74, v44, v45
    v_mfma_f32_32x32x8_bf16 v[56:71], a[70:71], v[116:117], v[56:71]
    v_exp_f32 v48, v48
    v_exp_f32 v49, v49
    v_exp_f32 v50, v50
    v_exp_f32 v51, v51
    v_cvt_pk_bf16_f32 v75, v46, v47
    v_cvt_pk_bf16_f32 v76, v48, v49
    v_mfma_f32_32x32x16_bf16 v[208:223], a[92:95], v[84:87], v[208:223]
    v_exp_f32 v52, v52
    v_exp_f32 v53, v53
    v_exp_f32 v54, v54
    v_exp_f32 v55, v55
    v_cvt_pk_bf16_f32 v77, v50, v51
    v_cvt_pk_bf16_f32 v78, v52, v53
    v_cvt_pk_bf16_f32 v79, v54, v55
    v_mfma_f32_32x32x16_bf16 v[40:55], a[64:67], v[88:91], 0
    v_exp_f32 v56, v56
    v_exp_f32 v57, v57
    v_exp_f32 v58, v58
    v_exp_f32 v59, v59
    v_cvt_pk_bf16_f32 v80, v56, v57
    v_mfma_f32_32x32x16_bf16 v[224:239], a[88:91], v[72:75], v[224:239]
    v_exp_f32 v60, v60
    v_exp_f32 v61, v61
    v_exp_f32 v62, v62
    v_exp_f32 v63, v63
    v_cvt_pk_bf16_f32 v81, v58, v59
    v_cvt_pk_bf16_f32 v82, v60, v61
    v_mfma_f32_32x32x8_bf16 v[40:55], a[70:71], v[94:95], v[40:55]
    v_exp_f32 v64, v64
    v_exp_f32 v65, v65
    v_exp_f32 v66, v66
    v_exp_f32 v67, v67
    v_cvt_pk_bf16_f32 v83, v62, v63
    v_cvt_pk_bf16_f32 v84, v64, v65
    v_mfma_f32_32x32x16_bf16 v[224:239], a[92:95], v[76:79], v[224:239]
    v_exp_f32 v68, v68
    v_exp_f32 v69, v69
    v_exp_f32 v70, v70
    v_exp_f32 v71, v71
    v_cvt_pk_bf16_f32 v85, v66, v67
    v_cvt_pk_bf16_f32 v86, v68, v69
    v_cvt_pk_bf16_f32 v87, v70, v71
    v_mfma_f32_32x32x16_bf16 v[56:71], a[64:67], v[96:99], 0
    s_mov_b64 exec, 0xff
    buffer_load_dword v39, v33, s[16:19], s48 offen sc1
    s_mov_b64 exec, -1
    v_exp_f32 v40, v40
    v_exp_f32 v41, v41
    v_exp_f32 v42, v42
    v_exp_f32 v43, v43
    v_cvt_pk_bf16_f32 v72, v40, v41
    v_mfma_f32_32x32x16_bf16 v[240:255], a[88:91], v[80:83], v[240:255]
    v_exp_f32 v44, v44
    v_exp_f32 v45, v45
    v_exp_f32 v46, v46
    v_exp_f32 v47, v47
    v_cvt_pk_bf16_f32 v73, v42, v43
    v_cvt_pk_bf16_f32 v74, v44, v45
    v_mfma_f32_32x32x8_bf16 v[56:71], a[70:71], v[102:103], v[56:71]
    v_exp_f32 v48, v48
    v_exp_f32 v49, v49
    v_exp_f32 v50, v50
    v_exp_f32 v51, v51
    v_cvt_pk_bf16_f32 v75, v46, v47
    v_cvt_pk_bf16_f32 v76, v48, v49
    v_mfma_f32_32x32x16_bf16 v[240:255], a[92:95], v[84:87], v[240:255]
    v_exp_f32 v52, v52
    v_exp_f32 v53, v53
    v_exp_f32 v54, v54
    v_exp_f32 v55, v55
    v_cvt_pk_bf16_f32 v77, v50, v51
    v_cvt_pk_bf16_f32 v78, v52, v53
    v_cvt_pk_bf16_f32 v79, v54, v55
    v_mfma_f32_32x32x16_bf16 v[40:55], a[64:67], v[104:107], 0
    v_exp_f32 v56, v56
    v_exp_f32 v57, v57
    v_exp_f32 v58, v58
    v_exp_f32 v59, v59
    v_cvt_pk_bf16_f32 v80, v56, v57
    v_mfma_f32_32x32x16_bf16 v[192:207], a[96:99], v[72:75], v[192:207]
    v_exp_f32 v60, v60
    v_exp_f32 v61, v61
    v_exp_f32 v62, v62
    v_exp_f32 v63, v63
    v_cvt_pk_bf16_f32 v81, v58, v59
    v_cvt_pk_bf16_f32 v82, v60, v61
    v_mfma_f32_32x32x8_bf16 v[40:55], a[70:71], v[110:111], v[40:55]
    v_exp_f32 v64, v64
    v_exp_f32 v65, v65
    v_exp_f32 v66, v66
    v_exp_f32 v67, v67
    v_cvt_pk_bf16_f32 v83, v62, v63
    v_cvt_pk_bf16_f32 v84, v64, v65
    v_mfma_f32_32x32x16_bf16 v[192:207], a[100:103], v[76:79], v[192:207]
    v_exp_f32 v68, v68
    v_exp_f32 v69, v69
    v_exp_f32 v70, v70
    v_exp_f32 v71, v71
    v_cvt_pk_bf16_f32 v85, v66, v67
    v_cvt_pk_bf16_f32 v86, v68, v69
    v_cvt_pk_bf16_f32 v87, v70, v71
    v_mfma_f32_32x32x16_bf16 v[56:71], a[64:67], v[112:115], 0
    v_exp_f32 v40, v40
    v_exp_f32 v41, v41
    v_exp_f32 v42, v42
    v_exp_f32 v43, v43
    v_cvt_pk_bf16_f32 v72, v40, v41
    v_mfma_f32_32x32x16_bf16 v[208:223], a[96:99], v[80:83], v[208:223]
    v_exp_f32 v44, v44
    v_exp_f32 v45, v45
    v_exp_f32 v46, v46
    v_exp_f32 v47, v47
    v_cvt_pk_bf16_f32 v73, v42, v43
    v_cvt_pk_bf16_f32 v74, v44, v45
    v_mfma_f32_32x32x8_bf16 v[56:71], a[70:71], v[118:119], v[56:71]
    v_exp_f32 v48, v48
    v_exp_f32 v49, v49
    v_exp_f32 v50, v50
    v_exp_f32 v51, v51
    v_cvt_pk_bf16_f32 v75, v46, v47
    v_cvt_pk_bf16_f32 v76, v48, v49
    v_mfma_f32_32x32x16_bf16 v[208:223], a[100:103], v[84:87], v[208:223]
    v_exp_f32 v52, v52
    v_exp_f32 v53, v53
    v_exp_f32 v54, v54
    v_exp_f32 v55, v55
    v_cvt_pk_bf16_f32 v77, v50, v51
    v_cvt_pk_bf16_f32 v78, v52, v53
    v_cvt_pk_bf16_f32 v79, v54, v55
    v_mfma_f32_32x32x16_bf16 v[40:55], a[104:107], v[88:91], 0
    v_exp_f32 v56, v56
    v_exp_f32 v57, v57
    v_exp_f32 v58, v58
    v_exp_f32 v59, v59
    v_cvt_pk_bf16_f32 v80, v56, v57
    v_mfma_f32_32x32x16_bf16 v[224:239], a[96:99], v[72:75], v[224:239]
    v_exp_f32 v60, v60
    v_exp_f32 v61, v61
    v_exp_f32 v62, v62
    v_exp_f32 v63, v63
    v_cvt_pk_bf16_f32 v81, v58, v59
    v_cvt_pk_bf16_f32 v82, v60, v61
    v_mfma_f32_32x32x8_bf16 v[40:55], a[120:121], v[92:93], v[40:55]
    v_exp_f32 v64, v64
    v_exp_f32 v65, v65
    v_exp_f32 v66, v66
    v_exp_f32 v67, v67
    v_cvt_pk_bf16_f32 v83, v62, v63
    v_cvt_pk_bf16_f32 v84, v64, v65
    v_mfma_f32_32x32x16_bf16 v[224:239], a[100:103], v[76:79], v[224:239]
    v_exp_f32 v68, v68
    v_exp_f32 v69, v69
    v_exp_f32 v70, v70
    v_exp_f32 v71, v71
    v_cvt_pk_bf16_f32 v85, v66, v67
    v_cvt_pk_bf16_f32 v86, v68, v69
    v_cvt_pk_bf16_f32 v87, v70, v71
    v_mfma_f32_32x32x16_bf16 v[56:71], a[104:107], v[96:99], 0
    v_exp_f32 v40, v40
    v_exp_f32 v41, v41
    v_exp_f32 v42, v42
    v_exp_f32 v43, v43
    v_cvt_pk_bf16_f32 v72, v40, v41
    v_mfma_f32_32x32x16_bf16 v[240:255], a[96:99], v[80:83], v[240:255]
    v_exp_f32 v44, v44
    v_exp_f32 v45, v45
    v_exp_f32 v46, v46
    v_exp_f32 v47, v47
    v_cvt_pk_bf16_f32 v73, v42, v43
    v_cvt_pk_bf16_f32 v74, v44, v45
    v_mfma_f32_32x32x8_bf16 v[56:71], a[120:121], v[100:101], v[56:71]
    v_exp_f32 v48, v48
    v_exp_f32 v49, v49
    v_exp_f32 v50, v50
    v_exp_f32 v51, v51
    v_cvt_pk_bf16_f32 v75, v46, v47
    v_cvt_pk_bf16_f32 v76, v48, v49
    v_mfma_f32_32x32x16_bf16 v[240:255], a[100:103], v[84:87], v[240:255]
    v_exp_f32 v52, v52
    v_exp_f32 v53, v53
    v_exp_f32 v54, v54
    v_exp_f32 v55, v55
    v_cvt_pk_bf16_f32 v77, v50, v51
    v_cvt_pk_bf16_f32 v78, v52, v53
    v_cvt_pk_bf16_f32 v79, v54, v55
    v_mfma_f32_32x32x16_bf16 v[40:55], a[104:107], v[104:107], 0
    v_exp_f32 v56, v56
    v_exp_f32 v57, v57
    v_exp_f32 v58, v58
    v_exp_f32 v59, v59
    v_cvt_pk_bf16_f32 v80, v56, v57
    v_mfma_f32_32x32x16_bf16 v[192:207], a[124:127], v[72:75], v[192:207]
    v_exp_f32 v60, v60
    v_exp_f32 v61, v61
    v_exp_f32 v62, v62
    v_exp_f32 v63, v63
    v_cvt_pk_bf16_f32 v81, v58, v59
    v_cvt_pk_bf16_f32 v82, v60, v61
    v_mfma_f32_32x32x8_bf16 v[40:55], a[120:121], v[108:109], v[40:55]
    v_exp_f32 v64, v64
    v_exp_f32 v65, v65
    v_exp_f32 v66, v66
    v_exp_f32 v67, v67
    v_cvt_pk_bf16_f32 v83, v62, v63
    v_cvt_pk_bf16_f32 v84, v64, v65
    v_mfma_f32_32x32x16_bf16 v[192:207], a[128:131], v[76:79], v[192:207]
    v_exp_f32 v68, v68
    v_exp_f32 v69, v69
    v_exp_f32 v70, v70
    v_exp_f32 v71, v71
    v_cvt_pk_bf16_f32 v85, v66, v67
    v_cvt_pk_bf16_f32 v86, v68, v69
    v_cvt_pk_bf16_f32 v87, v70, v71
    s_waitcnt vmcnt(0)
    s_mov_b64 exec, 0xff
    v_cmp_ne_u32 vcc, 1, v39
    s_mov_b64 exec, -1
    s_nop 3
    s_cbranch_vccnz L_pollfa
L_pollfa_ok:
    v_mfma_f32_32x32x16_bf16 v[56:71], a[104:107], v[112:115], 0
    buffer_load_dwordx4 v[168:171], v36, s[16:19], s64 offen offset:0 sc1
    v_exp_f32 v40, v40
    v_exp_f32 v41, v41
    v_exp_f32 v42, v42
    v_exp_f32 v43, v43
    v_cvt_pk_bf16_f32 v72, v40, v41
    v_mfma_f32_32x32x16_bf16 v[208:223], a[124:127], v[80:83], v[208:223]
    buffer_load_dwordx4 v[172:175], v36, s[16:19], s65 offen offset:0 sc1
    v_exp_f32 v44, v44
    v_exp_f32 v45, v45
    v_exp_f32 v46, v46
    v_exp_f32 v47, v47
    v_cvt_pk_bf16_f32 v73, v42, v43
    v_cvt_pk_bf16_f32 v74, v44, v45
    v_mfma_f32_32x32x8_bf16 v[56:71], a[120:121], v[116:117], v[56:71]
    v_exp_f32 v48, v48
    v_exp_f32 v49, v49
    v_exp_f32 v50, v50
    v_exp_f32 v51, v51
    v_cvt_pk_bf16_f32 v75, v46, v47
    v_cvt_pk_bf16_f32 v76, v48, v49
    v_mfma_f32_32x32x16_bf16 v[208:223], a[128:131], v[84:87], v[208:223]
    buffer_load_dwordx4 v[176:179], v36, s[16:19], s64 offen offset:1024 sc1
    v_exp_f32 v52, v52
    v_exp_f32 v53, v53
    v_exp_f32 v54, v54
    v_exp_f32 v55, v55
    v_cvt_pk_bf16_f32 v77, v50, v51
    v_cvt_pk_bf16_f32 v78, v52, v53
    v_cvt_pk_bf16_f32 v79, v54, v55
    v_mfma_f32_32x32x16_bf16 v[40:55], a[108:111], v[88:91], 0
    buffer_load_dwordx4 v[180:183], v36, s[16:19], s65 offen offset:1024 sc1
    v_exp_f32 v56, v56
    v_exp_f32 v57, v57
    v_exp_f32 v58, v58
    v_exp_f32 v59, v59
    v_cvt_pk_bf16_f32 v80, v56, v57
    v_mfma_f32_32x32x16_bf16 v[224:239], a[124:127], v[72:75], v[224:239]
    buffer_load_dwordx4 v[184:187], v36, s[16:19], s64 offen offset:2048 sc1
    v_exp_f32 v60, v60
    v_exp_f32 v61, v61
    v_exp_f32 v62, v62
    v_exp_f32 v63, v63
    v_cvt_pk_bf16_f32 v81, v58, v59
    v_cvt_pk_bf16_f32 v82, v60, v61
    v_mfma_f32_32x32x8_bf16 v[40:55], a[120:121], v[94:95], v[40:55]
    v_exp_f32 v64, v64
    v_exp_f32 v65, v65
    v_exp_f32 v66, v66
    v_exp_f32 v67, v67
    v_cvt_pk_bf16_f32 v83, v62, v63
    v_cvt_pk_bf16_f32 v84, v64, v65
    v_mfma_f32_32x32x16_bf16 v[224:239], a[128:131], v[76:79], v[224:239]
    buffer_load_dwordx4 v[188:191], v36, s[16:19], s65 offen offset:2048 sc1
    v_exp_f32 v68, v68
    v_exp_f32 v69, v69
    v_exp_f32 v70, v70
    v_exp_f32 v71, v71
    v_cvt_pk_bf16_f32 v85, v66, v67
    v_cvt_pk_bf16_f32 v86, v68, v69
    v_cvt_pk_bf16_f32 v87, v70, v71
    v_mfma_f32_32x32x16_bf16 v[56:71], a[108:111], v[96:99], 0
    buffer_load_dwordx4 a[52:55], v36, s[16:19], s64 offen offset:3072 sc1
    v_exp_f32 v40, v40
    v_exp_f32 v41, v41
    v_exp_f32 v42, v42
    v_exp_f32 v43, v43
    v_cvt_pk_bf16_f32 v72, v40, v41
    v_mfma_f32_32x32x16_bf16 v[240:255], a[124:127], v[80:83], v[240:255]
    buffer_load_dwordx4 a[72:75], v36, s[16:19], s65 offen offset:3072 sc1
    v_exp_f32 v44, v44
    v_exp_f32 v45, v45
    v_exp_f32 v46, v46
    v_exp_f32 v47, v47
    v_cvt_pk_bf16_f32 v73, v42, v43
    v_cvt_pk_bf16_f32 v74, v44, v45
    v_mfma_f32_32x32x8_bf16 v[56:71], a[120:121], v[102:103], v[56:71]
    v_exp_f32 v48, v48
    v_exp_f32 v49, v49
    v_exp_f32 v50, v50
    v_exp_f32 v51, v51
    v_cvt_pk_bf16_f32 v75, v46, v47
    v_cvt_pk_bf16_f32 v76, v48, v49
    v_mfma_f32_32x32x16_bf16 v[240:255], a[128:131], v[84:87], v[240:255]
    buffer_load_dwordx4 a[76:79], v12, s[16:19], s64 offen offset:0 sc1
    v_exp_f32 v52, v52
    v_exp_f32 v53, v53
    v_exp_f32 v54, v54
    v_exp_f32 v55, v55
    v_cvt_pk_bf16_f32 v77, v50, v51
    v_cvt_pk_bf16_f32 v78, v52, v53
    v_cvt_pk_bf16_f32 v79, v54, v55
    v_mfma_f32_32x32x16_bf16 v[40:55], a[108:111], v[104:107], 0
    buffer_load_dwordx4 a[56:59], v12, s[16:19], s65 offen offset:0 sc1
    v_exp_f32 v56, v56
    v_exp_f32 v57, v57
    v_exp_f32 v58, v58
    v_exp_f32 v59, v59
    v_cvt_pk_bf16_f32 v80, v56, v57
    v_mfma_f32_32x32x16_bf16 v[192:207], a[132:135], v[72:75], v[192:207]
    buffer_load_dwordx4 a[80:83], v12, s[16:19], s64 offen offset:1024 sc1
    v_exp_f32 v60, v60
    v_exp_f32 v61, v61
    v_exp_f32 v62, v62
    v_exp_f32 v63, v63
    v_cvt_pk_bf16_f32 v81, v58, v59
    v_cvt_pk_bf16_f32 v82, v60, v61
    v_mfma_f32_32x32x8_bf16 v[40:55], a[120:121], v[110:111], v[40:55]
    v_exp_f32 v64, v64
    v_exp_f32 v65, v65
    v_exp_f32 v66, v66
    v_exp_f32 v67, v67
    v_cvt_pk_bf16_f32 v83, v62, v63
    v_cvt_pk_bf16_f32 v84, v64, v65
    v_mfma_f32_32x32x16_bf16 v[192:207], a[136:139], v[76:79], v[192:207]
    buffer_load_dwordx4 a[84:87], v12, s[16:19], s65 offen offset:1024 sc1
    v_exp_f32 v68, v68
    v_exp_f32 v69, v69
    v_exp_f32 v70, v70
    v_exp_f32 v71, v71
    v_cvt_pk_bf16_f32 v85, v66, v67
    v_cvt_pk_bf16_f32 v86, v68, v69
L_pd9824:
    s_cbranch_execz L_padend
    v_cvt_pk_bf16_f32 v87, v70, v71
    v_mfma_f32_32x32x16_bf16 v[56:71], a[108:111], v[112:115], 0
    buffer_load_dwordx4 a[60:63], v12, s[16:19], s64 offen offset:2048 sc1
    v_exp_f32 v40, v40
    v_exp_f32 v41, v41
    v_exp_f32 v42, v42
    v_exp_f32 v43, v43
    v_cvt_pk_bf16_f32 v72, v40, v41
    v_mfma_f32_32x32x16_bf16 v[208:223], a[132:135], v[80:83], v[208:223]
    buffer_load_dwordx4 a[88:91], v12, s[16:19], s65 offen offset:2048 sc1
    v_exp_f32 v44, v44
    v_exp_f32 v45, v45
    v_exp_f32 v46, v46
    v_exp_f32 v47, v47
    v_cvt_pk_bf16_f32 v73, v42, v43
    v_cvt_pk_bf16_f32 v74, v44, v45
    v_mfma_f32_32x32x8_bf16 v[56:71], a[120:121], v[118:119], v[56:71]
    v_exp_f32 v48, v48
    v_exp_f32 v49, v49
    v_exp_f32 v50, v50
    v_exp_f32 v51, v51
    v_cvt_pk_bf16_f32 v75, v46, v47
    v_cvt_pk_bf16_f32 v76, v48, v49
    v_mfma_f32_32x32x16_bf16 v[208:223], a[136:139], v[84:87], v[208:223]
    buffer_load_dwordx4 a[92:95], v12, s[16:19], s64 offen offset:3072 sc1
    v_exp_f32 v52, v52
    v_exp_f32 v53, v53
    v_exp_f32 v54, v54
    v_exp_f32 v55, v55
    v_cvt_pk_bf16_f32 v77, v50, v51
    v_cvt_pk_bf16_f32 v78, v52, v53
    v_cvt_pk_bf16_f32 v79, v54, v55
    v_mfma_f32_32x32x16_bf16 v[40:55], a[112:115], v[88:91], 0
    buffer_load_dwordx4 a[64:67], v12, s[16:19], s65 offen offset:3072 sc1
    v_exp_f32 v56, v56
    v_exp_f32 v57, v57
    v_exp_f32 v58, v58
    v_exp_f32 v59, v59
    v_cvt_pk_bf16_f32 v80, v56, v57
    v_mfma_f32_32x32x16_bf16 v[224:239], a[132:135], v[72:75], v[224:239]
    buffer_load_dwordx4 a[96:99], v13, s[16:19], s64 offen offset:0 sc1
    v_exp_f32 v60, v60
    v_exp_f32 v61, v61
    v_exp_f32 v62, v62
    v_exp_f32 v63, v63
    v_cvt_pk_bf16_f32 v81, v58, v59
    v_cvt_pk_bf16_f32 v82, v60, v61
    v_mfma_f32_32x32x8_bf16 v[40:55], a[122:123], v[92:93], v[40:55]
    v_exp_f32 v64, v64
    v_exp_f32 v65, v65
    v_exp_f32 v66, v66
    v_exp_f32 v67, v67
    v_cvt_pk_bf16_f32 v83, v62, v63
    v_cvt_pk_bf16_f32 v84, v64, v65
    v_mfma_f32_32x32x16_bf16 v[224:239], a[136:139], v[76:79], v[224:239]
    buffer_load_dwordx4 a[100:103], v13, s[16:19], s65 offen offset:0 sc1
    v_exp_f32 v68, v68
    v_exp_f32 v69, v69
    v_exp_f32 v70, v70
    v_exp_f32 v71, v71
    v_cvt_pk_bf16_f32 v85, v66, v67
    v_cvt_pk_bf16_f32 v86, v68, v69
    v_cvt_pk_bf16_f32 v87, v70, v71
    v_mfma_f32_32x32x16_bf16 v[56:71], a[112:115], v[96:99], 0
    buffer_load_dwordx4 a[68:71], v13, s[16:19], s64 offen offset:1024 sc1
    v_exp_f32 v40, v40
    v_exp_f32 v41, v41
    v_exp_f32 v42, v42
    v_exp_f32 v43, v43
    v_cvt_pk_bf16_f32 v72, v40, v41
    v_mfma_f32_32x32x16_bf16 v[240:255], a[132:135], v[80:83], v[240:255]
    buffer_load_dwordx4 a[104:107], v13, s[16:19], s65 offen offset:1024 sc1
    v_exp_f32 v44, v44
    v_exp_f32 v45, v45
    v_exp_f32 v46, v46
    v_exp_f32 v47, v47
    v_cvt_pk_bf16_f32 v73, v42, v43
    v_cvt_pk_bf16_f32 v74, v44, v45
    v_mfma_f32_32x32x8_bf16 v[56:71], a[122:123], v[100:101], v[56:71]
    v_exp_f32 v48, v48
    v_exp_f32 v49, v49
    v_exp_f32 v50, v50
    v_exp_f32 v51, v51
    v_cvt_pk_bf16_f32 v75, v46, v47
    v_cvt_pk_bf16_f32 v76, v48, v49
    v_mfma_f32_32x32x16_bf16 v[240:255], a[136:139], v[84:87], v[240:255]
    buffer_load_dwordx4 a[124:127], v36, s[16:19], s66 offen offset:0 sc1
    v_exp_f32 v52, v52
    v_exp_f32 v53, v53
    v_exp_f32 v54, v54
    v_exp_f32 v55, v55
    v_cvt_pk_bf16_f32 v77, v50, v51
    v_cvt_pk_bf16_f32 v78, v52, v53
    v_cvt_pk_bf16_f32 v79, v54, v55
    v_mfma_f32_32x32x16_bf16 v[40:55], a[112:115], v[104:107], 0
    buffer_load_dwordx4 a[128:131], v36, s[16:19], s67 offen offset:0 sc1
    v_exp_f32 v56, v56
    v_exp_f32 v57, v57
    v_exp_f32 v58, v58
    v_exp_f32 v59, v59
    v_cvt_pk_bf16_f32 v80, v56, v57
    v_mfma_f32_32x32x16_bf16 v[192:207], a[140:143], v[72:75], v[192:207]
    buffer_load_dwordx4 a[108:111], v36, s[16:19], s66 offen offset:1024 sc1
    v_exp_f32 v60, v60
    v_exp_f32 v61, v61
    v_exp_f32 v62, v62
    v_exp_f32 v63, v63
    v_cvt_pk_bf16_f32 v81, v58, v59
    v_cvt_pk_bf16_f32 v82, v60, v61
    v_mfma_f32_32x32x8_bf16 v[40:55], a[122:123], v[108:109], v[40:55]
    v_exp_f32 v64, v64
    v_exp_f32 v65, v65
    v_exp_f32 v66, v66
    v_exp_f32 v67, v67
    v_cvt_pk_bf16_f32 v83, v62, v63
    v_cvt_pk_bf16_f32 v84, v64, v65
    v_mfma_f32_32x32x16_bf16 v[192:207], a[144:147], v[76:79], v[192:207]
    buffer_load_dwordx4 a[132:135], v36, s[16:19], s67 offen offset:1024 sc1
    v_exp_f32 v68, v68
    v_exp_f32 v69, v69
    v_exp_f32 v70, v70
    v_exp_f32 v71, v71
    v_cvt_pk_bf16_f32 v85, v66, v67
    v_cvt_pk_bf16_f32 v86, v68, v69
    v_cvt_pk_bf16_f32 v87, v70, v71
    v_mfma_f32_32x32x16_bf16 v[56:71], a[112:115], v[112:115], 0
    buffer_load_dwordx4 a[136:139], v36, s[16:19], s66 offen offset:2048 sc1
    v_exp_f32 v40, v40
    v_exp_f32 v41, v41
    v_exp_f32 v42, v42
    v_exp_f32 v43, v43
    v_cvt_pk_bf16_f32 v72, v40, v41
    v_mfma_f32_32x32x16_bf16 v[208:223], a[140:143], v[80:83], v[208:223]
    v_exp_f32 v44, v44
    v_exp_f32 v45, v45
    v_exp_f32 v46, v46
    v_exp_f32 v47, v47
    v_cvt_pk_bf16_f32 v73, v42, v43
    v_cvt_pk_bf16_f32 v74, v44, v45
    v_mfma_f32_32x32x8_bf16 v[56:71], a[122:123], v[116:117], v[56:71]
    v_exp_f32 v48, v48
    v_exp_f32 v49, v49
    v_exp_f32 v50, v50
    v_exp_f32 v51, v51
    v_cvt_pk_bf16_f32 v75, v46, v47
    v_cvt_pk_bf16_f32 v76, v48, v49
    v_mfma_f32_32x32x16_bf16 v[208:223], a[144:147], v[84:87], v[208:223]
    v_exp_f32 v52, v52
    v_exp_f32 v53, v53
    v_exp_f32 v54, v54
    v_exp_f32 v55, v55
    v_cvt_pk_bf16_f32 v77, v50, v51
    v_cvt_pk_bf16_f32 v78, v52, v53
    v_cvt_pk_bf16_f32 v79, v54, v55
    v_mfma_f32_32x32x16_bf16 v[40:55], a[116:119], v[88:91], 0
    v_exp_f32 v56, v56
    v_exp_f32 v57, v57
    v_exp_f32 v58, v58
    v_exp_f32 v59, v59
    v_cvt_pk_bf16_f32 v80, v56, v57
    v_mfma_f32_32x32x16_bf16 v[224:239], a[140:143], v[72:75], v[224:239]
    v_exp_f32 v60, v60
    v_exp_f32 v61, v61
    v_exp_f32 v62, v62
    v_exp_f32 v63, v63
    v_cvt_pk_bf16_f32 v81, v58, v59
    v_cvt_pk_bf16_f32 v82, v60, v61
    v_mfma_f32_32x32x8_bf16 v[40:55], a[122:123], v[94:95], v[40:55]
    v_exp_f32 v64, v64
    v_exp_f32 v65, v65
    v_exp_f32 v66, v66
    v_exp_f32 v67, v67
    v_cvt_pk_bf16_f32 v83, v62, v63
    v_cvt_pk_bf16_f32 v84, v64, v65
    v_mfma_f32_32x32x16_bf16 v[224:239], a[144:147], v[76:79], v[224:239]
    v_exp_f32 v68, v68
    v_exp_f32 v69, v69
    v_exp_f32 v70, v70
    v_exp_f32 v71, v71
    v_cvt_pk_bf16_f32 v85, v66, v67
    v_cvt_pk_bf16_f32 v86, v68, v69
    v_cvt_pk_bf16_f32 v87, v70, v71
    v_mfma_f32_32x32x16_bf16 v[56:71], a[116:119], v[96:99], 0
    v_exp_f32 v40, v40
    v_exp_f32 v41, v41
    v_exp_f32 v42, v42
    v_exp_f32 v43, v43
    v_cvt_pk_bf16_f32 v72, v40, v41
    v_mfma_f32_32x32x16_bf16 v[240:255], a[140:143], v[80:83], v[240:255]
    v_exp_f32 v44, v44
    v_exp_f32 v45, v45
    v_exp_f32 v46, v46
    v_exp_f32 v47, v47
    v_cvt_pk_bf16_f32 v73, v42, v43
    v_cvt_pk_bf16_f32 v74, v44, v45
    v_mfma_f32_32x32x8_bf16 v[56:71], a[122:123], v[102:103], v[56:71]
    v_exp_f32 v48, v48
    v_exp_f32 v49, v49
    v_exp_f32 v50, v50
    v_exp_f32 v51, v51
    v_cvt_pk_bf16_f32 v75, v46, v47
    v_cvt_pk_bf16_f32 v76, v48, v49
    v_mfma_f32_32x32x16_bf16 v[240:255], a[144:147], v[84:87], v[240:255]
    v_exp_f32 v52, v52
    v_exp_f32 v53, v53
    v_exp_f32 v54, v54
    v_exp_f32 v55, v55
    v_cvt_pk_bf16_f32 v77, v50, v51
    v_cvt_pk_bf16_f32 v78, v52, v53
    v_cvt_pk_bf16_f32 v79, v54, v55
    v_mfma_f32_32x32x16_bf16 v[40:55], a[116:119], v[104:107], 0
    buffer_load_dwordx4 a[112:115], v36, s[16:19], s67 offen offset:2048 sc1
    v_exp_f32 v56, v56
    v_exp_f32 v57, v57
    v_exp_f32 v58, v58
    v_exp_f32 v59, v59
    v_cvt_pk_bf16_f32 v80, v56, v57
    v_mfma_f32_32x32x16_bf16 v[192:207], a[148:151], v[72:75], v[192:207]
    buffer_load_dwordx4 a[140:143], v36, s[16:19], s66 offen offset:3072 sc1
    v_exp_f32 v60, v60
    v_exp_f32 v61, v61
    v_exp_f32 v62, v62
    v_exp_f32 v63, v63
    v_cvt_pk_bf16_f32 v81, v58, v59
    v_cvt_pk_bf16_f32 v82, v60, v61
    v_mfma_f32_32x32x8_bf16 v[40:55], a[122:123], v[110:111], v[40:55]
    v_exp_f32 v64, v64
    v_exp_f32 v65, v65
    v_exp_f32 v66, v66
    v_exp_f32 v67, v67
    v_cvt_pk_bf16_f32 v83, v62, v63
    v_cvt_pk_bf16_f32 v84, v64, v65
    v_mfma_f32_32x32x16_bf16 v[192:207], a[152:155], v[76:79], v[192:207]
    buffer_load_dwordx4 a[144:147], v36, s[16:19], s67 offen offset:3072 sc1
    v_exp_f32 v68, v68
    v_exp_f32 v69, v69
    v_exp_f32 v70, v70
    v_exp_f32 v71, v71
    v_cvt_pk_bf16_f32 v85, v66, v67
    v_cvt_pk_bf16_f32 v86, v68, v69
    v_cvt_pk_bf16_f32 v87, v70, v71
    v_mfma_f32_32x32x16_bf16 v[56:71], a[116:119], v[112:115], 0
    s_nop 2
    ds_write_b128 v15, v[192:195] offset:12288
    v_exp_f32 v40, v40
    v_exp_f32 v41, v41
    v_exp_f32 v42, v42
    v_exp_f32 v43, v43
    v_cvt_pk_bf16_f32 v72, v40, v41
    v_mfma_f32_32x32x16_bf16 v[208:223], a[148:151], v[80:83], v[208:223]
    ds_write_b128 v15, v[196:199] offset:13312
    v_exp_f32 v44, v44
    v_exp_f32 v45, v45
    v_exp_f32 v46, v46
    v_exp_f32 v47, v47
    v_cvt_pk_bf16_f32 v73, v42, v43
    v_cvt_pk_bf16_f32 v74, v44, v45
    v_mfma_f32_32x32x8_bf16 v[56:71], a[122:123], v[118:119], v[56:71]
    v_exp_f32 v48, v48
    v_exp_f32 v49, v49
    v_exp_f32 v50, v50
    v_exp_f32 v51, v51
    v_cvt_pk_bf16_f32 v75, v46, v47
    v_cvt_pk_bf16_f32 v76, v48, v49
    v_mfma_f32_32x32x16_bf16 v[208:223], a[152:155], v[84:87], v[208:223]
    ds_write_b128 v15, v[200:203] offset:14336
    v_exp_f32 v52, v52
    v_exp_f32 v53, v53
    v_exp_f32 v54, v54
    v_exp_f32 v55, v55
    v_cvt_pk_bf16_f32 v77, v50, v51
    v_cvt_pk_bf16_f32 v78, v52, v53
    v_cvt_pk_bf16_f32 v79, v54, v55
    v_exp_f32 v56, v56
    v_exp_f32 v57, v57
    v_exp_f32 v58, v58
    v_exp_f32 v59, v59
    v_cvt_pk_bf16_f32 v80, v56, v57
    v_mfma_f32_32x32x16_bf16 v[224:239], a[148:151], v[72:75], v[224:239]
    ds_write_b128 v15, v[208:211] offset:24576
    v_exp_f32 v60, v60
    v_exp_f32 v61, v61
    v_exp_f32 v62, v62
    v_exp_f32 v63, v63
    v_cvt_pk_bf16_f32 v81, v58, v59
    v_cvt_pk_bf16_f32 v82, v60, v61
    v_exp_f32 v64, v64
    v_exp_f32 v65, v65
    v_exp_f32 v66, v66
    v_exp_f32 v67, v67
    v_cvt_pk_bf16_f32 v83, v62, v63
    v_cvt_pk_bf16_f32 v84, v64, v65
    v_mfma_f32_32x32x16_bf16 v[224:239], a[152:155], v[76:79], v[224:239]
    ds_write_b128 v15, v[212:215] offset:25600
    v_exp_f32 v68, v68
    v_exp_f32 v69, v69
    v_exp_f32 v70, v70
    v_exp_f32 v71, v71
    v_cvt_pk_bf16_f32 v85, v66, v67
    v_cvt_pk_bf16_f32 v86, v68, v69
    v_cvt_pk_bf16_f32 v87, v70, v71
    ds_write_b128 v15, v[216:219] offset:26624
    v_mfma_f32_32x32x16_bf16 v[240:255], a[148:151], v[80:83], v[240:255]
    v_mfma_f32_32x32x16_bf16 v[240:255], a[152:155], v[84:87], v[240:255]
    s_nop 0
    ds_write_b128 v15, v[224:227] offset:36864
    ds_write_b128 v15, v[228:231] offset:37888
    ds_write_b128 v15, v[232:235] offset:38912
    s_nop 7
    ds_write_b128 v15, v[240:243] offset:49152
    ds_write_b128 v15, v[244:247] offset:50176
    ds_write_b128 v15, v[248:251] offset:51200
    s_waitcnt lgkmcnt(0)
    s_barrier
    s_mul_i32 s76, s38, 12288
    s_add_u32 s76, s76, 81920
    v_add_u32 v25, s76, v36
    ds_read_b128 v[48:51], v25 offset:2048
    ds_read_b128 v[60:63], v25 offset:5120
    ds_read_b128 v[72:75], v25 offset:8192
    ds_read_b128 v[84:87], v25 offset:11264
    ds_read_b128 v[40:43], v25 offset:0
    ds_read_b128 v[52:55], v25 offset:3072
    ds_read_b128 v[64:67], v25 offset:6144
    ds_read_b128 v[76:79], v25 offset:9216
    ds_read_b128 v[44:47], v25 offset:1024
    ds_read_b128 v[56:59], v25 offset:4096
    ds_read_b128 v[68:71], v25 offset:7168
    ds_read_b128 v[80:83], v25 offset:10240
    s_waitcnt lgkmcnt(10)
    v_pk_add_f32 v[48:49], v[48:49], v[60:61]
    s_waitcnt lgkmcnt(8)
    v_pk_add_f32 v[72:73], v[72:73], v[84:85]
    v_pk_add_f32 v[48:49], v[48:49], v[72:73]
    v_mov_b32 v88, v48
    v_mov_b32 v90, v48
    v_pk_add_f32 v[50:51], v[50:51], v[62:63]
    v_pk_add_f32 v[74:75], v[74:75], v[86:87]
    v_pk_add_f32 v[50:51], v[50:51], v[74:75]
    v_permlane32_swap_b32 v88, v90
    v_rcp_f32 v88, v90
    s_waitcnt lgkmcnt(6)
    v_pk_add_f32 v[40:41], v[40:41], v[52:53]
    s_waitcnt lgkmcnt(4)
    v_pk_add_f32 v[64:65], v[64:65], v[76:77]
    v_pk_add_f32 v[40:41], v[40:41], v[64:65]
    v_pk_add_f32 v[42:43], v[42:43], v[54:55]
    v_pk_add_f32 v[66:67], v[66:67], v[78:79]
    v_pk_add_f32 v[42:43], v[42:43], v[66:67]
    s_waitcnt lgkmcnt(2)
    v_pk_add_f32 v[44:45], v[44:45], v[56:57]
    s_waitcnt lgkmcnt(0)
    v_pk_add_f32 v[68:69], v[68:69], v[80:81]
    v_pk_add_f32 v[44:45], v[44:45], v[68:69]
    v_pk_add_f32 v[46:47], v[46:47], v[58:59]
    v_pk_add_f32 v[70:71], v[70:71], v[82:83]
    v_pk_add_f32 v[46:47], v[46:47], v[70:71]
    v_pk_add_f32 v[64:65], v[40:41], v[42:43]
    v_pk_add_f32 v[66:67], v[44:45], v[46:47]
    v_pk_add_f32 v[68:69], v[48:49], v[50:51]
    v_mul_f32 v92, v88, v28
    v_pk_add_f32 v[64:65], v[64:65], v[66:67]
    v_pk_add_f32 v[64:65], v[64:65], v[68:69]
    v_add_f32 v64, v64, v65
    v_fmac_f32 v64, 0x5f800000, v90
    v_fmac_f32 v64, 0x5f800000, v88
    v_add_f32 v64, v64, v92
    v_mov_b32 v65, 0x207
    v_cmp_class_f32 s[60:61], v64, v65
    v_pk_mul_f32 v[40:41], v[40:41], v[92:93] op_sel_hi:[1,0]
    v_pk_mul_f32 v[42:43], v[42:43], v[92:93] op_sel_hi:[1,0]
    v_pk_mul_f32 v[44:45], v[44:45], v[92:93] op_sel_hi:[1,0]
    v_pk_mul_f32 v[46:47], v[46:47], v[92:93] op_sel_hi:[1,0]
    v_cvt_pk_bf16_f32 v52, v40, v41
    v_cvt_pk_bf16_f32 v53, v42, v43
    v_cvt_pk_bf16_f32 v54, v44, v45
    v_cvt_pk_bf16_f32 v55, v46, v47
    s_cmp_lg_u64 s[60:61], 0
    s_cbranch_scc1 L_slow1
    buffer_store_dwordx4 v[52:55], v26, s[16:19], s73 offen sc1
    v_pk_mul_f32 v[48:49], v[48:49], v[92:93] op_sel_hi:[1,0]
    v_pk_mul_f32 v[50:51], v[50:51], v[92:93] op_sel_hi:[1,0]
    v_cvt_pk_bf16_f32 v56, v48, v49
    v_cvt_pk_bf16_f32 v57, v50, v51
    buffer_store_dwordx2 v[56:57], v27, s[16:19], s73 offen offset:512 sc1
L_slow1_ret:
    s_waitcnt vmcnt(29)
    v_mfma_f32_16x16x32_bf16 v[192:195], a[160:163], v[168:171], 0
    buffer_load_dwordx4 a[116:119], v12, s[16:19], s66 offen offset:0 sc1
    buffer_load_dwordx4 a[148:151], v12, s[16:19], s67 offen offset:0 sc1
    s_waitcnt vmcnt(30)
    v_mfma_f32_16x16x32_bf16 v[212:215], a[160:163], v[172:175], 0
    s_mul_i32 s76, s38, 10240
    v_mfma_f32_16x16x32_bf16 v[196:199], a[180:183], v[168:171], 0
    s_add_u32 s77, s76, 34816
    v_mfma_f32_16x16x32_bf16 v[216:219], a[180:183], v[172:175], 0
    s_cmp_eq_u32 s38, 0
    v_mfma_f32_16x16x32_bf16 v[200:203], a[184:187], v[168:171], 0
    s_cselect_b32 s77, 20480, s77
    v_mfma_f32_16x16x32_bf16 v[220:223], a[184:187], v[172:175], 0
    v_lshlrev_b32 v7, 3, v1
    v_mfma_f32_16x16x32_bf16 v[204:207], a[156:159], v[168:171], 0
    v_add_u32 v232, s77, v7
    v_mfma_f32_16x16x32_bf16 v[224:227], a[156:159], v[172:175], 0
    s_add_u32 s76, s76, 81920
    v_mfma_f32_16x16x32_bf16 v[208:211], a[212:215], v[168:171], 0
    v_add_u32 v236, s76, v36
    v_mfma_f32_16x16x32_bf16 v[228:231], a[212:215], v[172:175], 0
    s_mul_i32 s76, s42, 5120
    s_waitcnt vmcnt(29)
    v_mfma_f32_16x16x32_bf16 v[192:195], a[216:219], v[176:179], v[192:195]
    s_lshl_b32 s77, s43, 8
    s_waitcnt vmcnt(28)
    v_mfma_f32_16x16x32_bf16 v[212:215], a[216:219], v[180:183], v[212:215]
    s_add_u32 s76, s76, s77
    v_mfma_f32_16x16x32_bf16 v[196:199], a[220:223], v[176:179], v[196:199]
    v_lshlrev_b32 v5, 3, v11
    v_mfma_f32_16x16x32_bf16 v[216:219], a[220:223], v[180:183], v[216:219]
    v_add_u32 v5, s76, v5
    v_mfma_f32_16x16x32_bf16 v[200:203], a[224:227], v[176:179], v[200:203]
    v_mul_u32_u24 v6, 34816, v10
    v_mfma_f32_16x16x32_bf16 v[220:223], a[224:227], v[180:183], v[220:223]
    v_add3_u32 v233, v5, v6, v8
    v_mfma_f32_16x16x32_bf16 v[204:207], a[228:231], v[176:179], v[204:207]
    v_mul_u32_u24 v6, 20480, v10
    v_mfma_f32_16x16x32_bf16 v[224:227], a[228:231], v[180:183], v[224:227]
    v_add3_u32 v234, v5, v6, v8
    v_mfma_f32_16x16x32_bf16 v[208:211], a[232:235], v[176:179], v[208:211]
    s_add_u32 s77, s77, 81920
    v_mfma_f32_16x16x32_bf16 v[228:231], a[232:235], v[180:183], v[228:231]
    v_lshl_add_u32 v238, v11, 3, v234
    s_waitcnt vmcnt(27)
    v_mfma_f32_16x16x32_bf16 v[192:195], a[236:239], v[184:187], v[192:195]
    v_add_u32 v238, s77, v238
    s_waitcnt vmcnt(26)
    v_mfma_f32_16x16x32_bf16 v[212:215], a[236:239], v[188:191], v[212:215]
    s_lshl_b32 s76, s36, 7
    v_mfma_f32_16x16x32_bf16 v[196:199], a[240:243], v[184:187], v[196:199]
    s_lshl_b32 s77, s39, 5
    v_mfma_f32_16x16x32_bf16 v[216:219], a[240:243], v[188:191], v[216:219]
    s_add_u32 s76, s76, s77
    v_mfma_f32_16x16x32_bf16 v[200:203], a[244:247], v[184:187], v[200:203]
    s_lshl_b32 s77, s42, 4
    v_mfma_f32_16x16x32_bf16 v[220:223], a[244:247], v[188:191], v[220:223]
    s_add_u32 s76, s76, s77
    v_mfma_f32_16x16x32_bf16 v[204:207], a[248:251], v[184:187], v[204:207]
    v_add_u32 v5, s76, v38
    v_mfma_f32_16x16x32_bf16 v[224:227], a[248:251], v[188:191], v[224:227]
    v_mul_u32_u24 v5, 1280, v5
    v_mfma_f32_16x16x32_bf16 v[208:211], a[252:255], v[184:187], v[208:211]
    v_lshrrev_b32 v6, 4, v11
    v_mfma_f32_16x16x32_bf16 v[228:231], a[252:255], v[188:191], v[228:231]
    v_mul_u32_u24 v6, 40, v6
    s_waitcnt vmcnt(25)
    v_mfma_f32_16x16x32_bf16 v[192:195], a[164:167], a[52:55], v[192:195]
    v_mul_u32_u24 v7, 20, v10
    s_waitcnt vmcnt(24)
    v_mfma_f32_16x16x32_bf16 v[212:215], a[164:167], a[72:75], v[212:215]
    v_add3_u32 v235, v5, v6, v7
    v_mfma_f32_16x16x32_bf16 v[196:199], a[188:191], a[52:55], v[196:199]
    s_mul_i32 s70, s37, 160
    v_mfma_f32_16x16x32_bf16 v[216:219], a[188:191], a[72:75], v[216:219]
    s_mul_i32 s77, s43, 80
    v_mfma_f32_16x16x32_bf16 v[200:203], a[192:195], a[52:55], v[200:203]
    s_add_u32 s70, s70, s77
    v_mfma_f32_16x16x32_bf16 v[220:223], a[192:195], a[72:75], v[220:223]
    s_add_u32 s71, s70, 81920
    v_mfma_f32_16x16x32_bf16 v[204:207], a[168:171], a[52:55], v[204:207]
    s_mov_b32 s4, s58
    v_mfma_f32_16x16x32_bf16 v[224:227], a[168:171], a[72:75], v[224:227]
    s_and_b32 s5, s59, 0xffff
    v_mfma_f32_16x16x32_bf16 v[208:211], a[196:199], a[52:55], v[208:211]
    s_mov_b32 s6, 0x00280000
    v_mfma_f32_16x16x32_bf16 v[228:231], a[196:199], a[72:75], v[228:231]
    s_mov_b32 s7, 0x00020000
    s_waitcnt vmcnt(23)
    v_mfma_f32_16x16x32_bf16 v[192:195], a[200:203], a[76:79], v[192:195]
    s_waitcnt vmcnt(22)
    v_mfma_f32_16x16x32_bf16 v[212:215], a[200:203], a[56:59], v[212:215]
    v_mfma_f32_16x16x32_bf16 v[196:199], a[172:175], a[76:79], v[196:199]
    v_mfma_f32_16x16x32_bf16 v[216:219], a[172:175], a[56:59], v[216:219]
    v_mfma_f32_16x16x32_bf16 v[200:203], a[204:207], a[76:79], v[200:203]
    v_mfma_f32_16x16x32_bf16 v[220:223], a[204:207], a[56:59], v[220:223]
    v_mfma_f32_16x16x32_bf16 v[204:207], a[208:211], a[76:79], v[204:207]
    v_mfma_f32_16x16x32_bf16 v[224:227], a[208:211], a[56:59], v[224:227]
    v_mfma_f32_16x16x32_bf16 v[208:211], a[176:179], a[76:79], v[208:211]
    v_mfma_f32_16x16x32_bf16 v[228:231], a[176:179], a[56:59], v[228:231]
    s_waitcnt vmcnt(21)
    v_mfma_f32_16x16x32_bf16 v[192:195], a[0:3], a[80:83], v[192:195]
    s_waitcnt vmcnt(20)
    v_mfma_f32_16x16x32_bf16 v[212:215], a[0:3], a[84:87], v[212:215]
    v_mfma_f32_16x16x32_bf16 v[196:199], a[20:23], a[80:83], v[196:199]
    v_mfma_f32_16x16x32_bf16 v[216:219], a[20:23], a[84:87], v[216:219]
    v_mfma_f32_16x16x32_bf16 v[200:203], a[24:27], a[80:83], v[200:203]
    v_mfma_f32_16x16x32_bf16 v[220:223], a[24:27], a[84:87], v[220:223]
    v_mfma_f32_16x16x32_bf16 v[204:207], a[4:7], a[80:83], v[204:207]
    v_mfma_f32_16x16x32_bf16 v[224:227], a[4:7], a[84:87], v[224:227]
    v_mfma_f32_16x16x32_bf16 v[208:211], a[28:31], a[80:83], v[208:211]
    v_mfma_f32_16x16x32_bf16 v[228:231], a[28:31], a[84:87], v[228:231]
    s_waitcnt vmcnt(19)
    v_mfma_f32_16x16x32_bf16 v[192:195], a[32:35], a[60:63], v[192:195]
    s_waitcnt vmcnt(18)
    v_mfma_f32_16x16x32_bf16 v[212:215], a[32:35], a[88:91], v[212:215]
    v_mfma_f32_16x16x32_bf16 v[196:199], a[8:11], a[60:63], v[196:199]
    v_mfma_f32_16x16x32_bf16 v[216:219], a[8:11], a[88:91], v[216:219]
    v_mfma_f32_16x16x32_bf16 v[200:203], a[36:39], a[60:63], v[200:203]
    v_mfma_f32_16x16x32_bf16 v[220:223], a[36:39], a[88:91], v[220:223]
    v_mfma_f32_16x16x32_bf16 v[204:207], a[40:43], a[60:63], v[204:207]
    v_mfma_f32_16x16x32_bf16 v[224:227], a[40:43], a[88:91], v[224:227]
    v_mfma_f32_16x16x32_bf16 v[208:211], a[12:15], a[60:63], v[208:211]
    v_mfma_f32_16x16x32_bf16 v[228:231], a[12:15], a[88:91], v[228:231]
    s_waitcnt vmcnt(17)
    v_mfma_f32_16x16x32_bf16 v[192:195], a[44:47], a[92:95], v[192:195]
    s_waitcnt vmcnt(16)
    v_mfma_f32_16x16x32_bf16 v[212:215], a[44:47], a[64:67], v[212:215]
    v_mfma_f32_16x16x32_bf16 v[196:199], a[48:51], a[92:95], v[196:199]
    v_mfma_f32_16x16x32_bf16 v[216:219], a[48:51], a[64:67], v[216:219]
    v_mfma_f32_16x16x32_bf16 v[200:203], a[16:19], a[92:95], v[200:203]
    v_mfma_f32_16x16x32_bf16 v[220:223], a[16:19], a[64:67], v[220:223]
    v_mfma_f32_16x16x32_bf16 v[204:207], v[120:123], a[92:95], v[204:207]
    v_mfma_f32_16x16x32_bf16 v[224:227], v[120:123], a[64:67], v[224:227]
    v_mfma_f32_16x16x32_bf16 v[208:211], v[124:127], a[92:95], v[208:211]
    v_mfma_f32_16x16x32_bf16 v[228:231], v[124:127], a[64:67], v[228:231]
    s_waitcnt vmcnt(15)
    v_mfma_f32_16x16x32_bf16 v[192:195], v[128:131], a[96:99], v[192:195]
    s_waitcnt vmcnt(14)
    v_mfma_f32_16x16x32_bf16 v[212:215], v[128:131], a[100:103], v[212:215]
    v_mfma_f32_16x16x32_bf16 v[196:199], v[132:135], a[96:99], v[196:199]
    v_mfma_f32_16x16x32_bf16 v[216:219], v[132:135], a[100:103], v[216:219]
    v_mfma_f32_16x16x32_bf16 v[200:203], v[136:139], a[96:99], v[200:203]
    v_mfma_f32_16x16x32_bf16 v[220:223], v[136:139], a[100:103], v[220:223]
    v_mfma_f32_16x16x32_bf16 v[204:207], v[140:143], a[96:99], v[204:207]
    v_mfma_f32_16x16x32_bf16 v[224:227], v[140:143], a[100:103], v[224:227]
    v_mfma_f32_16x16x32_bf16 v[208:211], v[144:147], a[96:99], v[208:211]
    v_mfma_f32_16x16x32_bf16 v[228:231], v[144:147], a[100:103], v[228:231]
    s_waitcnt vmcnt(13)
    v_mfma_f32_16x16x32_bf16 v[192:195], v[148:151], a[68:71], v[192:195]
    s_waitcnt vmcnt(12)
    v_mfma_f32_16x16x32_bf16 v[212:215], v[148:151], a[104:107], v[212:215]
    v_mfma_f32_16x16x32_bf16 v[196:199], v[152:155], a[68:71], v[196:199]
    v_mfma_f32_16x16x32_bf16 v[216:219], v[152:155], a[104:107], v[216:219]
    s_nop 3
    ds_write_b64 v232, v[192:193] offset:0
    v_mfma_f32_16x16x32_bf16 v[200:203], v[156:159], a[68:71], v[200:203]
    ds_write_b64 v232, v[194:195] offset:512
    v_mfma_f32_16x16x32_bf16 v[220:223], v[156:159], a[104:107], v[220:223]
    ds_write_b64 v232, v[212:213] offset:5120
    v_mfma_f32_16x16x32_bf16 v[204:207], v[160:163], a[68:71], v[204:207]
    ds_write_b64 v232, v[214:215] offset:5632
    v_mfma_f32_16x16x32_bf16 v[224:227], v[160:163], a[104:107], v[224:227]
    ds_write_b64 v232, v[196:197] offset:1024
    v_mfma_f32_16x16x32_bf16 v[208:211], v[164:167], a[68:71], v[208:211]
    ds_write_b64 v232, v[198:199] offset:1536
    v_mfma_f32_16x16x32_bf16 v[228:231], v[164:167], a[104:107], v[228:231]
    ds_write_b64 v232, v[216:217] offset:6144
    s_waitcnt vmcnt(11)
    v_mfma_f32_16x16x32_bf16 v[80:83], a[160:163], a[124:127], 0
    ds_write_b64 v232, v[218:219] offset:6656
    s_waitcnt vmcnt(10)
    v_mfma_f32_16x16x32_bf16 v[100:103], a[160:163], a[128:131], 0
    ds_write_b64 v232, v[200:201] offset:2048
    v_mfma_f32_16x16x32_bf16 v[84:87], a[180:183], a[124:127], 0
    ds_write_b64 v232, v[202:203] offset:2560
    v_mfma_f32_16x16x32_bf16 v[104:107], a[180:183], a[128:131], 0
    ds_write_b64 v232, v[220:221] offset:7168
    v_mfma_f32_16x16x32_bf16 v[88:91], a[184:187], a[124:127], 0
    ds_write_b64 v232, v[222:223] offset:7680
    v_mfma_f32_16x16x32_bf16 v[108:111], a[184:187], a[128:131], 0
    ds_write_b64 v232, v[204:205] offset:3072
    v_mfma_f32_16x16x32_bf16 v[92:95], a[156:159], a[124:127], 0
    ds_write_b64 v232, v[206:207] offset:3584
    v_mfma_f32_16x16x32_bf16 v[112:115], a[156:159], a[128:131], 0
    ds_write_b64 v232, v[224:225] offset:8192
    v_mfma_f32_16x16x32_bf16 v[96:99], a[212:215], a[124:127], 0
    ds_write_b64 v232, v[226:227] offset:8704
    v_mfma_f32_16x16x32_bf16 v[116:119], a[212:215], a[128:131], 0
    ds_write_b64 v232, v[208:209] offset:4096
    s_waitcnt vmcnt(9)
    v_mfma_f32_16x16x32_bf16 v[80:83], a[216:219], a[108:111], v[80:83]
    ds_write_b64 v232, v[210:211] offset:4608
    s_waitcnt vmcnt(8)
    v_mfma_f32_16x16x32_bf16 v[100:103], a[216:219], a[132:135], v[100:103]
    buffer_load_dwordx4 v[40:43], v12, s[16:19], s66 offen offset:1024 sc1
    ds_write_b64 v232, v[228:229] offset:9216
    v_mfma_f32_16x16x32_bf16 v[84:87], a[220:223], a[108:111], v[84:87]
    buffer_load_dwordx4 v[44:47], v12, s[16:19], s67 offen offset:1024 sc1
    ds_write_b64 v232, v[230:231] offset:9728
    v_mfma_f32_16x16x32_bf16 v[104:107], a[220:223], a[132:135], v[104:107]
    buffer_load_dwordx4 v[48:51], v12, s[16:19], s66 offen offset:2048 sc1
    v_mfma_f32_16x16x32_bf16 v[88:91], a[224:227], a[108:111], v[88:91]
    buffer_load_dwordx4 v[52:55], v12, s[16:19], s67 offen offset:2048 sc1
    v_mfma_f32_16x16x32_bf16 v[108:111], a[224:227], a[132:135], v[108:111]
    buffer_load_dwordx4 v[56:59], v12, s[16:19], s66 offen offset:3072 sc1
    v_mfma_f32_16x16x32_bf16 v[92:95], a[228:231], a[108:111], v[92:95]
    buffer_load_dwordx4 v[60:63], v12, s[16:19], s67 offen offset:3072 sc1
    v_mfma_f32_16x16x32_bf16 v[112:115], a[228:231], a[132:135], v[112:115]
    buffer_load_dwordx4 v[64:67], v13, s[16:19], s66 offen offset:0 sc1
    s_waitcnt lgkmcnt(0)
    s_barrier
    v_mfma_f32_16x16x32_bf16 v[96:99], a[232:235], a[108:111], v[96:99]
    buffer_load_dwordx4 v[68:71], v13, s[16:19], s67 offen offset:0 sc1
    ds_read2st64_b64 v[192:195], v233 offset0:40 offset1:41
    ds_read2st64_b64 v[212:215], v234 offset0:88 offset1:89
    v_mfma_f32_16x16x32_bf16 v[116:119], a[232:235], a[132:135], v[116:119]
    buffer_load_dwordx4 v[72:75], v13, s[16:19], s66 offen offset:1024 sc1
    ds_read2st64_b64 v[196:199], v233 offset0:42 offset1:43
    ds_read2st64_b64 v[216:219], v234 offset0:90 offset1:91
    s_waitcnt vmcnt(16)
    v_mfma_f32_16x16x32_bf16 v[80:83], a[236:239], a[136:139], v[80:83]
    buffer_load_dwordx4 v[76:79], v13, s[16:19], s67 offen offset:1024 sc1
    ds_read2st64_b64 v[200:203], v233 offset0:44 offset1:45
    s_waitcnt vmcnt(16)
    v_mfma_f32_16x16x32_bf16 v[100:103], a[236:239], a[112:115], v[100:103]
    ds_read2st64_b64 v[220:223], v234 offset0:92 offset1:93
    ds_read2st64_b64 v[204:207], v233 offset0:46 offset1:47
    v_mfma_f32_16x16x32_bf16 v[84:87], a[240:243], a[136:139], v[84:87]
    ds_read2st64_b64 v[224:227], v234 offset0:94 offset1:95
    v_mfma_f32_16x16x32_bf16 v[104:107], a[240:243], a[112:115], v[104:107]
    ds_read2st64_b64 v[208:211], v233 offset0:48 offset1:49
    ds_read2st64_b64 v[228:231], v234 offset0:96 offset1:97
    v_mfma_f32_16x16x32_bf16 v[88:91], a[244:247], a[136:139], v[88:91]
    s_waitcnt lgkmcnt(8)
    v_add_f32 v192, v192, v212
    v_add_f32 v193, v193, v213
    v_mfma_f32_16x16x32_bf16 v[108:111], a[244:247], a[112:115], v[108:111]
    v_add_f32 v194, v194, v214
    v_mfma_f32_16x16x32_bf16 v[92:95], a[248:251], a[136:139], v[92:95]
    v_add_f32 v195, v195, v215
    s_waitcnt lgkmcnt(6)
    v_add_f32 v196, v196, v216
    v_mfma_f32_16x16x32_bf16 v[112:115], a[248:251], a[112:115], v[112:115]
L_pd10456:
    s_cbranch_execz L_padend
    v_add_f32 v197, v197, v217
    v_mfma_f32_16x16x32_bf16 v[96:99], a[252:255], a[136:139], v[96:99]
    v_add_f32 v198, v198, v218
    v_add_f32 v199, v199, v219
    v_mfma_f32_16x16x32_bf16 v[116:119], a[252:255], a[112:115], v[116:119]
    s_waitcnt lgkmcnt(4)
    v_add_f32 v200, v200, v220
    v_add_f32 v201, v201, v221
    s_waitcnt vmcnt(15)
    v_mfma_f32_16x16x32_bf16 v[80:83], a[164:167], a[140:143], v[80:83]
    v_add_f32 v202, v202, v222
    s_waitcnt vmcnt(14)
    v_mfma_f32_16x16x32_bf16 v[100:103], a[164:167], a[144:147], v[100:103]
    v_add_f32 v203, v203, v223
    s_waitcnt lgkmcnt(2)
    v_add_f32 v204, v204, v224
    v_mfma_f32_16x16x32_bf16 v[84:87], a[188:191], a[140:143], v[84:87]
    v_add_f32 v205, v205, v225
    v_mfma_f32_16x16x32_bf16 v[104:107], a[188:191], a[144:147], v[104:107]
    v_add_f32 v206, v206, v226
    v_add_f32 v207, v207, v227
    v_mfma_f32_16x16x32_bf16 v[88:91], a[192:195], a[140:143], v[88:91]
    s_waitcnt lgkmcnt(0)
    v_add_f32 v208, v208, v228
    v_add_f32 v209, v209, v229
    v_mfma_f32_16x16x32_bf16 v[108:111], a[192:195], a[144:147], v[108:111]
    v_add_f32 v210, v210, v230
    v_mfma_f32_16x16x32_bf16 v[92:95], a[168:171], a[140:143], v[92:95]
    v_add_f32 v211, v211, v231
    v_permlane32_swap_b32 v192, v202
    v_mfma_f32_16x16x32_bf16 v[112:115], a[168:171], a[144:147], v[112:115]
    v_permlane32_swap_b32 v193, v203
    v_mfma_f32_16x16x32_bf16 v[96:99], a[196:199], a[140:143], v[96:99]
    v_permlane32_swap_b32 v194, v204
    v_permlane32_swap_b32 v195, v205
    v_mfma_f32_16x16x32_bf16 v[116:119], a[196:199], a[144:147], v[116:119]
    v_permlane32_swap_b32 v196, v206
    v_permlane32_swap_b32 v197, v207
    s_waitcnt vmcnt(11)
    v_mfma_f32_16x16x32_bf16 v[80:83], a[200:203], a[116:119], v[80:83]
    v_permlane32_swap_b32 v198, v208
    s_waitcnt vmcnt(10)
    v_mfma_f32_16x16x32_bf16 v[100:103], a[200:203], a[148:151], v[100:103]
    v_permlane32_swap_b32 v199, v209
    v_permlane32_swap_b32 v200, v210
    v_mfma_f32_16x16x32_bf16 v[84:87], a[172:175], a[116:119], v[84:87]
    v_permlane32_swap_b32 v201, v211
    v_mfma_f32_16x16x32_bf16 v[104:107], a[172:175], a[148:151], v[104:107]
    s_waitcnt vmcnt(9)
    v_max3_u32 v2, v40, v41, v42
    v_mfma_f32_16x16x32_bf16 v[88:91], a[204:207], a[116:119], v[88:91]
    s_waitcnt vmcnt(8)
    v_max3_u32 v3, v43, v44, v45
    v_mfma_f32_16x16x32_bf16 v[108:111], a[204:207], a[148:151], v[108:111]
    v_max3_u32 v2, v2, v46, v47
    v_mfma_f32_16x16x32_bf16 v[92:95], a[208:211], a[116:119], v[92:95]
    v_max_u32 v2, v2, v3
    v_mfma_f32_16x16x32_bf16 v[112:115], a[208:211], a[148:151], v[112:115]
    v_cmp_eq_u32 vcc, -1, v2
    s_mov_b32 s77, 5
    v_mfma_f32_16x16x32_bf16 v[96:99], a[176:179], a[116:119], v[96:99]
    v_mfma_f32_16x16x32_bf16 v[116:119], a[176:179], a[148:151], v[116:119]
    s_cbranch_vccnz L_fbr
L_fbr5:
    v_mfma_f32_16x16x32_bf16 v[80:83], a[0:3], v[40:43], v[80:83]
    v_add_f32 v192, v192, v202
    v_add_f32 v193, v193, v203
    v_mfma_f32_16x16x32_bf16 v[100:103], a[0:3], v[44:47], v[100:103]
    v_add_f32 v194, v194, v204
    v_add_f32 v195, v195, v205
    v_mfma_f32_16x16x32_bf16 v[84:87], a[20:23], v[40:43], v[84:87]
    v_add_f32 v196, v196, v206
    v_mfma_f32_16x16x32_bf16 v[104:107], a[20:23], v[44:47], v[104:107]
    v_add_f32 v197, v197, v207
    v_add_f32 v198, v198, v208
    v_mfma_f32_16x16x32_bf16 v[88:91], a[24:27], v[40:43], v[88:91]
    v_add_f32 v199, v199, v209
    s_waitcnt vmcnt(7)
    v_max3_u32 v2, v48, v49, v50
    v_mfma_f32_16x16x32_bf16 v[108:111], a[24:27], v[44:47], v[108:111]
    s_waitcnt vmcnt(6)
    v_max3_u32 v3, v51, v52, v53
    v_mfma_f32_16x16x32_bf16 v[92:95], a[4:7], v[40:43], v[92:95]
    v_max3_u32 v2, v2, v54, v55
    v_max_u32 v2, v2, v3
    v_mfma_f32_16x16x32_bf16 v[112:115], a[4:7], v[44:47], v[112:115]
    v_cmp_eq_u32 vcc, -1, v2
    s_mov_b32 s77, 6
    v_mfma_f32_16x16x32_bf16 v[96:99], a[28:31], v[40:43], v[96:99]
    v_mfma_f32_16x16x32_bf16 v[116:119], a[28:31], v[44:47], v[116:119]
    s_cbranch_vccnz L_fbr
L_fbr6:
    v_mfma_f32_16x16x32_bf16 v[80:83], a[32:35], v[48:51], v[80:83]
    s_waitcnt vmcnt(5)
    v_max3_u32 v2, v56, v57, v58
    s_waitcnt vmcnt(4)
    v_max3_u32 v2, v2, v59, v60
    v_mfma_f32_16x16x32_bf16 v[100:103], a[32:35], v[52:55], v[100:103]
    v_max3_u32 v2, v2, v61, v62
    v_mfma_f32_16x16x32_bf16 v[84:87], a[8:11], v[48:51], v[84:87]
    s_waitcnt vmcnt(3)
    v_max3_u32 v2, v2, v63, v64
    v_max3_u32 v2, v2, v65, v66
    v_mfma_f32_16x16x32_bf16 v[104:107], a[8:11], v[52:55], v[104:107]
    s_waitcnt vmcnt(2)
    v_max3_u32 v2, v2, v67, v68
    v_mfma_f32_16x16x32_bf16 v[88:91], a[36:39], v[48:51], v[88:91]
    v_max3_u32 v2, v2, v69, v70
    s_waitcnt vmcnt(1)
    v_max3_u32 v2, v2, v71, v72
    v_mfma_f32_16x16x32_bf16 v[108:111], a[36:39], v[52:55], v[108:111]
    v_max3_u32 v2, v2, v73, v74
    v_mfma_f32_16x16x32_bf16 v[92:95], a[40:43], v[48:51], v[92:95]
    s_waitcnt vmcnt(0)
    v_max3_u32 v2, v2, v75, v76
    v_max3_u32 v2, v2, v77, v78
    v_mfma_f32_16x16x32_bf16 v[112:115], a[40:43], v[52:55], v[112:115]
    v_max_u32 v2, v2, v79
    v_mfma_f32_16x16x32_bf16 v[96:99], a[12:15], v[48:51], v[96:99]
    v_cmp_eq_u32 vcc, -1, v2
    s_mov_b32 s77, 7
    v_mfma_f32_16x16x32_bf16 v[116:119], a[12:15], v[52:55], v[116:119]
    s_nop 1
    s_cbranch_vccnz L_fbr
L_fbr7:
    v_mfma_f32_16x16x32_bf16 v[80:83], a[44:47], v[56:59], v[80:83]
    v_add_f32 v200, v200, v210
    v_add_f32 v201, v201, v211
    v_mfma_f32_16x16x32_bf16 v[100:103], a[44:47], v[60:63], v[100:103]
    v_cvt_pk_bf16_f32 v212, v192, v193
    v_mfma_f32_16x16x32_bf16 v[80:83], v[128:131], v[64:67], v[80:83]
    v_mfma_f32_16x16x32_bf16 v[100:103], v[128:131], v[68:71], v[100:103]
    v_mfma_f32_16x16x32_bf16 v[80:83], v[148:151], v[72:75], v[80:83]
    v_mfma_f32_16x16x32_bf16 v[100:103], v[148:151], v[76:79], v[100:103]
    v_mfma_f32_16x16x32_bf16 v[84:87], a[48:51], v[56:59], v[84:87]
    v_cvt_pk_bf16_f32 v213, v194, v195
    v_cvt_pk_bf16_f32 v214, v196, v197
    v_mfma_f32_16x16x32_bf16 v[104:107], a[48:51], v[60:63], v[104:107]
    v_cvt_pk_bf16_f32 v215, v198, v199
    v_mfma_f32_16x16x32_bf16 v[84:87], v[132:135], v[64:67], v[84:87]
    v_mfma_f32_16x16x32_bf16 v[104:107], v[132:135], v[68:71], v[104:107]
    ds_write_b64 v236, v[80:81] offset:0
    ds_write_b64 v236, v[82:83] offset:8
    v_mfma_f32_16x16x32_bf16 v[84:87], v[152:155], v[72:75], v[84:87]
    ds_write_b64 v236, v[100:101] offset:5120
    v_mfma_f32_16x16x32_bf16 v[104:107], v[152:155], v[76:79], v[104:107]
    ds_write_b64 v236, v[102:103] offset:5128
    v_mfma_f32_16x16x32_bf16 v[88:91], a[16:19], v[56:59], v[88:91]
    v_cvt_pk_bf16_f32 v216, v200, v201
    buffer_store_dwordx4 v[212:215], v235, s[4:7], s70 offen
    v_mfma_f32_16x16x32_bf16 v[108:111], a[16:19], v[60:63], v[108:111]
    buffer_store_dword v216, v235, s[4:7], s70 offen offset:16
    v_mfma_f32_16x16x32_bf16 v[88:91], v[136:139], v[64:67], v[88:91]
    v_mfma_f32_16x16x32_bf16 v[108:111], v[136:139], v[68:71], v[108:111]
    ds_write_b64 v236, v[84:85] offset:1024
    ds_write_b64 v236, v[86:87] offset:1032
    v_mfma_f32_16x16x32_bf16 v[88:91], v[156:159], v[72:75], v[88:91]
    ds_write_b64 v236, v[104:105] offset:6144
    v_mfma_f32_16x16x32_bf16 v[108:111], v[156:159], v[76:79], v[108:111]
    ds_write_b64 v236, v[106:107] offset:6152
    v_mfma_f32_16x16x32_bf16 v[92:95], v[120:123], v[56:59], v[92:95]
    v_mfma_f32_16x16x32_bf16 v[112:115], v[120:123], v[60:63], v[112:115]
    v_mfma_f32_16x16x32_bf16 v[92:95], v[140:143], v[64:67], v[92:95]
    v_mfma_f32_16x16x32_bf16 v[112:115], v[140:143], v[68:71], v[112:115]
    s_nop 0
    ds_write_b64 v236, v[88:89] offset:2048
    ds_write_b64 v236, v[90:91] offset:2056
    v_mfma_f32_16x16x32_bf16 v[92:95], v[160:163], v[72:75], v[92:95]
    ds_write_b64 v236, v[108:109] offset:7168
    v_mfma_f32_16x16x32_bf16 v[112:115], v[160:163], v[76:79], v[112:115]
    ds_write_b64 v236, v[110:111] offset:7176
    v_mfma_f32_16x16x32_bf16 v[96:99], v[124:127], v[56:59], v[96:99]
    v_mfma_f32_16x16x32_bf16 v[116:119], v[124:127], v[60:63], v[116:119]
    v_mfma_f32_16x16x32_bf16 v[96:99], v[144:147], v[64:67], v[96:99]
    v_mfma_f32_16x16x32_bf16 v[116:119], v[144:147], v[68:71], v[116:119]
    s_nop 0
    ds_write_b64 v236, v[92:93] offset:3072
    ds_write_b64 v236, v[94:95] offset:3080
    v_mfma_f32_16x16x32_bf16 v[96:99], v[164:167], v[72:75], v[96:99]
    ds_write_b64 v236, v[112:113] offset:8192
    v_mfma_f32_16x16x32_bf16 v[116:119], v[164:167], v[76:79], v[116:119]
    ds_write_b64 v236, v[114:115] offset:8200
    s_nop 4
    ds_write_b128 v236, v[96:99] offset:4096
    s_nop 0
    ds_write_b128 v236, v[116:119] offset:9216
    s_waitcnt lgkmcnt(0)
    s_barrier
    ds_read_b128 v[192:195], v238 offset:0
    ds_read_b128 v[212:215], v238 offset:10240
    ds_read_b128 v[196:199], v238 offset:1024
    ds_read_b128 v[216:219], v238 offset:11264
    ds_read_b128 v[200:203], v238 offset:2048
    ds_read_b128 v[220:223], v238 offset:12288
    ds_read_b128 v[204:207], v238 offset:3072
    ds_read_b128 v[224:227], v238 offset:13312
    ds_read_b128 v[208:211], v238 offset:4096
    ds_read_b128 v[228:231], v238 offset:14336
    s_waitcnt lgkmcnt(8)
    v_pk_add_f32 v[192:193], v[192:193], v[212:213]
    v_pk_add_f32 v[194:195], v[194:195], v[214:215]
    s_waitcnt lgkmcnt(6)
    v_pk_add_f32 v[196:197], v[196:197], v[216:217]
    v_pk_add_f32 v[198:199], v[198:199], v[218:219]
    s_waitcnt lgkmcnt(4)
    v_pk_add_f32 v[200:201], v[200:201], v[220:221]
    v_pk_add_f32 v[202:203], v[202:203], v[222:223]
    s_waitcnt lgkmcnt(2)
    v_pk_add_f32 v[204:205], v[204:205], v[224:225]
    v_pk_add_f32 v[206:207], v[206:207], v[226:227]
    s_waitcnt lgkmcnt(0)
    v_pk_add_f32 v[208:209], v[208:209], v[228:229]
    v_pk_add_f32 v[210:211], v[210:211], v[230:231]
    v_permlane32_swap_b32 v192, v202
    v_permlane32_swap_b32 v193, v203
    v_permlane32_swap_b32 v194, v204
    v_permlane32_swap_b32 v195, v205
    v_permlane32_swap_b32 v196, v206
    v_permlane32_swap_b32 v197, v207
    v_permlane32_swap_b32 v198, v208
    v_permlane32_swap_b32 v199, v209
    v_permlane32_swap_b32 v200, v210
    v_permlane32_swap_b32 v201, v211
    v_pk_add_f32 v[192:193], v[192:193], v[202:203]
    v_pk_add_f32 v[194:195], v[194:195], v[204:205]
    v_pk_add_f32 v[196:197], v[196:197], v[206:207]
    v_pk_add_f32 v[198:199], v[198:199], v[208:209]
    v_pk_add_f32 v[200:201], v[200:201], v[210:211]
    v_cvt_pk_bf16_f32 v212, v192, v193
    v_cvt_pk_bf16_f32 v213, v194, v195
    v_cvt_pk_bf16_f32 v214, v196, v197
    v_cvt_pk_bf16_f32 v215, v198, v199
    v_cvt_pk_bf16_f32 v216, v200, v201
    buffer_store_dwordx4 v[212:215], v235, s[4:7], s71 offen
    buffer_store_dword v216, v235, s[4:7], s71 offen offset:16
L_end:
    s_endpgm
L_padend:
    s_cmp_eq_u32 s39, 0
    s_cbranch_scc1 L_padretq
    s_branch L_padretk
L_qpoll1:
    s_mov_b32 s76, 0
L_qpoll1_l:
    s_mov_b64 exec, 0x1ffff
    s_sleep 2
    buffer_load_dword v39, v31, s[20:23], 0 offen sc1
    s_waitcnt vmcnt(0)
    v_cmp_gt_u32 vcc, 2, v39
    s_mov_b64 exec, -1
    s_add_u32 s76, s76, 1
    s_cmp_lt_u32 s76, 0x400000
    s_cselect_b64 vcc, vcc, 0
    s_nop 3
    s_cbranch_vccnz L_qpoll1_l
    s_branch L_qpoll1_ok
L_kpoll1:
    s_mov_b32 s76, 0
L_kpoll1_l:
    s_mov_b64 exec, 0x1ffff
    s_sleep 2
    buffer_load_dword v39, v31, s[20:23], 0 offen sc1
    s_waitcnt vmcnt(0)
    v_cmp_gt_u32 vcc, 2, v39
    s_mov_b64 exec, -1
    s_add_u32 s76, s76, 1
    s_cmp_lt_u32 s76, 0x400000
    s_cselect_b64 vcc, vcc, 0
    s_nop 3
    s_cbranch_vccnz L_kpoll1_l
    s_branch L_kpoll1_ok
L_pollq:
    s_mov_b32 s76, 0
L_pollq_l:
    s_mov_b64 exec, 1
    s_sleep 2
    buffer_load_dword v39, v31, s[16:19], s47 offen sc1
    s_waitcnt vmcnt(0)
    v_cmp_ne_u32 vcc, 1, v39
    s_mov_b64 exec, -1
    s_add_u32 s76, s76, 1
    s_cmp_lt_u32 s76, 0x400000
    s_cselect_b64 vcc, vcc, 0
    s_nop 3
    s_cbranch_vccnz L_pollq_l
    s_branch L_pollq_ok
L_poll2:
    s_mov_b32 s76, 0
L_poll2_l:
    s_mov_b64 exec, 1
    s_sleep 2
    buffer_load_dword v39, v8, s[16:19], s56 offen sc1
    s_waitcnt vmcnt(0)
    v_cmp_ne_u32 vcc, 32, v39
    s_mov_b64 exec, -1
    s_add_u32 s76, s76, 1
    s_cmp_lt_u32 s76, 0x400000
    s_cselect_b64 vcc, vcc, 0
    s_nop 3
    s_cbranch_vccnz L_poll2_l
    s_branch L_poll2_ok
L_pollfa:
    s_mov_b32 s76, 0
L_pollfa_l:
    s_mov_b64 exec, 0xff
    s_sleep 2
    buffer_load_dword v39, v33, s[16:19], s48 offen sc1
    s_waitcnt vmcnt(0)
    v_cmp_ne_u32 vcc, 1, v39
    s_mov_b64 exec, -1
    s_add_u32 s76, s76, 1
    s_cmp_lt_u32 s76, 0x400000
    s_cselect_b64 vcc, vcc, 0
    s_nop 3
    s_cbranch_vccnz L_pollfa_l
    s_branch L_pollfa_ok
L_fbr:
    s_mov_b32 s76, 0
L_fbr_l:
    s_waitcnt vmcnt(0)
    s_mov_b32 s78, 0
    v_max3_u32 v2, v40, v41, v42
    v_max3_u32 v3, v43, v44, v45
    v_max3_u32 v2, v2, v46, v47
    v_max_u32 v2, v2, v3
    v_cmp_eq_u32 vcc, -1, v2
    s_nop 3
    s_cbranch_vccz L_fbr_s5
    buffer_load_dwordx4 v[40:43], v12, s[16:19], s66 offen offset:1024 sc1
    buffer_load_dwordx4 v[44:47], v12, s[16:19], s67 offen offset:1024 sc1
    s_mov_b32 s78, 1
L_fbr_s5:
    v_max3_u32 v2, v48, v49, v50
    v_max3_u32 v3, v51, v52, v53
    v_max3_u32 v2, v2, v54, v55
    v_max_u32 v2, v2, v3
    v_cmp_eq_u32 vcc, -1, v2
    s_nop 3
    s_cbranch_vccz L_fbr_s6
    buffer_load_dwordx4 v[48:51], v12, s[16:19], s66 offen offset:2048 sc1
    buffer_load_dwordx4 v[52:55], v12, s[16:19], s67 offen offset:2048 sc1
    s_mov_b32 s78, 1
L_fbr_s6:
    v_max3_u32 v2, v56, v57, v58
    v_max3_u32 v3, v59, v60, v61
    v_max3_u32 v2, v2, v62, v63
    v_max_u32 v2, v2, v3
    v_cmp_eq_u32 vcc, -1, v2
    s_nop 3
    s_cbranch_vccz L_fbr_s7
    buffer_load_dwordx4 v[56:59], v12, s[16:19], s66 offen offset:3072 sc1
    buffer_load_dwordx4 v[60:63], v12, s[16:19], s67 offen offset:3072 sc1
    s_mov_b32 s78, 1
L_fbr_s7:
    v_max3_u32 v2, v64, v65, v66
    v_max3_u32 v3, v67, v68, v69
    v_max3_u32 v2, v2, v70, v71
    v_max_u32 v2, v2, v3
    v_cmp_eq_u32 vcc, -1, v2
    s_nop 3
    s_cbranch_vccz L_fbr_s8
    buffer_load_dwordx4 v[64:67], v13, s[16:19], s66 offen offset:0 sc1
    buffer_load_dwordx4 v[68:71], v13, s[16:19], s67 offen offset:0 sc1
    s_mov_b32 s78, 1
L_fbr_s8:
    v_max3_u32 v2, v72, v73, v74
    v_max3_u32 v3, v75, v76, v77
    v_max3_u32 v2, v2, v78, v79
    v_max_u32 v2, v2, v3
    v_cmp_eq_u32 vcc, -1, v2
    s_nop 3
    s_cbranch_vccz L_fbr_s9
    buffer_load_dwordx4 v[72:75], v13, s[16:19], s66 offen offset:1024 sc1
    buffer_load_dwordx4 v[76:79], v13, s[16:19], s67 offen offset:1024 sc1
    s_mov_b32 s78, 1
L_fbr_s9:
    s_add_u32 s76, s76, 1
    s_cmp_lt_u32 s76, 0x400000
    s_cselect_b32 s78, s78, 0
    s_cmp_lg_u32 s78, 0
    s_cbranch_scc1 L_fbr_l
    s_waitcnt vmcnt(0)
    s_cmp_eq_u32 s77, 5
    s_cbranch_scc1 L_fbr5
    s_cmp_eq_u32 s77, 6
    s_cbranch_scc1 L_fbr6
    s_branch L_fbr7
L_slow0:
    s_waitcnt vmcnt(0) lgkmcnt(0)
    s_nop 15
    s_mul_i32 s76, s42, 6144
    s_lshl_b32 s77, s43, 9
    s_add_u32 s76, s76, s77
    v_add_u32 v4, s76, v16
    v_add_u32 v5, s76, v17
    v_add_u32 v6, s76, v18
    ds_read_b128 v[176:179], v4 offset:0
    ds_read_b64 v[180:181], v5 offset:4096
    ds_read_b64 v[182:183], v6 offset:4096
    v_mov_b32 v2, 0xff800000
    v_mov_b32 v136, 0
    v_mov_b32 v137, 0
    v_mov_b32 v138, 0
    v_mov_b32 v139, 0
    v_mov_b32 v140, 0
    v_mov_b32 v141, 0
    v_mov_b32 v142, 0
    v_mov_b32 v143, 0
    v_mov_b32 v144, 0
    v_mov_b32 v145, 0
    v_mov_b32 v146, 0
    v_mov_b32 v147, 0
    v_mov_b32 v148, 0
    v_mov_b32 v149, 0
    v_mov_b32 v150, 0
    v_mov_b32 v151, 0
    s_waitcnt lgkmcnt(0)
    s_mov_b32 s76, 0
    s_nop 2
L_slow0_0:
    s_lshl_b32 s77, s76, 12
    s_lshl_b32 s78, s76, 10
    s_add_u32 s78, s78, 65536
    s_mul_i32 s79, s76, 5376
    buffer_load_dwordx4 v[164:167], v36, s[16:19], s78 offen sc1
    buffer_load_dwordx4 v[160:163], v36, s[16:19], s77 offen offset:0 sc1
    s_waitcnt vmcnt(0)
    v_mfma_f32_32x32x16_bf16 v[120:135], v[160:163], v[176:179], 0
    s_nop 9
    v_mfma_f32_32x32x8_bf16 v[120:135], v[164:165], v[180:181], v[120:135]
    s_nop 11
    v_max3_f32 v2, v2, v120, v121
    v_max3_f32 v2, v2, v122, v123
    v_max3_f32 v2, v2, v124, v125
    v_max3_f32 v2, v2, v126, v127
    v_max3_f32 v2, v2, v128, v129
    v_max3_f32 v2, v2, v130, v131
    v_max3_f32 v2, v2, v132, v133
    v_max3_f32 v2, v2, v134, v135
    buffer_load_dwordx4 v[160:163], v36, s[16:19], s77 offen offset:1024 sc1
    s_waitcnt vmcnt(0)
    v_mfma_f32_32x32x16_bf16 v[120:135], v[160:163], v[176:179], 0
    s_nop 9
    v_mfma_f32_32x32x8_bf16 v[120:135], v[164:165], v[182:183], v[120:135]
    s_nop 11
    v_max3_f32 v2, v2, v120, v121
    v_max3_f32 v2, v2, v122, v123
    v_max3_f32 v2, v2, v124, v125
    v_max3_f32 v2, v2, v126, v127
    v_max3_f32 v2, v2, v128, v129
    v_max3_f32 v2, v2, v130, v131
    v_max3_f32 v2, v2, v132, v133
    v_max3_f32 v2, v2, v134, v135
    buffer_load_dwordx4 v[160:163], v36, s[16:19], s77 offen offset:2048 sc1
    s_waitcnt vmcnt(0)
    v_mfma_f32_32x32x16_bf16 v[120:135], v[160:163], v[176:179], 0
    s_nop 9
    v_mfma_f32_32x32x8_bf16 v[120:135], v[166:167], v[180:181], v[120:135]
    s_nop 11
    v_max3_f32 v2, v2, v120, v121
    v_max3_f32 v2, v2, v122, v123
    v_max3_f32 v2, v2, v124, v125
    v_max3_f32 v2, v2, v126, v127
    v_max3_f32 v2, v2, v128, v129
    v_max3_f32 v2, v2, v130, v131
    v_max3_f32 v2, v2, v132, v133
    v_max3_f32 v2, v2, v134, v135
    buffer_load_dwordx4 v[160:163], v36, s[16:19], s77 offen offset:3072 sc1
    s_waitcnt vmcnt(0)
    v_mfma_f32_32x32x16_bf16 v[120:135], v[160:163], v[176:179], 0
    s_nop 9
    v_mfma_f32_32x32x8_bf16 v[120:135], v[166:167], v[182:183], v[120:135]
    s_nop 11
    v_max3_f32 v2, v2, v120, v121
    v_max3_f32 v2, v2, v122, v123
    v_max3_f32 v2, v2, v124, v125
    v_max3_f32 v2, v2, v126, v127
    v_max3_f32 v2, v2, v128, v129
    v_max3_f32 v2, v2, v130, v131
    v_max3_f32 v2, v2, v132, v133
    v_max3_f32 v2, v2, v134, v135
    s_add_u32 s76, s76, 1
    s_cmp_lt_u32 s76, 16
    s_nop 2
    s_cbranch_scc1 L_slow0_0
    v_mov_b32 v3, v2
    s_nop 1
    v_permlane32_swap_b32 v2, v3
    v_max_f32 v2, v2, v3
    s_mov_b32 s76, 0
    s_nop 3
L_slow0_1:
    s_lshl_b32 s77, s76, 12
    s_lshl_b32 s78, s76, 10
    s_add_u32 s78, s78, 65536
    s_mul_i32 s79, s76, 5376
    buffer_load_dwordx4 v[164:167], v36, s[16:19], s78 offen sc1
    buffer_load_dwordx4 v[160:163], v36, s[16:19], s77 offen offset:0 sc1
    buffer_load_dwordx4 v[168:171], v9, s[16:19], s79 offen offset:0 sc1
    buffer_load_dwordx4 v[172:175], v9, s[16:19], s79 offen offset:672 sc1
    s_add_u32 s79, s79, 1344
    s_waitcnt vmcnt(2)
    v_mfma_f32_32x32x16_bf16 v[120:135], v[160:163], v[176:179], 0
    s_nop 9
    v_mfma_f32_32x32x8_bf16 v[120:135], v[164:165], v[180:181], v[120:135]
    s_nop 11
    v_sub_f32 v120, v120, v2
    v_sub_f32 v121, v121, v2
    v_sub_f32 v122, v122, v2
    v_sub_f32 v123, v123, v2
    v_sub_f32 v124, v124, v2
    v_sub_f32 v125, v125, v2
    v_sub_f32 v126, v126, v2
    v_sub_f32 v127, v127, v2
    v_sub_f32 v128, v128, v2
    v_sub_f32 v129, v129, v2
    v_sub_f32 v130, v130, v2
    v_sub_f32 v131, v131, v2
    v_sub_f32 v132, v132, v2
    v_sub_f32 v133, v133, v2
    v_sub_f32 v134, v134, v2
    v_sub_f32 v135, v135, v2
    v_exp_f32 v120, v120
    v_exp_f32 v121, v121
    v_exp_f32 v122, v122
    v_exp_f32 v123, v123
    v_exp_f32 v124, v124
    v_exp_f32 v125, v125
    v_exp_f32 v126, v126
    v_exp_f32 v127, v127
    v_exp_f32 v128, v128
    v_exp_f32 v129, v129
    v_exp_f32 v130, v130
    v_exp_f32 v131, v131
    v_exp_f32 v132, v132
    v_exp_f32 v133, v133
    v_exp_f32 v134, v134
    v_exp_f32 v135, v135
    v_cvt_pk_bf16_f32 v152, v120, v121
    v_cvt_pk_bf16_f32 v153, v122, v123
    v_cvt_pk_bf16_f32 v154, v124, v125
    v_cvt_pk_bf16_f32 v155, v126, v127
    v_cvt_pk_bf16_f32 v156, v128, v129
    v_cvt_pk_bf16_f32 v157, v130, v131
    v_cvt_pk_bf16_f32 v158, v132, v133
    v_cvt_pk_bf16_f32 v159, v134, v135
    s_waitcnt vmcnt(1)
    v_mfma_f32_32x32x16_bf16 v[136:151], v[168:171], v[152:155], v[136:151]
    s_waitcnt vmcnt(0)
    v_mfma_f32_32x32x16_bf16 v[136:151], v[172:175], v[156:159], v[136:151]
    s_nop 7
    buffer_load_dwordx4 v[160:163], v36, s[16:19], s77 offen offset:1024 sc1
    buffer_load_dwordx4 v[168:171], v9, s[16:19], s79 offen offset:0 sc1
    buffer_load_dwordx4 v[172:175], v9, s[16:19], s79 offen offset:672 sc1
    s_add_u32 s79, s79, 1344
    s_waitcnt vmcnt(2)
    v_mfma_f32_32x32x16_bf16 v[120:135], v[160:163], v[176:179], 0
    s_nop 9
    v_mfma_f32_32x32x8_bf16 v[120:135], v[164:165], v[182:183], v[120:135]
    s_nop 11
    v_sub_f32 v120, v120, v2
    v_sub_f32 v121, v121, v2
    v_sub_f32 v122, v122, v2
    v_sub_f32 v123, v123, v2
    v_sub_f32 v124, v124, v2
    v_sub_f32 v125, v125, v2
    v_sub_f32 v126, v126, v2
    v_sub_f32 v127, v127, v2
    v_sub_f32 v128, v128, v2
    v_sub_f32 v129, v129, v2
    v_sub_f32 v130, v130, v2
    v_sub_f32 v131, v131, v2
    v_sub_f32 v132, v132, v2
    v_sub_f32 v133, v133, v2
    v_sub_f32 v134, v134, v2
    v_sub_f32 v135, v135, v2
    v_exp_f32 v120, v120
    v_exp_f32 v121, v121
    v_exp_f32 v122, v122
    v_exp_f32 v123, v123
    v_exp_f32 v124, v124
    v_exp_f32 v125, v125
    v_exp_f32 v126, v126
    v_exp_f32 v127, v127
    v_exp_f32 v128, v128
    v_exp_f32 v129, v129
    v_exp_f32 v130, v130
    v_exp_f32 v131, v131
    v_exp_f32 v132, v132
    v_exp_f32 v133, v133
    v_exp_f32 v134, v134
    v_exp_f32 v135, v135
    v_cvt_pk_bf16_f32 v152, v120, v121
    v_cvt_pk_bf16_f32 v153, v122, v123
    v_cvt_pk_bf16_f32 v154, v124, v125
    v_cvt_pk_bf16_f32 v155, v126, v127
    v_cvt_pk_bf16_f32 v156, v128, v129
    v_cvt_pk_bf16_f32 v157, v130, v131
    v_cvt_pk_bf16_f32 v158, v132, v133
    v_cvt_pk_bf16_f32 v159, v134, v135
    s_waitcnt vmcnt(1)
    v_mfma_f32_32x32x16_bf16 v[136:151], v[168:171], v[152:155], v[136:151]
    s_waitcnt vmcnt(0)
    v_mfma_f32_32x32x16_bf16 v[136:151], v[172:175], v[156:159], v[136:151]
    s_nop 7
    buffer_load_dwordx4 v[160:163], v36, s[16:19], s77 offen offset:2048 sc1
    buffer_load_dwordx4 v[168:171], v9, s[16:19], s79 offen offset:0 sc1
    buffer_load_dwordx4 v[172:175], v9, s[16:19], s79 offen offset:672 sc1
    s_add_u32 s79, s79, 1344
    s_waitcnt vmcnt(2)
    v_mfma_f32_32x32x16_bf16 v[120:135], v[160:163], v[176:179], 0
    s_nop 9
    v_mfma_f32_32x32x8_bf16 v[120:135], v[166:167], v[180:181], v[120:135]
    s_nop 11
    v_sub_f32 v120, v120, v2
    v_sub_f32 v121, v121, v2
    v_sub_f32 v122, v122, v2
    v_sub_f32 v123, v123, v2
    v_sub_f32 v124, v124, v2
    v_sub_f32 v125, v125, v2
    v_sub_f32 v126, v126, v2
    v_sub_f32 v127, v127, v2
    v_sub_f32 v128, v128, v2
    v_sub_f32 v129, v129, v2
    v_sub_f32 v130, v130, v2
    v_sub_f32 v131, v131, v2
    v_sub_f32 v132, v132, v2
    v_sub_f32 v133, v133, v2
    v_sub_f32 v134, v134, v2
    v_sub_f32 v135, v135, v2
    v_exp_f32 v120, v120
    v_exp_f32 v121, v121
    v_exp_f32 v122, v122
    v_exp_f32 v123, v123
    v_exp_f32 v124, v124
    v_exp_f32 v125, v125
    v_exp_f32 v126, v126
    v_exp_f32 v127, v127
    v_exp_f32 v128, v128
    v_exp_f32 v129, v129
    v_exp_f32 v130, v130
    v_exp_f32 v131, v131
    v_exp_f32 v132, v132
    v_exp_f32 v133, v133
    v_exp_f32 v134, v134
    v_exp_f32 v135, v135
    v_cvt_pk_bf16_f32 v152, v120, v121
    v_cvt_pk_bf16_f32 v153, v122, v123
    v_cvt_pk_bf16_f32 v154, v124, v125
    v_cvt_pk_bf16_f32 v155, v126, v127
    v_cvt_pk_bf16_f32 v156, v128, v129
    v_cvt_pk_bf16_f32 v157, v130, v131
    v_cvt_pk_bf16_f32 v158, v132, v133
    v_cvt_pk_bf16_f32 v159, v134, v135
    s_waitcnt vmcnt(1)
    v_mfma_f32_32x32x16_bf16 v[136:151], v[168:171], v[152:155], v[136:151]
    s_waitcnt vmcnt(0)
    v_mfma_f32_32x32x16_bf16 v[136:151], v[172:175], v[156:159], v[136:151]
    s_nop 7
    buffer_load_dwordx4 v[160:163], v36, s[16:19], s77 offen offset:3072 sc1
    buffer_load_dwordx4 v[168:171], v9, s[16:19], s79 offen offset:0 sc1
    buffer_load_dwordx4 v[172:175], v9, s[16:19], s79 offen offset:672 sc1
    s_add_u32 s79, s79, 1344
    s_waitcnt vmcnt(2)
    v_mfma_f32_32x32x16_bf16 v[120:135], v[160:163], v[176:179], 0
    s_nop 9
    v_mfma_f32_32x32x8_bf16 v[120:135], v[166:167], v[182:183], v[120:135]
    s_nop 11
    v_sub_f32 v120, v120, v2
    v_sub_f32 v121, v121, v2
    v_sub_f32 v122, v122, v2
    v_sub_f32 v123, v123, v2
    v_sub_f32 v124, v124, v2
    v_sub_f32 v125, v125, v2
    v_sub_f32 v126, v126, v2
    v_sub_f32 v127, v127, v2
    v_sub_f32 v128, v128, v2
    v_sub_f32 v129, v129, v2
    v_sub_f32 v130, v130, v2
    v_sub_f32 v131, v131, v2
    v_sub_f32 v132, v132, v2
    v_sub_f32 v133, v133, v2
    v_sub_f32 v134, v134, v2
    v_sub_f32 v135, v135, v2
    v_exp_f32 v120, v120
    v_exp_f32 v121, v121
    v_exp_f32 v122, v122
    v_exp_f32 v123, v123
    v_exp_f32 v124, v124
    v_exp_f32 v125, v125
    v_exp_f32 v126, v126
    v_exp_f32 v127, v127
    v_exp_f32 v128, v128
    v_exp_f32 v129, v129
    v_exp_f32 v130, v130
    v_exp_f32 v131, v131
    v_exp_f32 v132, v132
    v_exp_f32 v133, v133
    v_exp_f32 v134, v134
    v_exp_f32 v135, v135
    v_cvt_pk_bf16_f32 v152, v120, v121
    v_cvt_pk_bf16_f32 v153, v122, v123
    v_cvt_pk_bf16_f32 v154, v124, v125
    v_cvt_pk_bf16_f32 v155, v126, v127
    v_cvt_pk_bf16_f32 v156, v128, v129
    v_cvt_pk_bf16_f32 v157, v130, v131
    v_cvt_pk_bf16_f32 v158, v132, v133
    v_cvt_pk_bf16_f32 v159, v134, v135
    s_waitcnt vmcnt(1)
    v_mfma_f32_32x32x16_bf16 v[136:151], v[168:171], v[152:155], v[136:151]
    s_waitcnt vmcnt(0)
    v_mfma_f32_32x32x16_bf16 v[136:151], v[172:175], v[156:159], v[136:151]
    s_nop 7
    s_add_u32 s76, s76, 1
    s_cmp_lt_u32 s76, 16
    s_nop 1
    s_cbranch_scc1 L_slow0_1
    v_mov_b32 v4, v144
    v_mov_b32 v5, v144
    s_nop 1
    v_permlane32_swap_b32 v4, v5
    v_rcp_f32 v5, v5
    s_nop 0
    v_mul_f32 v4, v5, v20
    v_mul_f32 v136, v136, v4
    v_mul_f32 v137, v137, v4
    v_mul_f32 v138, v138, v4
    v_mul_f32 v139, v139, v4
    v_mul_f32 v140, v140, v4
    v_mul_f32 v141, v141, v4
    v_mul_f32 v142, v142, v4
    v_mul_f32 v143, v143, v4
    v_mul_f32 v144, v144, v4
    v_mul_f32 v145, v145, v4
    v_mul_f32 v146, v146, v4
    v_mul_f32 v147, v147, v4
    v_cvt_pk_bf16_f32 v152, v136, v137
    v_min_u32 v152, -2, v152
    v_cvt_pk_bf16_f32 v153, v138, v139
    v_min_u32 v153, -2, v153
    v_cvt_pk_bf16_f32 v154, v140, v141
    v_min_u32 v154, -2, v154
    v_cvt_pk_bf16_f32 v155, v142, v143
    v_min_u32 v155, -2, v155
    v_cvt_pk_bf16_f32 v156, v144, v145
    v_min_u32 v156, -2, v156
    v_cvt_pk_bf16_f32 v157, v146, v147
    v_min_u32 v157, -2, v157
    buffer_store_dwordx4 v[152:155], v26, s[16:19], s72 offen sc1
    buffer_store_dwordx2 v[156:157], v27, s[16:19], s72 offen offset:512 sc1
    s_waitcnt vmcnt(0)
    s_nop 1
    s_branch L_slow0_ret
L_slow1:
    s_waitcnt vmcnt(0) lgkmcnt(0)
    s_nop 15
    s_mul_i32 s76, s42, 6144
    s_lshl_b32 s77, s43, 9
    s_add_u32 s76, s76, s77
    v_add_u32 v4, s76, v16
    v_add_u32 v5, s76, v17
    v_add_u32 v6, s76, v18
    ds_read_b128 v[96:99], v4 offset:1024
    ds_read_b64 v[100:101], v5 offset:5120
    ds_read_b64 v[102:103], v6 offset:5120
    v_mov_b32 v2, 0xff800000
    v_mov_b32 v56, 0
    v_mov_b32 v57, 0
    v_mov_b32 v58, 0
    v_mov_b32 v59, 0
    v_mov_b32 v60, 0
    v_mov_b32 v61, 0
    v_mov_b32 v62, 0
    v_mov_b32 v63, 0
    v_mov_b32 v64, 0
    v_mov_b32 v65, 0
    v_mov_b32 v66, 0
    v_mov_b32 v67, 0
    v_mov_b32 v68, 0
    v_mov_b32 v69, 0
    v_mov_b32 v70, 0
    v_mov_b32 v71, 0
    s_waitcnt lgkmcnt(0)
    s_mov_b32 s76, 0
    s_nop 2
L_slow1_0:
    s_lshl_b32 s77, s76, 12
    s_lshl_b32 s78, s76, 10
    s_add_u32 s78, s78, 65536
    s_mul_i32 s79, s76, 5376
    buffer_load_dwordx4 v[84:87], v36, s[16:19], s78 offen sc1
    buffer_load_dwordx4 v[80:83], v36, s[16:19], s77 offen offset:0 sc1
    s_waitcnt vmcnt(0)
    v_mfma_f32_32x32x16_bf16 v[40:55], v[80:83], v[96:99], 0
    s_nop 9
    v_mfma_f32_32x32x8_bf16 v[40:55], v[84:85], v[100:101], v[40:55]
    s_nop 11
    v_max3_f32 v2, v2, v40, v41
    v_max3_f32 v2, v2, v42, v43
    v_max3_f32 v2, v2, v44, v45
    v_max3_f32 v2, v2, v46, v47
    v_max3_f32 v2, v2, v48, v49
    v_max3_f32 v2, v2, v50, v51
    v_max3_f32 v2, v2, v52, v53
    v_max3_f32 v2, v2, v54, v55
    buffer_load_dwordx4 v[80:83], v36, s[16:19], s77 offen offset:1024 sc1
    s_waitcnt vmcnt(0)
    v_mfma_f32_32x32x16_bf16 v[40:55], v[80:83], v[96:99], 0
    s_nop 9
    v_mfma_f32_32x32x8_bf16 v[40:55], v[84:85], v[102:103], v[40:55]
    s_nop 11
    v_max3_f32 v2, v2, v40, v41
    v_max3_f32 v2, v2, v42, v43
    v_max3_f32 v2, v2, v44, v45
    v_max3_f32 v2, v2, v46, v47
    v_max3_f32 v2, v2, v48, v49
    v_max3_f32 v2, v2, v50, v51
    v_max3_f32 v2, v2, v52, v53
    v_max3_f32 v2, v2, v54, v55
    buffer_load_dwordx4 v[80:83], v36, s[16:19], s77 offen offset:2048 sc1
    s_waitcnt vmcnt(0)
    v_mfma_f32_32x32x16_bf16 v[40:55], v[80:83], v[96:99], 0
    s_nop 9
    v_mfma_f32_32x32x8_bf16 v[40:55], v[86:87], v[100:101], v[40:55]
    s_nop 11
    v_max3_f32 v2, v2, v40, v41
    v_max3_f32 v2, v2, v42, v43
    v_max3_f32 v2, v2, v44, v45
    v_max3_f32 v2, v2, v46, v47
    v_max3_f32 v2, v2, v48, v49
    v_max3_f32 v2, v2, v50, v51
    v_max3_f32 v2, v2, v52, v53
    v_max3_f32 v2, v2, v54, v55
    buffer_load_dwordx4 v[80:83], v36, s[16:19], s77 offen offset:3072 sc1
    s_waitcnt vmcnt(0)
    v_mfma_f32_32x32x16_bf16 v[40:55], v[80:83], v[96:99], 0
    s_nop 9
    v_mfma_f32_32x32x8_bf16 v[40:55], v[86:87], v[102:103], v[40:55]
    s_nop 11
    v_max3_f32 v2, v2, v40, v41
    v_max3_f32 v2, v2, v42, v43
    v_max3_f32 v2, v2, v44, v45
    v_max3_f32 v2, v2, v46, v47
    v_max3_f32 v2, v2, v48, v49
    v_max3_f32 v2, v2, v50, v51
    v_max3_f32 v2, v2, v52, v53
    v_max3_f32 v2, v2, v54, v55
    s_add_u32 s76, s76, 1
    s_cmp_lt_u32 s76, 16
    s_nop 2
    s_cbranch_scc1 L_slow1_0
    v_mov_b32 v3, v2
    s_nop 1
    v_permlane32_swap_b32 v2, v3
    v_max_f32 v2, v2, v3
    s_mov_b32 s76, 0
    s_nop 3
L_slow1_1:
    s_lshl_b32 s77, s76, 12
    s_lshl_b32 s78, s76, 10
    s_add_u32 s78, s78, 65536
    s_mul_i32 s79, s76, 5376
    buffer_load_dwordx4 v[84:87], v36, s[16:19], s78 offen sc1
    buffer_load_dwordx4 v[80:83], v36, s[16:19], s77 offen offset:0 sc1
    buffer_load_dwordx4 v[88:91], v9, s[16:19], s79 offen offset:0 sc1
    buffer_load_dwordx4 v[92:95], v9, s[16:19], s79 offen offset:672 sc1
    s_add_u32 s79, s79, 1344
    s_waitcnt vmcnt(2)
    v_mfma_f32_32x32x16_bf16 v[40:55], v[80:83], v[96:99], 0
    s_nop 9
    v_mfma_f32_32x32x8_bf16 v[40:55], v[84:85], v[100:101], v[40:55]
    s_nop 11
    v_sub_f32 v40, v40, v2
    v_sub_f32 v41, v41, v2
    v_sub_f32 v42, v42, v2
    v_sub_f32 v43, v43, v2
    v_sub_f32 v44, v44, v2
    v_sub_f32 v45, v45, v2
    v_sub_f32 v46, v46, v2
    v_sub_f32 v47, v47, v2
    v_sub_f32 v48, v48, v2
    v_sub_f32 v49, v49, v2
    v_sub_f32 v50, v50, v2
    v_sub_f32 v51, v51, v2
    v_sub_f32 v52, v52, v2
    v_sub_f32 v53, v53, v2
    v_sub_f32 v54, v54, v2
    v_sub_f32 v55, v55, v2
    v_exp_f32 v40, v40
    v_exp_f32 v41, v41
    v_exp_f32 v42, v42
    v_exp_f32 v43, v43
    v_exp_f32 v44, v44
    v_exp_f32 v45, v45
    v_exp_f32 v46, v46
    v_exp_f32 v47, v47
    v_exp_f32 v48, v48
    v_exp_f32 v49, v49
    v_exp_f32 v50, v50
    v_exp_f32 v51, v51
    v_exp_f32 v52, v52
    v_exp_f32 v53, v53
    v_exp_f32 v54, v54
    v_exp_f32 v55, v55
    v_cvt_pk_bf16_f32 v72, v40, v41
    v_cvt_pk_bf16_f32 v73, v42, v43
    v_cvt_pk_bf16_f32 v74, v44, v45
    v_cvt_pk_bf16_f32 v75, v46, v47
    v_cvt_pk_bf16_f32 v76, v48, v49
    v_cvt_pk_bf16_f32 v77, v50, v51
    v_cvt_pk_bf16_f32 v78, v52, v53
    v_cvt_pk_bf16_f32 v79, v54, v55
    s_waitcnt vmcnt(1)
    v_mfma_f32_32x32x16_bf16 v[56:71], v[88:91], v[72:75], v[56:71]
    s_waitcnt vmcnt(0)
    v_mfma_f32_32x32x16_bf16 v[56:71], v[92:95], v[76:79], v[56:71]
    s_nop 7
    buffer_load_dwordx4 v[80:83], v36, s[16:19], s77 offen offset:1024 sc1
    buffer_load_dwordx4 v[88:91], v9, s[16:19], s79 offen offset:0 sc1
    buffer_load_dwordx4 v[92:95], v9, s[16:19], s79 offen offset:672 sc1
    s_add_u32 s79, s79, 1344
    s_waitcnt vmcnt(2)
    v_mfma_f32_32x32x16_bf16 v[40:55], v[80:83], v[96:99], 0
    s_nop 9
    v_mfma_f32_32x32x8_bf16 v[40:55], v[84:85], v[102:103], v[40:55]
    s_nop 11
    v_sub_f32 v40, v40, v2
    v_sub_f32 v41, v41, v2
    v_sub_f32 v42, v42, v2
    v_sub_f32 v43, v43, v2
    v_sub_f32 v44, v44, v2
    v_sub_f32 v45, v45, v2
    v_sub_f32 v46, v46, v2
    v_sub_f32 v47, v47, v2
    v_sub_f32 v48, v48, v2
    v_sub_f32 v49, v49, v2
    v_sub_f32 v50, v50, v2
    v_sub_f32 v51, v51, v2
    v_sub_f32 v52, v52, v2
    v_sub_f32 v53, v53, v2
    v_sub_f32 v54, v54, v2
    v_sub_f32 v55, v55, v2
    v_exp_f32 v40, v40
    v_exp_f32 v41, v41
    v_exp_f32 v42, v42
    v_exp_f32 v43, v43
    v_exp_f32 v44, v44
    v_exp_f32 v45, v45
    v_exp_f32 v46, v46
    v_exp_f32 v47, v47
    v_exp_f32 v48, v48
    v_exp_f32 v49, v49
    v_exp_f32 v50, v50
    v_exp_f32 v51, v51
    v_exp_f32 v52, v52
    v_exp_f32 v53, v53
    v_exp_f32 v54, v54
    v_exp_f32 v55, v55
    v_cvt_pk_bf16_f32 v72, v40, v41
    v_cvt_pk_bf16_f32 v73, v42, v43
    v_cvt_pk_bf16_f32 v74, v44, v45
    v_cvt_pk_bf16_f32 v75, v46, v47
    v_cvt_pk_bf16_f32 v76, v48, v49
    v_cvt_pk_bf16_f32 v77, v50, v51
    v_cvt_pk_bf16_f32 v78, v52, v53
    v_cvt_pk_bf16_f32 v79, v54, v55
    s_waitcnt vmcnt(1)
    v_mfma_f32_32x32x16_bf16 v[56:71], v[88:91], v[72:75], v[56:71]
    s_waitcnt vmcnt(0)
    v_mfma_f32_32x32x16_bf16 v[56:71], v[92:95], v[76:79], v[56:71]
    s_nop 7
    buffer_load_dwordx4 v[80:83], v36, s[16:19], s77 offen offset:2048 sc1
    buffer_load_dwordx4 v[88:91], v9, s[16:19], s79 offen offset:0 sc1
    buffer_load_dwordx4 v[92:95], v9, s[16:19], s79 offen offset:672 sc1
    s_add_u32 s79, s79, 1344
    s_waitcnt vmcnt(2)
    v_mfma_f32_32x32x16_bf16 v[40:55], v[80:83], v[96:99], 0
    s_nop 9
    v_mfma_f32_32x32x8_bf16 v[40:55], v[86:87], v[100:101], v[40:55]
    s_nop 11
    v_sub_f32 v40, v40, v2
    v_sub_f32 v41, v41, v2
    v_sub_f32 v42, v42, v2
    v_sub_f32 v43, v43, v2
    v_sub_f32 v44, v44, v2
    v_sub_f32 v45, v45, v2
    v_sub_f32 v46, v46, v2
    v_sub_f32 v47, v47, v2
    v_sub_f32 v48, v48, v2
    v_sub_f32 v49, v49, v2
    v_sub_f32 v50, v50, v2
    v_sub_f32 v51, v51, v2
    v_sub_f32 v52, v52, v2
    v_sub_f32 v53, v53, v2
    v_sub_f32 v54, v54, v2
    v_sub_f32 v55, v55, v2
    v_exp_f32 v40, v40
    v_exp_f32 v41, v41
    v_exp_f32 v42, v42
    v_exp_f32 v43, v43
    v_exp_f32 v44, v44
    v_exp_f32 v45, v45
    v_exp_f32 v46, v46
    v_exp_f32 v47, v47
    v_exp_f32 v48, v48
    v_exp_f32 v49, v49
    v_exp_f32 v50, v50
    v_exp_f32 v51, v51
    v_exp_f32 v52, v52
    v_exp_f32 v53, v53
    v_exp_f32 v54, v54
    v_exp_f32 v55, v55
    v_cvt_pk_bf16_f32 v72, v40, v41
    v_cvt_pk_bf16_f32 v73, v42, v43
    v_cvt_pk_bf16_f32 v74, v44, v45
    v_cvt_pk_bf16_f32 v75, v46, v47
    v_cvt_pk_bf16_f32 v76, v48, v49
    v_cvt_pk_bf16_f32 v77, v50, v51
    v_cvt_pk_bf16_f32 v78, v52, v53
    v_cvt_pk_bf16_f32 v79, v54, v55
    s_waitcnt vmcnt(1)
    v_mfma_f32_32x32x16_bf16 v[56:71], v[88:91], v[72:75], v[56:71]
    s_waitcnt vmcnt(0)
    v_mfma_f32_32x32x16_bf16 v[56:71], v[92:95], v[76:79], v[56:71]
    s_nop 7
    buffer_load_dwordx4 v[80:83], v36, s[16:19], s77 offen offset:3072 sc1
    buffer_load_dwordx4 v[88:91], v9, s[16:19], s79 offen offset:0 sc1
    buffer_load_dwordx4 v[92:95], v9, s[16:19], s79 offen offset:672 sc1
    s_add_u32 s79, s79, 1344
    s_waitcnt vmcnt(2)
    v_mfma_f32_32x32x16_bf16 v[40:55], v[80:83], v[96:99], 0
    s_nop 9
    v_mfma_f32_32x32x8_bf16 v[40:55], v[86:87], v[102:103], v[40:55]
    s_nop 11
    v_sub_f32 v40, v40, v2
    v_sub_f32 v41, v41, v2
    v_sub_f32 v42, v42, v2
    v_sub_f32 v43, v43, v2
    v_sub_f32 v44, v44, v2
    v_sub_f32 v45, v45, v2
    v_sub_f32 v46, v46, v2
    v_sub_f32 v47, v47, v2
    v_sub_f32 v48, v48, v2
    v_sub_f32 v49, v49, v2
    v_sub_f32 v50, v50, v2
    v_sub_f32 v51, v51, v2
    v_sub_f32 v52, v52, v2
    v_sub_f32 v53, v53, v2
    v_sub_f32 v54, v54, v2
    v_sub_f32 v55, v55, v2
    v_exp_f32 v40, v40
    v_exp_f32 v41, v41
    v_exp_f32 v42, v42
    v_exp_f32 v43, v43
    v_exp_f32 v44, v44
    v_exp_f32 v45, v45
    v_exp_f32 v46, v46
    v_exp_f32 v47, v47
    v_exp_f32 v48, v48
    v_exp_f32 v49, v49
    v_exp_f32 v50, v50
    v_exp_f32 v51, v51
    v_exp_f32 v52, v52
    v_exp_f32 v53, v53
    v_exp_f32 v54, v54
    v_exp_f32 v55, v55
    v_cvt_pk_bf16_f32 v72, v40, v41
    v_cvt_pk_bf16_f32 v73, v42, v43
    v_cvt_pk_bf16_f32 v74, v44, v45
    v_cvt_pk_bf16_f32 v75, v46, v47
    v_cvt_pk_bf16_f32 v76, v48, v49
    v_cvt_pk_bf16_f32 v77, v50, v51
    v_cvt_pk_bf16_f32 v78, v52, v53
    v_cvt_pk_bf16_f32 v79, v54, v55
    s_waitcnt vmcnt(1)
    v_mfma_f32_32x32x16_bf16 v[56:71], v[88:91], v[72:75], v[56:71]
    s_waitcnt vmcnt(0)
    v_mfma_f32_32x32x16_bf16 v[56:71], v[92:95], v[76:79], v[56:71]
    s_nop 7
    s_add_u32 s76, s76, 1
    s_cmp_lt_u32 s76, 16
    s_nop 1
    s_cbranch_scc1 L_slow1_1
    v_mov_b32 v4, v64
    v_mov_b32 v5, v64
    s_nop 1
    v_permlane32_swap_b32 v4, v5
    v_rcp_f32 v5, v5
    s_nop 0
    v_mul_f32 v4, v5, v28
    v_mul_f32 v56, v56, v4
    v_mul_f32 v57, v57, v4
    v_mul_f32 v58, v58, v4
    v_mul_f32 v59, v59, v4
    v_mul_f32 v60, v60, v4
    v_mul_f32 v61, v61, v4
    v_mul_f32 v62, v62, v4
    v_mul_f32 v63, v63, v4
    v_mul_f32 v64, v64, v4
    v_mul_f32 v65, v65, v4
    v_mul_f32 v66, v66, v4
    v_mul_f32 v67, v67, v4
    v_cvt_pk_bf16_f32 v72, v56, v57
    v_min_u32 v72, -2, v72
    v_cvt_pk_bf16_f32 v73, v58, v59
    v_min_u32 v73, -2, v73
    v_cvt_pk_bf16_f32 v74, v60, v61
    v_min_u32 v74, -2, v74
    v_cvt_pk_bf16_f32 v75, v62, v63
    v_min_u32 v75, -2, v75
    v_cvt_pk_bf16_f32 v76, v64, v65
    v_min_u32 v76, -2, v76
    v_cvt_pk_bf16_f32 v77, v66, v67
    v_min_u32 v77, -2, v77
    buffer_store_dwordx4 v[72:75], v26, s[16:19], s73 offen sc1
    buffer_store_dwordx2 v[76:77], v27, s[16:19], s73 offen offset:512 sc1
    s_waitcnt vmcnt(0)
    s_nop 1
    s_branch L_slow1_ret
L_codeend:
    s_endpgm
.section .rodata,"a"
.p2align 6
.amdhsa_kernel gated_mix__linear_kernel_hedgehog__grouped_kv_mqa__prompt_kernel
  .amdhsa_next_free_vgpr 512
  .amdhsa_next_free_sgpr 102
  .amdhsa_accum_offset 256
  .amdhsa_group_segment_fixed_size 0
  .amdhsa_kernarg_size 104
  .amdhsa_user_sgpr_count 2
  .amdhsa_user_sgpr_kernarg_segment_ptr 1
  .amdhsa_system_sgpr_workgroup_id_x 1
.end_amdhsa_kernel
```
